```python
import torch

def _softmax(x, axis=-1):
    return torch.softmax(x, dim=axis)

def _gelu(x):
    return torch.nn.functional.gelu(x, approximate='tanh')

def _silu(x):
    return torch.nn.functional.silu(x)

def _sigmoid(x):
    return torch.sigmoid(x)

def _layernorm(x, axis=-1, eps=1e-05):
    m = x.mean(dim=axis, keepdim=True)
    v = x.var(dim=axis, keepdim=True, unbiased=False)
    return (x - m) / torch.sqrt(v + eps)

def _scatter_add(tgt, idx, src, axis=0):
    return tgt.clone().index_add_(axis, idx, src)

def _segment_sum(src, seg, n):
    out = torch.zeros((n,) + src.shape[1:], dtype=src.dtype)
    return out.index_add_(0, seg, src)

def _pad(x, pw):
    flat = tuple((v for pair in reversed(pw) for v in pair))
    return torch.nn.functional.pad(x, flat)
kernel_name = 'adaLN_cond__compressed_kv_cla__dense_activation_relu__prompt'

def setup_inputs():

    _w = lambda a: (lambda t: t.to(torch.bfloat16) if t.is_floating_point() else t)(torch.as_tensor(a))

    def _A_setup():
        B, H, Sq, Sk, D, M = (1, 32, 2048, 2048, 128, 1024)
        Dc = 4 * D
        return {'x': _w((lambda *s: torch.randn(*s, dtype=torch.bfloat16) * 0.05)(B, Sq, M)), 'c_kv': _w((lambda *s: torch.randn(*s, dtype=torch.bfloat16) * 1.6)(B, Sk, Dc)), 'w_q': _w((lambda *s: torch.randn(*s, dtype=torch.bfloat16) * 0.8)(M, H, D) * M ** (-0.5)), 'w_uk': _w((lambda *s: torch.randn(*s, dtype=torch.bfloat16) * 0.8)(Dc, H, D) * Dc ** (-0.5)), 'w_uv': _w((lambda *s: torch.randn(*s, dtype=torch.bfloat16) * 1.6)(Dc, H, D) * Dc ** (-0.5)), 'w_o': _w((lambda *s: torch.randn(*s, dtype=torch.bfloat16) * 1.6)(H, D, M) * (H * D) ** (-0.5))}
    _A_in = _A_setup()

    def _B_setup():
        B, S, D, Dff = (1, 2048, 1024, 3584)
        return {'x': _w((lambda *s: torch.randn(*s, dtype=torch.bfloat16) * 0.05)(B, S, D)), 'w1': _w((lambda *s: torch.randn(*s, dtype=torch.bfloat16) * 0.05)(D, Dff)), 'w2': _w((lambda *s: torch.randn(*s, dtype=torch.bfloat16) * 0.05)(Dff, D))}
    _B_in = _B_setup()
    return {'A_x': _A_in['x'], 'A_c_kv': _A_in['c_kv'], 'A_w_q': _A_in['w_q'], 'A_w_uk': _A_in['w_uk'], 'A_w_uv': _A_in['w_uv'], 'A_w_o': _A_in['w_o'], 'B_x': _B_in['x'], 'B_w1': _B_in['w1'], 'B_w2': _B_in['w2'], 'c': _w((lambda *s: torch.randn(*s, dtype=torch.bfloat16) * 0.1)(1, 1024) * 8.0), 'w_mod': _w((lambda *s: torch.randn(*s, dtype=torch.bfloat16) * 0.1)(1024, 6 * 1024) * 1024 ** (-0.5) * 8.0)}

def reference(A_x, A_c_kv, A_w_q, A_w_uk, A_w_uv, A_w_o, B_x, B_w1, B_w2, c, w_mod):

    def _A_ref(x, c_kv, w_q, w_uk, w_uv, w_o):
        B, Sq, M = (x.shape[0], x.shape[1], x.shape[2])
        Sk = c_kv.shape[1]
        H, D = (w_q.shape[1], w_q.shape[2])
        q = torch.einsum('bqm,mhd->bhqd', x, w_q)
        k = torch.einsum('bkc,chd->bhkd', c_kv, w_uk)
        v = torch.einsum('bkc,chd->bhkd', c_kv, w_uv)
        scores = torch.einsum('bhqd,bhkd->bhqk', q, k) * D ** (-0.5)
        off = Sk - Sq
        qi = torch.arange(Sq)[:, None]
        kj = torch.arange(Sk)[None, :]
        cmask = kj <= qi + off
        scores = torch.where(cmask[None, None], scores, -1000000000.0)
        p = _softmax(scores, axis=-1)
        ctx = torch.einsum('bhqk,bhkd->bhqd', p, v)
        return torch.einsum('bhqd,hdm->bqm', ctx, w_o)

    def _B_ref(x, w1, w2):
        h = torch.einsum('bsd,df->bsf', x, w1)
        zero = torch.zeros_like(h)
        h = torch.maximum(h, zero)
        return torch.einsum('bsf,fd->bsd', h, w2)
    x = A_x
    mod = (_silu(c) @ w_mod).reshape(c.shape[0], 6, 1, -1)
    sa, ca, ga, sb, cb, gb = (mod[:, 0].clone(), mod[:, 1].clone(), mod[:, 2].clone(), mod[:, 3].clone(), mod[:, 4].clone(), mod[:, 5].clone())
    h = _layernorm(x, axis=-1) * (1 + ca) + sa
    x = x + ga * _A_ref(h, A_c_kv, A_w_q, A_w_uk, A_w_uv, A_w_o)
    h = _layernorm(x, axis=-1) * (1 + cb) + sb
    x = x + gb * _B_ref(h, B_w1, B_w2)
    return x
```

```asm
; @launch kernel=kvproj_kernel grid=(256,1,1) block=(256,1,1) lds=163840
; @launch kernel=attn_kernel grid=(256,1,1) block=(256,1,1) lds=163840
; @launch kernel=oproj_kernel grid=(256,1,1) block=(256,1,1) lds=163840
; @launch kernel=ffn1_kernel grid=(256,1,1) block=(256,1,1) lds=132864
; @launch kernel=ffn2_kernel grid=(256,1,1) block=(256,1,1) lds=163840
.amdgcn_target "amdgcn-amd-amdhsa--gfx950"
.macro M16 a:vararg
v_mfma_f32_16x16x32_bf16 \a
.endm
.macro M32 a:vararg
v_mfma_f32_32x32x16_bf16 \a
.endm
.macro DTR a:vararg
ds_read_b64_tr_b16 \a
.endm
.macro DR4 a:vararg
ds_read_b128 \a
.endm
.macro CVT a:vararg
v_cvt_pk_bf16_f32 \a
.endm
.macro ARD a:vararg
v_accvgpr_read_b32 \a
.endm
.macro AWR a:vararg
v_accvgpr_write_b32 \a
.endm
.macro EXP a:vararg
v_exp_f32 \a
.endm
.macro FAD a:vararg
v_add_f32 \a
.endm
.macro FSB a:vararg
v_sub_f32 \a
.endm
.macro FML a:vararg
v_mul_f32 \a
.endm
.macro CND a:vararg
v_cndmask_b32 \a
.endm
.text
.p2align 8
kvproj_kernel:
s_cmp_ge_u32 s2, 256
s_cbranch_scc1 L_kvproj_kernel_end
v_lshrrev_b32 v2, 6, v0
v_and_b32 v1, 63, v0
v_readfirstlane_b32 s3, v2
s_load_dwordx2 s[8:9], s[0:1], 8
s_load_dwordx4 s[40:43], s[0:1], 24
s_load_dwordx4 s[44:47], s[0:1], 72
s_load_dwordx2 s[48:49], s[0:1], 104
s_load_dwordx2 s[32:33], s[0:1], 0
s_load_dwordx2 s[36:37], s[0:1], 96
s_load_dwordx2 s[4:5], s[0:1], 16
s_and_b32 s50, s2, 7
s_lshr_b32 s51, s2, 3
s_and_b32 s52, s51, 7
s_lshr_b32 s51, s51, 3
s_and_b32 s53, s51, 1
s_lshl_b32 s50, s50, 1
s_add_u32 s53, s53, s50
s_lshr_b32 s51, s51, 1
s_and_b32 s54, s3, 1
v_lshrrev_b32 v10, 3, v1
v_lshrrev_b32 v11, 4, v1
v_and_b32 v12, 7, v1
v_xor_b32 v12, v12, v11
v_lshlrev_b32 v10, 10, v10
v_lshl_add_u32 v2, v12, 4, v10
v_xor_b32 v12, 4, v12
v_lshl_add_u32 v3, v12, 4, v10
s_lshl_b32 s56, s52, 18
s_lshl_b32 s57, s3, 16
s_add_u32 s56, s56, s57
v_add_u32 v2, s56, v2
v_add_u32 v3, s56, v3
v_add_u32 v3, 7168, v3
v_add_u32 v4, 14336, v2
v_add_u32 v5, 14336, v3
v_bfe_u32 v10, v1, 2, 2
v_lshrrev_b32 v12, 5, v1
v_lshl_add_u32 v10, v12, 2, v10
v_lshlrev_b32 v10, 13, v10
v_and_b32 v12, 1, v11
v_lshl_add_u32 v10, v12, 6, v10
v_and_b32 v12, 3, v1
s_lshl_b32 s56, s54, 1
v_xor_b32 v12, s56, v12
v_lshl_add_u32 v6, v12, 4, v10
s_lshl_b32 s56, s53, 9
s_lshl_b32 s57, s3, 16
s_add_u32 s56, s56, s57
v_add_u32 v6, s56, v6
v_add_u32 v7, 261120, v6
v_add_u32 v8, 261120, v7
v_add_u32 v9, 261120, v8
v_and_b32 v12, 15, v1
v_lshrrev_b32 v13, 1, v12
v_xor_b32 v13, v13, v11
v_lshlrev_b32 v13, 4, v13
v_lshl_add_u32 v10, v12, 7, v13
s_mul_i32 s58, s3, 24576
s_add_u32 s58, s58, 65536
v_add_u32 v10, s58, v10
v_bfe_u32 v13, v1, 2, 2
v_lshlrev_b32 v13, 6, v13
v_lshl_add_u32 v13, v11, 12, v13
v_and_b32 v12, 1, v1
v_lshl_add_u32 v13, v12, 3, v13
v_bfe_u32 v12, v1, 1, 1
v_and_b32 v14, 1, v11
v_lshl_add_u32 v12, v14, 1, v12
v_lshl_add_u32 v12, v12, 4, v13
v_xor_b32 v13, 32, v12
v_xor_b32 v11, 64, v10
s_lshl_b32 s55, s3, 12
s_waitcnt lgkmcnt(0)
s_cmp_eq_u32 s51, 0
s_cselect_b32 s12, s40, s42
s_cselect_b32 s13, s41, s43
s_mov_b32 s10, 2097152
s_mov_b32 s11, 0x20000
s_mov_b32 s14, 4194304
s_mov_b32 s15, 0x20000
s_add_u32 m0, s58, 0
s_mov_b32 s59, 0
buffer_load_dwordx4 v2, s[8:11], s59 offen offset:0 lds
buffer_load_dwordx4 v3, s[8:11], s59 offen offset:1024 lds
buffer_load_dwordx4 v4, s[8:11], s59 offen offset:2048 lds
buffer_load_dwordx4 v5, s[8:11], s59 offen offset:3072 lds
s_add_u32 m0, s58, 4096
s_mov_b32 s59, 32768
buffer_load_dwordx4 v2, s[8:11], s59 offen offset:0 lds
buffer_load_dwordx4 v3, s[8:11], s59 offen offset:1024 lds
buffer_load_dwordx4 v4, s[8:11], s59 offen offset:2048 lds
buffer_load_dwordx4 v5, s[8:11], s59 offen offset:3072 lds
s_add_u32 m0, s55, 0
s_mov_b32 s65, 0
buffer_load_dwordx4 v6, s[12:15], s65 offen offset:0 lds
buffer_load_dwordx4 v7, s[12:15], s65 offen offset:1024 lds
buffer_load_dwordx4 v8, s[12:15], s65 offen offset:2048 lds
buffer_load_dwordx4 v9, s[12:15], s65 offen offset:3072 lds
s_add_u32 m0, s58, 8192
s_mov_b32 s59, 128
buffer_load_dwordx4 v2, s[8:11], s59 offen offset:0 lds
buffer_load_dwordx4 v3, s[8:11], s59 offen offset:1024 lds
buffer_load_dwordx4 v4, s[8:11], s59 offen offset:2048 lds
buffer_load_dwordx4 v5, s[8:11], s59 offen offset:3072 lds
s_add_u32 m0, s58, 12288
s_mov_b32 s59, 32896
buffer_load_dwordx4 v2, s[8:11], s59 offen offset:0 lds
buffer_load_dwordx4 v3, s[8:11], s59 offen offset:1024 lds
buffer_load_dwordx4 v4, s[8:11], s59 offen offset:2048 lds
buffer_load_dwordx4 v5, s[8:11], s59 offen offset:3072 lds
s_add_u32 m0, s55, 16384
s_mov_b32 s65, 1048576
buffer_load_dwordx4 v6, s[12:15], s65 offen offset:0 lds
buffer_load_dwordx4 v7, s[12:15], s65 offen offset:1024 lds
buffer_load_dwordx4 v8, s[12:15], s65 offen offset:2048 lds
buffer_load_dwordx4 v9, s[12:15], s65 offen offset:3072 lds
s_add_u32 m0, s58, 16384
s_mov_b32 s59, 256
buffer_load_dwordx4 v2, s[8:11], s59 offen offset:0 lds
buffer_load_dwordx4 v3, s[8:11], s59 offen offset:1024 lds
buffer_load_dwordx4 v4, s[8:11], s59 offen offset:2048 lds
buffer_load_dwordx4 v5, s[8:11], s59 offen offset:3072 lds
s_add_u32 m0, s58, 20480
s_mov_b32 s59, 33024
buffer_load_dwordx4 v2, s[8:11], s59 offen offset:0 lds
buffer_load_dwordx4 v3, s[8:11], s59 offen offset:1024 lds
buffer_load_dwordx4 v4, s[8:11], s59 offen offset:2048 lds
buffer_load_dwordx4 v5, s[8:11], s59 offen offset:3072 lds
s_add_u32 m0, s55, 32768
s_mov_b32 s65, 2097152
buffer_load_dwordx4 v6, s[12:15], s65 offen offset:0 lds
buffer_load_dwordx4 v7, s[12:15], s65 offen offset:1024 lds
buffer_load_dwordx4 v8, s[12:15], s65 offen offset:2048 lds
buffer_load_dwordx4 v9, s[12:15], s65 offen offset:3072 lds
s_add_u32 s16, s48, 16777216
s_addc_u32 s17, s49, 0
s_mov_b32 s18, 33554432
s_mov_b32 s19, 0x20000
s_mov_b32 s20, s46
s_mov_b32 s21, s47
s_mov_b32 s22, 12582912
s_mov_b32 s23, 0x20000
s_mov_b32 s24, s44
s_mov_b32 s25, s45
s_mov_b32 s26, 2048
s_mov_b32 s27, 0x20000
s_mov_b32 s28, s48
s_mov_b32 s29, s49
s_mov_b32 s30, 196608
s_mov_b32 s31, 0x20000
s_and_b32 s60, s2, 31
s_lshr_b32 s61, s2, 5
s_lshl_b32 s62, s61, 7
s_lshl_b32 s63, s3, 5
s_add_u32 s62, s62, s63
v_lshrrev_b32 v14, 3, v1
v_add_u32 v14, s62, v14
v_lshlrev_b32 v15, 1, v14
v_mul_u32_u24 v14, 12288, v14
v_and_b32 v0, 7, v1
v_lshl_add_u32 v14, v0, 4, v14
s_lshl_b32 s63, s60, 7
v_add_u32 v14, s63, v14
buffer_load_ushort v248, v15, s[24:27], 0 offen offset:0
buffer_load_ushort v249, v15, s[24:27], 0 offen offset:16
buffer_load_ushort v250, v15, s[24:27], 0 offen offset:32
buffer_load_ushort v251, v15, s[24:27], 0 offen offset:48
s_mov_b32 s34, 4194304
s_mov_b32 s35, 0x20000
s_mov_b32 s38, 256
s_mov_b32 s39, 0x20000
s_mov_b32 s67, s2
v_mov_b32 v253, 1
s_cmp_eq_u32 s3, 0
s_cselect_b32 s56, 0, 64
v_add_u32 v254, s56, v1
v_lshlrev_b32 v254, 12, v254
v_lshrrev_b32 v15, 4, v1
v_lshrrev_b32 v16, 1, v15
v_and_b32 v15, 1, v15
v_lshlrev_b32 v15, 9, v15
v_lshl_add_u32 v15, v16, 10, v15
s_lshl_b32 s56, s53, 21
s_lshl_b32 s57, s52, 17
s_add_u32 s56, s56, s57
s_lshl_b32 s57, s3, 15
s_add_u32 s56, s56, s57
v_add_u32 v15, s56, v15
s_mov_b32 s66, 0x3e0293ee
s_cmp_eq_u32 s51, 0
s_cbranch_scc0 L_k1_v
v_lshl_add_u32 v15, v0, 4, v15
v_bfe_u32 v16, v1, 3, 1
v_lshl_add_u32 v15, v16, 8, v15
s_waitcnt vmcnt(28)
s_barrier
DTR v[144:145],v12 offset:0
DTR v[146:147],v12 offset:512
DTR v[148:149],v13 offset:0
DTR v[150:151],v13 offset:512
DTR v[152:153],v12 offset:256
DTR v[154:155],v12 offset:768
DTR v[156:157],v13 offset:256
DTR v[158:159],v13 offset:768
DR4 a[0:3],v10 offset:0
DR4 a[4:7],v10 offset:2048
DR4 a[8:11],v10 offset:4096
DR4 a[12:15],v10 offset:6144
DR4 a[16:19],v11 offset:0
DR4 a[20:23],v11 offset:2048
DR4 a[24:27],v11 offset:4096
DR4 a[28:31],v11 offset:6144
s_waitcnt lgkmcnt(0)
s_waitcnt vmcnt(20)
M16 v[16:19],v[144:147],a[0:3],0
DTR v[160:161],v12 offset:1024
DTR v[162:163],v12 offset:1536
M16 v[20:23],v[148:151],a[0:3],0
DR4 a[32:35],v10 offset:8192
s_add_u32 m0, s58, 0
M16 v[24:27],v[144:147],a[4:7],0
DTR v[164:165],v13 offset:1024
s_mov_b32 s59, 384
M16 v[28:31],v[148:151],a[4:7],0
DTR v[166:167],v13 offset:1536
M16 v[32:35],v[144:147],a[8:11],0
DR4 a[36:39],v10 offset:10240
M16 v[36:39],v[148:151],a[8:11],0
DTR v[168:169],v12 offset:1280
M16 v[40:43],v[144:147],a[12:15],0
DTR v[170:171],v12 offset:1792
M16 v[44:47],v[148:151],a[12:15],0
DR4 a[40:43],v10 offset:12288
M16 v[48:51],v[152:155],a[0:3],0
DTR v[172:173],v13 offset:1280
M16 v[52:55],v[156:159],a[0:3],0
DTR v[174:175],v13 offset:1792
M16 v[56:59],v[152:155],a[4:7],0
DR4 a[44:47],v10 offset:14336
M16 v[60:63],v[156:159],a[4:7],0
buffer_load_dwordx4 v2, s[8:11], s59 offen offset:0 lds
M16 v[64:67],v[152:155],a[8:11],0
buffer_load_dwordx4 v3, s[8:11], s59 offen offset:1024 lds
M16 v[68:71],v[156:159],a[8:11],0
buffer_load_dwordx4 v4, s[8:11], s59 offen offset:2048 lds
M16 v[72:75],v[152:155],a[12:15],0
buffer_load_dwordx4 v5, s[8:11], s59 offen offset:3072 lds
M16 v[76:79],v[156:159],a[12:15],0
s_add_u32 m0, s55, 49152
s_mov_b32 s65, 3145728
buffer_load_dwordx4 v6, s[12:15], s65 offen offset:0 lds
s_add_u32 m0, s55, 49152
s_nop 0
buffer_load_dwordx4 v7, s[12:15], s65 offen offset:1024 lds
s_waitcnt lgkmcnt(0)
M16 v[16:19],v[160:163],a[16:19],v[16:19]
DTR v[144:145],v12 offset:2048
DTR v[146:147],v12 offset:2560
M16 v[20:23],v[164:167],a[16:19],v[20:23]
DR4 a[48:51],v11 offset:8192
s_add_u32 m0, s58, 4096
M16 v[24:27],v[160:163],a[20:23],v[24:27]
DTR v[148:149],v13 offset:2048
s_mov_b32 s59, 33152
M16 v[28:31],v[164:167],a[20:23],v[28:31]
DTR v[150:151],v13 offset:2560
M16 v[32:35],v[160:163],a[24:27],v[32:35]
DR4 a[52:55],v11 offset:10240
M16 v[36:39],v[164:167],a[24:27],v[36:39]
DTR v[152:153],v12 offset:2304
M16 v[40:43],v[160:163],a[28:31],v[40:43]
DTR v[154:155],v12 offset:2816
M16 v[44:47],v[164:167],a[28:31],v[44:47]
DR4 a[56:59],v11 offset:12288
M16 v[48:51],v[168:171],a[16:19],v[48:51]
DTR v[156:157],v13 offset:2304
M16 v[52:55],v[172:175],a[16:19],v[52:55]
DTR v[158:159],v13 offset:2816
M16 v[56:59],v[168:171],a[20:23],v[56:59]
DR4 a[60:63],v11 offset:14336
M16 v[60:63],v[172:175],a[20:23],v[60:63]
buffer_load_dwordx4 v2, s[8:11], s59 offen offset:0 lds
M16 v[64:67],v[168:171],a[24:27],v[64:67]
buffer_load_dwordx4 v3, s[8:11], s59 offen offset:1024 lds
M16 v[68:71],v[172:175],a[24:27],v[68:71]
buffer_load_dwordx4 v4, s[8:11], s59 offen offset:2048 lds
M16 v[72:75],v[168:171],a[28:31],v[72:75]
buffer_load_dwordx4 v5, s[8:11], s59 offen offset:3072 lds
M16 v[76:79],v[172:175],a[28:31],v[76:79]
s_add_u32 m0, s55, 49152
s_nop 0
buffer_load_dwordx4 v8, s[12:15], s65 offen offset:2048 lds
s_waitcnt lgkmcnt(0)
s_waitcnt vmcnt(19)
M16 v[16:19],v[144:147],a[32:35],v[16:19]
DTR v[160:161],v12 offset:3072
DTR v[162:163],v12 offset:3584
M16 v[20:23],v[148:151],a[32:35],v[20:23]
DR4 a[64:67],v10 offset:16384
s_add_u32 m0, s58, 8192
M16 v[24:27],v[144:147],a[36:39],v[24:27]
DTR v[164:165],v13 offset:3072
s_mov_b32 s59, 512
M16 v[28:31],v[148:151],a[36:39],v[28:31]
DTR v[166:167],v13 offset:3584
M16 v[32:35],v[144:147],a[40:43],v[32:35]
DR4 a[68:71],v10 offset:18432
M16 v[36:39],v[148:151],a[40:43],v[36:39]
DTR v[168:169],v12 offset:3328
M16 v[40:43],v[144:147],a[44:47],v[40:43]
DTR v[170:171],v12 offset:3840
M16 v[44:47],v[148:151],a[44:47],v[44:47]
DR4 a[72:75],v10 offset:20480
M16 v[48:51],v[152:155],a[32:35],v[48:51]
DTR v[172:173],v13 offset:3328
M16 v[52:55],v[156:159],a[32:35],v[52:55]
DTR v[174:175],v13 offset:3840
M16 v[56:59],v[152:155],a[36:39],v[56:59]
DR4 a[76:79],v10 offset:22528
M16 v[60:63],v[156:159],a[36:39],v[60:63]
buffer_load_dwordx4 v2, s[8:11], s59 offen offset:0 lds
M16 v[64:67],v[152:155],a[40:43],v[64:67]
buffer_load_dwordx4 v3, s[8:11], s59 offen offset:1024 lds
M16 v[68:71],v[156:159],a[40:43],v[68:71]
buffer_load_dwordx4 v4, s[8:11], s59 offen offset:2048 lds
M16 v[72:75],v[152:155],a[44:47],v[72:75]
buffer_load_dwordx4 v5, s[8:11], s59 offen offset:3072 lds
M16 v[76:79],v[156:159],a[44:47],v[76:79]
s_add_u32 m0, s55, 49152
s_nop 0
buffer_load_dwordx4 v9, s[12:15], s65 offen offset:3072 lds
s_waitcnt lgkmcnt(0)
s_barrier
M16 v[16:19],v[160:163],a[48:51],v[16:19]
DTR v[144:145],v12 offset:16384
DTR v[146:147],v12 offset:16896
M16 v[20:23],v[164:167],a[48:51],v[20:23]
DR4 a[80:83],v11 offset:16384
s_add_u32 m0, s58, 12288
M16 v[24:27],v[160:163],a[52:55],v[24:27]
DTR v[148:149],v13 offset:16384
s_mov_b32 s59, 33280
M16 v[28:31],v[164:167],a[52:55],v[28:31]
DTR v[150:151],v13 offset:16896
M16 v[32:35],v[160:163],a[56:59],v[32:35]
DR4 a[84:87],v11 offset:18432
M16 v[36:39],v[164:167],a[56:59],v[36:39]
DTR v[152:153],v12 offset:16640
M16 v[40:43],v[160:163],a[60:63],v[40:43]
DTR v[154:155],v12 offset:17152
M16 v[44:47],v[164:167],a[60:63],v[44:47]
DR4 a[88:91],v11 offset:20480
M16 v[48:51],v[168:171],a[48:51],v[48:51]
DTR v[156:157],v13 offset:16640
M16 v[52:55],v[172:175],a[48:51],v[52:55]
DTR v[158:159],v13 offset:17152
M16 v[56:59],v[168:171],a[52:55],v[56:59]
DR4 a[92:95],v11 offset:22528
M16 v[60:63],v[172:175],a[52:55],v[60:63]
buffer_load_dwordx4 v2, s[8:11], s59 offen offset:0 lds
M16 v[64:67],v[168:171],a[56:59],v[64:67]
buffer_load_dwordx4 v3, s[8:11], s59 offen offset:1024 lds
M16 v[68:71],v[172:175],a[56:59],v[68:71]
buffer_load_dwordx4 v4, s[8:11], s59 offen offset:2048 lds
M16 v[72:75],v[168:171],a[60:63],v[72:75]
buffer_load_dwordx4 v5, s[8:11], s59 offen offset:3072 lds
M16 v[76:79],v[172:175],a[60:63],v[76:79]
s_add_u32 m0, s55, 0
s_mov_b32 s65, 128
buffer_load_dwordx4 v6, s[12:15], s65 offen offset:0 lds
s_waitcnt lgkmcnt(0)
s_waitcnt vmcnt(11)
M16 v[16:19],v[144:147],a[64:67],v[16:19]
DTR v[160:161],v12 offset:17408
DTR v[162:163],v12 offset:17920
M16 v[20:23],v[148:151],a[64:67],v[20:23]
DR4 a[96:99],v10 offset:0
s_add_u32 m0, s58, 16384
M16 v[24:27],v[144:147],a[68:71],v[24:27]
DTR v[164:165],v13 offset:17408
s_mov_b32 s59, 640
M16 v[28:31],v[148:151],a[68:71],v[28:31]
DTR v[166:167],v13 offset:17920
M16 v[32:35],v[144:147],a[72:75],v[32:35]
DR4 a[100:103],v10 offset:2048
M16 v[36:39],v[148:151],a[72:75],v[36:39]
DTR v[168:169],v12 offset:17664
M16 v[40:43],v[144:147],a[76:79],v[40:43]
DTR v[170:171],v12 offset:18176
M16 v[44:47],v[148:151],a[76:79],v[44:47]
DR4 a[104:107],v10 offset:4096
M16 v[48:51],v[152:155],a[64:67],v[48:51]
DTR v[172:173],v13 offset:17664
M16 v[52:55],v[156:159],a[64:67],v[52:55]
DTR v[174:175],v13 offset:18176
M16 v[56:59],v[152:155],a[68:71],v[56:59]
DR4 a[108:111],v10 offset:6144
M16 v[60:63],v[156:159],a[68:71],v[60:63]
buffer_load_dwordx4 v2, s[8:11], s59 offen offset:0 lds
M16 v[64:67],v[152:155],a[72:75],v[64:67]
buffer_load_dwordx4 v3, s[8:11], s59 offen offset:1024 lds
M16 v[68:71],v[156:159],a[72:75],v[68:71]
buffer_load_dwordx4 v4, s[8:11], s59 offen offset:2048 lds
M16 v[72:75],v[152:155],a[76:79],v[72:75]
buffer_load_dwordx4 v5, s[8:11], s59 offen offset:3072 lds
M16 v[76:79],v[156:159],a[76:79],v[76:79]
s_add_u32 m0, s55, 0
s_nop 0
buffer_load_dwordx4 v7, s[12:15], s65 offen offset:1024 lds
s_waitcnt lgkmcnt(0)
M16 v[16:19],v[160:163],a[80:83],v[16:19]
DTR v[144:145],v12 offset:18432
DTR v[146:147],v12 offset:18944
M16 v[20:23],v[164:167],a[80:83],v[20:23]
DR4 a[112:115],v11 offset:0
s_add_u32 m0, s58, 20480
M16 v[24:27],v[160:163],a[84:87],v[24:27]
DTR v[148:149],v13 offset:18432
s_mov_b32 s59, 33408
M16 v[28:31],v[164:167],a[84:87],v[28:31]
DTR v[150:151],v13 offset:18944
M16 v[32:35],v[160:163],a[88:91],v[32:35]
DR4 a[116:119],v11 offset:2048
M16 v[36:39],v[164:167],a[88:91],v[36:39]
DTR v[152:153],v12 offset:18688
M16 v[40:43],v[160:163],a[92:95],v[40:43]
DTR v[154:155],v12 offset:19200
M16 v[44:47],v[164:167],a[92:95],v[44:47]
DR4 a[120:123],v11 offset:4096
M16 v[48:51],v[168:171],a[80:83],v[48:51]
DTR v[156:157],v13 offset:18688
M16 v[52:55],v[172:175],a[80:83],v[52:55]
DTR v[158:159],v13 offset:19200
M16 v[56:59],v[168:171],a[84:87],v[56:59]
DR4 a[124:127],v11 offset:6144
M16 v[60:63],v[172:175],a[84:87],v[60:63]
buffer_load_dwordx4 v2, s[8:11], s59 offen offset:0 lds
M16 v[64:67],v[168:171],a[88:91],v[64:67]
buffer_load_dwordx4 v3, s[8:11], s59 offen offset:1024 lds
M16 v[68:71],v[172:175],a[88:91],v[68:71]
buffer_load_dwordx4 v4, s[8:11], s59 offen offset:2048 lds
M16 v[72:75],v[168:171],a[92:95],v[72:75]
buffer_load_dwordx4 v5, s[8:11], s59 offen offset:3072 lds
M16 v[76:79],v[172:175],a[92:95],v[76:79]
s_add_u32 m0, s55, 0
s_nop 0
buffer_load_dwordx4 v8, s[12:15], s65 offen offset:2048 lds
s_waitcnt lgkmcnt(0)
s_waitcnt vmcnt(11)
M16 v[16:19],v[144:147],a[96:99],v[16:19]
DTR v[160:161],v12 offset:19456
DTR v[162:163],v12 offset:19968
M16 v[20:23],v[148:151],a[96:99],v[20:23]
DR4 a[128:131],v10 offset:8192
s_add_u32 m0, s58, 0
M16 v[24:27],v[144:147],a[100:103],v[24:27]
DTR v[164:165],v13 offset:19456
s_mov_b32 s59, 768
M16 v[28:31],v[148:151],a[100:103],v[28:31]
DTR v[166:167],v13 offset:19968
M16 v[32:35],v[144:147],a[104:107],v[32:35]
DR4 a[132:135],v10 offset:10240
M16 v[36:39],v[148:151],a[104:107],v[36:39]
DTR v[168:169],v12 offset:19712
M16 v[40:43],v[144:147],a[108:111],v[40:43]
DTR v[170:171],v12 offset:20224
M16 v[44:47],v[148:151],a[108:111],v[44:47]
DR4 a[136:139],v10 offset:12288
M16 v[48:51],v[152:155],a[96:99],v[48:51]
DTR v[172:173],v13 offset:19712
M16 v[52:55],v[156:159],a[96:99],v[52:55]
DTR v[174:175],v13 offset:20224
M16 v[56:59],v[152:155],a[100:103],v[56:59]
DR4 a[140:143],v10 offset:14336
M16 v[60:63],v[156:159],a[100:103],v[60:63]
buffer_load_dwordx4 v2, s[8:11], s59 offen offset:0 lds
M16 v[64:67],v[152:155],a[104:107],v[64:67]
buffer_load_dwordx4 v3, s[8:11], s59 offen offset:1024 lds
M16 v[68:71],v[156:159],a[104:107],v[68:71]
buffer_load_dwordx4 v4, s[8:11], s59 offen offset:2048 lds
M16 v[72:75],v[152:155],a[108:111],v[72:75]
buffer_load_dwordx4 v5, s[8:11], s59 offen offset:3072 lds
M16 v[76:79],v[156:159],a[108:111],v[76:79]
s_add_u32 m0, s55, 0
s_nop 0
buffer_load_dwordx4 v9, s[12:15], s65 offen offset:3072 lds
s_mov_b32 s64, 0
buffer_load_dwordx4 v[176:179], v14, s[20:23], s64 offen
s_waitcnt lgkmcnt(0)
s_barrier
M16 v[16:19],v[160:163],a[112:115],v[16:19]
DTR v[144:145],v12 offset:32768
DTR v[146:147],v12 offset:33280
M16 v[20:23],v[164:167],a[112:115],v[20:23]
DR4 a[144:147],v11 offset:8192
s_add_u32 m0, s58, 4096
M16 v[24:27],v[160:163],a[116:119],v[24:27]
DTR v[148:149],v13 offset:32768
s_mov_b32 s59, 33536
M16 v[28:31],v[164:167],a[116:119],v[28:31]
DTR v[150:151],v13 offset:33280
M16 v[32:35],v[160:163],a[120:123],v[32:35]
DR4 a[148:151],v11 offset:10240
M16 v[36:39],v[164:167],a[120:123],v[36:39]
DTR v[152:153],v12 offset:33024
M16 v[40:43],v[160:163],a[124:127],v[40:43]
DTR v[154:155],v12 offset:33536
M16 v[44:47],v[164:167],a[124:127],v[44:47]
DR4 a[152:155],v11 offset:12288
M16 v[48:51],v[168:171],a[112:115],v[48:51]
DTR v[156:157],v13 offset:33024
M16 v[52:55],v[172:175],a[112:115],v[52:55]
DTR v[158:159],v13 offset:33536
M16 v[56:59],v[168:171],a[116:119],v[56:59]
DR4 a[156:159],v11 offset:14336
M16 v[60:63],v[172:175],a[116:119],v[60:63]
buffer_load_dwordx4 v2, s[8:11], s59 offen offset:0 lds
M16 v[64:67],v[168:171],a[120:123],v[64:67]
buffer_load_dwordx4 v3, s[8:11], s59 offen offset:1024 lds
M16 v[68:71],v[172:175],a[120:123],v[68:71]
buffer_load_dwordx4 v4, s[8:11], s59 offen offset:2048 lds
M16 v[72:75],v[168:171],a[124:127],v[72:75]
buffer_load_dwordx4 v5, s[8:11], s59 offen offset:3072 lds
M16 v[76:79],v[172:175],a[124:127],v[76:79]
s_add_u32 m0, s55, 16384
s_mov_b32 s65, 1048704
buffer_load_dwordx4 v6, s[12:15], s65 offen offset:0 lds
s_mov_b32 s64, 98304
buffer_load_dwordx4 v[180:183], v14, s[20:23], s64 offen
s_waitcnt lgkmcnt(0)
s_waitcnt vmcnt(13)
M16 v[16:19],v[144:147],a[128:131],v[16:19]
DTR v[160:161],v12 offset:33792
DTR v[162:163],v12 offset:34304
M16 v[20:23],v[148:151],a[128:131],v[20:23]
DR4 a[160:163],v10 offset:16384
s_add_u32 m0, s58, 8192
M16 v[24:27],v[144:147],a[132:135],v[24:27]
DTR v[164:165],v13 offset:33792
s_mov_b32 s59, 896
M16 v[28:31],v[148:151],a[132:135],v[28:31]
DTR v[166:167],v13 offset:34304
M16 v[32:35],v[144:147],a[136:139],v[32:35]
DR4 a[164:167],v10 offset:18432
M16 v[36:39],v[148:151],a[136:139],v[36:39]
DTR v[168:169],v12 offset:34048
M16 v[40:43],v[144:147],a[140:143],v[40:43]
DTR v[170:171],v12 offset:34560
M16 v[44:47],v[148:151],a[140:143],v[44:47]
DR4 a[168:171],v10 offset:20480
M16 v[48:51],v[152:155],a[128:131],v[48:51]
DTR v[172:173],v13 offset:34048
M16 v[52:55],v[156:159],a[128:131],v[52:55]
DTR v[174:175],v13 offset:34560
M16 v[56:59],v[152:155],a[132:135],v[56:59]
DR4 a[172:175],v10 offset:22528
M16 v[60:63],v[156:159],a[132:135],v[60:63]
buffer_load_dwordx4 v2, s[8:11], s59 offen offset:0 lds
M16 v[64:67],v[152:155],a[136:139],v[64:67]
buffer_load_dwordx4 v3, s[8:11], s59 offen offset:1024 lds
M16 v[68:71],v[156:159],a[136:139],v[68:71]
buffer_load_dwordx4 v4, s[8:11], s59 offen offset:2048 lds
M16 v[72:75],v[152:155],a[140:143],v[72:75]
buffer_load_dwordx4 v5, s[8:11], s59 offen offset:3072 lds
M16 v[76:79],v[156:159],a[140:143],v[76:79]
s_add_u32 m0, s55, 16384
s_nop 0
buffer_load_dwordx4 v7, s[12:15], s65 offen offset:1024 lds
s_mov_b32 s64, 196608
buffer_load_dwordx4 v[184:187], v14, s[20:23], s64 offen
s_waitcnt lgkmcnt(0)
M16 v[16:19],v[160:163],a[144:147],v[16:19]
DTR v[144:145],v12 offset:34816
DTR v[146:147],v12 offset:35328
M16 v[20:23],v[164:167],a[144:147],v[20:23]
DR4 a[176:179],v11 offset:16384
s_add_u32 m0, s58, 12288
M16 v[24:27],v[160:163],a[148:151],v[24:27]
DTR v[148:149],v13 offset:34816
s_mov_b32 s59, 33664
M16 v[28:31],v[164:167],a[148:151],v[28:31]
DTR v[150:151],v13 offset:35328
M16 v[32:35],v[160:163],a[152:155],v[32:35]
DR4 a[180:183],v11 offset:18432
M16 v[36:39],v[164:167],a[152:155],v[36:39]
DTR v[152:153],v12 offset:35072
M16 v[40:43],v[160:163],a[156:159],v[40:43]
DTR v[154:155],v12 offset:35584
M16 v[44:47],v[164:167],a[156:159],v[44:47]
DR4 a[184:187],v11 offset:20480
M16 v[48:51],v[168:171],a[144:147],v[48:51]
DTR v[156:157],v13 offset:35072
M16 v[52:55],v[172:175],a[144:147],v[52:55]
DTR v[158:159],v13 offset:35584
M16 v[56:59],v[168:171],a[148:151],v[56:59]
DR4 a[188:191],v11 offset:22528
M16 v[60:63],v[172:175],a[148:151],v[60:63]
buffer_load_dwordx4 v2, s[8:11], s59 offen offset:0 lds
M16 v[64:67],v[168:171],a[152:155],v[64:67]
buffer_load_dwordx4 v3, s[8:11], s59 offen offset:1024 lds
M16 v[68:71],v[172:175],a[152:155],v[68:71]
buffer_load_dwordx4 v4, s[8:11], s59 offen offset:2048 lds
M16 v[72:75],v[168:171],a[156:159],v[72:75]
buffer_load_dwordx4 v5, s[8:11], s59 offen offset:3072 lds
M16 v[76:79],v[172:175],a[156:159],v[76:79]
s_add_u32 m0, s55, 16384
s_nop 0
buffer_load_dwordx4 v8, s[12:15], s65 offen offset:2048 lds
s_mov_b32 s64, 294912
buffer_load_dwordx4 v[188:191], v14, s[20:23], s64 offen
s_waitcnt lgkmcnt(0)
s_waitcnt vmcnt(14)
M16 v[16:19],v[144:147],a[160:163],v[16:19]
DTR v[160:161],v12 offset:35840
DTR v[162:163],v12 offset:36352
M16 v[20:23],v[148:151],a[160:163],v[20:23]
DR4 a[192:195],v10 offset:0
s_add_u32 m0, s55, 16384
M16 v[24:27],v[144:147],a[164:167],v[24:27]
DTR v[164:165],v13 offset:35840
M16 v[28:31],v[148:151],a[164:167],v[28:31]
DTR v[166:167],v13 offset:36352
M16 v[32:35],v[144:147],a[168:171],v[32:35]
DR4 a[196:199],v10 offset:2048
M16 v[36:39],v[148:151],a[168:171],v[36:39]
DTR v[168:169],v12 offset:36096
M16 v[40:43],v[144:147],a[172:175],v[40:43]
DTR v[170:171],v12 offset:36608
M16 v[44:47],v[148:151],a[172:175],v[44:47]
DR4 a[200:203],v10 offset:4096
M16 v[48:51],v[152:155],a[160:163],v[48:51]
DTR v[172:173],v13 offset:36096
M16 v[52:55],v[156:159],a[160:163],v[52:55]
DTR v[174:175],v13 offset:36608
M16 v[56:59],v[152:155],a[164:167],v[56:59]
DR4 a[204:207],v10 offset:6144
M16 v[60:63],v[156:159],a[164:167],v[60:63]
buffer_load_dwordx4 v9, s[12:15], s65 offen offset:3072 lds
M16 v[64:67],v[152:155],a[168:171],v[64:67]
s_mov_b32 s64, 4096
M16 v[68:71],v[156:159],a[168:171],v[68:71]
buffer_load_dwordx4 v[192:195], v14, s[20:23], s64 offen
M16 v[72:75],v[152:155],a[172:175],v[72:75]
M16 v[76:79],v[156:159],a[172:175],v[76:79]
s_waitcnt lgkmcnt(0)
s_barrier
M16 v[16:19],v[160:163],a[176:179],v[16:19]
DTR v[144:145],v12 offset:49152
DTR v[146:147],v12 offset:49664
M16 v[20:23],v[164:167],a[176:179],v[20:23]
DR4 a[208:211],v11 offset:0
s_add_u32 m0, s55, 32768
M16 v[24:27],v[160:163],a[180:183],v[24:27]
DTR v[148:149],v13 offset:49152
s_mov_b32 s65, 2097280
M16 v[28:31],v[164:167],a[180:183],v[28:31]
DTR v[150:151],v13 offset:49664
M16 v[32:35],v[160:163],a[184:187],v[32:35]
DR4 a[212:215],v11 offset:2048
M16 v[36:39],v[164:167],a[184:187],v[36:39]
DTR v[152:153],v12 offset:49408
M16 v[40:43],v[160:163],a[188:191],v[40:43]
DTR v[154:155],v12 offset:49920
M16 v[44:47],v[164:167],a[188:191],v[44:47]
DR4 a[216:219],v11 offset:4096
M16 v[48:51],v[168:171],a[176:179],v[48:51]
DTR v[156:157],v13 offset:49408
M16 v[52:55],v[172:175],a[176:179],v[52:55]
DTR v[158:159],v13 offset:49920
M16 v[56:59],v[168:171],a[180:183],v[56:59]
DR4 a[220:223],v11 offset:6144
M16 v[60:63],v[172:175],a[180:183],v[60:63]
buffer_load_dwordx4 v6, s[12:15], s65 offen offset:0 lds
M16 v[64:67],v[168:171],a[184:187],v[64:67]
s_mov_b32 s64, 102400
M16 v[68:71],v[172:175],a[184:187],v[68:71]
buffer_load_dwordx4 v[196:199], v14, s[20:23], s64 offen
M16 v[72:75],v[168:171],a[188:191],v[72:75]
v_lshlrev_b32 v248, 16, v248
FML v252,0xbfb8aa3b,v248
M16 v[76:79],v[172:175],a[188:191],v[76:79]
EXP v252,v252
s_nop 0
FAD v252,1.0,v252
v_rcp_f32 v252, v252
s_nop 0
FML v248,v248,v252
v_lshlrev_b32 v249, 16, v249
FML v252,0xbfb8aa3b,v249
s_waitcnt vmcnt(6)
s_waitcnt lgkmcnt(10)
M16 v[16:19],v[144:147],a[192:195],v[16:19]
DTR v[160:161],v12 offset:50176
DTR v[162:163],v12 offset:50688
s_waitcnt lgkmcnt(9)
M16 v[20:23],v[148:151],a[192:195],v[20:23]
DR4 a[224:227],v10 offset:8192
M16 v[24:27],v[144:147],a[196:199],v[24:27]
DTR v[164:165],v13 offset:50176
M16 v[28:31],v[148:151],a[196:199],v[28:31]
DTR v[166:167],v13 offset:50688
M16 v[32:35],v[144:147],a[200:203],v[32:35]
DR4 a[228:231],v10 offset:10240
M16 v[36:39],v[148:151],a[200:203],v[36:39]
DTR v[168:169],v12 offset:50432
M16 v[40:43],v[144:147],a[204:207],v[40:43]
DTR v[170:171],v12 offset:50944
M16 v[44:47],v[148:151],a[204:207],v[44:47]
DR4 a[232:235],v10 offset:12288
s_waitcnt lgkmcnt(13)
M16 v[48:51],v[152:155],a[192:195],v[48:51]
DTR v[172:173],v13 offset:50432
s_waitcnt lgkmcnt(11)
M16 v[52:55],v[156:159],a[192:195],v[52:55]
DTR v[174:175],v13 offset:50944
M16 v[56:59],v[152:155],a[196:199],v[56:59]
DR4 a[236:239],v10 offset:14336
M16 v[60:63],v[156:159],a[196:199],v[60:63]
buffer_load_dwordx4 v7, s[12:15], s65 offen offset:1024 lds
M16 v[64:67],v[152:155],a[200:203],v[64:67]
s_mov_b32 s64, 200704
M16 v[68:71],v[156:159],a[200:203],v[68:71]
buffer_load_dwordx4 v[200:203], v14, s[20:23], s64 offen
M16 v[72:75],v[152:155],a[204:207],v[72:75]
EXP v252,v252
M16 v[76:79],v[156:159],a[204:207],v[76:79]
FAD v252,1.0,v252
v_rcp_f32 v252, v252
s_nop 0
FML v249,v249,v252
v_lshlrev_b32 v250, 16, v250
FML v252,0xbfb8aa3b,v250
EXP v252,v252
s_waitcnt lgkmcnt(10)
M16 v[16:19],v[160:163],a[208:211],v[16:19]
DTR v[144:145],v12 offset:51200
DTR v[146:147],v12 offset:51712
s_waitcnt lgkmcnt(9)
M16 v[20:23],v[164:167],a[208:211],v[20:23]
DR4 a[240:243],v11 offset:8192
M16 v[24:27],v[160:163],a[212:215],v[24:27]
DTR v[148:149],v13 offset:51200
M16 v[28:31],v[164:167],a[212:215],v[28:31]
DTR v[150:151],v13 offset:51712
M16 v[32:35],v[160:163],a[216:219],v[32:35]
DR4 a[244:247],v11 offset:10240
M16 v[36:39],v[164:167],a[216:219],v[36:39]
DTR v[152:153],v12 offset:51456
M16 v[40:43],v[160:163],a[220:223],v[40:43]
DTR v[154:155],v12 offset:51968
M16 v[44:47],v[164:167],a[220:223],v[44:47]
DR4 a[248:251],v11 offset:12288
s_waitcnt lgkmcnt(13)
M16 v[48:51],v[168:171],a[208:211],v[48:51]
DTR v[156:157],v13 offset:51456
s_waitcnt lgkmcnt(11)
M16 v[52:55],v[172:175],a[208:211],v[52:55]
DTR v[158:159],v13 offset:51968
M16 v[56:59],v[168:171],a[212:215],v[56:59]
DR4 a[252:255],v11 offset:14336
M16 v[60:63],v[172:175],a[212:215],v[60:63]
buffer_load_dwordx4 v8, s[12:15], s65 offen offset:2048 lds
M16 v[64:67],v[168:171],a[216:219],v[64:67]
s_mov_b32 s64, 299008
M16 v[68:71],v[172:175],a[216:219],v[68:71]
buffer_load_dwordx4 v[204:207], v14, s[20:23], s64 offen
M16 v[72:75],v[168:171],a[220:223],v[72:75]
FAD v252,1.0,v252
M16 v[76:79],v[172:175],a[220:223],v[76:79]
v_rcp_f32 v252, v252
s_nop 0
FML v250,v250,v252
v_lshlrev_b32 v251, 16, v251
FML v252,0xbfb8aa3b,v251
EXP v252,v252
s_nop 0
FAD v252,1.0,v252
s_waitcnt lgkmcnt(10)
M16 v[16:19],v[144:147],a[224:227],v[16:19]
DTR v[160:161],v12 offset:52224
s_waitcnt lgkmcnt(8)
M16 v[20:23],v[148:151],a[224:227],v[20:23]
DTR v[162:163],v12 offset:52736
M16 v[24:27],v[144:147],a[228:231],v[24:27]
DTR v[164:165],v13 offset:52224
M16 v[28:31],v[148:151],a[228:231],v[28:31]
DTR v[166:167],v13 offset:52736
M16 v[32:35],v[144:147],a[232:235],v[32:35]
DTR v[168:169],v12 offset:52480
M16 v[36:39],v[148:151],a[232:235],v[36:39]
DTR v[170:171],v12 offset:52992
M16 v[40:43],v[144:147],a[236:239],v[40:43]
DTR v[172:173],v13 offset:52480
M16 v[44:47],v[148:151],a[236:239],v[44:47]
DTR v[174:175],v13 offset:52992
s_waitcnt lgkmcnt(12)
M16 v[48:51],v[152:155],a[224:227],v[48:51]
buffer_load_dwordx4 v9, s[12:15], s65 offen offset:3072 lds
s_waitcnt lgkmcnt(9)
M16 v[52:55],v[156:159],a[224:227],v[52:55]
s_mov_b32 s64, 8192
M16 v[56:59],v[152:155],a[228:231],v[56:59]
buffer_load_dwordx4 v[208:211], v14, s[20:23], s64 offen
M16 v[60:63],v[156:159],a[228:231],v[60:63]
v_rcp_f32 v252, v252
M16 v[64:67],v[152:155],a[232:235],v[64:67]
FML v251,v251,v252
v_lshlrev_b32 v252, 16, v176
M16 v[68:71],v[156:159],a[232:235],v[68:71]
v_and_b32 v176, 0xffff0000, v176
FML v224,v252,v248
M16 v[72:75],v[152:155],a[236:239],v[72:75]
FML v225,v176,v248
v_lshlrev_b32 v252, 16, v177
M16 v[76:79],v[156:159],a[236:239],v[76:79]
v_and_b32 v177, 0xffff0000, v177
FML v226,v252,v248
FML v227,v177,v248
s_waitcnt lgkmcnt(0)
s_barrier
M16 v[16:19],v[160:163],a[240:243],v[16:19]
DTR v[144:145],v12 offset:0
s_add_u32 m0, s55, 49152
M16 v[20:23],v[164:167],a[240:243],v[20:23]
DTR v[146:147],v12 offset:512
s_mov_b32 s65, 3145856
M16 v[24:27],v[160:163],a[244:247],v[24:27]
DTR v[148:149],v13 offset:0
M16 v[28:31],v[164:167],a[244:247],v[28:31]
DTR v[150:151],v13 offset:512
M16 v[32:35],v[160:163],a[248:251],v[32:35]
DTR v[152:153],v12 offset:256
M16 v[36:39],v[164:167],a[248:251],v[36:39]
DTR v[154:155],v12 offset:768
M16 v[40:43],v[160:163],a[252:255],v[40:43]
DTR v[156:157],v13 offset:256
M16 v[44:47],v[164:167],a[252:255],v[44:47]
DTR v[158:159],v13 offset:768
M16 v[48:51],v[168:171],a[240:243],v[48:51]
buffer_load_dwordx4 v6, s[12:15], s65 offen offset:0 lds
M16 v[52:55],v[172:175],a[240:243],v[52:55]
s_mov_b32 s64, 106496
M16 v[56:59],v[168:171],a[244:247],v[56:59]
buffer_load_dwordx4 v[212:215], v14, s[20:23], s64 offen
M16 v[60:63],v[172:175],a[244:247],v[60:63]
v_lshlrev_b32 v252, 16, v178
v_and_b32 v178, 0xffff0000, v178
M16 v[64:67],v[168:171],a[248:251],v[64:67]
FML v228,v252,v248
FML v229,v178,v248
M16 v[68:71],v[172:175],a[248:251],v[68:71]
v_lshlrev_b32 v252, 16, v179
v_and_b32 v179, 0xffff0000, v179
M16 v[72:75],v[168:171],a[252:255],v[72:75]
FML v230,v252,v248
FML v231,v179,v248
M16 v[76:79],v[172:175],a[252:255],v[76:79]
v_lshlrev_b32 v252, 16, v180
v_and_b32 v180, 0xffff0000, v180
v_fmac_f32 v224, v252, v249
v_fmac_f32 v225, v180, v249
s_waitcnt lgkmcnt(6)
M16 v[80:83],v[144:147],a[0:3],0
DTR v[160:161],v12 offset:1024
s_waitcnt lgkmcnt(5)
M16 v[84:87],v[148:151],a[0:3],0
DTR v[162:163],v12 offset:1536
M16 v[88:91],v[144:147],a[4:7],0
DTR v[164:165],v13 offset:1024
M16 v[92:95],v[148:151],a[4:7],0
DTR v[166:167],v13 offset:1536
M16 v[96:99],v[144:147],a[8:11],0
DTR v[168:169],v12 offset:1280
M16 v[100:103],v[148:151],a[8:11],0
DTR v[170:171],v12 offset:1792
M16 v[104:107],v[144:147],a[12:15],0
DTR v[172:173],v13 offset:1280
M16 v[108:111],v[148:151],a[12:15],0
DTR v[174:175],v13 offset:1792
s_waitcnt lgkmcnt(10)
M16 v[112:115],v[152:155],a[0:3],0
buffer_load_dwordx4 v7, s[12:15], s65 offen offset:1024 lds
s_waitcnt lgkmcnt(8)
M16 v[116:119],v[156:159],a[0:3],0
s_mov_b32 s64, 204800
M16 v[120:123],v[152:155],a[4:7],0
buffer_load_dwordx4 v[216:219], v14, s[20:23], s64 offen
M16 v[124:127],v[156:159],a[4:7],0
v_lshlrev_b32 v252, 16, v181
v_and_b32 v181, 0xffff0000, v181
M16 v[128:131],v[152:155],a[8:11],0
v_fmac_f32 v226, v252, v249
v_fmac_f32 v227, v181, v249
M16 v[132:135],v[156:159],a[8:11],0
v_lshlrev_b32 v252, 16, v182
v_and_b32 v182, 0xffff0000, v182
M16 v[136:139],v[152:155],a[12:15],0
v_fmac_f32 v228, v252, v249
v_fmac_f32 v229, v182, v249
M16 v[140:143],v[156:159],a[12:15],0
v_lshlrev_b32 v252, 16, v183
v_and_b32 v183, 0xffff0000, v183
v_fmac_f32 v230, v252, v249
v_fmac_f32 v231, v183, v249
s_waitcnt lgkmcnt(6)
M16 v[80:83],v[160:163],a[16:19],v[80:83]
DTR v[144:145],v12 offset:2048
s_waitcnt lgkmcnt(5)
M16 v[84:87],v[164:167],a[16:19],v[84:87]
DTR v[146:147],v12 offset:2560
M16 v[88:91],v[160:163],a[20:23],v[88:91]
DTR v[148:149],v13 offset:2048
M16 v[92:95],v[164:167],a[20:23],v[92:95]
DTR v[150:151],v13 offset:2560
M16 v[96:99],v[160:163],a[24:27],v[96:99]
DTR v[152:153],v12 offset:2304
M16 v[100:103],v[164:167],a[24:27],v[100:103]
DTR v[154:155],v12 offset:2816
M16 v[104:107],v[160:163],a[28:31],v[104:107]
DTR v[156:157],v13 offset:2304
M16 v[108:111],v[164:167],a[28:31],v[108:111]
DTR v[158:159],v13 offset:2816
s_waitcnt lgkmcnt(10)
M16 v[112:115],v[168:171],a[16:19],v[112:115]
buffer_load_dwordx4 v8, s[12:15], s65 offen offset:2048 lds
s_waitcnt lgkmcnt(8)
M16 v[116:119],v[172:175],a[16:19],v[116:119]
FML v16,s66,v16
FML v17,s66,v17
M16 v[120:123],v[168:171],a[20:23],v[120:123]
FML v18,s66,v18
FML v19,s66,v19
M16 v[124:127],v[172:175],a[20:23],v[124:127]
FML v20,s66,v20
FML v21,s66,v21
M16 v[128:131],v[168:171],a[24:27],v[128:131]
FML v22,s66,v22
FML v23,s66,v23
M16 v[132:135],v[172:175],a[24:27],v[132:135]
CVT v16,v16,v17
CVT v17,v18,v19
M16 v[136:139],v[168:171],a[28:31],v[136:139]
CVT v18,v20,v21
CVT v19,v22,v23
M16 v[140:143],v[172:175],a[28:31],v[140:143]
s_mov_b32 s57, 0
buffer_store_dwordx4 v[16:19], v15, s[16:19], s57 offen offset:0 sc1
s_mov_b32 s64, 303104
buffer_load_dwordx4 v[220:223], v14, s[20:23], s64 offen
v_lshlrev_b32 v252, 16, v184
v_and_b32 v184, 0xffff0000, v184
v_fmac_f32 v224, v252, v250
v_fmac_f32 v225, v184, v250
v_lshlrev_b32 v252, 16, v185
v_and_b32 v185, 0xffff0000, v185
v_fmac_f32 v226, v252, v250
v_fmac_f32 v227, v185, v250
v_lshlrev_b32 v252, 16, v186
v_and_b32 v186, 0xffff0000, v186
v_fmac_f32 v228, v252, v250
v_fmac_f32 v229, v186, v250
s_waitcnt lgkmcnt(6)
M16 v[80:83],v[144:147],a[32:35],v[80:83]
DTR v[160:161],v12 offset:3072
s_waitcnt lgkmcnt(5)
M16 v[84:87],v[148:151],a[32:35],v[84:87]
DTR v[162:163],v12 offset:3584
M16 v[88:91],v[144:147],a[36:39],v[88:91]
DTR v[164:165],v13 offset:3072
M16 v[92:95],v[148:151],a[36:39],v[92:95]
DTR v[166:167],v13 offset:3584
M16 v[96:99],v[144:147],a[40:43],v[96:99]
DTR v[168:169],v12 offset:3328
M16 v[100:103],v[148:151],a[40:43],v[100:103]
DTR v[170:171],v12 offset:3840
M16 v[104:107],v[144:147],a[44:47],v[104:107]
DTR v[172:173],v13 offset:3328
M16 v[108:111],v[148:151],a[44:47],v[108:111]
DTR v[174:175],v13 offset:3840
s_waitcnt lgkmcnt(10)
M16 v[112:115],v[152:155],a[32:35],v[112:115]
buffer_load_dwordx4 v9, s[12:15], s65 offen offset:3072 lds
s_waitcnt lgkmcnt(8)
M16 v[116:119],v[156:159],a[32:35],v[116:119]
FML v24,s66,v24
FML v25,s66,v25
M16 v[120:123],v[152:155],a[36:39],v[120:123]
FML v26,s66,v26
FML v27,s66,v27
M16 v[124:127],v[156:159],a[36:39],v[124:127]
FML v28,s66,v28
FML v29,s66,v29
M16 v[128:131],v[152:155],a[40:43],v[128:131]
FML v30,s66,v30
FML v31,s66,v31
M16 v[132:135],v[156:159],a[40:43],v[132:135]
CVT v24,v24,v25
CVT v25,v26,v27
M16 v[136:139],v[152:155],a[44:47],v[136:139]
CVT v26,v28,v29
CVT v27,v30,v31
M16 v[140:143],v[156:159],a[44:47],v[140:143]
s_mov_b32 s57, 0
buffer_store_dwordx4 v[24:27], v15, s[16:19], s57 offen offset:128 sc1
v_lshlrev_b32 v252, 16, v187
v_and_b32 v187, 0xffff0000, v187
v_fmac_f32 v230, v252, v250
v_fmac_f32 v231, v187, v250
s_waitcnt vmcnt(19)
v_lshlrev_b32 v252, 16, v188
v_and_b32 v188, 0xffff0000, v188
v_fmac_f32 v224, v252, v251
v_fmac_f32 v225, v188, v251
v_lshlrev_b32 v252, 16, v189
v_and_b32 v189, 0xffff0000, v189
v_fmac_f32 v226, v252, v251
v_fmac_f32 v227, v189, v251
s_waitcnt lgkmcnt(0)
s_waitcnt vmcnt(18)
s_barrier
M16 v[80:83],v[160:163],a[48:51],v[80:83]
DTR v[144:145],v12 offset:16384
s_add_u32 m0, s55, 0
M16 v[84:87],v[164:167],a[48:51],v[84:87]
DTR v[146:147],v12 offset:16896
s_mov_b32 s65, 256
M16 v[88:91],v[160:163],a[52:55],v[88:91]
DTR v[148:149],v13 offset:16384
M16 v[92:95],v[164:167],a[52:55],v[92:95]
DTR v[150:151],v13 offset:16896
M16 v[96:99],v[160:163],a[56:59],v[96:99]
DTR v[152:153],v12 offset:16640
M16 v[100:103],v[164:167],a[56:59],v[100:103]
DTR v[154:155],v12 offset:17152
M16 v[104:107],v[160:163],a[60:63],v[104:107]
DTR v[156:157],v13 offset:16640
M16 v[108:111],v[164:167],a[60:63],v[108:111]
DTR v[158:159],v13 offset:17152
M16 v[112:115],v[168:171],a[48:51],v[112:115]
buffer_load_dwordx4 v6, s[12:15], s65 offen offset:0 lds
M16 v[116:119],v[172:175],a[48:51],v[116:119]
FML v32,s66,v32
FML v33,s66,v33
M16 v[120:123],v[168:171],a[52:55],v[120:123]
FML v34,s66,v34
FML v35,s66,v35
M16 v[124:127],v[172:175],a[52:55],v[124:127]
FML v36,s66,v36
FML v37,s66,v37
M16 v[128:131],v[168:171],a[56:59],v[128:131]
FML v38,s66,v38
FML v39,s66,v39
M16 v[132:135],v[172:175],a[56:59],v[132:135]
CVT v32,v32,v33
CVT v33,v34,v35
M16 v[136:139],v[168:171],a[60:63],v[136:139]
CVT v34,v36,v37
CVT v35,v38,v39
M16 v[140:143],v[172:175],a[60:63],v[140:143]
s_mov_b32 s57, 8192
buffer_store_dwordx4 v[32:35], v15, s[16:19], s57 offen offset:0 sc1
v_lshlrev_b32 v252, 16, v190
v_and_b32 v190, 0xffff0000, v190
v_fmac_f32 v228, v252, v251
v_fmac_f32 v229, v190, v251
v_lshlrev_b32 v252, 16, v191
v_and_b32 v191, 0xffff0000, v191
v_fmac_f32 v230, v252, v251
v_fmac_f32 v231, v191, v251
s_waitcnt vmcnt(19)
v_lshlrev_b32 v252, 16, v192
v_and_b32 v192, 0xffff0000, v192
FML v232,v252,v248
FML v233,v192,v248
v_lshrrev_b32 v5, 4, v1
v_lshlrev_b32 v5, 13, v5
v_and_b32 v4, 15, v1
v_lshl_add_u32 v5, v4, 6, v5
v_mov_b32 v4, 0x1000000
v_cmp_gt_u32 vcc, 32, v1
s_nop 1
CND v5,v4,v5,vcc
s_mov_b32 s6, 0x800000
s_mov_b32 s7, 0x20000
s_lshr_b32 s56, s2, 3
s_lshl_b32 s56, s56, 2
s_add_u32 s56, s56, s3
s_lshl_b32 s56, s56, 16
s_and_b32 s63, s2, 7
s_lshl_b32 s63, s63, 10
s_add_u32 s63, s63, s56
s_waitcnt lgkmcnt(6)
M16 v[80:83],v[144:147],a[64:67],v[80:83]
DTR v[160:161],v12 offset:17408
s_waitcnt lgkmcnt(5)
M16 v[84:87],v[148:151],a[64:67],v[84:87]
DTR v[162:163],v12 offset:17920
M16 v[88:91],v[144:147],a[68:71],v[88:91]
DTR v[164:165],v13 offset:17408
M16 v[92:95],v[148:151],a[68:71],v[92:95]
DTR v[166:167],v13 offset:17920
M16 v[96:99],v[144:147],a[72:75],v[96:99]
DTR v[168:169],v12 offset:17664
M16 v[100:103],v[148:151],a[72:75],v[100:103]
DTR v[170:171],v12 offset:18176
M16 v[104:107],v[144:147],a[76:79],v[104:107]
DTR v[172:173],v13 offset:17664
M16 v[108:111],v[148:151],a[76:79],v[108:111]
DTR v[174:175],v13 offset:18176
s_waitcnt lgkmcnt(10)
M16 v[112:115],v[152:155],a[64:67],v[112:115]
buffer_load_dwordx4 v7, s[12:15], s65 offen offset:1024 lds
s_waitcnt lgkmcnt(8)
M16 v[116:119],v[156:159],a[64:67],v[116:119]
FML v40,s66,v40
FML v41,s66,v41
M16 v[120:123],v[152:155],a[68:71],v[120:123]
FML v42,s66,v42
FML v43,s66,v43
M16 v[124:127],v[156:159],a[68:71],v[124:127]
FML v44,s66,v44
FML v45,s66,v45
M16 v[128:131],v[152:155],a[72:75],v[128:131]
FML v46,s66,v46
FML v47,s66,v47
M16 v[132:135],v[156:159],a[72:75],v[132:135]
CVT v40,v40,v41
CVT v41,v42,v43
M16 v[136:139],v[152:155],a[76:79],v[136:139]
CVT v42,v44,v45
CVT v43,v46,v47
M16 v[140:143],v[156:159],a[76:79],v[140:143]
s_mov_b32 s57, 8192
buffer_store_dwordx4 v[40:43], v15, s[16:19], s57 offen offset:128 sc1
v_lshlrev_b32 v252, 16, v193
v_and_b32 v193, 0xffff0000, v193
FML v234,v252,v248
FML v235,v193,v248
v_lshlrev_b32 v252, 16, v194
v_and_b32 v194, 0xffff0000, v194
FML v236,v252,v248
FML v237,v194,v248
v_lshlrev_b32 v252, 16, v195
v_and_b32 v195, 0xffff0000, v195
FML v238,v252,v248
FML v239,v195,v248
s_waitcnt vmcnt(19)
v_lshlrev_b32 v252, 16, v196
v_and_b32 v196, 0xffff0000, v196
buffer_load_dword v255, v5, s[4:7], s63 offen
s_add_u32 s63, s63, 16384
s_waitcnt lgkmcnt(6)
M16 v[80:83],v[160:163],a[80:83],v[80:83]
DTR v[144:145],v12 offset:18432
s_waitcnt lgkmcnt(5)
M16 v[84:87],v[164:167],a[80:83],v[84:87]
DTR v[146:147],v12 offset:18944
M16 v[88:91],v[160:163],a[84:87],v[88:91]
DTR v[148:149],v13 offset:18432
M16 v[92:95],v[164:167],a[84:87],v[92:95]
DTR v[150:151],v13 offset:18944
M16 v[96:99],v[160:163],a[88:91],v[96:99]
DTR v[152:153],v12 offset:18688
M16 v[100:103],v[164:167],a[88:91],v[100:103]
DTR v[154:155],v12 offset:19200
M16 v[104:107],v[160:163],a[92:95],v[104:107]
DTR v[156:157],v13 offset:18688
M16 v[108:111],v[164:167],a[92:95],v[108:111]
DTR v[158:159],v13 offset:19200
s_waitcnt lgkmcnt(10)
M16 v[112:115],v[168:171],a[80:83],v[112:115]
buffer_load_dwordx4 v8, s[12:15], s65 offen offset:2048 lds
s_waitcnt lgkmcnt(8)
M16 v[116:119],v[172:175],a[80:83],v[116:119]
FML v48,s66,v48
FML v49,s66,v49
M16 v[120:123],v[168:171],a[84:87],v[120:123]
FML v50,s66,v50
FML v51,s66,v51
M16 v[124:127],v[172:175],a[84:87],v[124:127]
FML v52,s66,v52
FML v53,s66,v53
M16 v[128:131],v[168:171],a[88:91],v[128:131]
FML v54,s66,v54
FML v55,s66,v55
M16 v[132:135],v[172:175],a[88:91],v[132:135]
CVT v48,v48,v49
CVT v49,v50,v51
M16 v[136:139],v[168:171],a[92:95],v[136:139]
CVT v50,v52,v53
CVT v51,v54,v55
M16 v[140:143],v[172:175],a[92:95],v[140:143]
s_mov_b32 s57, 0
buffer_store_dwordx4 v[48:51], v15, s[16:19], s57 offen offset:2048 sc1
v_fmac_f32 v232, v252, v249
v_fmac_f32 v233, v196, v249
v_lshlrev_b32 v252, 16, v197
v_and_b32 v197, 0xffff0000, v197
v_fmac_f32 v234, v252, v249
v_fmac_f32 v235, v197, v249
v_lshlrev_b32 v252, 16, v198
v_and_b32 v198, 0xffff0000, v198
v_fmac_f32 v236, v252, v249
v_fmac_f32 v237, v198, v249
v_lshlrev_b32 v252, 16, v199
v_and_b32 v199, 0xffff0000, v199
s_waitcnt lgkmcnt(6)
M16 v[80:83],v[144:147],a[96:99],v[80:83]
DTR v[160:161],v12 offset:19456
s_waitcnt lgkmcnt(5)
M16 v[84:87],v[148:151],a[96:99],v[84:87]
DTR v[162:163],v12 offset:19968
M16 v[88:91],v[144:147],a[100:103],v[88:91]
DTR v[164:165],v13 offset:19456
M16 v[92:95],v[148:151],a[100:103],v[92:95]
DTR v[166:167],v13 offset:19968
M16 v[96:99],v[144:147],a[104:107],v[96:99]
DTR v[168:169],v12 offset:19712
M16 v[100:103],v[148:151],a[104:107],v[100:103]
DTR v[170:171],v12 offset:20224
M16 v[104:107],v[144:147],a[108:111],v[104:107]
DTR v[172:173],v13 offset:19712
M16 v[108:111],v[148:151],a[108:111],v[108:111]
DTR v[174:175],v13 offset:20224
s_waitcnt lgkmcnt(10)
M16 v[112:115],v[152:155],a[96:99],v[112:115]
buffer_load_dwordx4 v9, s[12:15], s65 offen offset:3072 lds
s_waitcnt lgkmcnt(8)
M16 v[116:119],v[156:159],a[96:99],v[116:119]
FML v56,s66,v56
FML v57,s66,v57
M16 v[120:123],v[152:155],a[100:103],v[120:123]
FML v58,s66,v58
FML v59,s66,v59
M16 v[124:127],v[156:159],a[100:103],v[124:127]
FML v60,s66,v60
FML v61,s66,v61
M16 v[128:131],v[152:155],a[104:107],v[128:131]
FML v62,s66,v62
FML v63,s66,v63
M16 v[132:135],v[156:159],a[104:107],v[132:135]
CVT v56,v56,v57
CVT v57,v58,v59
M16 v[136:139],v[152:155],a[108:111],v[136:139]
CVT v58,v60,v61
CVT v59,v62,v63
M16 v[140:143],v[156:159],a[108:111],v[140:143]
s_mov_b32 s57, 0
buffer_store_dwordx4 v[56:59], v15, s[16:19], s57 offen offset:2176 sc1
v_fmac_f32 v238, v252, v249
v_fmac_f32 v239, v199, v249
s_waitcnt vmcnt(22)
v_lshlrev_b32 v252, 16, v200
v_and_b32 v200, 0xffff0000, v200
v_fmac_f32 v232, v252, v250
v_fmac_f32 v233, v200, v250
v_lshlrev_b32 v252, 16, v201
v_and_b32 v201, 0xffff0000, v201
v_fmac_f32 v234, v252, v250
v_fmac_f32 v235, v201, v250
v_lshlrev_b32 v252, 16, v202
v_and_b32 v202, 0xffff0000, v202
s_waitcnt lgkmcnt(0)
s_waitcnt vmcnt(19)
s_barrier
M16 v[80:83],v[160:163],a[112:115],v[80:83]
DTR v[144:145],v12 offset:32768
s_add_u32 m0, s55, 16384
M16 v[84:87],v[164:167],a[112:115],v[84:87]
DTR v[146:147],v12 offset:33280
s_mov_b32 s65, 1048832
M16 v[88:91],v[160:163],a[116:119],v[88:91]
DTR v[148:149],v13 offset:32768
M16 v[92:95],v[164:167],a[116:119],v[92:95]
DTR v[150:151],v13 offset:33280
M16 v[96:99],v[160:163],a[120:123],v[96:99]
DTR v[152:153],v12 offset:33024
M16 v[100:103],v[164:167],a[120:123],v[100:103]
DTR v[154:155],v12 offset:33536
M16 v[104:107],v[160:163],a[124:127],v[104:107]
DTR v[156:157],v13 offset:33024
M16 v[108:111],v[164:167],a[124:127],v[108:111]
DTR v[158:159],v13 offset:33536
M16 v[112:115],v[168:171],a[112:115],v[112:115]
buffer_load_dwordx4 v6, s[12:15], s65 offen offset:0 lds
M16 v[116:119],v[172:175],a[112:115],v[116:119]
FML v64,s66,v64
FML v65,s66,v65
M16 v[120:123],v[168:171],a[116:119],v[120:123]
FML v66,s66,v66
FML v67,s66,v67
M16 v[124:127],v[172:175],a[116:119],v[124:127]
FML v68,s66,v68
FML v69,s66,v69
M16 v[128:131],v[168:171],a[120:123],v[128:131]
FML v70,s66,v70
FML v71,s66,v71
M16 v[132:135],v[172:175],a[120:123],v[132:135]
CVT v64,v64,v65
CVT v65,v66,v67
M16 v[136:139],v[168:171],a[124:127],v[136:139]
CVT v66,v68,v69
CVT v67,v70,v71
M16 v[140:143],v[172:175],a[124:127],v[140:143]
s_mov_b32 s57, 8192
buffer_store_dwordx4 v[64:67], v15, s[16:19], s57 offen offset:2048 sc1
v_fmac_f32 v236, v252, v250
v_fmac_f32 v237, v202, v250
v_lshlrev_b32 v252, 16, v203
v_and_b32 v203, 0xffff0000, v203
v_fmac_f32 v238, v252, v250
v_fmac_f32 v239, v203, v250
v_lshlrev_b32 v252, 16, v204
v_and_b32 v204, 0xffff0000, v204
v_fmac_f32 v232, v252, v251
v_fmac_f32 v233, v204, v251
v_lshlrev_b32 v252, 16, v205
v_and_b32 v205, 0xffff0000, v205
s_waitcnt lgkmcnt(6)
M16 v[80:83],v[144:147],a[128:131],v[80:83]
DTR v[160:161],v12 offset:33792
s_waitcnt lgkmcnt(5)
M16 v[84:87],v[148:151],a[128:131],v[84:87]
DTR v[162:163],v12 offset:34304
M16 v[88:91],v[144:147],a[132:135],v[88:91]
DTR v[164:165],v13 offset:33792
M16 v[92:95],v[148:151],a[132:135],v[92:95]
DTR v[166:167],v13 offset:34304
M16 v[96:99],v[144:147],a[136:139],v[96:99]
DTR v[168:169],v12 offset:34048
M16 v[100:103],v[148:151],a[136:139],v[100:103]
DTR v[170:171],v12 offset:34560
M16 v[104:107],v[144:147],a[140:143],v[104:107]
DTR v[172:173],v13 offset:34048
M16 v[108:111],v[148:151],a[140:143],v[108:111]
DTR v[174:175],v13 offset:34560
s_waitcnt lgkmcnt(10)
M16 v[112:115],v[152:155],a[128:131],v[112:115]
buffer_load_dwordx4 v7, s[12:15], s65 offen offset:1024 lds
s_waitcnt lgkmcnt(8)
M16 v[116:119],v[156:159],a[128:131],v[116:119]
FML v72,s66,v72
FML v73,s66,v73
M16 v[120:123],v[152:155],a[132:135],v[120:123]
FML v74,s66,v74
FML v75,s66,v75
M16 v[124:127],v[156:159],a[132:135],v[124:127]
FML v76,s66,v76
FML v77,s66,v77
M16 v[128:131],v[152:155],a[136:139],v[128:131]
FML v78,s66,v78
FML v79,s66,v79
M16 v[132:135],v[156:159],a[136:139],v[132:135]
CVT v72,v72,v73
CVT v73,v74,v75
M16 v[136:139],v[152:155],a[140:143],v[136:139]
CVT v74,v76,v77
CVT v75,v78,v79
M16 v[140:143],v[156:159],a[140:143],v[140:143]
s_mov_b32 s57, 8192
buffer_store_dwordx4 v[72:75], v15, s[16:19], s57 offen offset:2176 sc1
v_fmac_f32 v234, v252, v251
v_fmac_f32 v235, v205, v251
v_lshlrev_b32 v252, 16, v206
v_and_b32 v206, 0xffff0000, v206
v_fmac_f32 v236, v252, v251
v_fmac_f32 v237, v206, v251
v_lshlrev_b32 v252, 16, v207
v_and_b32 v207, 0xffff0000, v207
v_fmac_f32 v238, v252, v251
v_fmac_f32 v239, v207, v251
s_waitcnt vmcnt(22)
v_lshlrev_b32 v252, 16, v208
v_and_b32 v208, 0xffff0000, v208
s_waitcnt lgkmcnt(6)
M16 v[80:83],v[160:163],a[144:147],v[80:83]
DTR v[144:145],v12 offset:34816
s_waitcnt lgkmcnt(5)
M16 v[84:87],v[164:167],a[144:147],v[84:87]
DTR v[146:147],v12 offset:35328
M16 v[88:91],v[160:163],a[148:151],v[88:91]
DTR v[148:149],v13 offset:34816
M16 v[92:95],v[164:167],a[148:151],v[92:95]
DTR v[150:151],v13 offset:35328
M16 v[96:99],v[160:163],a[152:155],v[96:99]
DTR v[152:153],v12 offset:35072
M16 v[100:103],v[164:167],a[152:155],v[100:103]
DTR v[154:155],v12 offset:35584
M16 v[104:107],v[160:163],a[156:159],v[104:107]
DTR v[156:157],v13 offset:35072
M16 v[108:111],v[164:167],a[156:159],v[108:111]
DTR v[158:159],v13 offset:35584
s_waitcnt lgkmcnt(10)
M16 v[112:115],v[168:171],a[144:147],v[112:115]
buffer_load_dwordx4 v8, s[12:15], s65 offen offset:2048 lds
s_waitcnt lgkmcnt(8)
M16 v[116:119],v[172:175],a[144:147],v[116:119]
FML v240,v252,v248
FML v241,v208,v248
M16 v[120:123],v[168:171],a[148:151],v[120:123]
v_lshlrev_b32 v252, 16, v209
v_and_b32 v209, 0xffff0000, v209
M16 v[124:127],v[172:175],a[148:151],v[124:127]
FML v242,v252,v248
FML v243,v209,v248
M16 v[128:131],v[168:171],a[152:155],v[128:131]
v_lshlrev_b32 v252, 16, v210
v_and_b32 v210, 0xffff0000, v210
M16 v[132:135],v[172:175],a[152:155],v[132:135]
FML v244,v252,v248
FML v245,v210,v248
M16 v[136:139],v[168:171],a[156:159],v[136:139]
v_lshlrev_b32 v252, 16, v211
v_and_b32 v211, 0xffff0000, v211
M16 v[140:143],v[172:175],a[156:159],v[140:143]
s_waitcnt lgkmcnt(6)
M16 v[80:83],v[144:147],a[160:163],v[80:83]
DTR v[160:161],v12 offset:35840
s_waitcnt lgkmcnt(5)
M16 v[84:87],v[148:151],a[160:163],v[84:87]
DTR v[162:163],v12 offset:36352
M16 v[88:91],v[144:147],a[164:167],v[88:91]
DTR v[164:165],v13 offset:35840
M16 v[92:95],v[148:151],a[164:167],v[92:95]
DTR v[166:167],v13 offset:36352
M16 v[96:99],v[144:147],a[168:171],v[96:99]
DTR v[168:169],v12 offset:36096
M16 v[100:103],v[148:151],a[168:171],v[100:103]
DTR v[170:171],v12 offset:36608
M16 v[104:107],v[144:147],a[172:175],v[104:107]
DTR v[172:173],v13 offset:36096
M16 v[108:111],v[148:151],a[172:175],v[108:111]
DTR v[174:175],v13 offset:36608
s_waitcnt lgkmcnt(10)
M16 v[112:115],v[152:155],a[160:163],v[112:115]
buffer_load_dwordx4 v9, s[12:15], s65 offen offset:3072 lds
s_waitcnt lgkmcnt(8)
M16 v[116:119],v[156:159],a[160:163],v[116:119]
FML v246,v252,v248
FML v247,v211,v248
M16 v[120:123],v[152:155],a[164:167],v[120:123]
s_waitcnt vmcnt(22)
v_lshlrev_b32 v252, 16, v212
v_and_b32 v212, 0xffff0000, v212
M16 v[124:127],v[156:159],a[164:167],v[124:127]
v_fmac_f32 v240, v252, v249
v_fmac_f32 v241, v212, v249
M16 v[128:131],v[152:155],a[168:171],v[128:131]
v_lshlrev_b32 v252, 16, v213
v_and_b32 v213, 0xffff0000, v213
M16 v[132:135],v[156:159],a[168:171],v[132:135]
v_fmac_f32 v242, v252, v249
v_fmac_f32 v243, v213, v249
M16 v[136:139],v[152:155],a[172:175],v[136:139]
v_lshlrev_b32 v252, 16, v214
v_and_b32 v214, 0xffff0000, v214
M16 v[140:143],v[156:159],a[172:175],v[140:143]
s_waitcnt lgkmcnt(0)
s_waitcnt vmcnt(16)
s_barrier
M16 v[80:83],v[160:163],a[176:179],v[80:83]
DTR v[144:145],v12 offset:49152
s_add_u32 m0, s55, 32768
M16 v[84:87],v[164:167],a[176:179],v[84:87]
DTR v[146:147],v12 offset:49664
s_mov_b32 s65, 2097408
M16 v[88:91],v[160:163],a[180:183],v[88:91]
DTR v[148:149],v13 offset:49152
M16 v[92:95],v[164:167],a[180:183],v[92:95]
DTR v[150:151],v13 offset:49664
M16 v[96:99],v[160:163],a[184:187],v[96:99]
DTR v[152:153],v12 offset:49408
M16 v[100:103],v[164:167],a[184:187],v[100:103]
DTR v[154:155],v12 offset:49920
M16 v[104:107],v[160:163],a[188:191],v[104:107]
DTR v[156:157],v13 offset:49408
M16 v[108:111],v[164:167],a[188:191],v[108:111]
DTR v[158:159],v13 offset:49920
M16 v[112:115],v[168:171],a[176:179],v[112:115]
buffer_load_dwordx4 v6, s[12:15], s65 offen offset:0 lds
M16 v[116:119],v[172:175],a[176:179],v[116:119]
v_fmac_f32 v244, v252, v249
v_fmac_f32 v245, v214, v249
M16 v[120:123],v[168:171],a[180:183],v[120:123]
v_lshlrev_b32 v252, 16, v215
v_and_b32 v215, 0xffff0000, v215
M16 v[124:127],v[172:175],a[180:183],v[124:127]
v_fmac_f32 v246, v252, v249
v_fmac_f32 v247, v215, v249
M16 v[128:131],v[168:171],a[184:187],v[128:131]
v_lshlrev_b32 v252, 16, v216
v_and_b32 v216, 0xffff0000, v216
M16 v[132:135],v[172:175],a[184:187],v[132:135]
v_fmac_f32 v240, v252, v250
v_fmac_f32 v241, v216, v250
M16 v[136:139],v[168:171],a[188:191],v[136:139]
v_lshlrev_b32 v252, 16, v217
M16 v[140:143],v[172:175],a[188:191],v[140:143]
v_and_b32 v217, 0xffff0000, v217
s_waitcnt lgkmcnt(6)
M16 v[80:83],v[144:147],a[192:195],v[80:83]
DTR v[160:161],v12 offset:50176
s_waitcnt lgkmcnt(5)
M16 v[84:87],v[148:151],a[192:195],v[84:87]
DTR v[162:163],v12 offset:50688
M16 v[88:91],v[144:147],a[196:199],v[88:91]
DTR v[164:165],v13 offset:50176
M16 v[92:95],v[148:151],a[196:199],v[92:95]
DTR v[166:167],v13 offset:50688
M16 v[96:99],v[144:147],a[200:203],v[96:99]
DTR v[168:169],v12 offset:50432
M16 v[100:103],v[148:151],a[200:203],v[100:103]
DTR v[170:171],v12 offset:50944
M16 v[104:107],v[144:147],a[204:207],v[104:107]
DTR v[172:173],v13 offset:50432
M16 v[108:111],v[148:151],a[204:207],v[108:111]
DTR v[174:175],v13 offset:50944
s_waitcnt lgkmcnt(10)
M16 v[112:115],v[152:155],a[192:195],v[112:115]
buffer_load_dwordx4 v7, s[12:15], s65 offen offset:1024 lds
s_waitcnt lgkmcnt(8)
M16 v[116:119],v[156:159],a[192:195],v[116:119]
v_fmac_f32 v242, v252, v250
v_fmac_f32 v243, v217, v250
M16 v[120:123],v[152:155],a[196:199],v[120:123]
v_lshlrev_b32 v252, 16, v218
v_and_b32 v218, 0xffff0000, v218
M16 v[124:127],v[156:159],a[196:199],v[124:127]
v_fmac_f32 v244, v252, v250
v_fmac_f32 v245, v218, v250
M16 v[128:131],v[152:155],a[200:203],v[128:131]
v_lshlrev_b32 v252, 16, v219
v_and_b32 v219, 0xffff0000, v219
M16 v[132:135],v[156:159],a[200:203],v[132:135]
v_fmac_f32 v246, v252, v250
v_fmac_f32 v247, v219, v250
M16 v[136:139],v[152:155],a[204:207],v[136:139]
v_lshlrev_b32 v252, 16, v220
v_and_b32 v220, 0xffff0000, v220
M16 v[140:143],v[156:159],a[204:207],v[140:143]
s_waitcnt vmcnt(12)
buffer_load_dword v255, v5, s[4:7], s63 offen
s_add_u32 s63, s63, 16384
s_waitcnt lgkmcnt(6)
M16 v[80:83],v[160:163],a[208:211],v[80:83]
DTR v[144:145],v12 offset:51200
s_waitcnt lgkmcnt(5)
M16 v[84:87],v[164:167],a[208:211],v[84:87]
DTR v[146:147],v12 offset:51712
M16 v[88:91],v[160:163],a[212:215],v[88:91]
DTR v[148:149],v13 offset:51200
M16 v[92:95],v[164:167],a[212:215],v[92:95]
DTR v[150:151],v13 offset:51712
M16 v[96:99],v[160:163],a[216:219],v[96:99]
DTR v[152:153],v12 offset:51456
M16 v[100:103],v[164:167],a[216:219],v[100:103]
DTR v[154:155],v12 offset:51968
M16 v[104:107],v[160:163],a[220:223],v[104:107]
DTR v[156:157],v13 offset:51456
M16 v[108:111],v[164:167],a[220:223],v[108:111]
DTR v[158:159],v13 offset:51968
s_waitcnt lgkmcnt(10)
M16 v[112:115],v[168:171],a[208:211],v[112:115]
buffer_load_dwordx4 v8, s[12:15], s65 offen offset:2048 lds
s_waitcnt lgkmcnt(8)
M16 v[116:119],v[172:175],a[208:211],v[116:119]
v_fmac_f32 v240, v252, v251
v_fmac_f32 v241, v220, v251
M16 v[120:123],v[168:171],a[212:215],v[120:123]
v_lshlrev_b32 v252, 16, v221
v_and_b32 v221, 0xffff0000, v221
M16 v[124:127],v[172:175],a[212:215],v[124:127]
v_fmac_f32 v242, v252, v251
v_fmac_f32 v243, v221, v251
M16 v[128:131],v[168:171],a[216:219],v[128:131]
v_lshlrev_b32 v252, 16, v222
v_and_b32 v222, 0xffff0000, v222
M16 v[132:135],v[172:175],a[216:219],v[132:135]
v_fmac_f32 v244, v252, v251
v_fmac_f32 v245, v222, v251
M16 v[136:139],v[168:171],a[220:223],v[136:139]
v_lshlrev_b32 v252, 16, v223
v_and_b32 v223, 0xffff0000, v223
M16 v[140:143],v[172:175],a[220:223],v[140:143]
v_fmac_f32 v246, v252, v251
v_fmac_f32 v247, v223, v251
s_waitcnt lgkmcnt(6)
M16 v[80:83],v[144:147],a[224:227],v[80:83]
DTR v[160:161],v12 offset:52224
s_waitcnt lgkmcnt(5)
M16 v[84:87],v[148:151],a[224:227],v[84:87]
DTR v[162:163],v12 offset:52736
M16 v[88:91],v[144:147],a[228:231],v[88:91]
DTR v[164:165],v13 offset:52224
M16 v[92:95],v[148:151],a[228:231],v[92:95]
DTR v[166:167],v13 offset:52736
M16 v[96:99],v[144:147],a[232:235],v[96:99]
DTR v[168:169],v12 offset:52480
M16 v[100:103],v[148:151],a[232:235],v[100:103]
DTR v[170:171],v12 offset:52992
M16 v[104:107],v[144:147],a[236:239],v[104:107]
DTR v[172:173],v13 offset:52480
M16 v[108:111],v[148:151],a[236:239],v[108:111]
DTR v[174:175],v13 offset:52992
s_waitcnt lgkmcnt(10)
M16 v[112:115],v[152:155],a[224:227],v[112:115]
buffer_load_dwordx4 v9, s[12:15], s65 offen offset:3072 lds
s_waitcnt lgkmcnt(8)
M16 v[116:119],v[156:159],a[224:227],v[116:119]
v_mul_u32_u24 v14, 96, v1
s_mul_i32 s56, s3, 6144
M16 v[120:123],v[152:155],a[228:231],v[120:123]
s_add_u32 s56, s56, 65536
v_add_u32 v14, s56, v14
M16 v[124:127],v[156:159],a[228:231],v[124:127]
ds_write_b128 v14, v[224:227] offset:0
ds_write_b128 v14, v[228:231] offset:16
M16 v[128:131],v[152:155],a[232:235],v[128:131]
ds_write_b128 v14, v[232:235] offset:32
ds_write_b128 v14, v[236:239] offset:48
M16 v[132:135],v[156:159],a[232:235],v[132:135]
ds_write_b128 v14, v[240:243] offset:64
M16 v[136:139],v[152:155],a[236:239],v[136:139]
ds_write_b128 v14, v[244:247] offset:80
M16 v[140:143],v[156:159],a[236:239],v[140:143]
s_waitcnt lgkmcnt(0)
s_waitcnt vmcnt(12)
s_barrier
M16 v[80:83],v[160:163],a[240:243],v[80:83]
DTR v[144:145],v12 offset:0
s_add_u32 m0, s55, 49152
M16 v[84:87],v[164:167],a[240:243],v[84:87]
DTR v[146:147],v12 offset:512
s_mov_b32 s65, 3145984
M16 v[88:91],v[160:163],a[244:247],v[88:91]
DTR v[148:149],v13 offset:0
M16 v[92:95],v[164:167],a[244:247],v[92:95]
DTR v[150:151],v13 offset:512
M16 v[96:99],v[160:163],a[248:251],v[96:99]
DTR v[152:153],v12 offset:256
M16 v[100:103],v[164:167],a[248:251],v[100:103]
DTR v[154:155],v12 offset:768
M16 v[104:107],v[160:163],a[252:255],v[104:107]
DTR v[156:157],v13 offset:256
M16 v[108:111],v[164:167],a[252:255],v[108:111]
DTR v[158:159],v13 offset:768
M16 v[112:115],v[168:171],a[240:243],v[112:115]
buffer_load_dwordx4 v6, s[12:15], s65 offen offset:0 lds
M16 v[116:119],v[172:175],a[240:243],v[116:119]
v_lshrrev_b32 v14, 3, v1
v_mul_u32_u24 v14, 96, v14
M16 v[120:123],v[168:171],a[244:247],v[120:123]
v_lshl_add_u32 v14, v0, 2, v14
s_lshl_b32 s56, s3, 5
M16 v[124:127],v[172:175],a[244:247],v[124:127]
s_add_u32 s56, s56, 65536
v_add_u32 v14, s56, v14
M16 v[128:131],v[168:171],a[248:251],v[128:131]
ds_read_b32 v176, v14 offset:0
ds_read_b32 v177, v14 offset:768
M16 v[132:135],v[172:175],a[248:251],v[132:135]
ds_read_b32 v178, v14 offset:1536
ds_read_b32 v179, v14 offset:2304
M16 v[136:139],v[168:171],a[252:255],v[136:139]
ds_read_b32 v180, v14 offset:3072
ds_read_b32 v181, v14 offset:3840
M16 v[140:143],v[172:175],a[252:255],v[140:143]
ds_read_b32 v182, v14 offset:4608
ds_read_b32 v183, v14 offset:5376
ds_read_b32 v184, v14 offset:6144
ds_read_b32 v185, v14 offset:6912
ds_read_b32 v186, v14 offset:7680
ds_read_b32 v187, v14 offset:8448
ds_read_b32 v188, v14 offset:9216
ds_read_b32 v189, v14 offset:9984
ds_read_b32 v190, v14 offset:10752
s_waitcnt lgkmcnt(15)
M16 v[16:19],v[144:147],a[0:3],0
DTR v[160:161],v12 offset:1024
s_waitcnt lgkmcnt(15)
M16 v[20:23],v[148:151],a[0:3],0
DTR v[162:163],v12 offset:1536
M16 v[24:27],v[144:147],a[4:7],0
DTR v[164:165],v13 offset:1024
M16 v[28:31],v[148:151],a[4:7],0
DTR v[166:167],v13 offset:1536
M16 v[32:35],v[144:147],a[8:11],0
DTR v[168:169],v12 offset:1280
M16 v[36:39],v[148:151],a[8:11],0
DTR v[170:171],v12 offset:1792
M16 v[40:43],v[144:147],a[12:15],0
DTR v[172:173],v13 offset:1280
M16 v[44:47],v[148:151],a[12:15],0
DTR v[174:175],v13 offset:1792
s_waitcnt lgkmcnt(15)
M16 v[48:51],v[152:155],a[0:3],0
buffer_load_dwordx4 v7, s[12:15], s65 offen offset:1024 lds
s_waitcnt lgkmcnt(15)
M16 v[52:55],v[156:159],a[0:3],0
ds_read_b32 v191, v14 offset:11520
ds_read_b32 v192, v14 offset:12288
M16 v[56:59],v[152:155],a[4:7],0
ds_read_b32 v193, v14 offset:13056
ds_read_b32 v194, v14 offset:13824
M16 v[60:63],v[156:159],a[4:7],0
ds_read_b32 v195, v14 offset:14592
ds_read_b32 v196, v14 offset:15360
M16 v[64:67],v[152:155],a[8:11],0
ds_read_b32 v197, v14 offset:16128
ds_read_b32 v198, v14 offset:16896
M16 v[68:71],v[156:159],a[8:11],0
ds_read_b32 v199, v14 offset:17664
ds_read_b32 v200, v14 offset:18432
M16 v[72:75],v[152:155],a[12:15],0
ds_read_b32 v201, v14 offset:19200
ds_read_b32 v202, v14 offset:19968
M16 v[76:79],v[156:159],a[12:15],0
ds_read_b32 v203, v14 offset:20736
ds_read_b32 v204, v14 offset:21504
ds_read_b32 v205, v14 offset:22272
ds_read_b32 v206, v14 offset:23040
ds_read_b32 v207, v14 offset:23808
s_waitcnt lgkmcnt(15)
M16 v[16:19],v[160:163],a[16:19],v[16:19]
DTR v[144:145],v12 offset:2048
s_waitcnt lgkmcnt(15)
M16 v[20:23],v[164:167],a[16:19],v[20:23]
DTR v[146:147],v12 offset:2560
M16 v[24:27],v[160:163],a[20:23],v[24:27]
DTR v[148:149],v13 offset:2048
M16 v[28:31],v[164:167],a[20:23],v[28:31]
DTR v[150:151],v13 offset:2560
M16 v[32:35],v[160:163],a[24:27],v[32:35]
DTR v[152:153],v12 offset:2304
M16 v[36:39],v[164:167],a[24:27],v[36:39]
DTR v[154:155],v12 offset:2816
M16 v[40:43],v[160:163],a[28:31],v[40:43]
DTR v[156:157],v13 offset:2304
M16 v[44:47],v[164:167],a[28:31],v[44:47]
DTR v[158:159],v13 offset:2816
s_waitcnt lgkmcnt(15)
M16 v[48:51],v[168:171],a[16:19],v[48:51]
buffer_load_dwordx4 v8, s[12:15], s65 offen offset:2048 lds
s_waitcnt lgkmcnt(15)
M16 v[52:55],v[172:175],a[16:19],v[52:55]
FML v80,s66,v80
FML v81,s66,v81
M16 v[56:59],v[168:171],a[20:23],v[56:59]
FML v82,s66,v82
FML v83,s66,v83
M16 v[60:63],v[172:175],a[20:23],v[60:63]
FML v84,s66,v84
FML v85,s66,v85
M16 v[64:67],v[168:171],a[24:27],v[64:67]
FML v86,s66,v86
FML v87,s66,v87
M16 v[68:71],v[172:175],a[24:27],v[68:71]
CVT v80,v80,v81
CVT v81,v82,v83
M16 v[72:75],v[168:171],a[28:31],v[72:75]
CVT v82,v84,v85
CVT v83,v86,v87
M16 v[76:79],v[172:175],a[28:31],v[76:79]
s_mov_b32 s57, 4096
buffer_store_dwordx4 v[80:83], v15, s[16:19], s57 offen offset:0 sc1
s_waitcnt lgkmcnt(6)
M16 v[16:19],v[144:147],a[32:35],v[16:19]
DTR v[160:161],v12 offset:3072
s_waitcnt lgkmcnt(5)
M16 v[20:23],v[148:151],a[32:35],v[20:23]
DTR v[162:163],v12 offset:3584
M16 v[24:27],v[144:147],a[36:39],v[24:27]
DTR v[164:165],v13 offset:3072
M16 v[28:31],v[148:151],a[36:39],v[28:31]
DTR v[166:167],v13 offset:3584
M16 v[32:35],v[144:147],a[40:43],v[32:35]
DTR v[168:169],v12 offset:3328
M16 v[36:39],v[148:151],a[40:43],v[36:39]
DTR v[170:171],v12 offset:3840
M16 v[40:43],v[144:147],a[44:47],v[40:43]
DTR v[172:173],v13 offset:3328
M16 v[44:47],v[148:151],a[44:47],v[44:47]
DTR v[174:175],v13 offset:3840
s_waitcnt lgkmcnt(10)
M16 v[48:51],v[152:155],a[32:35],v[48:51]
buffer_load_dwordx4 v9, s[12:15], s65 offen offset:3072 lds
s_waitcnt lgkmcnt(8)
M16 v[52:55],v[156:159],a[32:35],v[52:55]
FML v88,s66,v88
FML v89,s66,v89
M16 v[56:59],v[152:155],a[36:39],v[56:59]
FML v90,s66,v90
FML v91,s66,v91
M16 v[60:63],v[156:159],a[36:39],v[60:63]
FML v92,s66,v92
FML v93,s66,v93
M16 v[64:67],v[152:155],a[40:43],v[64:67]
FML v94,s66,v94
FML v95,s66,v95
M16 v[68:71],v[156:159],a[40:43],v[68:71]
CVT v88,v88,v89
CVT v89,v90,v91
M16 v[72:75],v[152:155],a[44:47],v[72:75]
CVT v90,v92,v93
CVT v91,v94,v95
M16 v[76:79],v[156:159],a[44:47],v[76:79]
s_mov_b32 s57, 4096
buffer_store_dwordx4 v[88:91], v15, s[16:19], s57 offen offset:128 sc1
FAD v176,v176,v177
FAD v192,v192,v193
FAD v176,v176,v178
FAD v192,v192,v194
FAD v176,v176,v179
FAD v192,v192,v195
FAD v176,v176,v180
FAD v192,v192,v196
FAD v176,v176,v181
FAD v192,v192,v197
s_waitcnt lgkmcnt(0)
s_waitcnt vmcnt(11)
s_barrier
M16 v[16:19],v[160:163],a[48:51],v[16:19]
DTR v[144:145],v12 offset:16384
s_add_u32 m0, s55, 0
M16 v[20:23],v[164:167],a[48:51],v[20:23]
DTR v[146:147],v12 offset:16896
s_mov_b32 s65, 384
M16 v[24:27],v[160:163],a[52:55],v[24:27]
DTR v[148:149],v13 offset:16384
M16 v[28:31],v[164:167],a[52:55],v[28:31]
DTR v[150:151],v13 offset:16896
M16 v[32:35],v[160:163],a[56:59],v[32:35]
DTR v[152:153],v12 offset:16640
M16 v[36:39],v[164:167],a[56:59],v[36:39]
DTR v[154:155],v12 offset:17152
M16 v[40:43],v[160:163],a[60:63],v[40:43]
DTR v[156:157],v13 offset:16640
M16 v[44:47],v[164:167],a[60:63],v[44:47]
DTR v[158:159],v13 offset:17152
M16 v[48:51],v[168:171],a[48:51],v[48:51]
buffer_load_dwordx4 v6, s[12:15], s65 offen offset:0 lds
M16 v[52:55],v[172:175],a[48:51],v[52:55]
FML v96,s66,v96
FML v97,s66,v97
M16 v[56:59],v[168:171],a[52:55],v[56:59]
FML v98,s66,v98
FML v99,s66,v99
M16 v[60:63],v[172:175],a[52:55],v[60:63]
FML v100,s66,v100
FML v101,s66,v101
M16 v[64:67],v[168:171],a[56:59],v[64:67]
FML v102,s66,v102
FML v103,s66,v103
M16 v[68:71],v[172:175],a[56:59],v[68:71]
CVT v96,v96,v97
CVT v97,v98,v99
M16 v[72:75],v[168:171],a[60:63],v[72:75]
CVT v98,v100,v101
CVT v99,v102,v103
M16 v[76:79],v[172:175],a[60:63],v[76:79]
s_mov_b32 s57, 12288
buffer_store_dwordx4 v[96:99], v15, s[16:19], s57 offen offset:0 sc1
FAD v176,v176,v182
FAD v192,v192,v198
FAD v176,v176,v183
FAD v192,v192,v199
FAD v176,v176,v184
FAD v192,v192,v200
FAD v176,v176,v185
FAD v192,v192,v201
FAD v176,v176,v186
FAD v192,v192,v202
FAD v176,v176,v187
FAD v192,v192,v203
s_waitcnt lgkmcnt(6)
M16 v[16:19],v[144:147],a[64:67],v[16:19]
DTR v[160:161],v12 offset:17408
s_waitcnt lgkmcnt(5)
M16 v[20:23],v[148:151],a[64:67],v[20:23]
DTR v[162:163],v12 offset:17920
M16 v[24:27],v[144:147],a[68:71],v[24:27]
DTR v[164:165],v13 offset:17408
M16 v[28:31],v[148:151],a[68:71],v[28:31]
DTR v[166:167],v13 offset:17920
M16 v[32:35],v[144:147],a[72:75],v[32:35]
DTR v[168:169],v12 offset:17664
M16 v[36:39],v[148:151],a[72:75],v[36:39]
DTR v[170:171],v12 offset:18176
M16 v[40:43],v[144:147],a[76:79],v[40:43]
DTR v[172:173],v13 offset:17664
M16 v[44:47],v[148:151],a[76:79],v[44:47]
DTR v[174:175],v13 offset:18176
s_waitcnt lgkmcnt(10)
M16 v[48:51],v[152:155],a[64:67],v[48:51]
buffer_load_dwordx4 v7, s[12:15], s65 offen offset:1024 lds
s_waitcnt lgkmcnt(8)
M16 v[52:55],v[156:159],a[64:67],v[52:55]
FML v104,s66,v104
FML v105,s66,v105
M16 v[56:59],v[152:155],a[68:71],v[56:59]
FML v106,s66,v106
FML v107,s66,v107
M16 v[60:63],v[156:159],a[68:71],v[60:63]
FML v108,s66,v108
FML v109,s66,v109
M16 v[64:67],v[152:155],a[72:75],v[64:67]
FML v110,s66,v110
FML v111,s66,v111
M16 v[68:71],v[156:159],a[72:75],v[68:71]
CVT v104,v104,v105
CVT v105,v106,v107
M16 v[72:75],v[152:155],a[76:79],v[72:75]
CVT v106,v108,v109
CVT v107,v110,v111
M16 v[76:79],v[156:159],a[76:79],v[76:79]
s_mov_b32 s57, 12288
buffer_store_dwordx4 v[104:107], v15, s[16:19], s57 offen offset:128 sc1
FAD v176,v176,v188
FAD v192,v192,v204
FAD v176,v176,v189
FAD v192,v192,v205
FAD v176,v176,v190
FAD v192,v192,v206
FAD v176,v176,v191
FAD v192,v192,v207
FAD v176,v176,v192
s_mul_i32 s56, s61, 24576
s_lshl_b32 s57, s3, 13
s_add_u32 s56, s56, s57
s_lshl_b32 s57, s60, 8
s_add_u32 s56, s56, s57
s_cmp_eq_u32 s3, 3
s_cselect_b32 s56, 0x1000000, s56
v_lshlrev_b32 v14, 2, v1
buffer_store_dword v176, v14, s[28:31], s56 offen sc1
s_waitcnt lgkmcnt(6)
M16 v[16:19],v[160:163],a[80:83],v[16:19]
DTR v[144:145],v12 offset:18432
s_waitcnt lgkmcnt(5)
M16 v[20:23],v[164:167],a[80:83],v[20:23]
DTR v[146:147],v12 offset:18944
M16 v[24:27],v[160:163],a[84:87],v[24:27]
DTR v[148:149],v13 offset:18432
M16 v[28:31],v[164:167],a[84:87],v[28:31]
DTR v[150:151],v13 offset:18944
M16 v[32:35],v[160:163],a[88:91],v[32:35]
DTR v[152:153],v12 offset:18688
M16 v[36:39],v[164:167],a[88:91],v[36:39]
DTR v[154:155],v12 offset:19200
M16 v[40:43],v[160:163],a[92:95],v[40:43]
DTR v[156:157],v13 offset:18688
M16 v[44:47],v[164:167],a[92:95],v[44:47]
DTR v[158:159],v13 offset:19200
s_waitcnt lgkmcnt(10)
M16 v[48:51],v[168:171],a[80:83],v[48:51]
buffer_load_dwordx4 v8, s[12:15], s65 offen offset:2048 lds
s_waitcnt lgkmcnt(8)
M16 v[52:55],v[172:175],a[80:83],v[52:55]
FML v112,s66,v112
FML v113,s66,v113
M16 v[56:59],v[168:171],a[84:87],v[56:59]
FML v114,s66,v114
FML v115,s66,v115
M16 v[60:63],v[172:175],a[84:87],v[60:63]
FML v116,s66,v116
FML v117,s66,v117
M16 v[64:67],v[168:171],a[88:91],v[64:67]
FML v118,s66,v118
FML v119,s66,v119
M16 v[68:71],v[172:175],a[88:91],v[68:71]
CVT v112,v112,v113
CVT v113,v114,v115
M16 v[72:75],v[168:171],a[92:95],v[72:75]
CVT v114,v116,v117
CVT v115,v118,v119
M16 v[76:79],v[172:175],a[92:95],v[76:79]
s_mov_b32 s57, 4096
buffer_store_dwordx4 v[112:115], v15, s[16:19], s57 offen offset:2048 sc1
s_waitcnt vmcnt(15)
buffer_load_dword v255, v5, s[4:7], s63 offen
s_add_u32 s63, s63, 16384
s_waitcnt lgkmcnt(6)
M16 v[16:19],v[144:147],a[96:99],v[16:19]
DTR v[160:161],v12 offset:19456
s_waitcnt lgkmcnt(5)
M16 v[20:23],v[148:151],a[96:99],v[20:23]
DTR v[162:163],v12 offset:19968
M16 v[24:27],v[144:147],a[100:103],v[24:27]
DTR v[164:165],v13 offset:19456
M16 v[28:31],v[148:151],a[100:103],v[28:31]
DTR v[166:167],v13 offset:19968
M16 v[32:35],v[144:147],a[104:107],v[32:35]
DTR v[168:169],v12 offset:19712
M16 v[36:39],v[148:151],a[104:107],v[36:39]
DTR v[170:171],v12 offset:20224
M16 v[40:43],v[144:147],a[108:111],v[40:43]
DTR v[172:173],v13 offset:19712
M16 v[44:47],v[148:151],a[108:111],v[44:47]
DTR v[174:175],v13 offset:20224
s_waitcnt lgkmcnt(10)
M16 v[48:51],v[152:155],a[96:99],v[48:51]
buffer_load_dwordx4 v9, s[12:15], s65 offen offset:3072 lds
s_waitcnt lgkmcnt(8)
M16 v[52:55],v[156:159],a[96:99],v[52:55]
FML v120,s66,v120
FML v121,s66,v121
M16 v[56:59],v[152:155],a[100:103],v[56:59]
FML v122,s66,v122
FML v123,s66,v123
M16 v[60:63],v[156:159],a[100:103],v[60:63]
FML v124,s66,v124
FML v125,s66,v125
M16 v[64:67],v[152:155],a[104:107],v[64:67]
FML v126,s66,v126
FML v127,s66,v127
M16 v[68:71],v[156:159],a[104:107],v[68:71]
CVT v120,v120,v121
CVT v121,v122,v123
M16 v[72:75],v[152:155],a[108:111],v[72:75]
CVT v122,v124,v125
CVT v123,v126,v127
M16 v[76:79],v[156:159],a[108:111],v[76:79]
s_mov_b32 s57, 4096
buffer_store_dwordx4 v[120:123], v15, s[16:19], s57 offen offset:2176 sc1
s_waitcnt lgkmcnt(0)
s_waitcnt vmcnt(16)
s_barrier
M16 v[16:19],v[160:163],a[112:115],v[16:19]
DTR v[144:145],v12 offset:32768
s_add_u32 m0, s55, 16384
M16 v[20:23],v[164:167],a[112:115],v[20:23]
DTR v[146:147],v12 offset:33280
s_mov_b32 s65, 1048960
M16 v[24:27],v[160:163],a[116:119],v[24:27]
DTR v[148:149],v13 offset:32768
M16 v[28:31],v[164:167],a[116:119],v[28:31]
DTR v[150:151],v13 offset:33280
M16 v[32:35],v[160:163],a[120:123],v[32:35]
DTR v[152:153],v12 offset:33024
M16 v[36:39],v[164:167],a[120:123],v[36:39]
DTR v[154:155],v12 offset:33536
M16 v[40:43],v[160:163],a[124:127],v[40:43]
DTR v[156:157],v13 offset:33024
M16 v[44:47],v[164:167],a[124:127],v[44:47]
DTR v[158:159],v13 offset:33536
M16 v[48:51],v[168:171],a[112:115],v[48:51]
buffer_load_dwordx4 v6, s[12:15], s65 offen offset:0 lds
M16 v[52:55],v[172:175],a[112:115],v[52:55]
FML v128,s66,v128
FML v129,s66,v129
M16 v[56:59],v[168:171],a[116:119],v[56:59]
FML v130,s66,v130
FML v131,s66,v131
M16 v[60:63],v[172:175],a[116:119],v[60:63]
FML v132,s66,v132
FML v133,s66,v133
M16 v[64:67],v[168:171],a[120:123],v[64:67]
FML v134,s66,v134
FML v135,s66,v135
M16 v[68:71],v[172:175],a[120:123],v[68:71]
CVT v128,v128,v129
CVT v129,v130,v131
M16 v[72:75],v[168:171],a[124:127],v[72:75]
CVT v130,v132,v133
CVT v131,v134,v135
M16 v[76:79],v[172:175],a[124:127],v[76:79]
s_mov_b32 s57, 12288
buffer_store_dwordx4 v[128:131], v15, s[16:19], s57 offen offset:2048 sc1
s_waitcnt lgkmcnt(6)
M16 v[16:19],v[144:147],a[128:131],v[16:19]
DTR v[160:161],v12 offset:33792
s_waitcnt lgkmcnt(5)
M16 v[20:23],v[148:151],a[128:131],v[20:23]
DTR v[162:163],v12 offset:34304
M16 v[24:27],v[144:147],a[132:135],v[24:27]
DTR v[164:165],v13 offset:33792
M16 v[28:31],v[148:151],a[132:135],v[28:31]
DTR v[166:167],v13 offset:34304
M16 v[32:35],v[144:147],a[136:139],v[32:35]
DTR v[168:169],v12 offset:34048
M16 v[36:39],v[148:151],a[136:139],v[36:39]
DTR v[170:171],v12 offset:34560
M16 v[40:43],v[144:147],a[140:143],v[40:43]
DTR v[172:173],v13 offset:34048
M16 v[44:47],v[148:151],a[140:143],v[44:47]
DTR v[174:175],v13 offset:34560
s_waitcnt lgkmcnt(10)
M16 v[48:51],v[152:155],a[128:131],v[48:51]
buffer_load_dwordx4 v7, s[12:15], s65 offen offset:1024 lds
s_waitcnt lgkmcnt(8)
M16 v[52:55],v[156:159],a[128:131],v[52:55]
FML v136,s66,v136
FML v137,s66,v137
M16 v[56:59],v[152:155],a[132:135],v[56:59]
FML v138,s66,v138
FML v139,s66,v139
M16 v[60:63],v[156:159],a[132:135],v[60:63]
FML v140,s66,v140
FML v141,s66,v141
M16 v[64:67],v[152:155],a[136:139],v[64:67]
FML v142,s66,v142
FML v143,s66,v143
M16 v[68:71],v[156:159],a[136:139],v[68:71]
CVT v136,v136,v137
CVT v137,v138,v139
M16 v[72:75],v[152:155],a[140:143],v[72:75]
CVT v138,v140,v141
CVT v139,v142,v143
M16 v[76:79],v[156:159],a[140:143],v[76:79]
s_mov_b32 s57, 12288
buffer_store_dwordx4 v[136:139], v15, s[16:19], s57 offen offset:2176 sc1
s_waitcnt lgkmcnt(6)
M16 v[16:19],v[160:163],a[144:147],v[16:19]
DTR v[144:145],v12 offset:34816
s_waitcnt lgkmcnt(5)
M16 v[20:23],v[164:167],a[144:147],v[20:23]
DTR v[146:147],v12 offset:35328
M16 v[24:27],v[160:163],a[148:151],v[24:27]
DTR v[148:149],v13 offset:34816
M16 v[28:31],v[164:167],a[148:151],v[28:31]
DTR v[150:151],v13 offset:35328
M16 v[32:35],v[160:163],a[152:155],v[32:35]
DTR v[152:153],v12 offset:35072
M16 v[36:39],v[164:167],a[152:155],v[36:39]
DTR v[154:155],v12 offset:35584
M16 v[40:43],v[160:163],a[156:159],v[40:43]
DTR v[156:157],v13 offset:35072
M16 v[44:47],v[164:167],a[156:159],v[44:47]
DTR v[158:159],v13 offset:35584
s_waitcnt lgkmcnt(10)
M16 v[48:51],v[168:171],a[144:147],v[48:51]
buffer_load_dwordx4 v8, s[12:15], s65 offen offset:2048 lds
s_waitcnt lgkmcnt(8)
M16 v[52:55],v[172:175],a[144:147],v[52:55]
M16 v[56:59],v[168:171],a[148:151],v[56:59]
M16 v[60:63],v[172:175],a[148:151],v[60:63]
M16 v[64:67],v[168:171],a[152:155],v[64:67]
M16 v[68:71],v[172:175],a[152:155],v[68:71]
M16 v[72:75],v[168:171],a[156:159],v[72:75]
M16 v[76:79],v[172:175],a[156:159],v[76:79]
s_waitcnt lgkmcnt(6)
M16 v[16:19],v[144:147],a[160:163],v[16:19]
DTR v[160:161],v12 offset:35840
s_waitcnt lgkmcnt(5)
M16 v[20:23],v[148:151],a[160:163],v[20:23]
DTR v[162:163],v12 offset:36352
M16 v[24:27],v[144:147],a[164:167],v[24:27]
DTR v[164:165],v13 offset:35840
M16 v[28:31],v[148:151],a[164:167],v[28:31]
DTR v[166:167],v13 offset:36352
M16 v[32:35],v[144:147],a[168:171],v[32:35]
DTR v[168:169],v12 offset:36096
M16 v[36:39],v[148:151],a[168:171],v[36:39]
DTR v[170:171],v12 offset:36608
M16 v[40:43],v[144:147],a[172:175],v[40:43]
DTR v[172:173],v13 offset:36096
M16 v[44:47],v[148:151],a[172:175],v[44:47]
DTR v[174:175],v13 offset:36608
s_waitcnt lgkmcnt(10)
M16 v[48:51],v[152:155],a[160:163],v[48:51]
buffer_load_dwordx4 v9, s[12:15], s65 offen offset:3072 lds
s_waitcnt lgkmcnt(8)
M16 v[52:55],v[156:159],a[160:163],v[52:55]
M16 v[56:59],v[152:155],a[164:167],v[56:59]
M16 v[60:63],v[156:159],a[164:167],v[60:63]
M16 v[64:67],v[152:155],a[168:171],v[64:67]
M16 v[68:71],v[156:159],a[168:171],v[68:71]
M16 v[72:75],v[152:155],a[172:175],v[72:75]
M16 v[76:79],v[156:159],a[172:175],v[76:79]
s_waitcnt lgkmcnt(0)
s_waitcnt vmcnt(11)
s_barrier
M16 v[16:19],v[160:163],a[176:179],v[16:19]
DTR v[144:145],v12 offset:49152
s_add_u32 m0, s55, 32768
M16 v[20:23],v[164:167],a[176:179],v[20:23]
DTR v[146:147],v12 offset:49664
M16 v[24:27],v[160:163],a[180:183],v[24:27]
DTR v[148:149],v13 offset:49152
s_mov_b32 s65, 2097536
M16 v[28:31],v[164:167],a[180:183],v[28:31]
DTR v[150:151],v13 offset:49664
M16 v[32:35],v[160:163],a[184:187],v[32:35]
DTR v[152:153],v12 offset:49408
M16 v[36:39],v[164:167],a[184:187],v[36:39]
DTR v[154:155],v12 offset:49920
M16 v[40:43],v[160:163],a[188:191],v[40:43]
DTR v[156:157],v13 offset:49408
M16 v[44:47],v[164:167],a[188:191],v[44:47]
DTR v[158:159],v13 offset:49920
M16 v[48:51],v[168:171],a[176:179],v[48:51]
buffer_load_dwordx4 v6, s[12:15], s65 offen offset:0 lds
M16 v[52:55],v[172:175],a[176:179],v[52:55]
M16 v[56:59],v[168:171],a[180:183],v[56:59]
buffer_atomic_add v253, v254, s[36:39], 0 offen sc0 sc1
M16 v[60:63],v[172:175],a[180:183],v[60:63]
M16 v[64:67],v[168:171],a[184:187],v[64:67]
M16 v[68:71],v[172:175],a[184:187],v[68:71]
M16 v[72:75],v[168:171],a[188:191],v[72:75]
M16 v[76:79],v[172:175],a[188:191],v[76:79]
s_waitcnt lgkmcnt(6)
M16 v[16:19],v[144:147],a[192:195],v[16:19]
DTR v[160:161],v12 offset:50176
s_waitcnt lgkmcnt(5)
M16 v[20:23],v[148:151],a[192:195],v[20:23]
DTR v[162:163],v12 offset:50688
M16 v[24:27],v[144:147],a[196:199],v[24:27]
DTR v[164:165],v13 offset:50176
M16 v[28:31],v[148:151],a[196:199],v[28:31]
DTR v[166:167],v13 offset:50688
M16 v[32:35],v[144:147],a[200:203],v[32:35]
DTR v[168:169],v12 offset:50432
M16 v[36:39],v[148:151],a[200:203],v[36:39]
DTR v[170:171],v12 offset:50944
M16 v[40:43],v[144:147],a[204:207],v[40:43]
DTR v[172:173],v13 offset:50432
M16 v[44:47],v[148:151],a[204:207],v[44:47]
DTR v[174:175],v13 offset:50944
s_waitcnt lgkmcnt(10)
M16 v[48:51],v[152:155],a[192:195],v[48:51]
buffer_load_dwordx4 v7, s[12:15], s65 offen offset:1024 lds
s_waitcnt lgkmcnt(8)
M16 v[52:55],v[156:159],a[192:195],v[52:55]
M16 v[56:59],v[152:155],a[196:199],v[56:59]
M16 v[60:63],v[156:159],a[196:199],v[60:63]
M16 v[64:67],v[152:155],a[200:203],v[64:67]
M16 v[68:71],v[156:159],a[200:203],v[68:71]
M16 v[72:75],v[152:155],a[204:207],v[72:75]
M16 v[76:79],v[156:159],a[204:207],v[76:79]
s_waitcnt lgkmcnt(6)
M16 v[16:19],v[160:163],a[208:211],v[16:19]
DTR v[144:145],v12 offset:51200
s_waitcnt lgkmcnt(5)
M16 v[20:23],v[164:167],a[208:211],v[20:23]
DTR v[146:147],v12 offset:51712
M16 v[24:27],v[160:163],a[212:215],v[24:27]
DTR v[148:149],v13 offset:51200
M16 v[28:31],v[164:167],a[212:215],v[28:31]
DTR v[150:151],v13 offset:51712
M16 v[32:35],v[160:163],a[216:219],v[32:35]
DTR v[152:153],v12 offset:51456
M16 v[36:39],v[164:167],a[216:219],v[36:39]
DTR v[154:155],v12 offset:51968
M16 v[40:43],v[160:163],a[220:223],v[40:43]
DTR v[156:157],v13 offset:51456
M16 v[44:47],v[164:167],a[220:223],v[44:47]
DTR v[158:159],v13 offset:51968
s_waitcnt lgkmcnt(10)
M16 v[48:51],v[168:171],a[208:211],v[48:51]
buffer_load_dwordx4 v8, s[12:15], s65 offen offset:2048 lds
s_waitcnt lgkmcnt(8)
M16 v[52:55],v[172:175],a[208:211],v[52:55]
M16 v[56:59],v[168:171],a[212:215],v[56:59]
M16 v[60:63],v[172:175],a[212:215],v[60:63]
M16 v[64:67],v[168:171],a[216:219],v[64:67]
M16 v[68:71],v[172:175],a[216:219],v[68:71]
M16 v[72:75],v[168:171],a[220:223],v[72:75]
M16 v[76:79],v[172:175],a[220:223],v[76:79]
s_waitcnt lgkmcnt(6)
M16 v[16:19],v[144:147],a[224:227],v[16:19]
DTR v[160:161],v12 offset:52224
s_waitcnt lgkmcnt(5)
M16 v[20:23],v[148:151],a[224:227],v[20:23]
DTR v[162:163],v12 offset:52736
M16 v[24:27],v[144:147],a[228:231],v[24:27]
DTR v[164:165],v13 offset:52224
M16 v[28:31],v[148:151],a[228:231],v[28:31]
DTR v[166:167],v13 offset:52736
M16 v[32:35],v[144:147],a[232:235],v[32:35]
DTR v[168:169],v12 offset:52480
M16 v[36:39],v[148:151],a[232:235],v[36:39]
DTR v[170:171],v12 offset:52992
M16 v[40:43],v[144:147],a[236:239],v[40:43]
DTR v[172:173],v13 offset:52480
M16 v[44:47],v[148:151],a[236:239],v[44:47]
DTR v[174:175],v13 offset:52992
s_waitcnt lgkmcnt(10)
M16 v[48:51],v[152:155],a[224:227],v[48:51]
buffer_load_dwordx4 v9, s[12:15], s65 offen offset:3072 lds
s_waitcnt lgkmcnt(8)
M16 v[52:55],v[156:159],a[224:227],v[52:55]
s_waitcnt vmcnt(13)
buffer_load_dword v255, v5, s[4:7], s63 offen
M16 v[56:59],v[152:155],a[228:231],v[56:59]
M16 v[60:63],v[156:159],a[228:231],v[60:63]
M16 v[64:67],v[152:155],a[232:235],v[64:67]
s_add_u32 s63, s63, 16384
M16 v[68:71],v[156:159],a[232:235],v[68:71]
M16 v[72:75],v[152:155],a[236:239],v[72:75]
M16 v[76:79],v[156:159],a[236:239],v[76:79]
s_waitcnt lgkmcnt(0)
s_waitcnt vmcnt(13)
s_barrier
M16 v[16:19],v[160:163],a[240:243],v[16:19]
DTR v[144:145],v12 offset:0
s_add_u32 m0, s55, 49152
M16 v[20:23],v[164:167],a[240:243],v[20:23]
DTR v[146:147],v12 offset:512
M16 v[24:27],v[160:163],a[244:247],v[24:27]
DTR v[148:149],v13 offset:0
M16 v[28:31],v[164:167],a[244:247],v[28:31]
DTR v[150:151],v13 offset:512
M16 v[32:35],v[160:163],a[248:251],v[32:35]
DTR v[152:153],v12 offset:256
s_mov_b32 s65, 3146112
M16 v[36:39],v[164:167],a[248:251],v[36:39]
DTR v[154:155],v12 offset:768
M16 v[40:43],v[160:163],a[252:255],v[40:43]
DTR v[156:157],v13 offset:256
M16 v[44:47],v[164:167],a[252:255],v[44:47]
DTR v[158:159],v13 offset:768
M16 v[48:51],v[168:171],a[240:243],v[48:51]
buffer_load_dwordx4 v6, s[12:15], s65 offen offset:0 lds
M16 v[52:55],v[172:175],a[240:243],v[52:55]
M16 v[56:59],v[168:171],a[244:247],v[56:59]
M16 v[60:63],v[172:175],a[244:247],v[60:63]
M16 v[64:67],v[168:171],a[248:251],v[64:67]
M16 v[68:71],v[172:175],a[248:251],v[68:71]
M16 v[72:75],v[168:171],a[252:255],v[72:75]
M16 v[76:79],v[172:175],a[252:255],v[76:79]
s_waitcnt lgkmcnt(0)
M16 v[80:83],v[144:147],a[0:3],0
DTR v[160:161],v12 offset:1024
M16 v[84:87],v[148:151],a[0:3],0
DTR v[162:163],v12 offset:1536
M16 v[88:91],v[144:147],a[4:7],0
DTR v[164:165],v13 offset:1024
M16 v[92:95],v[148:151],a[4:7],0
DTR v[166:167],v13 offset:1536
M16 v[96:99],v[144:147],a[8:11],0
DTR v[168:169],v12 offset:1280
M16 v[100:103],v[148:151],a[8:11],0
DTR v[170:171],v12 offset:1792
M16 v[104:107],v[144:147],a[12:15],0
DTR v[172:173],v13 offset:1280
M16 v[108:111],v[148:151],a[12:15],0
DTR v[174:175],v13 offset:1792
M16 v[112:115],v[152:155],a[0:3],0
buffer_load_dwordx4 v7, s[12:15], s65 offen offset:1024 lds
M16 v[116:119],v[156:159],a[0:3],0
M16 v[120:123],v[152:155],a[4:7],0
M16 v[124:127],v[156:159],a[4:7],0
M16 v[128:131],v[152:155],a[8:11],0
M16 v[132:135],v[156:159],a[8:11],0
M16 v[136:139],v[152:155],a[12:15],0
M16 v[140:143],v[156:159],a[12:15],0
s_waitcnt lgkmcnt(6)
M16 v[80:83],v[160:163],a[16:19],v[80:83]
DTR v[144:145],v12 offset:2048
s_waitcnt lgkmcnt(5)
M16 v[84:87],v[164:167],a[16:19],v[84:87]
DTR v[146:147],v12 offset:2560
M16 v[88:91],v[160:163],a[20:23],v[88:91]
DTR v[148:149],v13 offset:2048
M16 v[92:95],v[164:167],a[20:23],v[92:95]
DTR v[150:151],v13 offset:2560
M16 v[96:99],v[160:163],a[24:27],v[96:99]
DTR v[152:153],v12 offset:2304
M16 v[100:103],v[164:167],a[24:27],v[100:103]
DTR v[154:155],v12 offset:2816
M16 v[104:107],v[160:163],a[28:31],v[104:107]
DTR v[156:157],v13 offset:2304
M16 v[108:111],v[164:167],a[28:31],v[108:111]
DTR v[158:159],v13 offset:2816
s_waitcnt lgkmcnt(10)
M16 v[112:115],v[168:171],a[16:19],v[112:115]
buffer_load_dwordx4 v8, s[12:15], s65 offen offset:2048 lds
s_waitcnt lgkmcnt(8)
M16 v[116:119],v[172:175],a[16:19],v[116:119]
FML v16,s66,v16
FML v17,s66,v17
M16 v[120:123],v[168:171],a[20:23],v[120:123]
FML v18,s66,v18
FML v19,s66,v19
M16 v[124:127],v[172:175],a[20:23],v[124:127]
FML v20,s66,v20
FML v21,s66,v21
M16 v[128:131],v[168:171],a[24:27],v[128:131]
FML v22,s66,v22
FML v23,s66,v23
M16 v[132:135],v[172:175],a[24:27],v[132:135]
CVT v16,v16,v17
CVT v17,v18,v19
M16 v[136:139],v[168:171],a[28:31],v[136:139]
CVT v18,v20,v21
CVT v19,v22,v23
M16 v[140:143],v[172:175],a[28:31],v[140:143]
s_mov_b32 s57, 1048576
buffer_store_dwordx4 v[16:19], v15, s[16:19], s57 offen offset:0 sc1
s_waitcnt lgkmcnt(6)
M16 v[80:83],v[144:147],a[32:35],v[80:83]
DTR v[160:161],v12 offset:3072
s_waitcnt lgkmcnt(5)
M16 v[84:87],v[148:151],a[32:35],v[84:87]
DTR v[162:163],v12 offset:3584
M16 v[88:91],v[144:147],a[36:39],v[88:91]
DTR v[164:165],v13 offset:3072
M16 v[92:95],v[148:151],a[36:39],v[92:95]
DTR v[166:167],v13 offset:3584
M16 v[96:99],v[144:147],a[40:43],v[96:99]
DTR v[168:169],v12 offset:3328
M16 v[100:103],v[148:151],a[40:43],v[100:103]
DTR v[170:171],v12 offset:3840
M16 v[104:107],v[144:147],a[44:47],v[104:107]
DTR v[172:173],v13 offset:3328
M16 v[108:111],v[148:151],a[44:47],v[108:111]
DTR v[174:175],v13 offset:3840
s_waitcnt lgkmcnt(10)
M16 v[112:115],v[152:155],a[32:35],v[112:115]
buffer_load_dwordx4 v9, s[12:15], s65 offen offset:3072 lds
s_waitcnt lgkmcnt(8)
M16 v[116:119],v[156:159],a[32:35],v[116:119]
FML v24,s66,v24
FML v25,s66,v25
M16 v[120:123],v[152:155],a[36:39],v[120:123]
FML v26,s66,v26
FML v27,s66,v27
M16 v[124:127],v[156:159],a[36:39],v[124:127]
FML v28,s66,v28
FML v29,s66,v29
M16 v[128:131],v[152:155],a[40:43],v[128:131]
FML v30,s66,v30
FML v31,s66,v31
M16 v[132:135],v[156:159],a[40:43],v[132:135]
CVT v24,v24,v25
CVT v25,v26,v27
M16 v[136:139],v[152:155],a[44:47],v[136:139]
CVT v26,v28,v29
CVT v27,v30,v31
M16 v[140:143],v[156:159],a[44:47],v[140:143]
s_mov_b32 s57, 1048576
buffer_store_dwordx4 v[24:27], v15, s[16:19], s57 offen offset:128 sc1
v_lshrrev_b32 v4, 3, v1
v_lshlrev_b32 v4, 6, v4
s_lshl_b32 s56, s3, 9
v_lshl_add_u32 v4, v0, 11, v4
s_lshl_b32 s57, s2, 14
s_add_u32 s56, s56, s57
s_waitcnt vmcnt(6)
buffer_load_dword v255, v4, s[32:35], s56 offen
s_waitcnt lgkmcnt(0)
s_barrier
M16 v[80:83],v[160:163],a[48:51],v[80:83]
DTR v[144:145],v12 offset:16384
FML v32,s66,v32
M16 v[84:87],v[164:167],a[48:51],v[84:87]
DTR v[146:147],v12 offset:16896
FML v33,s66,v33
M16 v[88:91],v[160:163],a[52:55],v[88:91]
DTR v[148:149],v13 offset:16384
FML v34,s66,v34
M16 v[92:95],v[164:167],a[52:55],v[92:95]
DTR v[150:151],v13 offset:16896
FML v35,s66,v35
M16 v[96:99],v[160:163],a[56:59],v[96:99]
DTR v[152:153],v12 offset:16640
FML v36,s66,v36
M16 v[100:103],v[164:167],a[56:59],v[100:103]
DTR v[154:155],v12 offset:17152
FML v37,s66,v37
M16 v[104:107],v[160:163],a[60:63],v[104:107]
DTR v[156:157],v13 offset:16640
FML v38,s66,v38
M16 v[108:111],v[164:167],a[60:63],v[108:111]
DTR v[158:159],v13 offset:17152
FML v39,s66,v39
M16 v[112:115],v[168:171],a[48:51],v[112:115]
CVT v32,v32,v33
M16 v[116:119],v[172:175],a[48:51],v[116:119]
CVT v33,v34,v35
M16 v[120:123],v[168:171],a[52:55],v[120:123]
CVT v34,v36,v37
M16 v[124:127],v[172:175],a[52:55],v[124:127]
CVT v35,v38,v39
M16 v[128:131],v[168:171],a[56:59],v[128:131]
s_mov_b32 s57, 1056768
M16 v[132:135],v[172:175],a[56:59],v[132:135]
buffer_store_dwordx4 v[32:35], v15, s[16:19], s57 offen offset:0 sc1
M16 v[136:139],v[168:171],a[60:63],v[136:139]
M16 v[140:143],v[172:175],a[60:63],v[140:143]
s_waitcnt lgkmcnt(6)
M16 v[80:83],v[144:147],a[64:67],v[80:83]
DTR v[160:161],v12 offset:17408
FML v40,s66,v40
s_waitcnt lgkmcnt(5)
M16 v[84:87],v[148:151],a[64:67],v[84:87]
DTR v[162:163],v12 offset:17920
FML v41,s66,v41
M16 v[88:91],v[144:147],a[68:71],v[88:91]
DTR v[164:165],v13 offset:17408
FML v42,s66,v42
M16 v[92:95],v[148:151],a[68:71],v[92:95]
DTR v[166:167],v13 offset:17920
FML v43,s66,v43
M16 v[96:99],v[144:147],a[72:75],v[96:99]
DTR v[168:169],v12 offset:17664
FML v44,s66,v44
M16 v[100:103],v[148:151],a[72:75],v[100:103]
DTR v[170:171],v12 offset:18176
FML v45,s66,v45
M16 v[104:107],v[144:147],a[76:79],v[104:107]
DTR v[172:173],v13 offset:17664
FML v46,s66,v46
M16 v[108:111],v[148:151],a[76:79],v[108:111]
DTR v[174:175],v13 offset:18176
FML v47,s66,v47
s_waitcnt lgkmcnt(10)
M16 v[112:115],v[152:155],a[64:67],v[112:115]
CVT v40,v40,v41
s_waitcnt lgkmcnt(8)
M16 v[116:119],v[156:159],a[64:67],v[116:119]
CVT v41,v42,v43
M16 v[120:123],v[152:155],a[68:71],v[120:123]
CVT v42,v44,v45
M16 v[124:127],v[156:159],a[68:71],v[124:127]
CVT v43,v46,v47
M16 v[128:131],v[152:155],a[72:75],v[128:131]
s_mov_b32 s57, 1056768
M16 v[132:135],v[156:159],a[72:75],v[132:135]
buffer_store_dwordx4 v[40:43], v15, s[16:19], s57 offen offset:128 sc1
M16 v[136:139],v[152:155],a[76:79],v[136:139]
M16 v[140:143],v[156:159],a[76:79],v[140:143]
s_waitcnt lgkmcnt(6)
M16 v[80:83],v[160:163],a[80:83],v[80:83]
DTR v[144:145],v12 offset:18432
FML v48,s66,v48
s_waitcnt lgkmcnt(5)
M16 v[84:87],v[164:167],a[80:83],v[84:87]
DTR v[146:147],v12 offset:18944
FML v49,s66,v49
M16 v[88:91],v[160:163],a[84:87],v[88:91]
DTR v[148:149],v13 offset:18432
FML v50,s66,v50
M16 v[92:95],v[164:167],a[84:87],v[92:95]
DTR v[150:151],v13 offset:18944
FML v51,s66,v51
M16 v[96:99],v[160:163],a[88:91],v[96:99]
DTR v[152:153],v12 offset:18688
FML v52,s66,v52
M16 v[100:103],v[164:167],a[88:91],v[100:103]
DTR v[154:155],v12 offset:19200
FML v53,s66,v53
M16 v[104:107],v[160:163],a[92:95],v[104:107]
DTR v[156:157],v13 offset:18688
FML v54,s66,v54
M16 v[108:111],v[164:167],a[92:95],v[108:111]
DTR v[158:159],v13 offset:19200
FML v55,s66,v55
s_waitcnt lgkmcnt(10)
M16 v[112:115],v[168:171],a[80:83],v[112:115]
CVT v48,v48,v49
s_waitcnt lgkmcnt(8)
M16 v[116:119],v[172:175],a[80:83],v[116:119]
CVT v49,v50,v51
M16 v[120:123],v[168:171],a[84:87],v[120:123]
CVT v50,v52,v53
M16 v[124:127],v[172:175],a[84:87],v[124:127]
CVT v51,v54,v55
M16 v[128:131],v[168:171],a[88:91],v[128:131]
s_mov_b32 s57, 1048576
M16 v[132:135],v[172:175],a[88:91],v[132:135]
buffer_store_dwordx4 v[48:51], v15, s[16:19], s57 offen offset:2048 sc1
M16 v[136:139],v[168:171],a[92:95],v[136:139]
M16 v[140:143],v[172:175],a[92:95],v[140:143]
s_waitcnt lgkmcnt(6)
M16 v[80:83],v[144:147],a[96:99],v[80:83]
DTR v[160:161],v12 offset:19456
FML v56,s66,v56
s_waitcnt lgkmcnt(5)
M16 v[84:87],v[148:151],a[96:99],v[84:87]
DTR v[162:163],v12 offset:19968
FML v57,s66,v57
M16 v[88:91],v[144:147],a[100:103],v[88:91]
DTR v[164:165],v13 offset:19456
FML v58,s66,v58
M16 v[92:95],v[148:151],a[100:103],v[92:95]
DTR v[166:167],v13 offset:19968
FML v59,s66,v59
M16 v[96:99],v[144:147],a[104:107],v[96:99]
DTR v[168:169],v12 offset:19712
FML v60,s66,v60
M16 v[100:103],v[148:151],a[104:107],v[100:103]
DTR v[170:171],v12 offset:20224
FML v61,s66,v61
M16 v[104:107],v[144:147],a[108:111],v[104:107]
DTR v[172:173],v13 offset:19712
FML v62,s66,v62
M16 v[108:111],v[148:151],a[108:111],v[108:111]
DTR v[174:175],v13 offset:20224
FML v63,s66,v63
s_waitcnt lgkmcnt(10)
M16 v[112:115],v[152:155],a[96:99],v[112:115]
CVT v56,v56,v57
s_waitcnt lgkmcnt(8)
M16 v[116:119],v[156:159],a[96:99],v[116:119]
CVT v57,v58,v59
M16 v[120:123],v[152:155],a[100:103],v[120:123]
CVT v58,v60,v61
M16 v[124:127],v[156:159],a[100:103],v[124:127]
CVT v59,v62,v63
M16 v[128:131],v[152:155],a[104:107],v[128:131]
s_mov_b32 s57, 1048576
M16 v[132:135],v[156:159],a[104:107],v[132:135]
buffer_store_dwordx4 v[56:59], v15, s[16:19], s57 offen offset:2176 sc1
M16 v[136:139],v[152:155],a[108:111],v[136:139]
M16 v[140:143],v[156:159],a[108:111],v[140:143]
s_waitcnt lgkmcnt(0)
s_barrier
M16 v[80:83],v[160:163],a[112:115],v[80:83]
DTR v[144:145],v12 offset:32768
FML v64,s66,v64
M16 v[84:87],v[164:167],a[112:115],v[84:87]
DTR v[146:147],v12 offset:33280
FML v65,s66,v65
M16 v[88:91],v[160:163],a[116:119],v[88:91]
DTR v[148:149],v13 offset:32768
FML v66,s66,v66
M16 v[92:95],v[164:167],a[116:119],v[92:95]
DTR v[150:151],v13 offset:33280
FML v67,s66,v67
M16 v[96:99],v[160:163],a[120:123],v[96:99]
DTR v[152:153],v12 offset:33024
FML v68,s66,v68
M16 v[100:103],v[164:167],a[120:123],v[100:103]
DTR v[154:155],v12 offset:33536
FML v69,s66,v69
M16 v[104:107],v[160:163],a[124:127],v[104:107]
DTR v[156:157],v13 offset:33024
FML v70,s66,v70
M16 v[108:111],v[164:167],a[124:127],v[108:111]
DTR v[158:159],v13 offset:33536
FML v71,s66,v71
M16 v[112:115],v[168:171],a[112:115],v[112:115]
CVT v64,v64,v65
M16 v[116:119],v[172:175],a[112:115],v[116:119]
CVT v65,v66,v67
M16 v[120:123],v[168:171],a[116:119],v[120:123]
CVT v66,v68,v69
M16 v[124:127],v[172:175],a[116:119],v[124:127]
CVT v67,v70,v71
M16 v[128:131],v[168:171],a[120:123],v[128:131]
s_mov_b32 s57, 1056768
M16 v[132:135],v[172:175],a[120:123],v[132:135]
buffer_store_dwordx4 v[64:67], v15, s[16:19], s57 offen offset:2048 sc1
M16 v[136:139],v[168:171],a[124:127],v[136:139]
M16 v[140:143],v[172:175],a[124:127],v[140:143]
s_waitcnt lgkmcnt(6)
M16 v[80:83],v[144:147],a[128:131],v[80:83]
DTR v[160:161],v12 offset:33792
FML v72,s66,v72
s_waitcnt lgkmcnt(5)
M16 v[84:87],v[148:151],a[128:131],v[84:87]
DTR v[162:163],v12 offset:34304
FML v73,s66,v73
M16 v[88:91],v[144:147],a[132:135],v[88:91]
DTR v[164:165],v13 offset:33792
FML v74,s66,v74
M16 v[92:95],v[148:151],a[132:135],v[92:95]
DTR v[166:167],v13 offset:34304
FML v75,s66,v75
M16 v[96:99],v[144:147],a[136:139],v[96:99]
DTR v[168:169],v12 offset:34048
FML v76,s66,v76
M16 v[100:103],v[148:151],a[136:139],v[100:103]
DTR v[170:171],v12 offset:34560
FML v77,s66,v77
M16 v[104:107],v[144:147],a[140:143],v[104:107]
DTR v[172:173],v13 offset:34048
FML v78,s66,v78
M16 v[108:111],v[148:151],a[140:143],v[108:111]
DTR v[174:175],v13 offset:34560
FML v79,s66,v79
s_waitcnt lgkmcnt(10)
M16 v[112:115],v[152:155],a[128:131],v[112:115]
CVT v72,v72,v73
s_waitcnt lgkmcnt(8)
M16 v[116:119],v[156:159],a[128:131],v[116:119]
CVT v73,v74,v75
M16 v[120:123],v[152:155],a[132:135],v[120:123]
CVT v74,v76,v77
M16 v[124:127],v[156:159],a[132:135],v[124:127]
CVT v75,v78,v79
M16 v[128:131],v[152:155],a[136:139],v[128:131]
s_mov_b32 s57, 1056768
M16 v[132:135],v[156:159],a[136:139],v[132:135]
buffer_store_dwordx4 v[72:75], v15, s[16:19], s57 offen offset:2176 sc1
M16 v[136:139],v[152:155],a[140:143],v[136:139]
M16 v[140:143],v[156:159],a[140:143],v[140:143]
s_waitcnt lgkmcnt(6)
M16 v[80:83],v[160:163],a[144:147],v[80:83]
DTR v[144:145],v12 offset:34816
s_waitcnt lgkmcnt(5)
M16 v[84:87],v[164:167],a[144:147],v[84:87]
DTR v[146:147],v12 offset:35328
M16 v[88:91],v[160:163],a[148:151],v[88:91]
DTR v[148:149],v13 offset:34816
M16 v[92:95],v[164:167],a[148:151],v[92:95]
DTR v[150:151],v13 offset:35328
M16 v[96:99],v[160:163],a[152:155],v[96:99]
DTR v[152:153],v12 offset:35072
M16 v[100:103],v[164:167],a[152:155],v[100:103]
DTR v[154:155],v12 offset:35584
M16 v[104:107],v[160:163],a[156:159],v[104:107]
DTR v[156:157],v13 offset:35072
M16 v[108:111],v[164:167],a[156:159],v[108:111]
DTR v[158:159],v13 offset:35584
s_waitcnt lgkmcnt(10)
M16 v[112:115],v[168:171],a[144:147],v[112:115]
buffer_load_dword v252, off, s[36:39], 0 sc1
s_waitcnt lgkmcnt(8)
M16 v[116:119],v[172:175],a[144:147],v[116:119]
s_lshl_b32 s56, s3, 3
s_add_u32 s56, s56, 159744
M16 v[120:123],v[168:171],a[148:151],v[120:123]
v_mov_b32 v2, s56
M16 v[124:127],v[172:175],a[148:151],v[124:127]
M16 v[128:131],v[168:171],a[152:155],v[128:131]
M16 v[132:135],v[172:175],a[152:155],v[132:135]
v_lshl_add_u32 v2, v1, 5, v2
M16 v[136:139],v[168:171],a[156:159],v[136:139]
M16 v[140:143],v[172:175],a[156:159],v[140:143]
s_waitcnt lgkmcnt(6)
M16 v[80:83],v[144:147],a[160:163],v[80:83]
DTR v[160:161],v12 offset:35840
v_lshrrev_b32 v3, 3, v1
s_waitcnt lgkmcnt(5)
M16 v[84:87],v[148:151],a[160:163],v[84:87]
DTR v[162:163],v12 offset:36352
s_lshl_b32 s56, s3, 5
M16 v[88:91],v[144:147],a[164:167],v[88:91]
DTR v[164:165],v13 offset:35840
v_add_u32 v3, s56, v3
M16 v[92:95],v[148:151],a[164:167],v[92:95]
DTR v[166:167],v13 offset:36352
v_lshlrev_b32 v4, 11, v0
M16 v[96:99],v[144:147],a[168:171],v[96:99]
DTR v[168:169],v12 offset:36096
v_lshl_add_u32 v4, v3, 4, v4
M16 v[100:103],v[148:151],a[168:171],v[100:103]
DTR v[170:171],v12 offset:36608
s_lshl_b32 s57, s67, 14
M16 v[104:107],v[144:147],a[172:175],v[104:107]
DTR v[172:173],v13 offset:36096
s_lshl_b32 s56, s3, 6
M16 v[108:111],v[148:151],a[172:175],v[108:111]
DTR v[174:175],v13 offset:36608
v_add_u32 v6, s56, v1
s_waitcnt lgkmcnt(10)
M16 v[112:115],v[152:155],a[160:163],v[112:115]
buffer_load_dwordx4 v[16:19], v4, s[32:35], s57 offen offset:0
s_waitcnt lgkmcnt(8)
M16 v[116:119],v[156:159],a[160:163],v[116:119]
buffer_load_dwordx4 v[20:23], v4, s[32:35], s57 offen offset:128
M16 v[120:123],v[152:155],a[164:167],v[120:123]
buffer_load_dwordx4 v[24:27], v4, s[32:35], s57 offen offset:256
M16 v[124:127],v[156:159],a[164:167],v[124:127]
buffer_load_dwordx4 v[28:31], v4, s[32:35], s57 offen offset:384
M16 v[128:131],v[152:155],a[168:171],v[128:131]
v_lshlrev_b32 v5, 5, v6
s_cmp_lt_u32 s67, 24
M16 v[132:135],v[156:159],a[168:171],v[132:135]
s_cselect_b32 s56, s67, 0x10000
s_lshl_b32 s56, s56, 10
M16 v[136:139],v[152:155],a[172:175],v[136:139]
v_lshlrev_b32 v6, 2, v6
M16 v[140:143],v[156:159],a[172:175],v[140:143]
v_add_u32 v6, s56, v6
s_waitcnt lgkmcnt(0)
s_waitcnt vmcnt(13)
s_barrier
M16 v[80:83],v[160:163],a[176:179],v[80:83]
DTR v[144:145],v12 offset:49152
M16 v[84:87],v[164:167],a[176:179],v[84:87]
DTR v[146:147],v12 offset:49664
M16 v[88:91],v[160:163],a[180:183],v[88:91]
DTR v[148:149],v13 offset:49152
M16 v[92:95],v[164:167],a[180:183],v[92:95]
DTR v[150:151],v13 offset:49664
M16 v[96:99],v[160:163],a[184:187],v[96:99]
DTR v[152:153],v12 offset:49408
M16 v[100:103],v[164:167],a[184:187],v[100:103]
DTR v[154:155],v12 offset:49920
M16 v[104:107],v[160:163],a[188:191],v[104:107]
DTR v[156:157],v13 offset:49408
M16 v[108:111],v[164:167],a[188:191],v[108:111]
DTR v[158:159],v13 offset:49920
M16 v[112:115],v[168:171],a[176:179],v[112:115]
M16 v[116:119],v[172:175],a[176:179],v[116:119]
M16 v[120:123],v[168:171],a[180:183],v[120:123]
M16 v[124:127],v[172:175],a[180:183],v[124:127]
M16 v[128:131],v[168:171],a[184:187],v[128:131]
M16 v[132:135],v[172:175],a[184:187],v[132:135]
M16 v[136:139],v[168:171],a[188:191],v[136:139]
M16 v[140:143],v[172:175],a[188:191],v[140:143]
s_waitcnt lgkmcnt(6)
M16 v[80:83],v[144:147],a[192:195],v[80:83]
DTR v[160:161],v12 offset:50176
s_waitcnt lgkmcnt(5)
M16 v[84:87],v[148:151],a[192:195],v[84:87]
DTR v[162:163],v12 offset:50688
M16 v[88:91],v[144:147],a[196:199],v[88:91]
DTR v[164:165],v13 offset:50176
M16 v[92:95],v[148:151],a[196:199],v[92:95]
DTR v[166:167],v13 offset:50688
M16 v[96:99],v[144:147],a[200:203],v[96:99]
DTR v[168:169],v12 offset:50432
M16 v[100:103],v[148:151],a[200:203],v[100:103]
DTR v[170:171],v12 offset:50944
M16 v[104:107],v[144:147],a[204:207],v[104:107]
DTR v[172:173],v13 offset:50432
M16 v[108:111],v[148:151],a[204:207],v[108:111]
DTR v[174:175],v13 offset:50944
s_waitcnt lgkmcnt(10)
M16 v[112:115],v[152:155],a[192:195],v[112:115]
s_waitcnt lgkmcnt(8)
M16 v[116:119],v[156:159],a[192:195],v[116:119]
M16 v[120:123],v[152:155],a[196:199],v[120:123]
M16 v[124:127],v[156:159],a[196:199],v[124:127]
M16 v[128:131],v[152:155],a[200:203],v[128:131]
M16 v[132:135],v[156:159],a[200:203],v[132:135]
M16 v[136:139],v[152:155],a[204:207],v[136:139]
M16 v[140:143],v[156:159],a[204:207],v[140:143]
s_waitcnt lgkmcnt(6)
M16 v[80:83],v[160:163],a[208:211],v[80:83]
DTR v[144:145],v12 offset:51200
s_waitcnt lgkmcnt(5)
M16 v[84:87],v[164:167],a[208:211],v[84:87]
DTR v[146:147],v12 offset:51712
M16 v[88:91],v[160:163],a[212:215],v[88:91]
DTR v[148:149],v13 offset:51200
M16 v[92:95],v[164:167],a[212:215],v[92:95]
DTR v[150:151],v13 offset:51712
M16 v[96:99],v[160:163],a[216:219],v[96:99]
DTR v[152:153],v12 offset:51456
M16 v[100:103],v[164:167],a[216:219],v[100:103]
DTR v[154:155],v12 offset:51968
M16 v[104:107],v[160:163],a[220:223],v[104:107]
DTR v[156:157],v13 offset:51456
M16 v[108:111],v[164:167],a[220:223],v[108:111]
DTR v[158:159],v13 offset:51968
s_waitcnt lgkmcnt(10)
M16 v[112:115],v[168:171],a[208:211],v[112:115]
s_waitcnt lgkmcnt(8)
M16 v[116:119],v[172:175],a[208:211],v[116:119]
M16 v[120:123],v[168:171],a[212:215],v[120:123]
M16 v[124:127],v[172:175],a[212:215],v[124:127]
M16 v[128:131],v[168:171],a[216:219],v[128:131]
M16 v[132:135],v[172:175],a[216:219],v[132:135]
M16 v[136:139],v[168:171],a[220:223],v[136:139]
M16 v[140:143],v[172:175],a[220:223],v[140:143]
s_waitcnt lgkmcnt(6)
M16 v[80:83],v[144:147],a[224:227],v[80:83]
DTR v[160:161],v12 offset:52224
s_waitcnt vmcnt(4)
ds_write_b64 v2, v[252:253]
s_waitcnt lgkmcnt(6)
M16 v[84:87],v[148:151],a[224:227],v[84:87]
DTR v[162:163],v12 offset:52736
M16 v[88:91],v[144:147],a[228:231],v[88:91]
DTR v[164:165],v13 offset:52224
M16 v[92:95],v[148:151],a[228:231],v[92:95]
DTR v[166:167],v13 offset:52736
M16 v[96:99],v[144:147],a[232:235],v[96:99]
DTR v[168:169],v12 offset:52480
M16 v[100:103],v[148:151],a[232:235],v[100:103]
DTR v[170:171],v12 offset:52992
M16 v[104:107],v[144:147],a[236:239],v[104:107]
DTR v[172:173],v13 offset:52480
M16 v[108:111],v[148:151],a[236:239],v[108:111]
DTR v[174:175],v13 offset:52992
s_waitcnt lgkmcnt(11)
M16 v[112:115],v[152:155],a[224:227],v[112:115]
v_mov_b32 v2, 159744
s_waitcnt lgkmcnt(9)
M16 v[116:119],v[156:159],a[224:227],v[116:119]
M16 v[120:123],v[152:155],a[228:231],v[120:123]
M16 v[124:127],v[156:159],a[228:231],v[124:127]
M16 v[128:131],v[152:155],a[232:235],v[128:131]
M16 v[132:135],v[156:159],a[232:235],v[132:135]
M16 v[136:139],v[152:155],a[236:239],v[136:139]
M16 v[140:143],v[156:159],a[236:239],v[140:143]
s_waitcnt lgkmcnt(0)
s_barrier
ds_read_b64 v[252:253], v2
M16 v[80:83],v[160:163],a[240:243],v[80:83]
M16 v[84:87],v[164:167],a[240:243],v[84:87]
M16 v[88:91],v[160:163],a[244:247],v[88:91]
M16 v[92:95],v[164:167],a[244:247],v[92:95]
s_waitcnt lgkmcnt(0)
v_readfirstlane_b32 s68, v252
v_readfirstlane_b32 s69, v253
s_and_b32 s68, s68, 0xffff
s_cmp_eq_u32 s68, 256
s_cselect_b32 s65, 0, 0x1000000
s_add_u32 s59, s65, 0
buffer_load_dwordx4 v[176:179], v5, s[28:31], s59 offen
buffer_load_dwordx4 v[180:183], v5, s[28:31], s59 offen offset:16
buffer_load_dword v240, v6, s[28:31], s59 offen
s_add_u32 s59, s65, 24576
buffer_load_dwordx4 v[184:187], v5, s[28:31], s59 offen
M16 v[96:99],v[160:163],a[248:251],v[96:99]
buffer_load_dwordx4 v[188:191], v5, s[28:31], s59 offen offset:16
buffer_load_dword v241, v6, s[28:31], s59 offen
s_add_u32 s59, s65, 49152
buffer_load_dwordx4 v[192:195], v5, s[28:31], s59 offen
buffer_load_dwordx4 v[196:199], v5, s[28:31], s59 offen offset:16
M16 v[100:103],v[164:167],a[248:251],v[100:103]
buffer_load_dword v242, v6, s[28:31], s59 offen
s_add_u32 s59, s65, 73728
buffer_load_dwordx4 v[200:203], v5, s[28:31], s59 offen
buffer_load_dwordx4 v[204:207], v5, s[28:31], s59 offen offset:16
buffer_load_dword v243, v6, s[28:31], s59 offen
M16 v[104:107],v[160:163],a[252:255],v[104:107]
s_add_u32 s59, s65, 98304
buffer_load_dwordx4 v[208:211], v5, s[28:31], s59 offen
buffer_load_dwordx4 v[212:215], v5, s[28:31], s59 offen offset:16
buffer_load_dword v244, v6, s[28:31], s59 offen
s_add_u32 s59, s65, 122880
buffer_load_dwordx4 v[216:219], v5, s[28:31], s59 offen
M16 v[108:111],v[164:167],a[252:255],v[108:111]
buffer_load_dwordx4 v[220:223], v5, s[28:31], s59 offen offset:16
buffer_load_dword v245, v6, s[28:31], s59 offen
s_add_u32 s59, s65, 147456
buffer_load_dwordx4 v[224:227], v5, s[28:31], s59 offen
buffer_load_dwordx4 v[228:231], v5, s[28:31], s59 offen offset:16
M16 v[112:115],v[168:171],a[240:243],v[112:115]
buffer_load_dword v246, v6, s[28:31], s59 offen
s_add_u32 s59, s65, 172032
buffer_load_dwordx4 v[232:235], v5, s[28:31], s59 offen
buffer_load_dwordx4 v[236:239], v5, s[28:31], s59 offen offset:16
buffer_load_dword v247, v6, s[28:31], s59 offen
M16 v[116:119],v[172:175],a[240:243],v[116:119]
FML v80,s66,v80
FML v81,s66,v81
FML v82,s66,v82
FML v83,s66,v83
FML v84,s66,v84
FML v85,s66,v85
FML v86,s66,v86
FML v87,s66,v87
CVT v80,v80,v81
CVT v81,v82,v83
CVT v82,v84,v85
CVT v83,v86,v87
s_mov_b32 s57, 1052672
buffer_store_dwordx4 v[80:83], v15, s[16:19], s57 offen offset:0 sc1
M16 v[120:123],v[168:171],a[244:247],v[120:123]
M16 v[124:127],v[172:175],a[244:247],v[124:127]
FML v88,s66,v88
FML v89,s66,v89
FML v90,s66,v90
FML v91,s66,v91
FML v92,s66,v92
FML v93,s66,v93
FML v94,s66,v94
FML v95,s66,v95
CVT v88,v88,v89
CVT v89,v90,v91
CVT v90,v92,v93
CVT v91,v94,v95
s_mov_b32 s57, 1052672
buffer_store_dwordx4 v[88:91], v15, s[16:19], s57 offen offset:128 sc1
M16 v[128:131],v[168:171],a[248:251],v[128:131]
M16 v[132:135],v[172:175],a[248:251],v[132:135]
FML v96,s66,v96
FML v97,s66,v97
FML v98,s66,v98
FML v99,s66,v99
FML v100,s66,v100
FML v101,s66,v101
FML v102,s66,v102
FML v103,s66,v103
CVT v96,v96,v97
CVT v97,v98,v99
CVT v98,v100,v101
CVT v99,v102,v103
s_mov_b32 s57, 1060864
buffer_store_dwordx4 v[96:99], v15, s[16:19], s57 offen offset:0 sc1
M16 v[136:139],v[168:171],a[252:255],v[136:139]
M16 v[140:143],v[172:175],a[252:255],v[140:143]
FML v104,s66,v104
FML v105,s66,v105
FML v106,s66,v106
FML v107,s66,v107
FML v108,s66,v108
FML v109,s66,v109
FML v110,s66,v110
FML v111,s66,v111
CVT v104,v104,v105
CVT v105,v106,v107
CVT v106,v108,v109
CVT v107,v110,v111
s_mov_b32 s57, 1060864
buffer_store_dwordx4 v[104:107], v15, s[16:19], s57 offen offset:128 sc1
FML v112,s66,v112
FML v113,s66,v113
FML v114,s66,v114
FML v115,s66,v115
FML v116,s66,v116
FML v117,s66,v117
FML v118,s66,v118
FML v119,s66,v119
CVT v112,v112,v113
CVT v113,v114,v115
CVT v114,v116,v117
CVT v115,v118,v119
s_mov_b32 s57, 1052672
buffer_store_dwordx4 v[112:115], v15, s[16:19], s57 offen offset:2048 sc1
FML v120,s66,v120
FML v121,s66,v121
FML v122,s66,v122
FML v123,s66,v123
FML v124,s66,v124
FML v125,s66,v125
FML v126,s66,v126
FML v127,s66,v127
CVT v120,v120,v121
CVT v121,v122,v123
CVT v122,v124,v125
CVT v123,v126,v127
s_mov_b32 s57, 1052672
buffer_store_dwordx4 v[120:123], v15, s[16:19], s57 offen offset:2176 sc1
FML v128,s66,v128
FML v129,s66,v129
FML v130,s66,v130
FML v131,s66,v131
FML v132,s66,v132
FML v133,s66,v133
FML v134,s66,v134
FML v135,s66,v135
CVT v128,v128,v129
CVT v129,v130,v131
CVT v130,v132,v133
CVT v131,v134,v135
s_mov_b32 s57, 1060864
buffer_store_dwordx4 v[128:131], v15, s[16:19], s57 offen offset:2048 sc1
FML v136,s66,v136
FML v137,s66,v137
FML v138,s66,v138
FML v139,s66,v139
FML v140,s66,v140
FML v141,s66,v141
FML v142,s66,v142
FML v143,s66,v143
CVT v136,v136,v137
CVT v137,v138,v139
CVT v138,v140,v141
CVT v139,v142,v143
s_mov_b32 s57, 1060864
buffer_store_dwordx4 v[136:139], v15, s[16:19], s57 offen offset:2176 sc1
s_branch L_k1_fin
L_k1_v:
v_and_b32 v16, 15, v1
v_lshl_add_u32 v15, v16, 4, v15
s_waitcnt vmcnt(28)
s_barrier
DTR v[144:145],v12 offset:0
DTR v[146:147],v12 offset:512
DTR v[148:149],v13 offset:0
DTR v[150:151],v13 offset:512
DTR v[152:153],v12 offset:256
DTR v[154:155],v12 offset:768
DTR v[156:157],v13 offset:256
DTR v[158:159],v13 offset:768
DR4 a[0:3],v10 offset:0
DR4 a[4:7],v10 offset:2048
DR4 a[8:11],v10 offset:4096
DR4 a[12:15],v10 offset:6144
DR4 a[16:19],v11 offset:0
DR4 a[20:23],v11 offset:2048
DR4 a[24:27],v11 offset:4096
DR4 a[28:31],v11 offset:6144
s_waitcnt lgkmcnt(0)
s_waitcnt vmcnt(20)
M16 v[16:19],a[0:3],v[144:147],0
DTR v[160:161],v12 offset:1024
DTR v[162:163],v12 offset:1536
M16 v[20:23],a[4:7],v[144:147],0
DR4 a[32:35],v10 offset:8192
s_add_u32 m0, s58, 0
M16 v[24:27],a[0:3],v[148:151],0
DTR v[164:165],v13 offset:1024
s_mov_b32 s59, 384
M16 v[28:31],a[4:7],v[148:151],0
DTR v[166:167],v13 offset:1536
M16 v[32:35],a[0:3],v[152:155],0
DR4 a[36:39],v10 offset:10240
M16 v[36:39],a[4:7],v[152:155],0
DTR v[168:169],v12 offset:1280
M16 v[40:43],a[0:3],v[156:159],0
DTR v[170:171],v12 offset:1792
M16 v[44:47],a[4:7],v[156:159],0
DR4 a[40:43],v10 offset:12288
M16 v[48:51],a[8:11],v[144:147],0
DTR v[172:173],v13 offset:1280
M16 v[52:55],a[12:15],v[144:147],0
DTR v[174:175],v13 offset:1792
M16 v[56:59],a[8:11],v[148:151],0
DR4 a[44:47],v10 offset:14336
M16 v[60:63],a[12:15],v[148:151],0
buffer_load_dwordx4 v2, s[8:11], s59 offen offset:0 lds
M16 v[64:67],a[8:11],v[152:155],0
buffer_load_dwordx4 v3, s[8:11], s59 offen offset:1024 lds
M16 v[68:71],a[12:15],v[152:155],0
buffer_load_dwordx4 v4, s[8:11], s59 offen offset:2048 lds
M16 v[72:75],a[8:11],v[156:159],0
buffer_load_dwordx4 v5, s[8:11], s59 offen offset:3072 lds
M16 v[76:79],a[12:15],v[156:159],0
s_add_u32 m0, s55, 49152
s_mov_b32 s65, 3145728
buffer_load_dwordx4 v6, s[12:15], s65 offen offset:0 lds
s_add_u32 m0, s55, 49152
s_nop 0
buffer_load_dwordx4 v7, s[12:15], s65 offen offset:1024 lds
s_waitcnt lgkmcnt(0)
M16 v[16:19],a[16:19],v[160:163],v[16:19]
DTR v[144:145],v12 offset:2048
DTR v[146:147],v12 offset:2560
M16 v[20:23],a[20:23],v[160:163],v[20:23]
DR4 a[48:51],v11 offset:8192
s_add_u32 m0, s58, 4096
M16 v[24:27],a[16:19],v[164:167],v[24:27]
DTR v[148:149],v13 offset:2048
s_mov_b32 s59, 33152
M16 v[28:31],a[20:23],v[164:167],v[28:31]
DTR v[150:151],v13 offset:2560
M16 v[32:35],a[16:19],v[168:171],v[32:35]
DR4 a[52:55],v11 offset:10240
M16 v[36:39],a[20:23],v[168:171],v[36:39]
DTR v[152:153],v12 offset:2304
M16 v[40:43],a[16:19],v[172:175],v[40:43]
DTR v[154:155],v12 offset:2816
M16 v[44:47],a[20:23],v[172:175],v[44:47]
DR4 a[56:59],v11 offset:12288
M16 v[48:51],a[24:27],v[160:163],v[48:51]
DTR v[156:157],v13 offset:2304
M16 v[52:55],a[28:31],v[160:163],v[52:55]
DTR v[158:159],v13 offset:2816
M16 v[56:59],a[24:27],v[164:167],v[56:59]
DR4 a[60:63],v11 offset:14336
M16 v[60:63],a[28:31],v[164:167],v[60:63]
buffer_load_dwordx4 v2, s[8:11], s59 offen offset:0 lds
M16 v[64:67],a[24:27],v[168:171],v[64:67]
buffer_load_dwordx4 v3, s[8:11], s59 offen offset:1024 lds
M16 v[68:71],a[28:31],v[168:171],v[68:71]
buffer_load_dwordx4 v4, s[8:11], s59 offen offset:2048 lds
M16 v[72:75],a[24:27],v[172:175],v[72:75]
buffer_load_dwordx4 v5, s[8:11], s59 offen offset:3072 lds
M16 v[76:79],a[28:31],v[172:175],v[76:79]
s_add_u32 m0, s55, 49152
s_nop 0
buffer_load_dwordx4 v8, s[12:15], s65 offen offset:2048 lds
s_waitcnt lgkmcnt(0)
s_waitcnt vmcnt(19)
M16 v[16:19],a[32:35],v[144:147],v[16:19]
DTR v[160:161],v12 offset:3072
DTR v[162:163],v12 offset:3584
M16 v[20:23],a[36:39],v[144:147],v[20:23]
DR4 a[64:67],v10 offset:16384
s_add_u32 m0, s58, 8192
M16 v[24:27],a[32:35],v[148:151],v[24:27]
DTR v[164:165],v13 offset:3072
s_mov_b32 s59, 512
M16 v[28:31],a[36:39],v[148:151],v[28:31]
DTR v[166:167],v13 offset:3584
M16 v[32:35],a[32:35],v[152:155],v[32:35]
DR4 a[68:71],v10 offset:18432
M16 v[36:39],a[36:39],v[152:155],v[36:39]
DTR v[168:169],v12 offset:3328
M16 v[40:43],a[32:35],v[156:159],v[40:43]
DTR v[170:171],v12 offset:3840
M16 v[44:47],a[36:39],v[156:159],v[44:47]
DR4 a[72:75],v10 offset:20480
M16 v[48:51],a[40:43],v[144:147],v[48:51]
DTR v[172:173],v13 offset:3328
M16 v[52:55],a[44:47],v[144:147],v[52:55]
DTR v[174:175],v13 offset:3840
M16 v[56:59],a[40:43],v[148:151],v[56:59]
DR4 a[76:79],v10 offset:22528
M16 v[60:63],a[44:47],v[148:151],v[60:63]
buffer_load_dwordx4 v2, s[8:11], s59 offen offset:0 lds
M16 v[64:67],a[40:43],v[152:155],v[64:67]
buffer_load_dwordx4 v3, s[8:11], s59 offen offset:1024 lds
M16 v[68:71],a[44:47],v[152:155],v[68:71]
buffer_load_dwordx4 v4, s[8:11], s59 offen offset:2048 lds
M16 v[72:75],a[40:43],v[156:159],v[72:75]
buffer_load_dwordx4 v5, s[8:11], s59 offen offset:3072 lds
M16 v[76:79],a[44:47],v[156:159],v[76:79]
s_add_u32 m0, s55, 49152
s_nop 0
buffer_load_dwordx4 v9, s[12:15], s65 offen offset:3072 lds
s_waitcnt lgkmcnt(0)
s_barrier
M16 v[16:19],a[48:51],v[160:163],v[16:19]
DTR v[144:145],v12 offset:16384
DTR v[146:147],v12 offset:16896
M16 v[20:23],a[52:55],v[160:163],v[20:23]
DR4 a[80:83],v11 offset:16384
s_add_u32 m0, s58, 12288
M16 v[24:27],a[48:51],v[164:167],v[24:27]
DTR v[148:149],v13 offset:16384
s_mov_b32 s59, 33280
M16 v[28:31],a[52:55],v[164:167],v[28:31]
DTR v[150:151],v13 offset:16896
M16 v[32:35],a[48:51],v[168:171],v[32:35]
DR4 a[84:87],v11 offset:18432
M16 v[36:39],a[52:55],v[168:171],v[36:39]
DTR v[152:153],v12 offset:16640
M16 v[40:43],a[48:51],v[172:175],v[40:43]
DTR v[154:155],v12 offset:17152
M16 v[44:47],a[52:55],v[172:175],v[44:47]
DR4 a[88:91],v11 offset:20480
M16 v[48:51],a[56:59],v[160:163],v[48:51]
DTR v[156:157],v13 offset:16640
M16 v[52:55],a[60:63],v[160:163],v[52:55]
DTR v[158:159],v13 offset:17152
M16 v[56:59],a[56:59],v[164:167],v[56:59]
DR4 a[92:95],v11 offset:22528
M16 v[60:63],a[60:63],v[164:167],v[60:63]
buffer_load_dwordx4 v2, s[8:11], s59 offen offset:0 lds
M16 v[64:67],a[56:59],v[168:171],v[64:67]
buffer_load_dwordx4 v3, s[8:11], s59 offen offset:1024 lds
M16 v[68:71],a[60:63],v[168:171],v[68:71]
buffer_load_dwordx4 v4, s[8:11], s59 offen offset:2048 lds
M16 v[72:75],a[56:59],v[172:175],v[72:75]
buffer_load_dwordx4 v5, s[8:11], s59 offen offset:3072 lds
M16 v[76:79],a[60:63],v[172:175],v[76:79]
s_add_u32 m0, s55, 0
s_mov_b32 s65, 128
buffer_load_dwordx4 v6, s[12:15], s65 offen offset:0 lds
s_waitcnt lgkmcnt(0)
s_waitcnt vmcnt(11)
M16 v[16:19],a[64:67],v[144:147],v[16:19]
DTR v[160:161],v12 offset:17408
DTR v[162:163],v12 offset:17920
M16 v[20:23],a[68:71],v[144:147],v[20:23]
DR4 a[96:99],v10 offset:0
s_add_u32 m0, s58, 16384
M16 v[24:27],a[64:67],v[148:151],v[24:27]
DTR v[164:165],v13 offset:17408
s_mov_b32 s59, 640
M16 v[28:31],a[68:71],v[148:151],v[28:31]
DTR v[166:167],v13 offset:17920
M16 v[32:35],a[64:67],v[152:155],v[32:35]
DR4 a[100:103],v10 offset:2048
M16 v[36:39],a[68:71],v[152:155],v[36:39]
DTR v[168:169],v12 offset:17664
M16 v[40:43],a[64:67],v[156:159],v[40:43]
DTR v[170:171],v12 offset:18176
M16 v[44:47],a[68:71],v[156:159],v[44:47]
DR4 a[104:107],v10 offset:4096
M16 v[48:51],a[72:75],v[144:147],v[48:51]
DTR v[172:173],v13 offset:17664
M16 v[52:55],a[76:79],v[144:147],v[52:55]
DTR v[174:175],v13 offset:18176
M16 v[56:59],a[72:75],v[148:151],v[56:59]
DR4 a[108:111],v10 offset:6144
M16 v[60:63],a[76:79],v[148:151],v[60:63]
buffer_load_dwordx4 v2, s[8:11], s59 offen offset:0 lds
M16 v[64:67],a[72:75],v[152:155],v[64:67]
buffer_load_dwordx4 v3, s[8:11], s59 offen offset:1024 lds
M16 v[68:71],a[76:79],v[152:155],v[68:71]
buffer_load_dwordx4 v4, s[8:11], s59 offen offset:2048 lds
M16 v[72:75],a[72:75],v[156:159],v[72:75]
buffer_load_dwordx4 v5, s[8:11], s59 offen offset:3072 lds
M16 v[76:79],a[76:79],v[156:159],v[76:79]
s_add_u32 m0, s55, 0
s_nop 0
buffer_load_dwordx4 v7, s[12:15], s65 offen offset:1024 lds
s_waitcnt lgkmcnt(0)
M16 v[16:19],a[80:83],v[160:163],v[16:19]
DTR v[144:145],v12 offset:18432
DTR v[146:147],v12 offset:18944
M16 v[20:23],a[84:87],v[160:163],v[20:23]
DR4 a[112:115],v11 offset:0
s_add_u32 m0, s58, 20480
M16 v[24:27],a[80:83],v[164:167],v[24:27]
DTR v[148:149],v13 offset:18432
s_mov_b32 s59, 33408
M16 v[28:31],a[84:87],v[164:167],v[28:31]
DTR v[150:151],v13 offset:18944
M16 v[32:35],a[80:83],v[168:171],v[32:35]
DR4 a[116:119],v11 offset:2048
M16 v[36:39],a[84:87],v[168:171],v[36:39]
DTR v[152:153],v12 offset:18688
M16 v[40:43],a[80:83],v[172:175],v[40:43]
DTR v[154:155],v12 offset:19200
M16 v[44:47],a[84:87],v[172:175],v[44:47]
DR4 a[120:123],v11 offset:4096
M16 v[48:51],a[88:91],v[160:163],v[48:51]
DTR v[156:157],v13 offset:18688
M16 v[52:55],a[92:95],v[160:163],v[52:55]
DTR v[158:159],v13 offset:19200
M16 v[56:59],a[88:91],v[164:167],v[56:59]
DR4 a[124:127],v11 offset:6144
M16 v[60:63],a[92:95],v[164:167],v[60:63]
buffer_load_dwordx4 v2, s[8:11], s59 offen offset:0 lds
M16 v[64:67],a[88:91],v[168:171],v[64:67]
buffer_load_dwordx4 v3, s[8:11], s59 offen offset:1024 lds
M16 v[68:71],a[92:95],v[168:171],v[68:71]
buffer_load_dwordx4 v4, s[8:11], s59 offen offset:2048 lds
M16 v[72:75],a[88:91],v[172:175],v[72:75]
buffer_load_dwordx4 v5, s[8:11], s59 offen offset:3072 lds
M16 v[76:79],a[92:95],v[172:175],v[76:79]
s_add_u32 m0, s55, 0
s_nop 0
buffer_load_dwordx4 v8, s[12:15], s65 offen offset:2048 lds
s_waitcnt lgkmcnt(0)
s_waitcnt vmcnt(11)
M16 v[16:19],a[96:99],v[144:147],v[16:19]
DTR v[160:161],v12 offset:19456
DTR v[162:163],v12 offset:19968
M16 v[20:23],a[100:103],v[144:147],v[20:23]
DR4 a[128:131],v10 offset:8192
s_add_u32 m0, s58, 0
M16 v[24:27],a[96:99],v[148:151],v[24:27]
DTR v[164:165],v13 offset:19456
s_mov_b32 s59, 768
M16 v[28:31],a[100:103],v[148:151],v[28:31]
DTR v[166:167],v13 offset:19968
M16 v[32:35],a[96:99],v[152:155],v[32:35]
DR4 a[132:135],v10 offset:10240
M16 v[36:39],a[100:103],v[152:155],v[36:39]
DTR v[168:169],v12 offset:19712
M16 v[40:43],a[96:99],v[156:159],v[40:43]
DTR v[170:171],v12 offset:20224
M16 v[44:47],a[100:103],v[156:159],v[44:47]
DR4 a[136:139],v10 offset:12288
M16 v[48:51],a[104:107],v[144:147],v[48:51]
DTR v[172:173],v13 offset:19712
M16 v[52:55],a[108:111],v[144:147],v[52:55]
DTR v[174:175],v13 offset:20224
M16 v[56:59],a[104:107],v[148:151],v[56:59]
DR4 a[140:143],v10 offset:14336
M16 v[60:63],a[108:111],v[148:151],v[60:63]
buffer_load_dwordx4 v2, s[8:11], s59 offen offset:0 lds
M16 v[64:67],a[104:107],v[152:155],v[64:67]
buffer_load_dwordx4 v3, s[8:11], s59 offen offset:1024 lds
M16 v[68:71],a[108:111],v[152:155],v[68:71]
buffer_load_dwordx4 v4, s[8:11], s59 offen offset:2048 lds
M16 v[72:75],a[104:107],v[156:159],v[72:75]
buffer_load_dwordx4 v5, s[8:11], s59 offen offset:3072 lds
M16 v[76:79],a[108:111],v[156:159],v[76:79]
s_add_u32 m0, s55, 0
s_nop 0
buffer_load_dwordx4 v9, s[12:15], s65 offen offset:3072 lds
s_mov_b32 s64, 0
buffer_load_dwordx4 v[176:179], v14, s[20:23], s64 offen
s_waitcnt lgkmcnt(0)
s_barrier
M16 v[16:19],a[112:115],v[160:163],v[16:19]
DTR v[144:145],v12 offset:32768
DTR v[146:147],v12 offset:33280
M16 v[20:23],a[116:119],v[160:163],v[20:23]
DR4 a[144:147],v11 offset:8192
s_add_u32 m0, s58, 4096
M16 v[24:27],a[112:115],v[164:167],v[24:27]
DTR v[148:149],v13 offset:32768
s_mov_b32 s59, 33536
M16 v[28:31],a[116:119],v[164:167],v[28:31]
DTR v[150:151],v13 offset:33280
M16 v[32:35],a[112:115],v[168:171],v[32:35]
DR4 a[148:151],v11 offset:10240
M16 v[36:39],a[116:119],v[168:171],v[36:39]
DTR v[152:153],v12 offset:33024
M16 v[40:43],a[112:115],v[172:175],v[40:43]
DTR v[154:155],v12 offset:33536
M16 v[44:47],a[116:119],v[172:175],v[44:47]
DR4 a[152:155],v11 offset:12288
M16 v[48:51],a[120:123],v[160:163],v[48:51]
DTR v[156:157],v13 offset:33024
M16 v[52:55],a[124:127],v[160:163],v[52:55]
DTR v[158:159],v13 offset:33536
M16 v[56:59],a[120:123],v[164:167],v[56:59]
DR4 a[156:159],v11 offset:14336
M16 v[60:63],a[124:127],v[164:167],v[60:63]
buffer_load_dwordx4 v2, s[8:11], s59 offen offset:0 lds
M16 v[64:67],a[120:123],v[168:171],v[64:67]
buffer_load_dwordx4 v3, s[8:11], s59 offen offset:1024 lds
M16 v[68:71],a[124:127],v[168:171],v[68:71]
buffer_load_dwordx4 v4, s[8:11], s59 offen offset:2048 lds
M16 v[72:75],a[120:123],v[172:175],v[72:75]
buffer_load_dwordx4 v5, s[8:11], s59 offen offset:3072 lds
M16 v[76:79],a[124:127],v[172:175],v[76:79]
s_add_u32 m0, s55, 16384
s_mov_b32 s65, 1048704
buffer_load_dwordx4 v6, s[12:15], s65 offen offset:0 lds
s_mov_b32 s64, 98304
buffer_load_dwordx4 v[180:183], v14, s[20:23], s64 offen
s_waitcnt lgkmcnt(0)
s_waitcnt vmcnt(13)
M16 v[16:19],a[128:131],v[144:147],v[16:19]
DTR v[160:161],v12 offset:33792
DTR v[162:163],v12 offset:34304
M16 v[20:23],a[132:135],v[144:147],v[20:23]
DR4 a[160:163],v10 offset:16384
s_add_u32 m0, s58, 8192
M16 v[24:27],a[128:131],v[148:151],v[24:27]
DTR v[164:165],v13 offset:33792
s_mov_b32 s59, 896
M16 v[28:31],a[132:135],v[148:151],v[28:31]
DTR v[166:167],v13 offset:34304
M16 v[32:35],a[128:131],v[152:155],v[32:35]
DR4 a[164:167],v10 offset:18432
M16 v[36:39],a[132:135],v[152:155],v[36:39]
DTR v[168:169],v12 offset:34048
M16 v[40:43],a[128:131],v[156:159],v[40:43]
DTR v[170:171],v12 offset:34560
M16 v[44:47],a[132:135],v[156:159],v[44:47]
DR4 a[168:171],v10 offset:20480
M16 v[48:51],a[136:139],v[144:147],v[48:51]
DTR v[172:173],v13 offset:34048
M16 v[52:55],a[140:143],v[144:147],v[52:55]
DTR v[174:175],v13 offset:34560
M16 v[56:59],a[136:139],v[148:151],v[56:59]
DR4 a[172:175],v10 offset:22528
M16 v[60:63],a[140:143],v[148:151],v[60:63]
buffer_load_dwordx4 v2, s[8:11], s59 offen offset:0 lds
M16 v[64:67],a[136:139],v[152:155],v[64:67]
buffer_load_dwordx4 v3, s[8:11], s59 offen offset:1024 lds
M16 v[68:71],a[140:143],v[152:155],v[68:71]
buffer_load_dwordx4 v4, s[8:11], s59 offen offset:2048 lds
M16 v[72:75],a[136:139],v[156:159],v[72:75]
buffer_load_dwordx4 v5, s[8:11], s59 offen offset:3072 lds
M16 v[76:79],a[140:143],v[156:159],v[76:79]
s_add_u32 m0, s55, 16384
s_nop 0
buffer_load_dwordx4 v7, s[12:15], s65 offen offset:1024 lds
s_mov_b32 s64, 196608
buffer_load_dwordx4 v[184:187], v14, s[20:23], s64 offen
s_waitcnt lgkmcnt(0)
M16 v[16:19],a[144:147],v[160:163],v[16:19]
DTR v[144:145],v12 offset:34816
DTR v[146:147],v12 offset:35328
M16 v[20:23],a[148:151],v[160:163],v[20:23]
DR4 a[176:179],v11 offset:16384
s_add_u32 m0, s58, 12288
M16 v[24:27],a[144:147],v[164:167],v[24:27]
DTR v[148:149],v13 offset:34816
s_mov_b32 s59, 33664
M16 v[28:31],a[148:151],v[164:167],v[28:31]
DTR v[150:151],v13 offset:35328
M16 v[32:35],a[144:147],v[168:171],v[32:35]
DR4 a[180:183],v11 offset:18432
M16 v[36:39],a[148:151],v[168:171],v[36:39]
DTR v[152:153],v12 offset:35072
M16 v[40:43],a[144:147],v[172:175],v[40:43]
DTR v[154:155],v12 offset:35584
M16 v[44:47],a[148:151],v[172:175],v[44:47]
DR4 a[184:187],v11 offset:20480
M16 v[48:51],a[152:155],v[160:163],v[48:51]
DTR v[156:157],v13 offset:35072
M16 v[52:55],a[156:159],v[160:163],v[52:55]
DTR v[158:159],v13 offset:35584
M16 v[56:59],a[152:155],v[164:167],v[56:59]
DR4 a[188:191],v11 offset:22528
M16 v[60:63],a[156:159],v[164:167],v[60:63]
buffer_load_dwordx4 v2, s[8:11], s59 offen offset:0 lds
M16 v[64:67],a[152:155],v[168:171],v[64:67]
buffer_load_dwordx4 v3, s[8:11], s59 offen offset:1024 lds
M16 v[68:71],a[156:159],v[168:171],v[68:71]
buffer_load_dwordx4 v4, s[8:11], s59 offen offset:2048 lds
M16 v[72:75],a[152:155],v[172:175],v[72:75]
buffer_load_dwordx4 v5, s[8:11], s59 offen offset:3072 lds
M16 v[76:79],a[156:159],v[172:175],v[76:79]
s_add_u32 m0, s55, 16384
s_nop 0
buffer_load_dwordx4 v8, s[12:15], s65 offen offset:2048 lds
s_mov_b32 s64, 294912
buffer_load_dwordx4 v[188:191], v14, s[20:23], s64 offen
s_waitcnt lgkmcnt(0)
s_waitcnt vmcnt(14)
M16 v[16:19],a[160:163],v[144:147],v[16:19]
DTR v[160:161],v12 offset:35840
DTR v[162:163],v12 offset:36352
M16 v[20:23],a[164:167],v[144:147],v[20:23]
DR4 a[192:195],v10 offset:0
s_add_u32 m0, s55, 16384
M16 v[24:27],a[160:163],v[148:151],v[24:27]
DTR v[164:165],v13 offset:35840
M16 v[28:31],a[164:167],v[148:151],v[28:31]
DTR v[166:167],v13 offset:36352
M16 v[32:35],a[160:163],v[152:155],v[32:35]
DR4 a[196:199],v10 offset:2048
M16 v[36:39],a[164:167],v[152:155],v[36:39]
DTR v[168:169],v12 offset:36096
M16 v[40:43],a[160:163],v[156:159],v[40:43]
DTR v[170:171],v12 offset:36608
M16 v[44:47],a[164:167],v[156:159],v[44:47]
DR4 a[200:203],v10 offset:4096
M16 v[48:51],a[168:171],v[144:147],v[48:51]
DTR v[172:173],v13 offset:36096
M16 v[52:55],a[172:175],v[144:147],v[52:55]
DTR v[174:175],v13 offset:36608
M16 v[56:59],a[168:171],v[148:151],v[56:59]
DR4 a[204:207],v10 offset:6144
M16 v[60:63],a[172:175],v[148:151],v[60:63]
buffer_load_dwordx4 v9, s[12:15], s65 offen offset:3072 lds
M16 v[64:67],a[168:171],v[152:155],v[64:67]
s_mov_b32 s64, 4096
M16 v[68:71],a[172:175],v[152:155],v[68:71]
buffer_load_dwordx4 v[192:195], v14, s[20:23], s64 offen
M16 v[72:75],a[168:171],v[156:159],v[72:75]
M16 v[76:79],a[172:175],v[156:159],v[76:79]
s_waitcnt lgkmcnt(0)
s_barrier
M16 v[16:19],a[176:179],v[160:163],v[16:19]
DTR v[144:145],v12 offset:49152
DTR v[146:147],v12 offset:49664
M16 v[20:23],a[180:183],v[160:163],v[20:23]
DR4 a[208:211],v11 offset:0
s_add_u32 m0, s55, 32768
M16 v[24:27],a[176:179],v[164:167],v[24:27]
DTR v[148:149],v13 offset:49152
s_mov_b32 s65, 2097280
M16 v[28:31],a[180:183],v[164:167],v[28:31]
DTR v[150:151],v13 offset:49664
M16 v[32:35],a[176:179],v[168:171],v[32:35]
DR4 a[212:215],v11 offset:2048
M16 v[36:39],a[180:183],v[168:171],v[36:39]
DTR v[152:153],v12 offset:49408
M16 v[40:43],a[176:179],v[172:175],v[40:43]
DTR v[154:155],v12 offset:49920
M16 v[44:47],a[180:183],v[172:175],v[44:47]
DR4 a[216:219],v11 offset:4096
M16 v[48:51],a[184:187],v[160:163],v[48:51]
DTR v[156:157],v13 offset:49408
M16 v[52:55],a[188:191],v[160:163],v[52:55]
DTR v[158:159],v13 offset:49920
M16 v[56:59],a[184:187],v[164:167],v[56:59]
DR4 a[220:223],v11 offset:6144
M16 v[60:63],a[188:191],v[164:167],v[60:63]
buffer_load_dwordx4 v6, s[12:15], s65 offen offset:0 lds
M16 v[64:67],a[184:187],v[168:171],v[64:67]
s_mov_b32 s64, 102400
M16 v[68:71],a[188:191],v[168:171],v[68:71]
buffer_load_dwordx4 v[196:199], v14, s[20:23], s64 offen
M16 v[72:75],a[184:187],v[172:175],v[72:75]
v_lshlrev_b32 v248, 16, v248
FML v252,0xbfb8aa3b,v248
M16 v[76:79],a[188:191],v[172:175],v[76:79]
EXP v252,v252
s_nop 0
FAD v252,1.0,v252
v_rcp_f32 v252, v252
s_nop 0
FML v248,v248,v252
v_lshlrev_b32 v249, 16, v249
FML v252,0xbfb8aa3b,v249
s_waitcnt vmcnt(6)
s_waitcnt lgkmcnt(10)
M16 v[16:19],a[192:195],v[144:147],v[16:19]
DTR v[160:161],v12 offset:50176
DTR v[162:163],v12 offset:50688
M16 v[20:23],a[196:199],v[144:147],v[20:23]
DR4 a[224:227],v10 offset:8192
s_waitcnt lgkmcnt(10)
M16 v[24:27],a[192:195],v[148:151],v[24:27]
DTR v[164:165],v13 offset:50176
M16 v[28:31],a[196:199],v[148:151],v[28:31]
DTR v[166:167],v13 offset:50688
s_waitcnt lgkmcnt(9)
M16 v[32:35],a[192:195],v[152:155],v[32:35]
DR4 a[228:231],v10 offset:10240
M16 v[36:39],a[196:199],v[152:155],v[36:39]
DTR v[168:169],v12 offset:50432
s_waitcnt lgkmcnt(8)
M16 v[40:43],a[192:195],v[156:159],v[40:43]
DTR v[170:171],v12 offset:50944
M16 v[44:47],a[196:199],v[156:159],v[44:47]
DR4 a[232:235],v10 offset:12288
M16 v[48:51],a[200:203],v[144:147],v[48:51]
DTR v[172:173],v13 offset:50432
M16 v[52:55],a[204:207],v[144:147],v[52:55]
DTR v[174:175],v13 offset:50944
M16 v[56:59],a[200:203],v[148:151],v[56:59]
DR4 a[236:239],v10 offset:14336
M16 v[60:63],a[204:207],v[148:151],v[60:63]
buffer_load_dwordx4 v7, s[12:15], s65 offen offset:1024 lds
M16 v[64:67],a[200:203],v[152:155],v[64:67]
s_mov_b32 s64, 200704
M16 v[68:71],a[204:207],v[152:155],v[68:71]
buffer_load_dwordx4 v[200:203], v14, s[20:23], s64 offen
M16 v[72:75],a[200:203],v[156:159],v[72:75]
EXP v252,v252
M16 v[76:79],a[204:207],v[156:159],v[76:79]
FAD v252,1.0,v252
v_rcp_f32 v252, v252
s_nop 0
FML v249,v249,v252
v_lshlrev_b32 v250, 16, v250
FML v252,0xbfb8aa3b,v250
EXP v252,v252
s_waitcnt lgkmcnt(10)
M16 v[16:19],a[208:211],v[160:163],v[16:19]
DTR v[144:145],v12 offset:51200
DTR v[146:147],v12 offset:51712
M16 v[20:23],a[212:215],v[160:163],v[20:23]
DR4 a[240:243],v11 offset:8192
s_waitcnt lgkmcnt(10)
M16 v[24:27],a[208:211],v[164:167],v[24:27]
DTR v[148:149],v13 offset:51200
M16 v[28:31],a[212:215],v[164:167],v[28:31]
DTR v[150:151],v13 offset:51712
s_waitcnt lgkmcnt(9)
M16 v[32:35],a[208:211],v[168:171],v[32:35]
DR4 a[244:247],v11 offset:10240
M16 v[36:39],a[212:215],v[168:171],v[36:39]
DTR v[152:153],v12 offset:51456
s_waitcnt lgkmcnt(8)
M16 v[40:43],a[208:211],v[172:175],v[40:43]
DTR v[154:155],v12 offset:51968
M16 v[44:47],a[212:215],v[172:175],v[44:47]
DR4 a[248:251],v11 offset:12288
M16 v[48:51],a[216:219],v[160:163],v[48:51]
DTR v[156:157],v13 offset:51456
M16 v[52:55],a[220:223],v[160:163],v[52:55]
DTR v[158:159],v13 offset:51968
M16 v[56:59],a[216:219],v[164:167],v[56:59]
DR4 a[252:255],v11 offset:14336
M16 v[60:63],a[220:223],v[164:167],v[60:63]
buffer_load_dwordx4 v8, s[12:15], s65 offen offset:2048 lds
M16 v[64:67],a[216:219],v[168:171],v[64:67]
s_mov_b32 s64, 299008
M16 v[68:71],a[220:223],v[168:171],v[68:71]
buffer_load_dwordx4 v[204:207], v14, s[20:23], s64 offen
M16 v[72:75],a[216:219],v[172:175],v[72:75]
FAD v252,1.0,v252
M16 v[76:79],a[220:223],v[172:175],v[76:79]
v_rcp_f32 v252, v252
s_nop 0
FML v250,v250,v252
v_lshlrev_b32 v251, 16, v251
FML v252,0xbfb8aa3b,v251
EXP v252,v252
s_nop 0
FAD v252,1.0,v252
s_waitcnt lgkmcnt(10)
M16 v[16:19],a[224:227],v[144:147],v[16:19]
DTR v[160:161],v12 offset:52224
M16 v[20:23],a[228:231],v[144:147],v[20:23]
DTR v[162:163],v12 offset:52736
s_waitcnt lgkmcnt(9)
M16 v[24:27],a[224:227],v[148:151],v[24:27]
DTR v[164:165],v13 offset:52224
M16 v[28:31],a[228:231],v[148:151],v[28:31]
DTR v[166:167],v13 offset:52736
s_waitcnt lgkmcnt(8)
M16 v[32:35],a[224:227],v[152:155],v[32:35]
DTR v[168:169],v12 offset:52480
M16 v[36:39],a[228:231],v[152:155],v[36:39]
DTR v[170:171],v12 offset:52992
s_waitcnt lgkmcnt(7)
M16 v[40:43],a[224:227],v[156:159],v[40:43]
DTR v[172:173],v13 offset:52480
M16 v[44:47],a[228:231],v[156:159],v[44:47]
DTR v[174:175],v13 offset:52992
M16 v[48:51],a[232:235],v[144:147],v[48:51]
buffer_load_dwordx4 v9, s[12:15], s65 offen offset:3072 lds
M16 v[52:55],a[236:239],v[144:147],v[52:55]
s_mov_b32 s64, 8192
M16 v[56:59],a[232:235],v[148:151],v[56:59]
buffer_load_dwordx4 v[208:211], v14, s[20:23], s64 offen
M16 v[60:63],a[236:239],v[148:151],v[60:63]
v_rcp_f32 v252, v252
M16 v[64:67],a[232:235],v[152:155],v[64:67]
FML v251,v251,v252
v_lshlrev_b32 v252, 16, v176
M16 v[68:71],a[236:239],v[152:155],v[68:71]
v_and_b32 v176, 0xffff0000, v176
FML v224,v252,v248
M16 v[72:75],a[232:235],v[156:159],v[72:75]
FML v225,v176,v248
v_lshlrev_b32 v252, 16, v177
M16 v[76:79],a[236:239],v[156:159],v[76:79]
v_and_b32 v177, 0xffff0000, v177
FML v226,v252,v248
FML v227,v177,v248
s_waitcnt lgkmcnt(0)
s_barrier
M16 v[16:19],a[240:243],v[160:163],v[16:19]
DTR v[144:145],v12 offset:0
s_add_u32 m0, s55, 49152
M16 v[20:23],a[244:247],v[160:163],v[20:23]
DTR v[146:147],v12 offset:512
s_mov_b32 s65, 3145856
M16 v[24:27],a[240:243],v[164:167],v[24:27]
DTR v[148:149],v13 offset:0
M16 v[28:31],a[244:247],v[164:167],v[28:31]
DTR v[150:151],v13 offset:512
M16 v[32:35],a[240:243],v[168:171],v[32:35]
DTR v[152:153],v12 offset:256
M16 v[36:39],a[244:247],v[168:171],v[36:39]
DTR v[154:155],v12 offset:768
M16 v[40:43],a[240:243],v[172:175],v[40:43]
DTR v[156:157],v13 offset:256
M16 v[44:47],a[244:247],v[172:175],v[44:47]
DTR v[158:159],v13 offset:768
M16 v[48:51],a[248:251],v[160:163],v[48:51]
buffer_load_dwordx4 v6, s[12:15], s65 offen offset:0 lds
M16 v[52:55],a[252:255],v[160:163],v[52:55]
s_mov_b32 s64, 106496
M16 v[56:59],a[248:251],v[164:167],v[56:59]
buffer_load_dwordx4 v[212:215], v14, s[20:23], s64 offen
M16 v[60:63],a[252:255],v[164:167],v[60:63]
v_lshlrev_b32 v252, 16, v178
v_and_b32 v178, 0xffff0000, v178
M16 v[64:67],a[248:251],v[168:171],v[64:67]
FML v228,v252,v248
FML v229,v178,v248
M16 v[68:71],a[252:255],v[168:171],v[68:71]
v_lshlrev_b32 v252, 16, v179
v_and_b32 v179, 0xffff0000, v179
M16 v[72:75],a[248:251],v[172:175],v[72:75]
FML v230,v252,v248
FML v231,v179,v248
M16 v[76:79],a[252:255],v[172:175],v[76:79]
v_lshlrev_b32 v252, 16, v180
v_and_b32 v180, 0xffff0000, v180
v_fmac_f32 v224, v252, v249
v_fmac_f32 v225, v180, v249
s_waitcnt lgkmcnt(6)
M16 v[80:83],a[0:3],v[144:147],0
DTR v[160:161],v12 offset:1024
M16 v[84:87],a[4:7],v[144:147],0
DTR v[162:163],v12 offset:1536
s_waitcnt lgkmcnt(6)
M16 v[88:91],a[0:3],v[148:151],0
DTR v[164:165],v13 offset:1024
M16 v[92:95],a[4:7],v[148:151],0
DTR v[166:167],v13 offset:1536
s_waitcnt lgkmcnt(6)
M16 v[96:99],a[0:3],v[152:155],0
DTR v[168:169],v12 offset:1280
M16 v[100:103],a[4:7],v[152:155],0
DTR v[170:171],v12 offset:1792
s_waitcnt lgkmcnt(6)
M16 v[104:107],a[0:3],v[156:159],0
DTR v[172:173],v13 offset:1280
M16 v[108:111],a[4:7],v[156:159],0
DTR v[174:175],v13 offset:1792
M16 v[112:115],a[8:11],v[144:147],0
buffer_load_dwordx4 v7, s[12:15], s65 offen offset:1024 lds
M16 v[116:119],a[12:15],v[144:147],0
s_mov_b32 s64, 204800
M16 v[120:123],a[8:11],v[148:151],0
buffer_load_dwordx4 v[216:219], v14, s[20:23], s64 offen
M16 v[124:127],a[12:15],v[148:151],0
v_lshlrev_b32 v252, 16, v181
v_and_b32 v181, 0xffff0000, v181
M16 v[128:131],a[8:11],v[152:155],0
v_fmac_f32 v226, v252, v249
v_fmac_f32 v227, v181, v249
M16 v[132:135],a[12:15],v[152:155],0
v_lshlrev_b32 v252, 16, v182
v_and_b32 v182, 0xffff0000, v182
M16 v[136:139],a[8:11],v[156:159],0
v_fmac_f32 v228, v252, v249
v_fmac_f32 v229, v182, v249
M16 v[140:143],a[12:15],v[156:159],0
v_lshlrev_b32 v252, 16, v183
v_and_b32 v183, 0xffff0000, v183
v_fmac_f32 v230, v252, v249
v_fmac_f32 v231, v183, v249
s_waitcnt lgkmcnt(6)
M16 v[80:83],a[16:19],v[160:163],v[80:83]
DTR v[144:145],v12 offset:2048
M16 v[84:87],a[20:23],v[160:163],v[84:87]
DTR v[146:147],v12 offset:2560
s_waitcnt lgkmcnt(6)
M16 v[88:91],a[16:19],v[164:167],v[88:91]
DTR v[148:149],v13 offset:2048
M16 v[92:95],a[20:23],v[164:167],v[92:95]
DTR v[150:151],v13 offset:2560
s_waitcnt lgkmcnt(6)
M16 v[96:99],a[16:19],v[168:171],v[96:99]
DTR v[152:153],v12 offset:2304
M16 v[100:103],a[20:23],v[168:171],v[100:103]
DTR v[154:155],v12 offset:2816
s_waitcnt lgkmcnt(6)
M16 v[104:107],a[16:19],v[172:175],v[104:107]
DTR v[156:157],v13 offset:2304
M16 v[108:111],a[20:23],v[172:175],v[108:111]
DTR v[158:159],v13 offset:2816
M16 v[112:115],a[24:27],v[160:163],v[112:115]
buffer_load_dwordx4 v8, s[12:15], s65 offen offset:2048 lds
M16 v[116:119],a[28:31],v[160:163],v[116:119]
CVT v16,v16,v17
CVT v17,v18,v19
M16 v[120:123],a[24:27],v[164:167],v[120:123]
CVT v18,v20,v21
CVT v19,v22,v23
M16 v[124:127],a[28:31],v[164:167],v[124:127]
s_mov_b32 s57, 16384
M16 v[128:131],a[24:27],v[168:171],v[128:131]
buffer_store_dwordx4 v[16:19], v15, s[16:19], s57 offen offset:0 sc1
M16 v[132:135],a[28:31],v[168:171],v[132:135]
s_mov_b32 s64, 303104
M16 v[136:139],a[24:27],v[172:175],v[136:139]
buffer_load_dwordx4 v[220:223], v14, s[20:23], s64 offen
M16 v[140:143],a[28:31],v[172:175],v[140:143]
v_lshlrev_b32 v252, 16, v184
v_and_b32 v184, 0xffff0000, v184
v_fmac_f32 v224, v252, v250
v_fmac_f32 v225, v184, v250
v_lshlrev_b32 v252, 16, v185
v_and_b32 v185, 0xffff0000, v185
v_fmac_f32 v226, v252, v250
v_fmac_f32 v227, v185, v250
v_lshlrev_b32 v252, 16, v186
v_and_b32 v186, 0xffff0000, v186
v_fmac_f32 v228, v252, v250
v_fmac_f32 v229, v186, v250
s_waitcnt lgkmcnt(6)
M16 v[80:83],a[32:35],v[144:147],v[80:83]
DTR v[160:161],v12 offset:3072
M16 v[84:87],a[36:39],v[144:147],v[84:87]
DTR v[162:163],v12 offset:3584
s_waitcnt lgkmcnt(6)
M16 v[88:91],a[32:35],v[148:151],v[88:91]
DTR v[164:165],v13 offset:3072
M16 v[92:95],a[36:39],v[148:151],v[92:95]
DTR v[166:167],v13 offset:3584
s_waitcnt lgkmcnt(6)
M16 v[96:99],a[32:35],v[152:155],v[96:99]
DTR v[168:169],v12 offset:3328
M16 v[100:103],a[36:39],v[152:155],v[100:103]
DTR v[170:171],v12 offset:3840
s_waitcnt lgkmcnt(6)
M16 v[104:107],a[32:35],v[156:159],v[104:107]
DTR v[172:173],v13 offset:3328
M16 v[108:111],a[36:39],v[156:159],v[108:111]
DTR v[174:175],v13 offset:3840
M16 v[112:115],a[40:43],v[144:147],v[112:115]
buffer_load_dwordx4 v9, s[12:15], s65 offen offset:3072 lds
M16 v[116:119],a[44:47],v[144:147],v[116:119]
CVT v24,v24,v25
CVT v25,v26,v27
M16 v[120:123],a[40:43],v[148:151],v[120:123]
CVT v26,v28,v29
CVT v27,v30,v31
M16 v[124:127],a[44:47],v[148:151],v[124:127]
s_mov_b32 s57, 16384
M16 v[128:131],a[40:43],v[152:155],v[128:131]
buffer_store_dwordx4 v[24:27], v15, s[16:19], s57 offen offset:256 sc1
M16 v[132:135],a[44:47],v[152:155],v[132:135]
v_lshlrev_b32 v252, 16, v187
v_and_b32 v187, 0xffff0000, v187
M16 v[136:139],a[40:43],v[156:159],v[136:139]
v_fmac_f32 v230, v252, v250
v_fmac_f32 v231, v187, v250
M16 v[140:143],a[44:47],v[156:159],v[140:143]
s_waitcnt vmcnt(19)
v_lshlrev_b32 v252, 16, v188
v_and_b32 v188, 0xffff0000, v188
v_fmac_f32 v224, v252, v251
v_fmac_f32 v225, v188, v251
v_lshlrev_b32 v252, 16, v189
v_and_b32 v189, 0xffff0000, v189
v_fmac_f32 v226, v252, v251
v_fmac_f32 v227, v189, v251
s_waitcnt lgkmcnt(0)
s_waitcnt vmcnt(18)
s_barrier
M16 v[80:83],a[48:51],v[160:163],v[80:83]
DTR v[144:145],v12 offset:16384
s_add_u32 m0, s55, 0
M16 v[84:87],a[52:55],v[160:163],v[84:87]
DTR v[146:147],v12 offset:16896
s_mov_b32 s65, 256
M16 v[88:91],a[48:51],v[164:167],v[88:91]
DTR v[148:149],v13 offset:16384
M16 v[92:95],a[52:55],v[164:167],v[92:95]
DTR v[150:151],v13 offset:16896
M16 v[96:99],a[48:51],v[168:171],v[96:99]
DTR v[152:153],v12 offset:16640
M16 v[100:103],a[52:55],v[168:171],v[100:103]
DTR v[154:155],v12 offset:17152
M16 v[104:107],a[48:51],v[172:175],v[104:107]
DTR v[156:157],v13 offset:16640
M16 v[108:111],a[52:55],v[172:175],v[108:111]
DTR v[158:159],v13 offset:17152
M16 v[112:115],a[56:59],v[160:163],v[112:115]
buffer_load_dwordx4 v6, s[12:15], s65 offen offset:0 lds
M16 v[116:119],a[60:63],v[160:163],v[116:119]
CVT v32,v32,v33
CVT v33,v34,v35
M16 v[120:123],a[56:59],v[164:167],v[120:123]
CVT v34,v36,v37
CVT v35,v38,v39
M16 v[124:127],a[60:63],v[164:167],v[124:127]
s_mov_b32 s57, 20480
M16 v[128:131],a[56:59],v[168:171],v[128:131]
buffer_store_dwordx4 v[32:35], v15, s[16:19], s57 offen offset:0 sc1
M16 v[132:135],a[60:63],v[168:171],v[132:135]
v_lshlrev_b32 v252, 16, v190
v_and_b32 v190, 0xffff0000, v190
M16 v[136:139],a[56:59],v[172:175],v[136:139]
v_fmac_f32 v228, v252, v251
v_fmac_f32 v229, v190, v251
M16 v[140:143],a[60:63],v[172:175],v[140:143]
v_lshlrev_b32 v252, 16, v191
v_and_b32 v191, 0xffff0000, v191
v_fmac_f32 v230, v252, v251
v_fmac_f32 v231, v191, v251
s_waitcnt vmcnt(19)
v_lshlrev_b32 v252, 16, v192
v_and_b32 v192, 0xffff0000, v192
FML v232,v252,v248
FML v233,v192,v248
v_lshrrev_b32 v5, 4, v1
v_lshlrev_b32 v5, 13, v5
v_and_b32 v4, 15, v1
v_lshl_add_u32 v5, v4, 6, v5
v_mov_b32 v4, 0x1000000
v_cmp_gt_u32 vcc, 32, v1
s_nop 1
CND v5,v4,v5,vcc
s_mov_b32 s6, 0x800000
s_mov_b32 s7, 0x20000
s_lshr_b32 s56, s2, 3
s_lshl_b32 s56, s56, 2
s_add_u32 s56, s56, s3
s_lshl_b32 s56, s56, 16
s_and_b32 s63, s2, 7
s_lshl_b32 s63, s63, 10
s_add_u32 s63, s63, s56
s_waitcnt lgkmcnt(6)
M16 v[80:83],a[64:67],v[144:147],v[80:83]
DTR v[160:161],v12 offset:17408
M16 v[84:87],a[68:71],v[144:147],v[84:87]
DTR v[162:163],v12 offset:17920
s_waitcnt lgkmcnt(6)
M16 v[88:91],a[64:67],v[148:151],v[88:91]
DTR v[164:165],v13 offset:17408
M16 v[92:95],a[68:71],v[148:151],v[92:95]
DTR v[166:167],v13 offset:17920
s_waitcnt lgkmcnt(6)
M16 v[96:99],a[64:67],v[152:155],v[96:99]
DTR v[168:169],v12 offset:17664
M16 v[100:103],a[68:71],v[152:155],v[100:103]
DTR v[170:171],v12 offset:18176
s_waitcnt lgkmcnt(6)
M16 v[104:107],a[64:67],v[156:159],v[104:107]
DTR v[172:173],v13 offset:17664
M16 v[108:111],a[68:71],v[156:159],v[108:111]
DTR v[174:175],v13 offset:18176
M16 v[112:115],a[72:75],v[144:147],v[112:115]
buffer_load_dwordx4 v7, s[12:15], s65 offen offset:1024 lds
M16 v[116:119],a[76:79],v[144:147],v[116:119]
CVT v40,v40,v41
CVT v41,v42,v43
M16 v[120:123],a[72:75],v[148:151],v[120:123]
CVT v42,v44,v45
CVT v43,v46,v47
M16 v[124:127],a[76:79],v[148:151],v[124:127]
s_mov_b32 s57, 20480
M16 v[128:131],a[72:75],v[152:155],v[128:131]
buffer_store_dwordx4 v[40:43], v15, s[16:19], s57 offen offset:256 sc1
M16 v[132:135],a[76:79],v[152:155],v[132:135]
v_lshlrev_b32 v252, 16, v193
v_and_b32 v193, 0xffff0000, v193
M16 v[136:139],a[72:75],v[156:159],v[136:139]
FML v234,v252,v248
FML v235,v193,v248
M16 v[140:143],a[76:79],v[156:159],v[140:143]
v_lshlrev_b32 v252, 16, v194
v_and_b32 v194, 0xffff0000, v194
FML v236,v252,v248
FML v237,v194,v248
v_lshlrev_b32 v252, 16, v195
v_and_b32 v195, 0xffff0000, v195
FML v238,v252,v248
FML v239,v195,v248
s_waitcnt vmcnt(19)
v_lshlrev_b32 v252, 16, v196
v_and_b32 v196, 0xffff0000, v196
buffer_load_dword v255, v5, s[4:7], s63 offen
s_add_u32 s63, s63, 16384
s_waitcnt lgkmcnt(6)
M16 v[80:83],a[80:83],v[160:163],v[80:83]
DTR v[144:145],v12 offset:18432
M16 v[84:87],a[84:87],v[160:163],v[84:87]
DTR v[146:147],v12 offset:18944
s_waitcnt lgkmcnt(6)
M16 v[88:91],a[80:83],v[164:167],v[88:91]
DTR v[148:149],v13 offset:18432
M16 v[92:95],a[84:87],v[164:167],v[92:95]
DTR v[150:151],v13 offset:18944
s_waitcnt lgkmcnt(6)
M16 v[96:99],a[80:83],v[168:171],v[96:99]
DTR v[152:153],v12 offset:18688
M16 v[100:103],a[84:87],v[168:171],v[100:103]
DTR v[154:155],v12 offset:19200
s_waitcnt lgkmcnt(6)
M16 v[104:107],a[80:83],v[172:175],v[104:107]
DTR v[156:157],v13 offset:18688
M16 v[108:111],a[84:87],v[172:175],v[108:111]
DTR v[158:159],v13 offset:19200
M16 v[112:115],a[88:91],v[160:163],v[112:115]
buffer_load_dwordx4 v8, s[12:15], s65 offen offset:2048 lds
M16 v[116:119],a[92:95],v[160:163],v[116:119]
CVT v48,v48,v49
CVT v49,v50,v51
M16 v[120:123],a[88:91],v[164:167],v[120:123]
CVT v50,v52,v53
CVT v51,v54,v55
M16 v[124:127],a[92:95],v[164:167],v[124:127]
s_mov_b32 s57, 16384
M16 v[128:131],a[88:91],v[168:171],v[128:131]
buffer_store_dwordx4 v[48:51], v15, s[16:19], s57 offen offset:2048 sc1
M16 v[132:135],a[92:95],v[168:171],v[132:135]
v_fmac_f32 v232, v252, v249
v_fmac_f32 v233, v196, v249
M16 v[136:139],a[88:91],v[172:175],v[136:139]
v_lshlrev_b32 v252, 16, v197
v_and_b32 v197, 0xffff0000, v197
M16 v[140:143],a[92:95],v[172:175],v[140:143]
v_fmac_f32 v234, v252, v249
v_fmac_f32 v235, v197, v249
v_lshlrev_b32 v252, 16, v198
v_and_b32 v198, 0xffff0000, v198
v_fmac_f32 v236, v252, v249
v_fmac_f32 v237, v198, v249
v_lshlrev_b32 v252, 16, v199
v_and_b32 v199, 0xffff0000, v199
s_waitcnt lgkmcnt(6)
M16 v[80:83],a[96:99],v[144:147],v[80:83]
DTR v[160:161],v12 offset:19456
M16 v[84:87],a[100:103],v[144:147],v[84:87]
DTR v[162:163],v12 offset:19968
s_waitcnt lgkmcnt(6)
M16 v[88:91],a[96:99],v[148:151],v[88:91]
DTR v[164:165],v13 offset:19456
M16 v[92:95],a[100:103],v[148:151],v[92:95]
DTR v[166:167],v13 offset:19968
s_waitcnt lgkmcnt(6)
M16 v[96:99],a[96:99],v[152:155],v[96:99]
DTR v[168:169],v12 offset:19712
M16 v[100:103],a[100:103],v[152:155],v[100:103]
DTR v[170:171],v12 offset:20224
s_waitcnt lgkmcnt(6)
M16 v[104:107],a[96:99],v[156:159],v[104:107]
DTR v[172:173],v13 offset:19712
M16 v[108:111],a[100:103],v[156:159],v[108:111]
DTR v[174:175],v13 offset:20224
M16 v[112:115],a[104:107],v[144:147],v[112:115]
buffer_load_dwordx4 v9, s[12:15], s65 offen offset:3072 lds
M16 v[116:119],a[108:111],v[144:147],v[116:119]
CVT v56,v56,v57
CVT v57,v58,v59
M16 v[120:123],a[104:107],v[148:151],v[120:123]
CVT v58,v60,v61
CVT v59,v62,v63
M16 v[124:127],a[108:111],v[148:151],v[124:127]
s_mov_b32 s57, 16384
M16 v[128:131],a[104:107],v[152:155],v[128:131]
buffer_store_dwordx4 v[56:59], v15, s[16:19], s57 offen offset:2304 sc1
M16 v[132:135],a[108:111],v[152:155],v[132:135]
v_fmac_f32 v238, v252, v249
v_fmac_f32 v239, v199, v249
M16 v[136:139],a[104:107],v[156:159],v[136:139]
s_waitcnt vmcnt(22)
v_lshlrev_b32 v252, 16, v200
v_and_b32 v200, 0xffff0000, v200
M16 v[140:143],a[108:111],v[156:159],v[140:143]
v_fmac_f32 v232, v252, v250
v_fmac_f32 v233, v200, v250
v_lshlrev_b32 v252, 16, v201
v_and_b32 v201, 0xffff0000, v201
v_fmac_f32 v234, v252, v250
v_fmac_f32 v235, v201, v250
v_lshlrev_b32 v252, 16, v202
v_and_b32 v202, 0xffff0000, v202
s_waitcnt lgkmcnt(0)
s_waitcnt vmcnt(19)
s_barrier
M16 v[80:83],a[112:115],v[160:163],v[80:83]
DTR v[144:145],v12 offset:32768
s_add_u32 m0, s55, 16384
M16 v[84:87],a[116:119],v[160:163],v[84:87]
DTR v[146:147],v12 offset:33280
s_mov_b32 s65, 1048832
M16 v[88:91],a[112:115],v[164:167],v[88:91]
DTR v[148:149],v13 offset:32768
M16 v[92:95],a[116:119],v[164:167],v[92:95]
DTR v[150:151],v13 offset:33280
M16 v[96:99],a[112:115],v[168:171],v[96:99]
DTR v[152:153],v12 offset:33024
M16 v[100:103],a[116:119],v[168:171],v[100:103]
DTR v[154:155],v12 offset:33536
M16 v[104:107],a[112:115],v[172:175],v[104:107]
DTR v[156:157],v13 offset:33024
M16 v[108:111],a[116:119],v[172:175],v[108:111]
DTR v[158:159],v13 offset:33536
M16 v[112:115],a[120:123],v[160:163],v[112:115]
buffer_load_dwordx4 v6, s[12:15], s65 offen offset:0 lds
M16 v[116:119],a[124:127],v[160:163],v[116:119]
CVT v64,v64,v65
CVT v65,v66,v67
M16 v[120:123],a[120:123],v[164:167],v[120:123]
CVT v66,v68,v69
CVT v67,v70,v71
M16 v[124:127],a[124:127],v[164:167],v[124:127]
s_mov_b32 s57, 20480
M16 v[128:131],a[120:123],v[168:171],v[128:131]
buffer_store_dwordx4 v[64:67], v15, s[16:19], s57 offen offset:2048 sc1
M16 v[132:135],a[124:127],v[168:171],v[132:135]
v_fmac_f32 v236, v252, v250
v_fmac_f32 v237, v202, v250
M16 v[136:139],a[120:123],v[172:175],v[136:139]
v_lshlrev_b32 v252, 16, v203
v_and_b32 v203, 0xffff0000, v203
M16 v[140:143],a[124:127],v[172:175],v[140:143]
v_fmac_f32 v238, v252, v250
v_fmac_f32 v239, v203, v250
v_lshlrev_b32 v252, 16, v204
v_and_b32 v204, 0xffff0000, v204
v_fmac_f32 v232, v252, v251
v_fmac_f32 v233, v204, v251
v_lshlrev_b32 v252, 16, v205
v_and_b32 v205, 0xffff0000, v205
s_waitcnt lgkmcnt(6)
M16 v[80:83],a[128:131],v[144:147],v[80:83]
DTR v[160:161],v12 offset:33792
M16 v[84:87],a[132:135],v[144:147],v[84:87]
DTR v[162:163],v12 offset:34304
s_waitcnt lgkmcnt(6)
M16 v[88:91],a[128:131],v[148:151],v[88:91]
DTR v[164:165],v13 offset:33792
M16 v[92:95],a[132:135],v[148:151],v[92:95]
DTR v[166:167],v13 offset:34304
s_waitcnt lgkmcnt(6)
M16 v[96:99],a[128:131],v[152:155],v[96:99]
DTR v[168:169],v12 offset:34048
M16 v[100:103],a[132:135],v[152:155],v[100:103]
DTR v[170:171],v12 offset:34560
s_waitcnt lgkmcnt(6)
M16 v[104:107],a[128:131],v[156:159],v[104:107]
DTR v[172:173],v13 offset:34048
M16 v[108:111],a[132:135],v[156:159],v[108:111]
DTR v[174:175],v13 offset:34560
M16 v[112:115],a[136:139],v[144:147],v[112:115]
buffer_load_dwordx4 v7, s[12:15], s65 offen offset:1024 lds
M16 v[116:119],a[140:143],v[144:147],v[116:119]
CVT v72,v72,v73
CVT v73,v74,v75
M16 v[120:123],a[136:139],v[148:151],v[120:123]
CVT v74,v76,v77
CVT v75,v78,v79
M16 v[124:127],a[140:143],v[148:151],v[124:127]
s_mov_b32 s57, 20480
M16 v[128:131],a[136:139],v[152:155],v[128:131]
buffer_store_dwordx4 v[72:75], v15, s[16:19], s57 offen offset:2304 sc1
M16 v[132:135],a[140:143],v[152:155],v[132:135]
v_fmac_f32 v234, v252, v251
v_fmac_f32 v235, v205, v251
M16 v[136:139],a[136:139],v[156:159],v[136:139]
v_lshlrev_b32 v252, 16, v206
v_and_b32 v206, 0xffff0000, v206
M16 v[140:143],a[140:143],v[156:159],v[140:143]
v_fmac_f32 v236, v252, v251
v_fmac_f32 v237, v206, v251
v_lshlrev_b32 v252, 16, v207
v_and_b32 v207, 0xffff0000, v207
v_fmac_f32 v238, v252, v251
v_fmac_f32 v239, v207, v251
s_waitcnt vmcnt(22)
v_lshlrev_b32 v252, 16, v208
v_and_b32 v208, 0xffff0000, v208
s_waitcnt lgkmcnt(6)
M16 v[80:83],a[144:147],v[160:163],v[80:83]
DTR v[144:145],v12 offset:34816
M16 v[84:87],a[148:151],v[160:163],v[84:87]
DTR v[146:147],v12 offset:35328
s_waitcnt lgkmcnt(6)
M16 v[88:91],a[144:147],v[164:167],v[88:91]
DTR v[148:149],v13 offset:34816
M16 v[92:95],a[148:151],v[164:167],v[92:95]
DTR v[150:151],v13 offset:35328
s_waitcnt lgkmcnt(6)
M16 v[96:99],a[144:147],v[168:171],v[96:99]
DTR v[152:153],v12 offset:35072
M16 v[100:103],a[148:151],v[168:171],v[100:103]
DTR v[154:155],v12 offset:35584
s_waitcnt lgkmcnt(6)
M16 v[104:107],a[144:147],v[172:175],v[104:107]
DTR v[156:157],v13 offset:35072
M16 v[108:111],a[148:151],v[172:175],v[108:111]
DTR v[158:159],v13 offset:35584
M16 v[112:115],a[152:155],v[160:163],v[112:115]
buffer_load_dwordx4 v8, s[12:15], s65 offen offset:2048 lds
M16 v[116:119],a[156:159],v[160:163],v[116:119]
FML v240,v252,v248
FML v241,v208,v248
M16 v[120:123],a[152:155],v[164:167],v[120:123]
v_lshlrev_b32 v252, 16, v209
v_and_b32 v209, 0xffff0000, v209
M16 v[124:127],a[156:159],v[164:167],v[124:127]
FML v242,v252,v248
FML v243,v209,v248
M16 v[128:131],a[152:155],v[168:171],v[128:131]
v_lshlrev_b32 v252, 16, v210
v_and_b32 v210, 0xffff0000, v210
M16 v[132:135],a[156:159],v[168:171],v[132:135]
FML v244,v252,v248
FML v245,v210,v248
M16 v[136:139],a[152:155],v[172:175],v[136:139]
v_lshlrev_b32 v252, 16, v211
v_and_b32 v211, 0xffff0000, v211
M16 v[140:143],a[156:159],v[172:175],v[140:143]
s_waitcnt lgkmcnt(6)
M16 v[80:83],a[160:163],v[144:147],v[80:83]
DTR v[160:161],v12 offset:35840
M16 v[84:87],a[164:167],v[144:147],v[84:87]
DTR v[162:163],v12 offset:36352
s_waitcnt lgkmcnt(6)
M16 v[88:91],a[160:163],v[148:151],v[88:91]
DTR v[164:165],v13 offset:35840
M16 v[92:95],a[164:167],v[148:151],v[92:95]
DTR v[166:167],v13 offset:36352
s_waitcnt lgkmcnt(6)
M16 v[96:99],a[160:163],v[152:155],v[96:99]
DTR v[168:169],v12 offset:36096
M16 v[100:103],a[164:167],v[152:155],v[100:103]
DTR v[170:171],v12 offset:36608
s_waitcnt lgkmcnt(6)
M16 v[104:107],a[160:163],v[156:159],v[104:107]
DTR v[172:173],v13 offset:36096
M16 v[108:111],a[164:167],v[156:159],v[108:111]
DTR v[174:175],v13 offset:36608
M16 v[112:115],a[168:171],v[144:147],v[112:115]
buffer_load_dwordx4 v9, s[12:15], s65 offen offset:3072 lds
M16 v[116:119],a[172:175],v[144:147],v[116:119]
FML v246,v252,v248
FML v247,v211,v248
M16 v[120:123],a[168:171],v[148:151],v[120:123]
s_waitcnt vmcnt(22)
v_lshlrev_b32 v252, 16, v212
v_and_b32 v212, 0xffff0000, v212
M16 v[124:127],a[172:175],v[148:151],v[124:127]
v_fmac_f32 v240, v252, v249
v_fmac_f32 v241, v212, v249
M16 v[128:131],a[168:171],v[152:155],v[128:131]
v_lshlrev_b32 v252, 16, v213
v_and_b32 v213, 0xffff0000, v213
M16 v[132:135],a[172:175],v[152:155],v[132:135]
v_fmac_f32 v242, v252, v249
v_fmac_f32 v243, v213, v249
M16 v[136:139],a[168:171],v[156:159],v[136:139]
v_lshlrev_b32 v252, 16, v214
v_and_b32 v214, 0xffff0000, v214
M16 v[140:143],a[172:175],v[156:159],v[140:143]
s_waitcnt lgkmcnt(0)
s_waitcnt vmcnt(16)
s_barrier
M16 v[80:83],a[176:179],v[160:163],v[80:83]
DTR v[144:145],v12 offset:49152
s_add_u32 m0, s55, 32768
M16 v[84:87],a[180:183],v[160:163],v[84:87]
DTR v[146:147],v12 offset:49664
s_mov_b32 s65, 2097408
M16 v[88:91],a[176:179],v[164:167],v[88:91]
DTR v[148:149],v13 offset:49152
M16 v[92:95],a[180:183],v[164:167],v[92:95]
DTR v[150:151],v13 offset:49664
M16 v[96:99],a[176:179],v[168:171],v[96:99]
DTR v[152:153],v12 offset:49408
M16 v[100:103],a[180:183],v[168:171],v[100:103]
DTR v[154:155],v12 offset:49920
M16 v[104:107],a[176:179],v[172:175],v[104:107]
DTR v[156:157],v13 offset:49408
M16 v[108:111],a[180:183],v[172:175],v[108:111]
DTR v[158:159],v13 offset:49920
M16 v[112:115],a[184:187],v[160:163],v[112:115]
buffer_load_dwordx4 v6, s[12:15], s65 offen offset:0 lds
M16 v[116:119],a[188:191],v[160:163],v[116:119]
v_fmac_f32 v244, v252, v249
v_fmac_f32 v245, v214, v249
M16 v[120:123],a[184:187],v[164:167],v[120:123]
v_lshlrev_b32 v252, 16, v215
v_and_b32 v215, 0xffff0000, v215
M16 v[124:127],a[188:191],v[164:167],v[124:127]
v_fmac_f32 v246, v252, v249
v_fmac_f32 v247, v215, v249
M16 v[128:131],a[184:187],v[168:171],v[128:131]
v_lshlrev_b32 v252, 16, v216
v_and_b32 v216, 0xffff0000, v216
M16 v[132:135],a[188:191],v[168:171],v[132:135]
v_fmac_f32 v240, v252, v250
v_fmac_f32 v241, v216, v250
M16 v[136:139],a[184:187],v[172:175],v[136:139]
v_lshlrev_b32 v252, 16, v217
M16 v[140:143],a[188:191],v[172:175],v[140:143]
v_and_b32 v217, 0xffff0000, v217
s_waitcnt lgkmcnt(6)
M16 v[80:83],a[192:195],v[144:147],v[80:83]
DTR v[160:161],v12 offset:50176
M16 v[84:87],a[196:199],v[144:147],v[84:87]
DTR v[162:163],v12 offset:50688
s_waitcnt lgkmcnt(6)
M16 v[88:91],a[192:195],v[148:151],v[88:91]
DTR v[164:165],v13 offset:50176
M16 v[92:95],a[196:199],v[148:151],v[92:95]
DTR v[166:167],v13 offset:50688
s_waitcnt lgkmcnt(6)
M16 v[96:99],a[192:195],v[152:155],v[96:99]
DTR v[168:169],v12 offset:50432
M16 v[100:103],a[196:199],v[152:155],v[100:103]
DTR v[170:171],v12 offset:50944
s_waitcnt lgkmcnt(6)
M16 v[104:107],a[192:195],v[156:159],v[104:107]
DTR v[172:173],v13 offset:50432
M16 v[108:111],a[196:199],v[156:159],v[108:111]
DTR v[174:175],v13 offset:50944
M16 v[112:115],a[200:203],v[144:147],v[112:115]
buffer_load_dwordx4 v7, s[12:15], s65 offen offset:1024 lds
M16 v[116:119],a[204:207],v[144:147],v[116:119]
v_fmac_f32 v242, v252, v250
v_fmac_f32 v243, v217, v250
M16 v[120:123],a[200:203],v[148:151],v[120:123]
v_lshlrev_b32 v252, 16, v218
v_and_b32 v218, 0xffff0000, v218
M16 v[124:127],a[204:207],v[148:151],v[124:127]
v_fmac_f32 v244, v252, v250
v_fmac_f32 v245, v218, v250
M16 v[128:131],a[200:203],v[152:155],v[128:131]
v_lshlrev_b32 v252, 16, v219
v_and_b32 v219, 0xffff0000, v219
M16 v[132:135],a[204:207],v[152:155],v[132:135]
v_fmac_f32 v246, v252, v250
v_fmac_f32 v247, v219, v250
M16 v[136:139],a[200:203],v[156:159],v[136:139]
v_lshlrev_b32 v252, 16, v220
v_and_b32 v220, 0xffff0000, v220
M16 v[140:143],a[204:207],v[156:159],v[140:143]
s_waitcnt vmcnt(12)
buffer_load_dword v255, v5, s[4:7], s63 offen
s_add_u32 s63, s63, 16384
s_waitcnt lgkmcnt(6)
M16 v[80:83],a[208:211],v[160:163],v[80:83]
DTR v[144:145],v12 offset:51200
M16 v[84:87],a[212:215],v[160:163],v[84:87]
DTR v[146:147],v12 offset:51712
s_waitcnt lgkmcnt(6)
M16 v[88:91],a[208:211],v[164:167],v[88:91]
DTR v[148:149],v13 offset:51200
M16 v[92:95],a[212:215],v[164:167],v[92:95]
DTR v[150:151],v13 offset:51712
s_waitcnt lgkmcnt(6)
M16 v[96:99],a[208:211],v[168:171],v[96:99]
DTR v[152:153],v12 offset:51456
M16 v[100:103],a[212:215],v[168:171],v[100:103]
DTR v[154:155],v12 offset:51968
s_waitcnt lgkmcnt(6)
M16 v[104:107],a[208:211],v[172:175],v[104:107]
DTR v[156:157],v13 offset:51456
M16 v[108:111],a[212:215],v[172:175],v[108:111]
DTR v[158:159],v13 offset:51968
M16 v[112:115],a[216:219],v[160:163],v[112:115]
buffer_load_dwordx4 v8, s[12:15], s65 offen offset:2048 lds
M16 v[116:119],a[220:223],v[160:163],v[116:119]
v_fmac_f32 v240, v252, v251
v_fmac_f32 v241, v220, v251
M16 v[120:123],a[216:219],v[164:167],v[120:123]
v_lshlrev_b32 v252, 16, v221
v_and_b32 v221, 0xffff0000, v221
M16 v[124:127],a[220:223],v[164:167],v[124:127]
v_fmac_f32 v242, v252, v251
v_fmac_f32 v243, v221, v251
M16 v[128:131],a[216:219],v[168:171],v[128:131]
v_lshlrev_b32 v252, 16, v222
v_and_b32 v222, 0xffff0000, v222
M16 v[132:135],a[220:223],v[168:171],v[132:135]
v_fmac_f32 v244, v252, v251
v_fmac_f32 v245, v222, v251
M16 v[136:139],a[216:219],v[172:175],v[136:139]
v_lshlrev_b32 v252, 16, v223
v_and_b32 v223, 0xffff0000, v223
M16 v[140:143],a[220:223],v[172:175],v[140:143]
v_fmac_f32 v246, v252, v251
v_fmac_f32 v247, v223, v251
s_waitcnt lgkmcnt(6)
M16 v[80:83],a[224:227],v[144:147],v[80:83]
DTR v[160:161],v12 offset:52224
M16 v[84:87],a[228:231],v[144:147],v[84:87]
DTR v[162:163],v12 offset:52736
s_waitcnt lgkmcnt(6)
M16 v[88:91],a[224:227],v[148:151],v[88:91]
DTR v[164:165],v13 offset:52224
M16 v[92:95],a[228:231],v[148:151],v[92:95]
DTR v[166:167],v13 offset:52736
s_waitcnt lgkmcnt(6)
M16 v[96:99],a[224:227],v[152:155],v[96:99]
DTR v[168:169],v12 offset:52480
M16 v[100:103],a[228:231],v[152:155],v[100:103]
DTR v[170:171],v12 offset:52992
s_waitcnt lgkmcnt(6)
M16 v[104:107],a[224:227],v[156:159],v[104:107]
DTR v[172:173],v13 offset:52480
M16 v[108:111],a[228:231],v[156:159],v[108:111]
DTR v[174:175],v13 offset:52992
M16 v[112:115],a[232:235],v[144:147],v[112:115]
buffer_load_dwordx4 v9, s[12:15], s65 offen offset:3072 lds
M16 v[116:119],a[236:239],v[144:147],v[116:119]
v_mul_u32_u24 v14, 96, v1
s_mul_i32 s56, s3, 6144
M16 v[120:123],a[232:235],v[148:151],v[120:123]
s_add_u32 s56, s56, 65536
v_add_u32 v14, s56, v14
M16 v[124:127],a[236:239],v[148:151],v[124:127]
ds_write_b128 v14, v[224:227] offset:0
ds_write_b128 v14, v[228:231] offset:16
M16 v[128:131],a[232:235],v[152:155],v[128:131]
ds_write_b128 v14, v[232:235] offset:32
ds_write_b128 v14, v[236:239] offset:48
M16 v[132:135],a[236:239],v[152:155],v[132:135]
ds_write_b128 v14, v[240:243] offset:64
M16 v[136:139],a[232:235],v[156:159],v[136:139]
ds_write_b128 v14, v[244:247] offset:80
M16 v[140:143],a[236:239],v[156:159],v[140:143]
s_waitcnt lgkmcnt(0)
s_waitcnt vmcnt(12)
s_barrier
M16 v[80:83],a[240:243],v[160:163],v[80:83]
DTR v[144:145],v12 offset:0
s_add_u32 m0, s55, 49152
M16 v[84:87],a[244:247],v[160:163],v[84:87]
DTR v[146:147],v12 offset:512
s_mov_b32 s65, 3145984
M16 v[88:91],a[240:243],v[164:167],v[88:91]
DTR v[148:149],v13 offset:0
M16 v[92:95],a[244:247],v[164:167],v[92:95]
DTR v[150:151],v13 offset:512
M16 v[96:99],a[240:243],v[168:171],v[96:99]
DTR v[152:153],v12 offset:256
M16 v[100:103],a[244:247],v[168:171],v[100:103]
DTR v[154:155],v12 offset:768
M16 v[104:107],a[240:243],v[172:175],v[104:107]
DTR v[156:157],v13 offset:256
M16 v[108:111],a[244:247],v[172:175],v[108:111]
DTR v[158:159],v13 offset:768
M16 v[112:115],a[248:251],v[160:163],v[112:115]
buffer_load_dwordx4 v6, s[12:15], s65 offen offset:0 lds
M16 v[116:119],a[252:255],v[160:163],v[116:119]
v_lshrrev_b32 v14, 3, v1
v_mul_u32_u24 v14, 96, v14
M16 v[120:123],a[248:251],v[164:167],v[120:123]
v_lshl_add_u32 v14, v0, 2, v14
s_lshl_b32 s56, s3, 5
M16 v[124:127],a[252:255],v[164:167],v[124:127]
s_add_u32 s56, s56, 65536
v_add_u32 v14, s56, v14
M16 v[128:131],a[248:251],v[168:171],v[128:131]
ds_read_b32 v176, v14 offset:0
ds_read_b32 v177, v14 offset:768
M16 v[132:135],a[252:255],v[168:171],v[132:135]
ds_read_b32 v178, v14 offset:1536
ds_read_b32 v179, v14 offset:2304
M16 v[136:139],a[248:251],v[172:175],v[136:139]
ds_read_b32 v180, v14 offset:3072
ds_read_b32 v181, v14 offset:3840
M16 v[140:143],a[252:255],v[172:175],v[140:143]
ds_read_b32 v182, v14 offset:4608
ds_read_b32 v183, v14 offset:5376
ds_read_b32 v184, v14 offset:6144
ds_read_b32 v185, v14 offset:6912
ds_read_b32 v186, v14 offset:7680
ds_read_b32 v187, v14 offset:8448
ds_read_b32 v188, v14 offset:9216
ds_read_b32 v189, v14 offset:9984
ds_read_b32 v190, v14 offset:10752
s_waitcnt lgkmcnt(15)
M16 v[16:19],a[0:3],v[144:147],0
DTR v[160:161],v12 offset:1024
M16 v[20:23],a[4:7],v[144:147],0
DTR v[162:163],v12 offset:1536
s_waitcnt lgkmcnt(15)
M16 v[24:27],a[0:3],v[148:151],0
DTR v[164:165],v13 offset:1024
M16 v[28:31],a[4:7],v[148:151],0
DTR v[166:167],v13 offset:1536
s_waitcnt lgkmcnt(15)
M16 v[32:35],a[0:3],v[152:155],0
DTR v[168:169],v12 offset:1280
M16 v[36:39],a[4:7],v[152:155],0
DTR v[170:171],v12 offset:1792
s_waitcnt lgkmcnt(15)
M16 v[40:43],a[0:3],v[156:159],0
DTR v[172:173],v13 offset:1280
M16 v[44:47],a[4:7],v[156:159],0
DTR v[174:175],v13 offset:1792
M16 v[48:51],a[8:11],v[144:147],0
buffer_load_dwordx4 v7, s[12:15], s65 offen offset:1024 lds
M16 v[52:55],a[12:15],v[144:147],0
ds_read_b32 v191, v14 offset:11520
ds_read_b32 v192, v14 offset:12288
M16 v[56:59],a[8:11],v[148:151],0
ds_read_b32 v193, v14 offset:13056
ds_read_b32 v194, v14 offset:13824
M16 v[60:63],a[12:15],v[148:151],0
ds_read_b32 v195, v14 offset:14592
ds_read_b32 v196, v14 offset:15360
M16 v[64:67],a[8:11],v[152:155],0
ds_read_b32 v197, v14 offset:16128
ds_read_b32 v198, v14 offset:16896
M16 v[68:71],a[12:15],v[152:155],0
ds_read_b32 v199, v14 offset:17664
ds_read_b32 v200, v14 offset:18432
M16 v[72:75],a[8:11],v[156:159],0
ds_read_b32 v201, v14 offset:19200
ds_read_b32 v202, v14 offset:19968
M16 v[76:79],a[12:15],v[156:159],0
ds_read_b32 v203, v14 offset:20736
ds_read_b32 v204, v14 offset:21504
ds_read_b32 v205, v14 offset:22272
ds_read_b32 v206, v14 offset:23040
ds_read_b32 v207, v14 offset:23808
s_waitcnt lgkmcnt(15)
M16 v[16:19],a[16:19],v[160:163],v[16:19]
DTR v[144:145],v12 offset:2048
M16 v[20:23],a[20:23],v[160:163],v[20:23]
DTR v[146:147],v12 offset:2560
s_waitcnt lgkmcnt(15)
M16 v[24:27],a[16:19],v[164:167],v[24:27]
DTR v[148:149],v13 offset:2048
M16 v[28:31],a[20:23],v[164:167],v[28:31]
DTR v[150:151],v13 offset:2560
s_waitcnt lgkmcnt(15)
M16 v[32:35],a[16:19],v[168:171],v[32:35]
DTR v[152:153],v12 offset:2304
M16 v[36:39],a[20:23],v[168:171],v[36:39]
DTR v[154:155],v12 offset:2816
s_waitcnt lgkmcnt(15)
M16 v[40:43],a[16:19],v[172:175],v[40:43]
DTR v[156:157],v13 offset:2304
M16 v[44:47],a[20:23],v[172:175],v[44:47]
DTR v[158:159],v13 offset:2816
M16 v[48:51],a[24:27],v[160:163],v[48:51]
buffer_load_dwordx4 v8, s[12:15], s65 offen offset:2048 lds
M16 v[52:55],a[28:31],v[160:163],v[52:55]
CVT v80,v80,v81
CVT v81,v82,v83
M16 v[56:59],a[24:27],v[164:167],v[56:59]
CVT v82,v84,v85
CVT v83,v86,v87
M16 v[60:63],a[28:31],v[164:167],v[60:63]
s_mov_b32 s57, 24576
M16 v[64:67],a[24:27],v[168:171],v[64:67]
buffer_store_dwordx4 v[80:83], v15, s[16:19], s57 offen offset:0 sc1
M16 v[68:71],a[28:31],v[168:171],v[68:71]
M16 v[72:75],a[24:27],v[172:175],v[72:75]
M16 v[76:79],a[28:31],v[172:175],v[76:79]
s_waitcnt lgkmcnt(6)
M16 v[16:19],a[32:35],v[144:147],v[16:19]
DTR v[160:161],v12 offset:3072
M16 v[20:23],a[36:39],v[144:147],v[20:23]
DTR v[162:163],v12 offset:3584
s_waitcnt lgkmcnt(6)
M16 v[24:27],a[32:35],v[148:151],v[24:27]
DTR v[164:165],v13 offset:3072
M16 v[28:31],a[36:39],v[148:151],v[28:31]
DTR v[166:167],v13 offset:3584
s_waitcnt lgkmcnt(6)
M16 v[32:35],a[32:35],v[152:155],v[32:35]
DTR v[168:169],v12 offset:3328
M16 v[36:39],a[36:39],v[152:155],v[36:39]
DTR v[170:171],v12 offset:3840
s_waitcnt lgkmcnt(6)
M16 v[40:43],a[32:35],v[156:159],v[40:43]
DTR v[172:173],v13 offset:3328
M16 v[44:47],a[36:39],v[156:159],v[44:47]
DTR v[174:175],v13 offset:3840
M16 v[48:51],a[40:43],v[144:147],v[48:51]
buffer_load_dwordx4 v9, s[12:15], s65 offen offset:3072 lds
M16 v[52:55],a[44:47],v[144:147],v[52:55]
CVT v88,v88,v89
CVT v89,v90,v91
M16 v[56:59],a[40:43],v[148:151],v[56:59]
CVT v90,v92,v93
CVT v91,v94,v95
M16 v[60:63],a[44:47],v[148:151],v[60:63]
s_mov_b32 s57, 24576
M16 v[64:67],a[40:43],v[152:155],v[64:67]
buffer_store_dwordx4 v[88:91], v15, s[16:19], s57 offen offset:256 sc1
M16 v[68:71],a[44:47],v[152:155],v[68:71]
FAD v176,v176,v177
FAD v192,v192,v193
M16 v[72:75],a[40:43],v[156:159],v[72:75]
FAD v176,v176,v178
FAD v192,v192,v194
M16 v[76:79],a[44:47],v[156:159],v[76:79]
FAD v176,v176,v179
FAD v192,v192,v195
FAD v176,v176,v180
FAD v192,v192,v196
FAD v176,v176,v181
FAD v192,v192,v197
s_waitcnt lgkmcnt(0)
s_waitcnt vmcnt(11)
s_barrier
M16 v[16:19],a[48:51],v[160:163],v[16:19]
DTR v[144:145],v12 offset:16384
s_add_u32 m0, s55, 0
M16 v[20:23],a[52:55],v[160:163],v[20:23]
DTR v[146:147],v12 offset:16896
s_mov_b32 s65, 384
M16 v[24:27],a[48:51],v[164:167],v[24:27]
DTR v[148:149],v13 offset:16384
M16 v[28:31],a[52:55],v[164:167],v[28:31]
DTR v[150:151],v13 offset:16896
M16 v[32:35],a[48:51],v[168:171],v[32:35]
DTR v[152:153],v12 offset:16640
M16 v[36:39],a[52:55],v[168:171],v[36:39]
DTR v[154:155],v12 offset:17152
M16 v[40:43],a[48:51],v[172:175],v[40:43]
DTR v[156:157],v13 offset:16640
M16 v[44:47],a[52:55],v[172:175],v[44:47]
DTR v[158:159],v13 offset:17152
M16 v[48:51],a[56:59],v[160:163],v[48:51]
buffer_load_dwordx4 v6, s[12:15], s65 offen offset:0 lds
M16 v[52:55],a[60:63],v[160:163],v[52:55]
CVT v96,v96,v97
CVT v97,v98,v99
M16 v[56:59],a[56:59],v[164:167],v[56:59]
CVT v98,v100,v101
CVT v99,v102,v103
M16 v[60:63],a[60:63],v[164:167],v[60:63]
s_mov_b32 s57, 28672
M16 v[64:67],a[56:59],v[168:171],v[64:67]
buffer_store_dwordx4 v[96:99], v15, s[16:19], s57 offen offset:0 sc1
M16 v[68:71],a[60:63],v[168:171],v[68:71]
FAD v176,v176,v182
FAD v192,v192,v198
M16 v[72:75],a[56:59],v[172:175],v[72:75]
FAD v176,v176,v183
FAD v192,v192,v199
M16 v[76:79],a[60:63],v[172:175],v[76:79]
FAD v176,v176,v184
FAD v192,v192,v200
FAD v176,v176,v185
FAD v192,v192,v201
FAD v176,v176,v186
FAD v192,v192,v202
FAD v176,v176,v187
FAD v192,v192,v203
s_waitcnt lgkmcnt(6)
M16 v[16:19],a[64:67],v[144:147],v[16:19]
DTR v[160:161],v12 offset:17408
M16 v[20:23],a[68:71],v[144:147],v[20:23]
DTR v[162:163],v12 offset:17920
s_waitcnt lgkmcnt(6)
M16 v[24:27],a[64:67],v[148:151],v[24:27]
DTR v[164:165],v13 offset:17408
M16 v[28:31],a[68:71],v[148:151],v[28:31]
DTR v[166:167],v13 offset:17920
s_waitcnt lgkmcnt(6)
M16 v[32:35],a[64:67],v[152:155],v[32:35]
DTR v[168:169],v12 offset:17664
M16 v[36:39],a[68:71],v[152:155],v[36:39]
DTR v[170:171],v12 offset:18176
s_waitcnt lgkmcnt(6)
M16 v[40:43],a[64:67],v[156:159],v[40:43]
DTR v[172:173],v13 offset:17664
M16 v[44:47],a[68:71],v[156:159],v[44:47]
DTR v[174:175],v13 offset:18176
M16 v[48:51],a[72:75],v[144:147],v[48:51]
buffer_load_dwordx4 v7, s[12:15], s65 offen offset:1024 lds
M16 v[52:55],a[76:79],v[144:147],v[52:55]
CVT v104,v104,v105
CVT v105,v106,v107
M16 v[56:59],a[72:75],v[148:151],v[56:59]
CVT v106,v108,v109
CVT v107,v110,v111
M16 v[60:63],a[76:79],v[148:151],v[60:63]
s_mov_b32 s57, 28672
M16 v[64:67],a[72:75],v[152:155],v[64:67]
buffer_store_dwordx4 v[104:107], v15, s[16:19], s57 offen offset:256 sc1
M16 v[68:71],a[76:79],v[152:155],v[68:71]
FAD v176,v176,v188
FAD v192,v192,v204
M16 v[72:75],a[72:75],v[156:159],v[72:75]
FAD v176,v176,v189
FAD v192,v192,v205
M16 v[76:79],a[76:79],v[156:159],v[76:79]
FAD v176,v176,v190
FAD v192,v192,v206
FAD v176,v176,v191
FAD v192,v192,v207
FAD v176,v176,v192
s_mul_i32 s56, s61, 24576
s_lshl_b32 s57, s3, 13
s_add_u32 s56, s56, s57
s_lshl_b32 s57, s60, 8
s_add_u32 s56, s56, s57
s_cmp_eq_u32 s3, 3
s_cselect_b32 s56, 0x1000000, s56
v_lshlrev_b32 v14, 2, v1
buffer_store_dword v176, v14, s[28:31], s56 offen sc1
s_waitcnt lgkmcnt(6)
M16 v[16:19],a[80:83],v[160:163],v[16:19]
DTR v[144:145],v12 offset:18432
M16 v[20:23],a[84:87],v[160:163],v[20:23]
DTR v[146:147],v12 offset:18944
s_waitcnt lgkmcnt(6)
M16 v[24:27],a[80:83],v[164:167],v[24:27]
DTR v[148:149],v13 offset:18432
M16 v[28:31],a[84:87],v[164:167],v[28:31]
DTR v[150:151],v13 offset:18944
s_waitcnt lgkmcnt(6)
M16 v[32:35],a[80:83],v[168:171],v[32:35]
DTR v[152:153],v12 offset:18688
M16 v[36:39],a[84:87],v[168:171],v[36:39]
DTR v[154:155],v12 offset:19200
s_waitcnt lgkmcnt(6)
M16 v[40:43],a[80:83],v[172:175],v[40:43]
DTR v[156:157],v13 offset:18688
M16 v[44:47],a[84:87],v[172:175],v[44:47]
DTR v[158:159],v13 offset:19200
M16 v[48:51],a[88:91],v[160:163],v[48:51]
buffer_load_dwordx4 v8, s[12:15], s65 offen offset:2048 lds
M16 v[52:55],a[92:95],v[160:163],v[52:55]
CVT v112,v112,v113
CVT v113,v114,v115
M16 v[56:59],a[88:91],v[164:167],v[56:59]
CVT v114,v116,v117
CVT v115,v118,v119
M16 v[60:63],a[92:95],v[164:167],v[60:63]
s_mov_b32 s57, 24576
M16 v[64:67],a[88:91],v[168:171],v[64:67]
buffer_store_dwordx4 v[112:115], v15, s[16:19], s57 offen offset:2048 sc1
M16 v[68:71],a[92:95],v[168:171],v[68:71]
s_waitcnt vmcnt(15)
buffer_load_dword v255, v5, s[4:7], s63 offen
M16 v[72:75],a[88:91],v[172:175],v[72:75]
s_add_u32 s63, s63, 16384
M16 v[76:79],a[92:95],v[172:175],v[76:79]
s_waitcnt lgkmcnt(6)
M16 v[16:19],a[96:99],v[144:147],v[16:19]
DTR v[160:161],v12 offset:19456
M16 v[20:23],a[100:103],v[144:147],v[20:23]
DTR v[162:163],v12 offset:19968
s_waitcnt lgkmcnt(6)
M16 v[24:27],a[96:99],v[148:151],v[24:27]
DTR v[164:165],v13 offset:19456
M16 v[28:31],a[100:103],v[148:151],v[28:31]
DTR v[166:167],v13 offset:19968
s_waitcnt lgkmcnt(6)
M16 v[32:35],a[96:99],v[152:155],v[32:35]
DTR v[168:169],v12 offset:19712
M16 v[36:39],a[100:103],v[152:155],v[36:39]
DTR v[170:171],v12 offset:20224
s_waitcnt lgkmcnt(6)
M16 v[40:43],a[96:99],v[156:159],v[40:43]
DTR v[172:173],v13 offset:19712
M16 v[44:47],a[100:103],v[156:159],v[44:47]
DTR v[174:175],v13 offset:20224
M16 v[48:51],a[104:107],v[144:147],v[48:51]
buffer_load_dwordx4 v9, s[12:15], s65 offen offset:3072 lds
M16 v[52:55],a[108:111],v[144:147],v[52:55]
CVT v120,v120,v121
CVT v121,v122,v123
M16 v[56:59],a[104:107],v[148:151],v[56:59]
CVT v122,v124,v125
CVT v123,v126,v127
M16 v[60:63],a[108:111],v[148:151],v[60:63]
s_mov_b32 s57, 24576
M16 v[64:67],a[104:107],v[152:155],v[64:67]
buffer_store_dwordx4 v[120:123], v15, s[16:19], s57 offen offset:2304 sc1
M16 v[68:71],a[108:111],v[152:155],v[68:71]
M16 v[72:75],a[104:107],v[156:159],v[72:75]
M16 v[76:79],a[108:111],v[156:159],v[76:79]
s_waitcnt lgkmcnt(0)
s_waitcnt vmcnt(16)
s_barrier
M16 v[16:19],a[112:115],v[160:163],v[16:19]
DTR v[144:145],v12 offset:32768
s_add_u32 m0, s55, 16384
M16 v[20:23],a[116:119],v[160:163],v[20:23]
DTR v[146:147],v12 offset:33280
s_mov_b32 s65, 1048960
M16 v[24:27],a[112:115],v[164:167],v[24:27]
DTR v[148:149],v13 offset:32768
M16 v[28:31],a[116:119],v[164:167],v[28:31]
DTR v[150:151],v13 offset:33280
M16 v[32:35],a[112:115],v[168:171],v[32:35]
DTR v[152:153],v12 offset:33024
M16 v[36:39],a[116:119],v[168:171],v[36:39]
DTR v[154:155],v12 offset:33536
M16 v[40:43],a[112:115],v[172:175],v[40:43]
DTR v[156:157],v13 offset:33024
M16 v[44:47],a[116:119],v[172:175],v[44:47]
DTR v[158:159],v13 offset:33536
M16 v[48:51],a[120:123],v[160:163],v[48:51]
buffer_load_dwordx4 v6, s[12:15], s65 offen offset:0 lds
M16 v[52:55],a[124:127],v[160:163],v[52:55]
CVT v128,v128,v129
CVT v129,v130,v131
M16 v[56:59],a[120:123],v[164:167],v[56:59]
CVT v130,v132,v133
CVT v131,v134,v135
M16 v[60:63],a[124:127],v[164:167],v[60:63]
s_mov_b32 s57, 28672
M16 v[64:67],a[120:123],v[168:171],v[64:67]
M16 v[68:71],a[124:127],v[168:171],v[68:71]
buffer_store_dwordx4 v[128:131], v15, s[16:19], s57 offen offset:2048 sc1
M16 v[72:75],a[120:123],v[172:175],v[72:75]
M16 v[76:79],a[124:127],v[172:175],v[76:79]
s_waitcnt lgkmcnt(6)
M16 v[16:19],a[128:131],v[144:147],v[16:19]
DTR v[160:161],v12 offset:33792
M16 v[20:23],a[132:135],v[144:147],v[20:23]
DTR v[162:163],v12 offset:34304
s_waitcnt lgkmcnt(6)
M16 v[24:27],a[128:131],v[148:151],v[24:27]
DTR v[164:165],v13 offset:33792
M16 v[28:31],a[132:135],v[148:151],v[28:31]
DTR v[166:167],v13 offset:34304
s_waitcnt lgkmcnt(6)
M16 v[32:35],a[128:131],v[152:155],v[32:35]
DTR v[168:169],v12 offset:34048
M16 v[36:39],a[132:135],v[152:155],v[36:39]
DTR v[170:171],v12 offset:34560
s_waitcnt lgkmcnt(6)
M16 v[40:43],a[128:131],v[156:159],v[40:43]
DTR v[172:173],v13 offset:34048
M16 v[44:47],a[132:135],v[156:159],v[44:47]
DTR v[174:175],v13 offset:34560
M16 v[48:51],a[136:139],v[144:147],v[48:51]
buffer_load_dwordx4 v7, s[12:15], s65 offen offset:1024 lds
M16 v[52:55],a[140:143],v[144:147],v[52:55]
CVT v136,v136,v137
CVT v137,v138,v139
M16 v[56:59],a[136:139],v[148:151],v[56:59]
CVT v138,v140,v141
CVT v139,v142,v143
M16 v[60:63],a[140:143],v[148:151],v[60:63]
s_mov_b32 s57, 28672
M16 v[64:67],a[136:139],v[152:155],v[64:67]
buffer_store_dwordx4 v[136:139], v15, s[16:19], s57 offen offset:2304 sc1
M16 v[68:71],a[140:143],v[152:155],v[68:71]
M16 v[72:75],a[136:139],v[156:159],v[72:75]
M16 v[76:79],a[140:143],v[156:159],v[76:79]
s_waitcnt lgkmcnt(6)
M16 v[16:19],a[144:147],v[160:163],v[16:19]
DTR v[144:145],v12 offset:34816
M16 v[20:23],a[148:151],v[160:163],v[20:23]
DTR v[146:147],v12 offset:35328
s_waitcnt lgkmcnt(6)
M16 v[24:27],a[144:147],v[164:167],v[24:27]
DTR v[148:149],v13 offset:34816
M16 v[28:31],a[148:151],v[164:167],v[28:31]
DTR v[150:151],v13 offset:35328
s_waitcnt lgkmcnt(6)
M16 v[32:35],a[144:147],v[168:171],v[32:35]
DTR v[152:153],v12 offset:35072
M16 v[36:39],a[148:151],v[168:171],v[36:39]
DTR v[154:155],v12 offset:35584
s_waitcnt lgkmcnt(6)
M16 v[40:43],a[144:147],v[172:175],v[40:43]
DTR v[156:157],v13 offset:35072
M16 v[44:47],a[148:151],v[172:175],v[44:47]
DTR v[158:159],v13 offset:35584
M16 v[48:51],a[152:155],v[160:163],v[48:51]
buffer_load_dwordx4 v8, s[12:15], s65 offen offset:2048 lds
M16 v[52:55],a[156:159],v[160:163],v[52:55]
M16 v[56:59],a[152:155],v[164:167],v[56:59]
M16 v[60:63],a[156:159],v[164:167],v[60:63]
M16 v[64:67],a[152:155],v[168:171],v[64:67]
M16 v[68:71],a[156:159],v[168:171],v[68:71]
M16 v[72:75],a[152:155],v[172:175],v[72:75]
M16 v[76:79],a[156:159],v[172:175],v[76:79]
s_waitcnt lgkmcnt(6)
M16 v[16:19],a[160:163],v[144:147],v[16:19]
DTR v[160:161],v12 offset:35840
M16 v[20:23],a[164:167],v[144:147],v[20:23]
DTR v[162:163],v12 offset:36352
s_waitcnt lgkmcnt(6)
M16 v[24:27],a[160:163],v[148:151],v[24:27]
DTR v[164:165],v13 offset:35840
M16 v[28:31],a[164:167],v[148:151],v[28:31]
DTR v[166:167],v13 offset:36352
s_waitcnt lgkmcnt(6)
M16 v[32:35],a[160:163],v[152:155],v[32:35]
DTR v[168:169],v12 offset:36096
M16 v[36:39],a[164:167],v[152:155],v[36:39]
DTR v[170:171],v12 offset:36608
s_waitcnt lgkmcnt(6)
M16 v[40:43],a[160:163],v[156:159],v[40:43]
DTR v[172:173],v13 offset:36096
M16 v[44:47],a[164:167],v[156:159],v[44:47]
DTR v[174:175],v13 offset:36608
M16 v[48:51],a[168:171],v[144:147],v[48:51]
buffer_load_dwordx4 v9, s[12:15], s65 offen offset:3072 lds
M16 v[52:55],a[172:175],v[144:147],v[52:55]
M16 v[56:59],a[168:171],v[148:151],v[56:59]
M16 v[60:63],a[172:175],v[148:151],v[60:63]
M16 v[64:67],a[168:171],v[152:155],v[64:67]
M16 v[68:71],a[172:175],v[152:155],v[68:71]
M16 v[72:75],a[168:171],v[156:159],v[72:75]
M16 v[76:79],a[172:175],v[156:159],v[76:79]
s_waitcnt lgkmcnt(0)
s_waitcnt vmcnt(11)
s_barrier
M16 v[16:19],a[176:179],v[160:163],v[16:19]
DTR v[144:145],v12 offset:49152
s_add_u32 m0, s55, 32768
M16 v[20:23],a[180:183],v[160:163],v[20:23]
DTR v[146:147],v12 offset:49664
M16 v[24:27],a[176:179],v[164:167],v[24:27]
DTR v[148:149],v13 offset:49152
s_mov_b32 s65, 2097536
M16 v[28:31],a[180:183],v[164:167],v[28:31]
DTR v[150:151],v13 offset:49664
M16 v[32:35],a[176:179],v[168:171],v[32:35]
DTR v[152:153],v12 offset:49408
M16 v[36:39],a[180:183],v[168:171],v[36:39]
DTR v[154:155],v12 offset:49920
M16 v[40:43],a[176:179],v[172:175],v[40:43]
DTR v[156:157],v13 offset:49408
M16 v[44:47],a[180:183],v[172:175],v[44:47]
DTR v[158:159],v13 offset:49920
M16 v[48:51],a[184:187],v[160:163],v[48:51]
buffer_load_dwordx4 v6, s[12:15], s65 offen offset:0 lds
M16 v[52:55],a[188:191],v[160:163],v[52:55]
M16 v[56:59],a[184:187],v[164:167],v[56:59]
buffer_atomic_add v253, v254, s[36:39], 0 offen sc0 sc1
M16 v[60:63],a[188:191],v[164:167],v[60:63]
M16 v[64:67],a[184:187],v[168:171],v[64:67]
M16 v[68:71],a[188:191],v[168:171],v[68:71]
M16 v[72:75],a[184:187],v[172:175],v[72:75]
M16 v[76:79],a[188:191],v[172:175],v[76:79]
s_waitcnt lgkmcnt(6)
M16 v[16:19],a[192:195],v[144:147],v[16:19]
DTR v[160:161],v12 offset:50176
M16 v[20:23],a[196:199],v[144:147],v[20:23]
DTR v[162:163],v12 offset:50688
s_waitcnt lgkmcnt(6)
M16 v[24:27],a[192:195],v[148:151],v[24:27]
DTR v[164:165],v13 offset:50176
M16 v[28:31],a[196:199],v[148:151],v[28:31]
DTR v[166:167],v13 offset:50688
s_waitcnt lgkmcnt(6)
M16 v[32:35],a[192:195],v[152:155],v[32:35]
DTR v[168:169],v12 offset:50432
M16 v[36:39],a[196:199],v[152:155],v[36:39]
DTR v[170:171],v12 offset:50944
s_waitcnt lgkmcnt(6)
M16 v[40:43],a[192:195],v[156:159],v[40:43]
DTR v[172:173],v13 offset:50432
M16 v[44:47],a[196:199],v[156:159],v[44:47]
DTR v[174:175],v13 offset:50944
M16 v[48:51],a[200:203],v[144:147],v[48:51]
buffer_load_dwordx4 v7, s[12:15], s65 offen offset:1024 lds
M16 v[52:55],a[204:207],v[144:147],v[52:55]
M16 v[56:59],a[200:203],v[148:151],v[56:59]
M16 v[60:63],a[204:207],v[148:151],v[60:63]
M16 v[64:67],a[200:203],v[152:155],v[64:67]
M16 v[68:71],a[204:207],v[152:155],v[68:71]
M16 v[72:75],a[200:203],v[156:159],v[72:75]
M16 v[76:79],a[204:207],v[156:159],v[76:79]
s_waitcnt lgkmcnt(6)
M16 v[16:19],a[208:211],v[160:163],v[16:19]
DTR v[144:145],v12 offset:51200
M16 v[20:23],a[212:215],v[160:163],v[20:23]
DTR v[146:147],v12 offset:51712
s_waitcnt lgkmcnt(6)
M16 v[24:27],a[208:211],v[164:167],v[24:27]
DTR v[148:149],v13 offset:51200
M16 v[28:31],a[212:215],v[164:167],v[28:31]
DTR v[150:151],v13 offset:51712
s_waitcnt lgkmcnt(6)
M16 v[32:35],a[208:211],v[168:171],v[32:35]
DTR v[152:153],v12 offset:51456
M16 v[36:39],a[212:215],v[168:171],v[36:39]
DTR v[154:155],v12 offset:51968
s_waitcnt lgkmcnt(6)
M16 v[40:43],a[208:211],v[172:175],v[40:43]
DTR v[156:157],v13 offset:51456
M16 v[44:47],a[212:215],v[172:175],v[44:47]
DTR v[158:159],v13 offset:51968
M16 v[48:51],a[216:219],v[160:163],v[48:51]
buffer_load_dwordx4 v8, s[12:15], s65 offen offset:2048 lds
M16 v[52:55],a[220:223],v[160:163],v[52:55]
M16 v[56:59],a[216:219],v[164:167],v[56:59]
M16 v[60:63],a[220:223],v[164:167],v[60:63]
M16 v[64:67],a[216:219],v[168:171],v[64:67]
M16 v[68:71],a[220:223],v[168:171],v[68:71]
M16 v[72:75],a[216:219],v[172:175],v[72:75]
M16 v[76:79],a[220:223],v[172:175],v[76:79]
s_waitcnt lgkmcnt(6)
M16 v[16:19],a[224:227],v[144:147],v[16:19]
DTR v[160:161],v12 offset:52224
M16 v[20:23],a[228:231],v[144:147],v[20:23]
DTR v[162:163],v12 offset:52736
s_waitcnt lgkmcnt(6)
M16 v[24:27],a[224:227],v[148:151],v[24:27]
DTR v[164:165],v13 offset:52224
M16 v[28:31],a[228:231],v[148:151],v[28:31]
DTR v[166:167],v13 offset:52736
s_waitcnt lgkmcnt(6)
M16 v[32:35],a[224:227],v[152:155],v[32:35]
DTR v[168:169],v12 offset:52480
M16 v[36:39],a[228:231],v[152:155],v[36:39]
DTR v[170:171],v12 offset:52992
s_waitcnt lgkmcnt(6)
M16 v[40:43],a[224:227],v[156:159],v[40:43]
DTR v[172:173],v13 offset:52480
M16 v[44:47],a[228:231],v[156:159],v[44:47]
DTR v[174:175],v13 offset:52992
M16 v[48:51],a[232:235],v[144:147],v[48:51]
buffer_load_dwordx4 v9, s[12:15], s65 offen offset:3072 lds
M16 v[52:55],a[236:239],v[144:147],v[52:55]
s_waitcnt vmcnt(13)
buffer_load_dword v255, v5, s[4:7], s63 offen
M16 v[56:59],a[232:235],v[148:151],v[56:59]
M16 v[60:63],a[236:239],v[148:151],v[60:63]
M16 v[64:67],a[232:235],v[152:155],v[64:67]
s_add_u32 s63, s63, 16384
M16 v[68:71],a[236:239],v[152:155],v[68:71]
M16 v[72:75],a[232:235],v[156:159],v[72:75]
M16 v[76:79],a[236:239],v[156:159],v[76:79]
s_waitcnt lgkmcnt(0)
s_waitcnt vmcnt(13)
s_barrier
M16 v[16:19],a[240:243],v[160:163],v[16:19]
DTR v[144:145],v12 offset:0
s_add_u32 m0, s55, 49152
M16 v[20:23],a[244:247],v[160:163],v[20:23]
DTR v[146:147],v12 offset:512
M16 v[24:27],a[240:243],v[164:167],v[24:27]
DTR v[148:149],v13 offset:0
M16 v[28:31],a[244:247],v[164:167],v[28:31]
DTR v[150:151],v13 offset:512
M16 v[32:35],a[240:243],v[168:171],v[32:35]
DTR v[152:153],v12 offset:256
s_mov_b32 s65, 3146112
M16 v[36:39],a[244:247],v[168:171],v[36:39]
DTR v[154:155],v12 offset:768
M16 v[40:43],a[240:243],v[172:175],v[40:43]
DTR v[156:157],v13 offset:256
M16 v[44:47],a[244:247],v[172:175],v[44:47]
DTR v[158:159],v13 offset:768
M16 v[48:51],a[248:251],v[160:163],v[48:51]
buffer_load_dwordx4 v6, s[12:15], s65 offen offset:0 lds
M16 v[52:55],a[252:255],v[160:163],v[52:55]
M16 v[56:59],a[248:251],v[164:167],v[56:59]
M16 v[60:63],a[252:255],v[164:167],v[60:63]
M16 v[64:67],a[248:251],v[168:171],v[64:67]
M16 v[68:71],a[252:255],v[168:171],v[68:71]
M16 v[72:75],a[248:251],v[172:175],v[72:75]
M16 v[76:79],a[252:255],v[172:175],v[76:79]
s_waitcnt lgkmcnt(0)
M16 v[80:83],a[0:3],v[144:147],0
DTR v[160:161],v12 offset:1024
M16 v[84:87],a[4:7],v[144:147],0
DTR v[162:163],v12 offset:1536
M16 v[88:91],a[0:3],v[148:151],0
DTR v[164:165],v13 offset:1024
M16 v[92:95],a[4:7],v[148:151],0
DTR v[166:167],v13 offset:1536
M16 v[96:99],a[0:3],v[152:155],0
DTR v[168:169],v12 offset:1280
M16 v[100:103],a[4:7],v[152:155],0
DTR v[170:171],v12 offset:1792
M16 v[104:107],a[0:3],v[156:159],0
DTR v[172:173],v13 offset:1280
M16 v[108:111],a[4:7],v[156:159],0
DTR v[174:175],v13 offset:1792
M16 v[112:115],a[8:11],v[144:147],0
buffer_load_dwordx4 v7, s[12:15], s65 offen offset:1024 lds
M16 v[116:119],a[12:15],v[144:147],0
M16 v[120:123],a[8:11],v[148:151],0
M16 v[124:127],a[12:15],v[148:151],0
M16 v[128:131],a[8:11],v[152:155],0
M16 v[132:135],a[12:15],v[152:155],0
M16 v[136:139],a[8:11],v[156:159],0
M16 v[140:143],a[12:15],v[156:159],0
s_waitcnt lgkmcnt(6)
M16 v[80:83],a[16:19],v[160:163],v[80:83]
DTR v[144:145],v12 offset:2048
M16 v[84:87],a[20:23],v[160:163],v[84:87]
DTR v[146:147],v12 offset:2560
s_waitcnt lgkmcnt(6)
M16 v[88:91],a[16:19],v[164:167],v[88:91]
DTR v[148:149],v13 offset:2048
M16 v[92:95],a[20:23],v[164:167],v[92:95]
DTR v[150:151],v13 offset:2560
s_waitcnt lgkmcnt(6)
M16 v[96:99],a[16:19],v[168:171],v[96:99]
DTR v[152:153],v12 offset:2304
M16 v[100:103],a[20:23],v[168:171],v[100:103]
DTR v[154:155],v12 offset:2816
s_waitcnt lgkmcnt(6)
M16 v[104:107],a[16:19],v[172:175],v[104:107]
DTR v[156:157],v13 offset:2304
M16 v[108:111],a[20:23],v[172:175],v[108:111]
DTR v[158:159],v13 offset:2816
M16 v[112:115],a[24:27],v[160:163],v[112:115]
buffer_load_dwordx4 v8, s[12:15], s65 offen offset:2048 lds
M16 v[116:119],a[28:31],v[160:163],v[116:119]
CVT v16,v16,v17
CVT v17,v18,v19
M16 v[120:123],a[24:27],v[164:167],v[120:123]
CVT v18,v20,v21
CVT v19,v22,v23
M16 v[124:127],a[28:31],v[164:167],v[124:127]
s_mov_b32 s57, 1064960
M16 v[128:131],a[24:27],v[168:171],v[128:131]
buffer_store_dwordx4 v[16:19], v15, s[16:19], s57 offen offset:0 sc1
M16 v[132:135],a[28:31],v[168:171],v[132:135]
M16 v[136:139],a[24:27],v[172:175],v[136:139]
M16 v[140:143],a[28:31],v[172:175],v[140:143]
s_waitcnt lgkmcnt(6)
M16 v[80:83],a[32:35],v[144:147],v[80:83]
DTR v[160:161],v12 offset:3072
M16 v[84:87],a[36:39],v[144:147],v[84:87]
DTR v[162:163],v12 offset:3584
s_waitcnt lgkmcnt(6)
M16 v[88:91],a[32:35],v[148:151],v[88:91]
DTR v[164:165],v13 offset:3072
M16 v[92:95],a[36:39],v[148:151],v[92:95]
DTR v[166:167],v13 offset:3584
s_waitcnt lgkmcnt(6)
M16 v[96:99],a[32:35],v[152:155],v[96:99]
DTR v[168:169],v12 offset:3328
M16 v[100:103],a[36:39],v[152:155],v[100:103]
DTR v[170:171],v12 offset:3840
s_waitcnt lgkmcnt(6)
M16 v[104:107],a[32:35],v[156:159],v[104:107]
DTR v[172:173],v13 offset:3328
M16 v[108:111],a[36:39],v[156:159],v[108:111]
DTR v[174:175],v13 offset:3840
M16 v[112:115],a[40:43],v[144:147],v[112:115]
buffer_load_dwordx4 v9, s[12:15], s65 offen offset:3072 lds
M16 v[116:119],a[44:47],v[144:147],v[116:119]
CVT v24,v24,v25
CVT v25,v26,v27
M16 v[120:123],a[40:43],v[148:151],v[120:123]
CVT v26,v28,v29
CVT v27,v30,v31
M16 v[124:127],a[44:47],v[148:151],v[124:127]
s_mov_b32 s57, 1064960
M16 v[128:131],a[40:43],v[152:155],v[128:131]
buffer_store_dwordx4 v[24:27], v15, s[16:19], s57 offen offset:256 sc1
M16 v[132:135],a[44:47],v[152:155],v[132:135]
v_lshrrev_b32 v4, 3, v1
v_lshlrev_b32 v4, 6, v4
M16 v[136:139],a[40:43],v[156:159],v[136:139]
s_lshl_b32 s56, s3, 9
v_lshl_add_u32 v4, v0, 11, v4
M16 v[140:143],a[44:47],v[156:159],v[140:143]
s_lshl_b32 s57, s2, 14
s_add_u32 s56, s56, s57
s_waitcnt vmcnt(6)
buffer_load_dword v255, v4, s[32:35], s56 offen
s_waitcnt lgkmcnt(0)
s_barrier
M16 v[80:83],a[48:51],v[160:163],v[80:83]
DTR v[144:145],v12 offset:16384
CVT v32,v32,v33
M16 v[84:87],a[52:55],v[160:163],v[84:87]
DTR v[146:147],v12 offset:16896
M16 v[88:91],a[48:51],v[164:167],v[88:91]
DTR v[148:149],v13 offset:16384
CVT v33,v34,v35
M16 v[92:95],a[52:55],v[164:167],v[92:95]
DTR v[150:151],v13 offset:16896
M16 v[96:99],a[48:51],v[168:171],v[96:99]
DTR v[152:153],v12 offset:16640
CVT v34,v36,v37
M16 v[100:103],a[52:55],v[168:171],v[100:103]
DTR v[154:155],v12 offset:17152
M16 v[104:107],a[48:51],v[172:175],v[104:107]
DTR v[156:157],v13 offset:16640
CVT v35,v38,v39
M16 v[108:111],a[52:55],v[172:175],v[108:111]
DTR v[158:159],v13 offset:17152
M16 v[112:115],a[56:59],v[160:163],v[112:115]
M16 v[116:119],a[60:63],v[160:163],v[116:119]
s_mov_b32 s57, 1069056
M16 v[120:123],a[56:59],v[164:167],v[120:123]
M16 v[124:127],a[60:63],v[164:167],v[124:127]
buffer_store_dwordx4 v[32:35], v15, s[16:19], s57 offen offset:0 sc1
M16 v[128:131],a[56:59],v[168:171],v[128:131]
M16 v[132:135],a[60:63],v[168:171],v[132:135]
M16 v[136:139],a[56:59],v[172:175],v[136:139]
M16 v[140:143],a[60:63],v[172:175],v[140:143]
s_waitcnt lgkmcnt(6)
M16 v[80:83],a[64:67],v[144:147],v[80:83]
DTR v[160:161],v12 offset:17408
CVT v40,v40,v41
M16 v[84:87],a[68:71],v[144:147],v[84:87]
DTR v[162:163],v12 offset:17920
s_waitcnt lgkmcnt(6)
M16 v[88:91],a[64:67],v[148:151],v[88:91]
DTR v[164:165],v13 offset:17408
CVT v41,v42,v43
M16 v[92:95],a[68:71],v[148:151],v[92:95]
DTR v[166:167],v13 offset:17920
s_waitcnt lgkmcnt(6)
M16 v[96:99],a[64:67],v[152:155],v[96:99]
DTR v[168:169],v12 offset:17664
CVT v42,v44,v45
M16 v[100:103],a[68:71],v[152:155],v[100:103]
DTR v[170:171],v12 offset:18176
s_waitcnt lgkmcnt(6)
M16 v[104:107],a[64:67],v[156:159],v[104:107]
DTR v[172:173],v13 offset:17664
CVT v43,v46,v47
M16 v[108:111],a[68:71],v[156:159],v[108:111]
DTR v[174:175],v13 offset:18176
M16 v[112:115],a[72:75],v[144:147],v[112:115]
M16 v[116:119],a[76:79],v[144:147],v[116:119]
s_mov_b32 s57, 1069056
M16 v[120:123],a[72:75],v[148:151],v[120:123]
M16 v[124:127],a[76:79],v[148:151],v[124:127]
buffer_store_dwordx4 v[40:43], v15, s[16:19], s57 offen offset:256 sc1
M16 v[128:131],a[72:75],v[152:155],v[128:131]
M16 v[132:135],a[76:79],v[152:155],v[132:135]
M16 v[136:139],a[72:75],v[156:159],v[136:139]
M16 v[140:143],a[76:79],v[156:159],v[140:143]
s_waitcnt lgkmcnt(6)
M16 v[80:83],a[80:83],v[160:163],v[80:83]
DTR v[144:145],v12 offset:18432
CVT v48,v48,v49
M16 v[84:87],a[84:87],v[160:163],v[84:87]
DTR v[146:147],v12 offset:18944
s_waitcnt lgkmcnt(6)
M16 v[88:91],a[80:83],v[164:167],v[88:91]
DTR v[148:149],v13 offset:18432
CVT v49,v50,v51
M16 v[92:95],a[84:87],v[164:167],v[92:95]
DTR v[150:151],v13 offset:18944
s_waitcnt lgkmcnt(6)
M16 v[96:99],a[80:83],v[168:171],v[96:99]
DTR v[152:153],v12 offset:18688
CVT v50,v52,v53
M16 v[100:103],a[84:87],v[168:171],v[100:103]
DTR v[154:155],v12 offset:19200
s_waitcnt lgkmcnt(6)
M16 v[104:107],a[80:83],v[172:175],v[104:107]
DTR v[156:157],v13 offset:18688
CVT v51,v54,v55
M16 v[108:111],a[84:87],v[172:175],v[108:111]
DTR v[158:159],v13 offset:19200
M16 v[112:115],a[88:91],v[160:163],v[112:115]
M16 v[116:119],a[92:95],v[160:163],v[116:119]
s_mov_b32 s57, 1064960
M16 v[120:123],a[88:91],v[164:167],v[120:123]
M16 v[124:127],a[92:95],v[164:167],v[124:127]
buffer_store_dwordx4 v[48:51], v15, s[16:19], s57 offen offset:2048 sc1
M16 v[128:131],a[88:91],v[168:171],v[128:131]
M16 v[132:135],a[92:95],v[168:171],v[132:135]
M16 v[136:139],a[88:91],v[172:175],v[136:139]
M16 v[140:143],a[92:95],v[172:175],v[140:143]
s_waitcnt lgkmcnt(6)
M16 v[80:83],a[96:99],v[144:147],v[80:83]
DTR v[160:161],v12 offset:19456
CVT v56,v56,v57
M16 v[84:87],a[100:103],v[144:147],v[84:87]
DTR v[162:163],v12 offset:19968
s_waitcnt lgkmcnt(6)
M16 v[88:91],a[96:99],v[148:151],v[88:91]
DTR v[164:165],v13 offset:19456
CVT v57,v58,v59
M16 v[92:95],a[100:103],v[148:151],v[92:95]
DTR v[166:167],v13 offset:19968
s_waitcnt lgkmcnt(6)
M16 v[96:99],a[96:99],v[152:155],v[96:99]
DTR v[168:169],v12 offset:19712
CVT v58,v60,v61
M16 v[100:103],a[100:103],v[152:155],v[100:103]
DTR v[170:171],v12 offset:20224
s_waitcnt lgkmcnt(6)
M16 v[104:107],a[96:99],v[156:159],v[104:107]
DTR v[172:173],v13 offset:19712
CVT v59,v62,v63
M16 v[108:111],a[100:103],v[156:159],v[108:111]
DTR v[174:175],v13 offset:20224
M16 v[112:115],a[104:107],v[144:147],v[112:115]
M16 v[116:119],a[108:111],v[144:147],v[116:119]
s_mov_b32 s57, 1064960
M16 v[120:123],a[104:107],v[148:151],v[120:123]
M16 v[124:127],a[108:111],v[148:151],v[124:127]
buffer_store_dwordx4 v[56:59], v15, s[16:19], s57 offen offset:2304 sc1
M16 v[128:131],a[104:107],v[152:155],v[128:131]
M16 v[132:135],a[108:111],v[152:155],v[132:135]
M16 v[136:139],a[104:107],v[156:159],v[136:139]
M16 v[140:143],a[108:111],v[156:159],v[140:143]
s_waitcnt lgkmcnt(0)
s_barrier
M16 v[80:83],a[112:115],v[160:163],v[80:83]
DTR v[144:145],v12 offset:32768
CVT v64,v64,v65
M16 v[84:87],a[116:119],v[160:163],v[84:87]
DTR v[146:147],v12 offset:33280
M16 v[88:91],a[112:115],v[164:167],v[88:91]
DTR v[148:149],v13 offset:32768
CVT v65,v66,v67
M16 v[92:95],a[116:119],v[164:167],v[92:95]
DTR v[150:151],v13 offset:33280
M16 v[96:99],a[112:115],v[168:171],v[96:99]
DTR v[152:153],v12 offset:33024
CVT v66,v68,v69
M16 v[100:103],a[116:119],v[168:171],v[100:103]
DTR v[154:155],v12 offset:33536
M16 v[104:107],a[112:115],v[172:175],v[104:107]
DTR v[156:157],v13 offset:33024
CVT v67,v70,v71
M16 v[108:111],a[116:119],v[172:175],v[108:111]
DTR v[158:159],v13 offset:33536
M16 v[112:115],a[120:123],v[160:163],v[112:115]
M16 v[116:119],a[124:127],v[160:163],v[116:119]
s_mov_b32 s57, 1069056
M16 v[120:123],a[120:123],v[164:167],v[120:123]
M16 v[124:127],a[124:127],v[164:167],v[124:127]
buffer_store_dwordx4 v[64:67], v15, s[16:19], s57 offen offset:2048 sc1
M16 v[128:131],a[120:123],v[168:171],v[128:131]
M16 v[132:135],a[124:127],v[168:171],v[132:135]
M16 v[136:139],a[120:123],v[172:175],v[136:139]
M16 v[140:143],a[124:127],v[172:175],v[140:143]
s_waitcnt lgkmcnt(6)
M16 v[80:83],a[128:131],v[144:147],v[80:83]
DTR v[160:161],v12 offset:33792
CVT v72,v72,v73
M16 v[84:87],a[132:135],v[144:147],v[84:87]
DTR v[162:163],v12 offset:34304
s_waitcnt lgkmcnt(6)
M16 v[88:91],a[128:131],v[148:151],v[88:91]
DTR v[164:165],v13 offset:33792
CVT v73,v74,v75
M16 v[92:95],a[132:135],v[148:151],v[92:95]
DTR v[166:167],v13 offset:34304
s_waitcnt lgkmcnt(6)
M16 v[96:99],a[128:131],v[152:155],v[96:99]
DTR v[168:169],v12 offset:34048
CVT v74,v76,v77
M16 v[100:103],a[132:135],v[152:155],v[100:103]
DTR v[170:171],v12 offset:34560
s_waitcnt lgkmcnt(6)
M16 v[104:107],a[128:131],v[156:159],v[104:107]
DTR v[172:173],v13 offset:34048
CVT v75,v78,v79
M16 v[108:111],a[132:135],v[156:159],v[108:111]
DTR v[174:175],v13 offset:34560
M16 v[112:115],a[136:139],v[144:147],v[112:115]
M16 v[116:119],a[140:143],v[144:147],v[116:119]
s_mov_b32 s57, 1069056
M16 v[120:123],a[136:139],v[148:151],v[120:123]
M16 v[124:127],a[140:143],v[148:151],v[124:127]
buffer_store_dwordx4 v[72:75], v15, s[16:19], s57 offen offset:2304 sc1
M16 v[128:131],a[136:139],v[152:155],v[128:131]
M16 v[132:135],a[140:143],v[152:155],v[132:135]
M16 v[136:139],a[136:139],v[156:159],v[136:139]
M16 v[140:143],a[140:143],v[156:159],v[140:143]
s_waitcnt lgkmcnt(6)
M16 v[80:83],a[144:147],v[160:163],v[80:83]
DTR v[144:145],v12 offset:34816
M16 v[84:87],a[148:151],v[160:163],v[84:87]
DTR v[146:147],v12 offset:35328
s_waitcnt lgkmcnt(6)
M16 v[88:91],a[144:147],v[164:167],v[88:91]
DTR v[148:149],v13 offset:34816
M16 v[92:95],a[148:151],v[164:167],v[92:95]
DTR v[150:151],v13 offset:35328
s_waitcnt lgkmcnt(6)
M16 v[96:99],a[144:147],v[168:171],v[96:99]
DTR v[152:153],v12 offset:35072
M16 v[100:103],a[148:151],v[168:171],v[100:103]
DTR v[154:155],v12 offset:35584
s_waitcnt lgkmcnt(6)
M16 v[104:107],a[144:147],v[172:175],v[104:107]
DTR v[156:157],v13 offset:35072
M16 v[108:111],a[148:151],v[172:175],v[108:111]
DTR v[158:159],v13 offset:35584
M16 v[112:115],a[152:155],v[160:163],v[112:115]
buffer_load_dword v252, off, s[36:39], 0 sc1
M16 v[116:119],a[156:159],v[160:163],v[116:119]
s_lshl_b32 s56, s3, 3
s_add_u32 s56, s56, 159744
M16 v[120:123],a[152:155],v[164:167],v[120:123]
v_mov_b32 v2, s56
M16 v[124:127],a[156:159],v[164:167],v[124:127]
M16 v[128:131],a[152:155],v[168:171],v[128:131]
M16 v[132:135],a[156:159],v[168:171],v[132:135]
v_lshl_add_u32 v2, v1, 5, v2
M16 v[136:139],a[152:155],v[172:175],v[136:139]
M16 v[140:143],a[156:159],v[172:175],v[140:143]
s_waitcnt lgkmcnt(6)
M16 v[80:83],a[160:163],v[144:147],v[80:83]
DTR v[160:161],v12 offset:35840
v_lshrrev_b32 v3, 3, v1
M16 v[84:87],a[164:167],v[144:147],v[84:87]
DTR v[162:163],v12 offset:36352
s_lshl_b32 s56, s3, 5
s_waitcnt lgkmcnt(6)
M16 v[88:91],a[160:163],v[148:151],v[88:91]
DTR v[164:165],v13 offset:35840
v_add_u32 v3, s56, v3
M16 v[92:95],a[164:167],v[148:151],v[92:95]
DTR v[166:167],v13 offset:36352
v_lshlrev_b32 v4, 11, v0
s_waitcnt lgkmcnt(6)
M16 v[96:99],a[160:163],v[152:155],v[96:99]
DTR v[168:169],v12 offset:36096
v_lshl_add_u32 v4, v3, 4, v4
M16 v[100:103],a[164:167],v[152:155],v[100:103]
DTR v[170:171],v12 offset:36608
s_lshl_b32 s57, s67, 14
s_waitcnt lgkmcnt(6)
M16 v[104:107],a[160:163],v[156:159],v[104:107]
DTR v[172:173],v13 offset:36096
s_lshl_b32 s56, s3, 6
M16 v[108:111],a[164:167],v[156:159],v[108:111]
DTR v[174:175],v13 offset:36608
v_add_u32 v6, s56, v1
M16 v[112:115],a[168:171],v[144:147],v[112:115]
buffer_load_dwordx4 v[16:19], v4, s[32:35], s57 offen offset:0
M16 v[116:119],a[172:175],v[144:147],v[116:119]
buffer_load_dwordx4 v[20:23], v4, s[32:35], s57 offen offset:128
M16 v[120:123],a[168:171],v[148:151],v[120:123]
buffer_load_dwordx4 v[24:27], v4, s[32:35], s57 offen offset:256
M16 v[124:127],a[172:175],v[148:151],v[124:127]
buffer_load_dwordx4 v[28:31], v4, s[32:35], s57 offen offset:384
M16 v[128:131],a[168:171],v[152:155],v[128:131]
v_lshlrev_b32 v5, 5, v6
s_cmp_lt_u32 s67, 24
M16 v[132:135],a[172:175],v[152:155],v[132:135]
s_cselect_b32 s56, s67, 0x10000
s_lshl_b32 s56, s56, 10
M16 v[136:139],a[168:171],v[156:159],v[136:139]
v_lshlrev_b32 v6, 2, v6
M16 v[140:143],a[172:175],v[156:159],v[140:143]
v_add_u32 v6, s56, v6
s_waitcnt lgkmcnt(0)
s_waitcnt vmcnt(13)
s_barrier
M16 v[80:83],a[176:179],v[160:163],v[80:83]
DTR v[144:145],v12 offset:49152
M16 v[84:87],a[180:183],v[160:163],v[84:87]
DTR v[146:147],v12 offset:49664
M16 v[88:91],a[176:179],v[164:167],v[88:91]
DTR v[148:149],v13 offset:49152
M16 v[92:95],a[180:183],v[164:167],v[92:95]
DTR v[150:151],v13 offset:49664
M16 v[96:99],a[176:179],v[168:171],v[96:99]
DTR v[152:153],v12 offset:49408
M16 v[100:103],a[180:183],v[168:171],v[100:103]
DTR v[154:155],v12 offset:49920
M16 v[104:107],a[176:179],v[172:175],v[104:107]
DTR v[156:157],v13 offset:49408
M16 v[108:111],a[180:183],v[172:175],v[108:111]
DTR v[158:159],v13 offset:49920
M16 v[112:115],a[184:187],v[160:163],v[112:115]
M16 v[116:119],a[188:191],v[160:163],v[116:119]
M16 v[120:123],a[184:187],v[164:167],v[120:123]
M16 v[124:127],a[188:191],v[164:167],v[124:127]
M16 v[128:131],a[184:187],v[168:171],v[128:131]
M16 v[132:135],a[188:191],v[168:171],v[132:135]
M16 v[136:139],a[184:187],v[172:175],v[136:139]
M16 v[140:143],a[188:191],v[172:175],v[140:143]
s_waitcnt lgkmcnt(6)
M16 v[80:83],a[192:195],v[144:147],v[80:83]
DTR v[160:161],v12 offset:50176
M16 v[84:87],a[196:199],v[144:147],v[84:87]
DTR v[162:163],v12 offset:50688
s_waitcnt lgkmcnt(6)
M16 v[88:91],a[192:195],v[148:151],v[88:91]
DTR v[164:165],v13 offset:50176
M16 v[92:95],a[196:199],v[148:151],v[92:95]
DTR v[166:167],v13 offset:50688
s_waitcnt lgkmcnt(6)
M16 v[96:99],a[192:195],v[152:155],v[96:99]
DTR v[168:169],v12 offset:50432
M16 v[100:103],a[196:199],v[152:155],v[100:103]
DTR v[170:171],v12 offset:50944
s_waitcnt lgkmcnt(6)
M16 v[104:107],a[192:195],v[156:159],v[104:107]
DTR v[172:173],v13 offset:50432
M16 v[108:111],a[196:199],v[156:159],v[108:111]
DTR v[174:175],v13 offset:50944
M16 v[112:115],a[200:203],v[144:147],v[112:115]
M16 v[116:119],a[204:207],v[144:147],v[116:119]
M16 v[120:123],a[200:203],v[148:151],v[120:123]
M16 v[124:127],a[204:207],v[148:151],v[124:127]
M16 v[128:131],a[200:203],v[152:155],v[128:131]
M16 v[132:135],a[204:207],v[152:155],v[132:135]
M16 v[136:139],a[200:203],v[156:159],v[136:139]
M16 v[140:143],a[204:207],v[156:159],v[140:143]
s_waitcnt lgkmcnt(6)
M16 v[80:83],a[208:211],v[160:163],v[80:83]
DTR v[144:145],v12 offset:51200
M16 v[84:87],a[212:215],v[160:163],v[84:87]
DTR v[146:147],v12 offset:51712
s_waitcnt lgkmcnt(6)
M16 v[88:91],a[208:211],v[164:167],v[88:91]
DTR v[148:149],v13 offset:51200
M16 v[92:95],a[212:215],v[164:167],v[92:95]
DTR v[150:151],v13 offset:51712
s_waitcnt lgkmcnt(6)
M16 v[96:99],a[208:211],v[168:171],v[96:99]
DTR v[152:153],v12 offset:51456
M16 v[100:103],a[212:215],v[168:171],v[100:103]
DTR v[154:155],v12 offset:51968
s_waitcnt lgkmcnt(6)
M16 v[104:107],a[208:211],v[172:175],v[104:107]
DTR v[156:157],v13 offset:51456
M16 v[108:111],a[212:215],v[172:175],v[108:111]
DTR v[158:159],v13 offset:51968
M16 v[112:115],a[216:219],v[160:163],v[112:115]
M16 v[116:119],a[220:223],v[160:163],v[116:119]
M16 v[120:123],a[216:219],v[164:167],v[120:123]
M16 v[124:127],a[220:223],v[164:167],v[124:127]
M16 v[128:131],a[216:219],v[168:171],v[128:131]
M16 v[132:135],a[220:223],v[168:171],v[132:135]
M16 v[136:139],a[216:219],v[172:175],v[136:139]
M16 v[140:143],a[220:223],v[172:175],v[140:143]
s_waitcnt lgkmcnt(6)
M16 v[80:83],a[224:227],v[144:147],v[80:83]
DTR v[160:161],v12 offset:52224
s_waitcnt vmcnt(4)
ds_write_b64 v2, v[252:253]
M16 v[84:87],a[228:231],v[144:147],v[84:87]
DTR v[162:163],v12 offset:52736
s_waitcnt lgkmcnt(7)
M16 v[88:91],a[224:227],v[148:151],v[88:91]
DTR v[164:165],v13 offset:52224
M16 v[92:95],a[228:231],v[148:151],v[92:95]
DTR v[166:167],v13 offset:52736
s_waitcnt lgkmcnt(7)
M16 v[96:99],a[224:227],v[152:155],v[96:99]
DTR v[168:169],v12 offset:52480
M16 v[100:103],a[228:231],v[152:155],v[100:103]
DTR v[170:171],v12 offset:52992
s_waitcnt lgkmcnt(7)
M16 v[104:107],a[224:227],v[156:159],v[104:107]
DTR v[172:173],v13 offset:52480
M16 v[108:111],a[228:231],v[156:159],v[108:111]
DTR v[174:175],v13 offset:52992
M16 v[112:115],a[232:235],v[144:147],v[112:115]
v_mov_b32 v2, 159744
M16 v[116:119],a[236:239],v[144:147],v[116:119]
M16 v[120:123],a[232:235],v[148:151],v[120:123]
M16 v[124:127],a[236:239],v[148:151],v[124:127]
M16 v[128:131],a[232:235],v[152:155],v[128:131]
M16 v[132:135],a[236:239],v[152:155],v[132:135]
M16 v[136:139],a[232:235],v[156:159],v[136:139]
M16 v[140:143],a[236:239],v[156:159],v[140:143]
s_waitcnt lgkmcnt(0)
s_barrier
ds_read_b64 v[252:253], v2
M16 v[80:83],a[240:243],v[160:163],v[80:83]
M16 v[84:87],a[244:247],v[160:163],v[84:87]
M16 v[88:91],a[240:243],v[164:167],v[88:91]
M16 v[92:95],a[244:247],v[164:167],v[92:95]
s_waitcnt lgkmcnt(0)
v_readfirstlane_b32 s68, v252
v_readfirstlane_b32 s69, v253
s_and_b32 s68, s68, 0xffff
s_cmp_eq_u32 s68, 256
s_cselect_b32 s65, 0, 0x1000000
s_add_u32 s59, s65, 0
buffer_load_dwordx4 v[176:179], v5, s[28:31], s59 offen
buffer_load_dwordx4 v[180:183], v5, s[28:31], s59 offen offset:16
buffer_load_dword v240, v6, s[28:31], s59 offen
s_add_u32 s59, s65, 24576
buffer_load_dwordx4 v[184:187], v5, s[28:31], s59 offen
M16 v[96:99],a[240:243],v[168:171],v[96:99]
buffer_load_dwordx4 v[188:191], v5, s[28:31], s59 offen offset:16
buffer_load_dword v241, v6, s[28:31], s59 offen
s_add_u32 s59, s65, 49152
buffer_load_dwordx4 v[192:195], v5, s[28:31], s59 offen
buffer_load_dwordx4 v[196:199], v5, s[28:31], s59 offen offset:16
M16 v[100:103],a[244:247],v[168:171],v[100:103]
buffer_load_dword v242, v6, s[28:31], s59 offen
s_add_u32 s59, s65, 73728
buffer_load_dwordx4 v[200:203], v5, s[28:31], s59 offen
buffer_load_dwordx4 v[204:207], v5, s[28:31], s59 offen offset:16
buffer_load_dword v243, v6, s[28:31], s59 offen
M16 v[104:107],a[240:243],v[172:175],v[104:107]
s_add_u32 s59, s65, 98304
buffer_load_dwordx4 v[208:211], v5, s[28:31], s59 offen
buffer_load_dwordx4 v[212:215], v5, s[28:31], s59 offen offset:16
buffer_load_dword v244, v6, s[28:31], s59 offen
s_add_u32 s59, s65, 122880
buffer_load_dwordx4 v[216:219], v5, s[28:31], s59 offen
M16 v[108:111],a[244:247],v[172:175],v[108:111]
buffer_load_dwordx4 v[220:223], v5, s[28:31], s59 offen offset:16
buffer_load_dword v245, v6, s[28:31], s59 offen
s_add_u32 s59, s65, 147456
buffer_load_dwordx4 v[224:227], v5, s[28:31], s59 offen
buffer_load_dwordx4 v[228:231], v5, s[28:31], s59 offen offset:16
M16 v[112:115],a[248:251],v[160:163],v[112:115]
buffer_load_dword v246, v6, s[28:31], s59 offen
s_add_u32 s59, s65, 172032
buffer_load_dwordx4 v[232:235], v5, s[28:31], s59 offen
buffer_load_dwordx4 v[236:239], v5, s[28:31], s59 offen offset:16
buffer_load_dword v247, v6, s[28:31], s59 offen
M16 v[116:119],a[252:255],v[160:163],v[116:119]
CVT v80,v80,v81
CVT v81,v82,v83
CVT v82,v84,v85
CVT v83,v86,v87
s_mov_b32 s57, 1073152
buffer_store_dwordx4 v[80:83], v15, s[16:19], s57 offen offset:0 sc1
M16 v[120:123],a[248:251],v[164:167],v[120:123]
M16 v[124:127],a[252:255],v[164:167],v[124:127]
CVT v88,v88,v89
CVT v89,v90,v91
CVT v90,v92,v93
CVT v91,v94,v95
s_mov_b32 s57, 1073152
buffer_store_dwordx4 v[88:91], v15, s[16:19], s57 offen offset:256 sc1
M16 v[128:131],a[248:251],v[168:171],v[128:131]
M16 v[132:135],a[252:255],v[168:171],v[132:135]
CVT v96,v96,v97
CVT v97,v98,v99
CVT v98,v100,v101
CVT v99,v102,v103
s_mov_b32 s57, 1077248
buffer_store_dwordx4 v[96:99], v15, s[16:19], s57 offen offset:0 sc1
M16 v[136:139],a[248:251],v[172:175],v[136:139]
M16 v[140:143],a[252:255],v[172:175],v[140:143]
CVT v104,v104,v105
CVT v105,v106,v107
CVT v106,v108,v109
CVT v107,v110,v111
s_mov_b32 s57, 1077248
buffer_store_dwordx4 v[104:107], v15, s[16:19], s57 offen offset:256 sc1
CVT v112,v112,v113
CVT v113,v114,v115
CVT v114,v116,v117
CVT v115,v118,v119
s_mov_b32 s57, 1073152
buffer_store_dwordx4 v[112:115], v15, s[16:19], s57 offen offset:2048 sc1
CVT v120,v120,v121
CVT v121,v122,v123
CVT v122,v124,v125
CVT v123,v126,v127
s_mov_b32 s57, 1073152
buffer_store_dwordx4 v[120:123], v15, s[16:19], s57 offen offset:2304 sc1
CVT v128,v128,v129
CVT v129,v130,v131
CVT v130,v132,v133
CVT v131,v134,v135
s_mov_b32 s57, 1077248
buffer_store_dwordx4 v[128:131], v15, s[16:19], s57 offen offset:2048 sc1
CVT v136,v136,v137
CVT v137,v138,v139
CVT v138,v140,v141
CVT v139,v142,v143
s_mov_b32 s57, 1077248
buffer_store_dwordx4 v[136:139], v15, s[16:19], s57 offen offset:2304 sc1
L_k1_fin:
s_add_u32 s20, s48, 1048576
s_addc_u32 s21, s49, 0
s_mov_b32 s22, 4194304
s_mov_b32 s23, 0x20000
s_add_u32 s24, s48, 262144
s_addc_u32 s25, s49, 0
s_mov_b32 s26, 24576
s_mov_b32 s27, 0x20000
s_and_b32 s69, s69, 0xffff
s_cmp_lg_u32 s68, 256
s_cbranch_scc1 L_k1_slow
L_k1_ln:
s_waitcnt vmcnt(35)
v_lshlrev_b32 v32, 16, v16
v_and_b32 v33, 0xffff0000, v16
v_lshlrev_b32 v34, 16, v17
v_and_b32 v35, 0xffff0000, v17
v_lshlrev_b32 v36, 16, v18
v_and_b32 v37, 0xffff0000, v18
v_lshlrev_b32 v38, 16, v19
v_and_b32 v39, 0xffff0000, v19
s_waitcnt vmcnt(34)
v_lshlrev_b32 v40, 16, v20
v_and_b32 v41, 0xffff0000, v20
v_lshlrev_b32 v42, 16, v21
v_and_b32 v43, 0xffff0000, v21
v_lshlrev_b32 v44, 16, v22
v_and_b32 v45, 0xffff0000, v22
v_lshlrev_b32 v46, 16, v23
v_and_b32 v47, 0xffff0000, v23
s_waitcnt vmcnt(33)
v_lshlrev_b32 v48, 16, v24
v_and_b32 v49, 0xffff0000, v24
v_lshlrev_b32 v50, 16, v25
v_and_b32 v51, 0xffff0000, v25
v_lshlrev_b32 v52, 16, v26
v_and_b32 v53, 0xffff0000, v26
v_lshlrev_b32 v54, 16, v27
v_and_b32 v55, 0xffff0000, v27
s_waitcnt vmcnt(32)
v_lshlrev_b32 v56, 16, v28
v_and_b32 v57, 0xffff0000, v28
v_lshlrev_b32 v58, 16, v29
v_and_b32 v59, 0xffff0000, v29
v_lshlrev_b32 v60, 16, v30
v_and_b32 v61, 0xffff0000, v30
v_lshlrev_b32 v62, 16, v31
v_and_b32 v63, 0xffff0000, v31
FAD v8,v32,v33
FML v9,v32,v32
v_fmac_f32 v9, v33, v33
FAD v8,v8,v34
v_fmac_f32 v9, v34, v34
FAD v8,v8,v35
v_fmac_f32 v9, v35, v35
FAD v8,v8,v36
v_fmac_f32 v9, v36, v36
FAD v8,v8,v37
v_fmac_f32 v9, v37, v37
FAD v8,v8,v38
v_fmac_f32 v9, v38, v38
FAD v8,v8,v39
v_fmac_f32 v9, v39, v39
FAD v8,v8,v40
v_fmac_f32 v9, v40, v40
FAD v8,v8,v41
v_fmac_f32 v9, v41, v41
FAD v8,v8,v42
v_fmac_f32 v9, v42, v42
FAD v8,v8,v43
v_fmac_f32 v9, v43, v43
FAD v8,v8,v44
v_fmac_f32 v9, v44, v44
FAD v8,v8,v45
v_fmac_f32 v9, v45, v45
FAD v8,v8,v46
v_fmac_f32 v9, v46, v46
FAD v8,v8,v47
v_fmac_f32 v9, v47, v47
FAD v8,v8,v48
v_fmac_f32 v9, v48, v48
FAD v8,v8,v49
v_fmac_f32 v9, v49, v49
FAD v8,v8,v50
v_fmac_f32 v9, v50, v50
FAD v8,v8,v51
v_fmac_f32 v9, v51, v51
FAD v8,v8,v52
v_fmac_f32 v9, v52, v52
FAD v8,v8,v53
v_fmac_f32 v9, v53, v53
FAD v8,v8,v54
v_fmac_f32 v9, v54, v54
FAD v8,v8,v55
v_fmac_f32 v9, v55, v55
FAD v8,v8,v56
v_fmac_f32 v9, v56, v56
FAD v8,v8,v57
v_fmac_f32 v9, v57, v57
FAD v8,v8,v58
v_fmac_f32 v9, v58, v58
FAD v8,v8,v59
v_fmac_f32 v9, v59, v59
FAD v8,v8,v60
v_fmac_f32 v9, v60, v60
FAD v8,v8,v61
v_fmac_f32 v9, v61, v61
FAD v8,v8,v62
v_fmac_f32 v9, v62, v62
FAD v8,v8,v63
v_fmac_f32 v9, v63, v63
s_nop 0
v_add_f32_dpp v8, v8, v8 row_ror:8 row_mask:0xf bank_mask:0xf
v_add_f32_dpp v9, v9, v9 row_ror:8 row_mask:0xf bank_mask:0xf
v_mov_b32 v10, v8
v_mov_b32 v11, v9
s_nop 0
v_permlane16_swap_b32 v8, v10
v_permlane16_swap_b32 v9, v11
FAD v8,v8,v10
FAD v9,v9,v11
v_mov_b32 v10, v8
v_mov_b32 v11, v9
s_nop 0
v_permlane32_swap_b32 v8, v10
v_permlane32_swap_b32 v9, v11
FAD v8,v8,v10
FAD v9,v9,v11
v_lshlrev_b32 v10, 3, v0
v_add_u32 v10, 65536, v10
s_lshl_b32 s56, s3, 6
v_add_u32 v11, s56, v10
ds_write_b64 v11, v[8:9] offset:8192
v_add_u32 v5, 65536, v5
s_waitcnt vmcnt(28)
v_pk_add_f32 v[176:177], v[176:177], v[184:185]
v_pk_add_f32 v[178:179], v[178:179], v[186:187]
s_waitcnt vmcnt(27)
v_pk_add_f32 v[180:181], v[180:181], v[188:189]
v_pk_add_f32 v[182:183], v[182:183], v[190:191]
s_waitcnt vmcnt(25)
v_pk_add_f32 v[176:177], v[176:177], v[192:193]
v_pk_add_f32 v[178:179], v[178:179], v[194:195]
s_waitcnt vmcnt(24)
v_pk_add_f32 v[180:181], v[180:181], v[196:197]
v_pk_add_f32 v[182:183], v[182:183], v[198:199]
s_waitcnt vmcnt(22)
v_pk_add_f32 v[176:177], v[176:177], v[200:201]
v_pk_add_f32 v[178:179], v[178:179], v[202:203]
s_waitcnt vmcnt(21)
v_pk_add_f32 v[180:181], v[180:181], v[204:205]
v_pk_add_f32 v[182:183], v[182:183], v[206:207]
s_waitcnt vmcnt(19)
v_pk_add_f32 v[176:177], v[176:177], v[208:209]
v_pk_add_f32 v[178:179], v[178:179], v[210:211]
s_waitcnt vmcnt(18)
v_pk_add_f32 v[180:181], v[180:181], v[212:213]
v_pk_add_f32 v[182:183], v[182:183], v[214:215]
s_waitcnt vmcnt(16)
v_pk_add_f32 v[176:177], v[176:177], v[216:217]
v_pk_add_f32 v[178:179], v[178:179], v[218:219]
s_waitcnt vmcnt(15)
v_pk_add_f32 v[180:181], v[180:181], v[220:221]
v_pk_add_f32 v[182:183], v[182:183], v[222:223]
s_waitcnt vmcnt(13)
v_pk_add_f32 v[176:177], v[176:177], v[224:225]
v_pk_add_f32 v[178:179], v[178:179], v[226:227]
s_waitcnt vmcnt(12)
v_pk_add_f32 v[180:181], v[180:181], v[228:229]
v_pk_add_f32 v[182:183], v[182:183], v[230:231]
s_waitcnt vmcnt(10)
v_pk_add_f32 v[176:177], v[176:177], v[232:233]
v_pk_add_f32 v[178:179], v[178:179], v[234:235]
s_waitcnt vmcnt(9)
v_pk_add_f32 v[180:181], v[180:181], v[236:237]
v_pk_add_f32 v[182:183], v[182:183], v[238:239]
ds_write_b128 v5, v[176:179]
ds_write_b128 v5, v[180:183] offset:16
FAD v240,v240,v241
FAD v240,v240,v242
FAD v240,v240,v243
FAD v240,v240,v244
FAD v240,v240,v245
FAD v240,v240,v246
s_waitcnt vmcnt(8)
FAD v240,v240,v247
buffer_store_dword v240, v6, s[24:27], 0 offen sc1
s_waitcnt lgkmcnt(0)
s_barrier
ds_read_b64 v[72:73], v10 offset:8192
ds_read_b64 v[74:75], v10 offset:8256
ds_read_b64 v[76:77], v10 offset:8320
ds_read_b64 v[78:79], v10 offset:8384
v_lshlrev_b32 v12, 5, v3
v_add_u32 v12, 65536, v12
DR4 v[80:83],v12 offset:0
DR4 v[112:115],v12 offset:4096
DR4 v[84:87],v12 offset:16
DR4 v[116:119],v12 offset:4112
DR4 v[88:91],v12 offset:256
DR4 v[120:123],v12 offset:4352
DR4 v[92:95],v12 offset:272
DR4 v[124:127],v12 offset:4368
DR4 v[96:99],v12 offset:512
DR4 v[128:131],v12 offset:4608
DR4 v[100:103],v12 offset:528
DR4 v[132:135],v12 offset:4624
DR4 v[104:107],v12 offset:768
DR4 v[136:139],v12 offset:4864
DR4 v[108:111],v12 offset:784
DR4 v[140:143],v12 offset:4880
s_waitcnt lgkmcnt(15)
FAD v72,v72,v74
FAD v73,v73,v75
s_waitcnt lgkmcnt(15)
FAD v76,v76,v78
FAD v77,v77,v79
FAD v8,v72,v76
FAD v9,v73,v77
FML v8,0xba800000,v8
FML v9,0x3a800000,v9
v_fma_f32 v9, -v8, v8, v9
v_max_f32 v9, 0, v9
FAD v9,0x3727c5ac,v9
v_rsq_f32 v10, v9
v_mov_b32 v9, v8
v_mov_b32 v11, v10
s_lshr_b32 s56, s67, 2
s_lshl_b32 s56, s56, 16
s_and_b32 s57, s67, 3
s_lshl_b32 s57, s57, 7
s_add_u32 s56, s56, s57
v_lshlrev_b32 v13, 9, v3
v_lshl_add_u32 v13, v0, 4, v13
v_pk_add_f32 v[32:33], v[32:33], v[8:9]
s_waitcnt lgkmcnt(14)
v_pk_fma_f32 v[112:113], v[112:113], v[10:11], v[10:11]
v_pk_fma_f32 v[32:33], v[32:33], v[112:113], v[80:81]
v_pk_add_f32 v[34:35], v[34:35], v[8:9]
v_pk_fma_f32 v[114:115], v[114:115], v[10:11], v[10:11]
v_pk_fma_f32 v[34:35], v[34:35], v[114:115], v[82:83]
v_pk_add_f32 v[36:37], v[36:37], v[8:9]
s_waitcnt lgkmcnt(12)
v_pk_fma_f32 v[116:117], v[116:117], v[10:11], v[10:11]
v_pk_fma_f32 v[36:37], v[36:37], v[116:117], v[84:85]
v_pk_add_f32 v[38:39], v[38:39], v[8:9]
v_pk_fma_f32 v[118:119], v[118:119], v[10:11], v[10:11]
v_pk_fma_f32 v[38:39], v[38:39], v[118:119], v[86:87]
CVT v16,v32,v33
CVT v17,v34,v35
CVT v18,v36,v37
CVT v19,v38,v39
buffer_store_dwordx4 v[16:19], v13, s[20:23], s56 offen sc1
s_add_u32 s56, s56, 4096
v_pk_add_f32 v[40:41], v[40:41], v[8:9]
s_waitcnt lgkmcnt(10)
v_pk_fma_f32 v[120:121], v[120:121], v[10:11], v[10:11]
v_pk_fma_f32 v[40:41], v[40:41], v[120:121], v[88:89]
v_pk_add_f32 v[42:43], v[42:43], v[8:9]
v_pk_fma_f32 v[122:123], v[122:123], v[10:11], v[10:11]
v_pk_fma_f32 v[42:43], v[42:43], v[122:123], v[90:91]
v_pk_add_f32 v[44:45], v[44:45], v[8:9]
s_waitcnt lgkmcnt(8)
v_pk_fma_f32 v[124:125], v[124:125], v[10:11], v[10:11]
v_pk_fma_f32 v[44:45], v[44:45], v[124:125], v[92:93]
v_pk_add_f32 v[46:47], v[46:47], v[8:9]
v_pk_fma_f32 v[126:127], v[126:127], v[10:11], v[10:11]
v_pk_fma_f32 v[46:47], v[46:47], v[126:127], v[94:95]
CVT v20,v40,v41
CVT v21,v42,v43
CVT v22,v44,v45
CVT v23,v46,v47
buffer_store_dwordx4 v[20:23], v13, s[20:23], s56 offen sc1
s_add_u32 s56, s56, 4096
v_pk_add_f32 v[48:49], v[48:49], v[8:9]
s_waitcnt lgkmcnt(6)
v_pk_fma_f32 v[128:129], v[128:129], v[10:11], v[10:11]
v_pk_fma_f32 v[48:49], v[48:49], v[128:129], v[96:97]
v_pk_add_f32 v[50:51], v[50:51], v[8:9]
v_pk_fma_f32 v[130:131], v[130:131], v[10:11], v[10:11]
v_pk_fma_f32 v[50:51], v[50:51], v[130:131], v[98:99]
v_pk_add_f32 v[52:53], v[52:53], v[8:9]
s_waitcnt lgkmcnt(4)
v_pk_fma_f32 v[132:133], v[132:133], v[10:11], v[10:11]
v_pk_fma_f32 v[52:53], v[52:53], v[132:133], v[100:101]
v_pk_add_f32 v[54:55], v[54:55], v[8:9]
v_pk_fma_f32 v[134:135], v[134:135], v[10:11], v[10:11]
v_pk_fma_f32 v[54:55], v[54:55], v[134:135], v[102:103]
CVT v24,v48,v49
CVT v25,v50,v51
CVT v26,v52,v53
CVT v27,v54,v55
buffer_store_dwordx4 v[24:27], v13, s[20:23], s56 offen sc1
s_add_u32 s56, s56, 4096
v_pk_add_f32 v[56:57], v[56:57], v[8:9]
s_waitcnt lgkmcnt(2)
v_pk_fma_f32 v[136:137], v[136:137], v[10:11], v[10:11]
v_pk_fma_f32 v[56:57], v[56:57], v[136:137], v[104:105]
v_pk_add_f32 v[58:59], v[58:59], v[8:9]
v_pk_fma_f32 v[138:139], v[138:139], v[10:11], v[10:11]
v_pk_fma_f32 v[58:59], v[58:59], v[138:139], v[106:107]
v_pk_add_f32 v[60:61], v[60:61], v[8:9]
s_waitcnt lgkmcnt(0)
v_pk_fma_f32 v[140:141], v[140:141], v[10:11], v[10:11]
v_pk_fma_f32 v[60:61], v[60:61], v[140:141], v[108:109]
v_pk_add_f32 v[62:63], v[62:63], v[8:9]
v_pk_fma_f32 v[142:143], v[142:143], v[10:11], v[10:11]
v_pk_fma_f32 v[62:63], v[62:63], v[142:143], v[110:111]
CVT v28,v56,v57
CVT v29,v58,v59
CVT v30,v60,v61
CVT v31,v62,v63
buffer_store_dwordx4 v[28:31], v13, s[20:23], s56 offen sc1
s_add_u32 s56, s56, 4096
s_cmp_ge_u32 s69, 255
s_cbranch_scc1 L_k1_last
L_k1_out:
s_endpgm
L_k1_slow:
s_waitcnt vmcnt(0) lgkmcnt(0)
s_cmp_lg_u32 s3, 0
s_cbranch_scc1 L_k1_sj
s_mov_b32 s56, 4000
L_k1_poll:
buffer_load_dword v252, off, s[36:39], 0 sc1
s_waitcnt vmcnt(0)
v_readfirstlane_b32 s68, v252
s_nop 0
s_and_b32 s68, s68, 0xffff
s_cmp_eq_u32 s68, 256
s_cbranch_scc1 L_k1_pd
s_sub_u32 s56, s56, 1
s_cmp_lg_u32 s56, 0
s_cbranch_scc1 L_k1_poll
L_k1_reg:
s_and_b32 s56, s2, 31
s_lshl_b32 s56, 1, s56
s_lshr_b32 s57, s2, 5
s_lshl_b32 s57, s57, 2
v_mov_b32 v252, s56
buffer_atomic_or v252, v254, s[36:39], s57 offen offset:128 sc0 sc1
s_waitcnt vmcnt(0)
v_mov_b32 v252, 0x10000
buffer_atomic_add v252, v254, s[36:39], 0 offen sc0 sc1
s_waitcnt vmcnt(0)
L_k1_pd:
v_lshlrev_b32 v2, 2, v1
v_add_u32 v2, 159744, v2
ds_write_b32 v2, v252
L_k1_sj:
s_waitcnt lgkmcnt(0)
s_barrier
v_mov_b32 v2, 159744
ds_read_b32 v252, v2
s_waitcnt lgkmcnt(0)
v_readfirstlane_b32 s68, v252
s_nop 0
s_and_b32 s68, s68, 0xffff
s_cmp_lg_u32 s68, 256
s_cbranch_scc1 L_k1_out
L_k1_ld:
s_mov_b32 s65, 0
v_lshrrev_b32 v3, 3, v1
s_lshl_b32 s56, s3, 5
v_add_u32 v3, s56, v3
v_lshlrev_b32 v4, 11, v0
v_lshl_add_u32 v4, v3, 4, v4
s_lshl_b32 s57, s67, 14
s_lshl_b32 s56, s3, 6
v_add_u32 v6, s56, v1
buffer_load_dwordx4 v[16:19], v4, s[32:35], s57 offen offset:0
buffer_load_dwordx4 v[20:23], v4, s[32:35], s57 offen offset:128
buffer_load_dwordx4 v[24:27], v4, s[32:35], s57 offen offset:256
buffer_load_dwordx4 v[28:31], v4, s[32:35], s57 offen offset:384
v_lshlrev_b32 v5, 5, v6
s_cmp_lt_u32 s67, 24
s_cselect_b32 s56, s67, 0x10000
s_lshl_b32 s56, s56, 10
v_lshlrev_b32 v6, 2, v6
v_add_u32 v6, s56, v6
s_add_u32 s59, s65, 0
buffer_load_dwordx4 v[176:179], v5, s[28:31], s59 offen
buffer_load_dwordx4 v[180:183], v5, s[28:31], s59 offen offset:16
buffer_load_dword v240, v6, s[28:31], s59 offen
s_add_u32 s59, s65, 24576
buffer_load_dwordx4 v[184:187], v5, s[28:31], s59 offen
buffer_load_dwordx4 v[188:191], v5, s[28:31], s59 offen offset:16
buffer_load_dword v241, v6, s[28:31], s59 offen
s_add_u32 s59, s65, 49152
buffer_load_dwordx4 v[192:195], v5, s[28:31], s59 offen
buffer_load_dwordx4 v[196:199], v5, s[28:31], s59 offen offset:16
buffer_load_dword v242, v6, s[28:31], s59 offen
s_add_u32 s59, s65, 73728
buffer_load_dwordx4 v[200:203], v5, s[28:31], s59 offen
buffer_load_dwordx4 v[204:207], v5, s[28:31], s59 offen offset:16
buffer_load_dword v243, v6, s[28:31], s59 offen
s_add_u32 s59, s65, 98304
buffer_load_dwordx4 v[208:211], v5, s[28:31], s59 offen
buffer_load_dwordx4 v[212:215], v5, s[28:31], s59 offen offset:16
buffer_load_dword v244, v6, s[28:31], s59 offen
s_add_u32 s59, s65, 122880
buffer_load_dwordx4 v[216:219], v5, s[28:31], s59 offen
buffer_load_dwordx4 v[220:223], v5, s[28:31], s59 offen offset:16
buffer_load_dword v245, v6, s[28:31], s59 offen
s_add_u32 s59, s65, 147456
buffer_load_dwordx4 v[224:227], v5, s[28:31], s59 offen
buffer_load_dwordx4 v[228:231], v5, s[28:31], s59 offen offset:16
buffer_load_dword v246, v6, s[28:31], s59 offen
s_add_u32 s59, s65, 172032
buffer_load_dwordx4 v[232:235], v5, s[28:31], s59 offen
buffer_load_dwordx4 v[236:239], v5, s[28:31], s59 offen offset:16
buffer_load_dword v247, v6, s[28:31], s59 offen
s_waitcnt vmcnt(0)
s_branch L_k1_ln
L_k1_last:
s_cmp_eq_u32 s69, 256
s_cbranch_scc1 L_k1_nx
s_mov_b32 s69, 256
v_lshlrev_b32 v2, 2, v1
buffer_load_dword v255, v2, s[36:39], 0 offen offset:128 sc1
s_lshl_b32 s56, s3, 8
s_add_u32 s56, s56, 159744
v_add_u32 v3, s56, v2
s_waitcnt vmcnt(0)
ds_write_b32 v3, v255
v_add_u32 v3, 159744, v2
s_waitcnt lgkmcnt(0)
s_barrier
ds_read_b32 v255, v3
L_k1_nx:
s_waitcnt vmcnt(0) lgkmcnt(0)
v_cmp_ne_u32 vcc, 0, v255
s_nop 4
s_cmp_eq_u64 vcc, 0
s_cbranch_scc1 L_k1_out
s_ff1_i32_b64 s56, vcc
s_nop 3
v_readlane_b32 s57, v255, s56
s_nop 0
s_ff1_i32_b32 s67, s57
s_bitset0_b32 s57, s67
s_mov_b32 m0, s56
s_nop 3
v_writelane_b32 v255, s57, m0
s_lshl_b32 s56, s56, 5
s_add_u32 s67, s67, s56
s_barrier
s_branch L_k1_ld
L_kvproj_kernel_end:
s_endpgm
.p2align 8
attn_kernel:
s_cmp_ge_u32 s2, 256
s_cbranch_scc1 L_attn_kernel_end
v_lshrrev_b32 v2, 6, v0
v_and_b32 v1, 63, v0
v_readfirstlane_b32 s3, v2
s_load_dwordx2 s[12:13], s[0:1], 16
s_load_dwordx2 s[48:49], s[0:1], 104
s_load_dwordx2 s[24:25], s[0:1], 40
s_load_dwordx2 s[28:29], s[0:1], 64
s_load_dwordx2 s[32:33], s[0:1], 56
s_and_b32 s50, s2, 7
s_lshl_b32 s50, s50, 2
s_bfe_u32 s51, s2, 0x20003
s_add_u32 s50, s50, s51
s_lshr_b32 s51, s2, 5
s_lshl_b32 s58, s3, 12
v_lshlrev_b32 v4, 4, v1
v_add_u32 v5, 65536, v4
v_add_u32 v6, s58, v4
s_lshl_b32 s52, s51, 2
s_add_u32 s52, s52, s3
s_lshl_b32 s53, s51, 2
s_sub_u32 s53, 60, s53
s_add_u32 s53, s53, s3
s_lshl_b32 s62, s53, 16
s_lshl_b32 s63, s52, 16
v_bfe_u32 v8, v1, 2, 2
v_lshlrev_b32 v9, 13, v8
v_lshrrev_b32 v10, 4, v1
v_lshl_add_u32 v9, v10, 6, v9
v_and_b32 v11, 3, v1
v_lshl_add_u32 v9, v11, 4, v9
s_lshl_b32 s56, s3, 15
s_lshl_b32 s57, s50, 8
s_add_u32 s56, s56, s57
v_add_u32 v12, s56, v9
v_add_u32 v13, 130048, v12
v_add_u32 v14, 130048, v13
v_add_u32 v15, 130048, v14
v_lshrrev_b32 v9, 5, v1
v_lshlrev_b32 v3, 13, v9
v_lshl_add_u32 v3, v8, 6, v3
v_bfe_u32 v8, v1, 1, 1
v_lshl_add_u32 v3, v8, 5, v3
v_and_b32 v8, 1, v10
v_lshl_add_u32 v3, v8, 4, v3
v_and_b32 v8, 1, v1
v_lshl_add_u32 v3, v8, 3, v3
v_add_u32 v3, 98304, v3
s_waitcnt lgkmcnt(0)
s_mov_b32 s14, 8388608
s_mov_b32 s15, 0x20000
s_add_u32 s8, s48, 1048576
s_addc_u32 s9, s49, 0
s_mov_b32 s10, 4194304
s_mov_b32 s11, 0x20000
s_add_u32 s16, s48, 16777216
s_addc_u32 s17, s49, 0
s_mov_b32 s18, 33554432
s_mov_b32 s19, 0x20000
s_add_u32 m0, s58, 98304
s_mov_b32 s65, 0
buffer_load_dwordx4 v12, s[12:15], s65 offen offset:0 lds
buffer_load_dwordx4 v13, s[12:15], s65 offen offset:1024 lds
buffer_load_dwordx4 v14, s[12:15], s65 offen offset:2048 lds
buffer_load_dwordx4 v15, s[12:15], s65 offen offset:3072 lds
buffer_load_dwordx4 a[128:131], v4, s[8:11], s62 offen offset:0
buffer_load_dwordx4 a[132:135], v4, s[8:11], s63 offen offset:0
buffer_load_dwordx4 a[136:139], v4, s[8:11], s62 offen offset:1024
buffer_load_dwordx4 a[140:143], v4, s[8:11], s63 offen offset:1024
buffer_load_dwordx4 a[144:147], v4, s[8:11], s62 offen offset:2048
buffer_load_dwordx4 a[148:151], v4, s[8:11], s63 offen offset:2048
s_add_u32 m0, s58, 114688
s_mov_b32 s65, 524288
buffer_load_dwordx4 v12, s[12:15], s65 offen offset:0 lds
buffer_load_dwordx4 v13, s[12:15], s65 offen offset:1024 lds
buffer_load_dwordx4 v14, s[12:15], s65 offen offset:2048 lds
buffer_load_dwordx4 v15, s[12:15], s65 offen offset:3072 lds
buffer_load_dwordx4 a[152:155], v4, s[8:11], s62 offen offset:3072
buffer_load_dwordx4 a[156:159], v4, s[8:11], s63 offen offset:3072
s_add_u32 s62, s62, 4096
s_add_u32 s63, s63, 4096
buffer_load_dwordx4 a[160:163], v4, s[8:11], s62 offen offset:0
buffer_load_dwordx4 a[164:167], v4, s[8:11], s63 offen offset:0
buffer_load_dwordx4 a[168:171], v4, s[8:11], s62 offen offset:1024
buffer_load_dwordx4 a[172:175], v4, s[8:11], s63 offen offset:1024
buffer_load_dwordx4 a[176:179], v4, s[8:11], s62 offen offset:2048
buffer_load_dwordx4 a[180:183], v4, s[8:11], s63 offen offset:2048
s_add_u32 m0, s58, 131072
s_mov_b32 s65, 1048576
buffer_load_dwordx4 v12, s[12:15], s65 offen offset:0 lds
buffer_load_dwordx4 v13, s[12:15], s65 offen offset:1024 lds
buffer_load_dwordx4 v14, s[12:15], s65 offen offset:2048 lds
buffer_load_dwordx4 v15, s[12:15], s65 offen offset:3072 lds
s_add_u32 s20, s48, 50331648
s_addc_u32 s21, s49, 0
s_mov_b32 s22, 16777216
s_mov_b32 s23, 0x20000
s_lshl_b32 s60, s50, 20
s_add_u32 s61, s60, 16384
s_mov_b32 s59, s60
s_lshl_b32 s66, s50, 12
s_lshl_b32 s67, s52, 18
s_add_u32 s67, s67, s66
s_lshl_b32 s68, s53, 18
s_add_u32 s68, s68, s66
v_and_b32 v8, 15, v1
v_lshlrev_b32 v7, 4, v8
v_lshl_add_u32 v7, v9, 8, v7
v_and_b32 v8, 1, v10
v_lshl_add_u32 v7, v8, 17, v7
v_and_b32 v8, 31, v1
v_lshlrev_b32 v9, 2, v9
v_sub_u32 v248, v8, v9
s_lshl_b32 s56, s3, 5
v_add_u32 v248, s56, v248
v_add_u32 v249, -64, v248
v_mov_b32 v250, 0xff800000
v_mov_b32 v255, 0x47800000
v_mov_b32 v242, 0
v_mov_b32 v243, 0
s_cmp_eq_u32 s51, 0
s_cselect_b32 s56, 0, 1000
v_add_u32 v2, s56, v248
s_waitcnt vmcnt(22)
s_barrier
DTR a[192:193],v3 offset:0
DTR a[194:195],v3 offset:4096
DTR a[196:197],v3 offset:256
DTR a[198:199],v3 offset:4352
DTR a[200:201],v3 offset:512
DTR a[202:203],v3 offset:4608
DTR a[204:205],v3 offset:768
DTR a[206:207],v3 offset:4864
s_waitcnt vmcnt(21) lgkmcnt(6)
M32 v[16:31],a[192:195],a[128:131],0
DTR a[208:209],v3 offset:1024
DTR a[210:211],v3 offset:5120
AWR a0,0
s_waitcnt vmcnt(20)
M32 v[80:95],a[192:195],a[132:135],0
DTR a[212:213],v3 offset:1280
DTR a[214:215],v3 offset:5376
buffer_load_dwordx4 a[184:187], v4, s[8:11], s62 offen offset:3072
s_waitcnt lgkmcnt(8)
M32 v[32:47],a[196:199],a[128:131],0
DTR a[216:217],v3 offset:1536
AWR a1,0
M32 v[96:111],a[196:199],a[132:135],0
DTR a[218:219],v3 offset:5632
DTR a[220:221],v3 offset:1792
buffer_load_dwordx4 a[188:191], v4, s[8:11], s63 offen offset:3072
s_waitcnt lgkmcnt(9)
M32 v[48:63],a[200:203],a[128:131],0
DTR a[222:223],v3 offset:5888
s_add_u32 m0, s58, 147456
s_mov_b32 s65, 1572864
AWR a2,0
M32 v[112:127],a[200:203],a[132:135],0
s_add_u32 s62, s62, 4096
buffer_load_dwordx4 v12, s[12:15], s65 offen offset:0 lds
s_waitcnt lgkmcnt(8)
M32 v[64:79],a[204:207],a[128:131],0
s_add_u32 s63, s63, 4096
buffer_load_dwordx4 v13, s[12:15], s65 offen offset:1024 lds
AWR a3,0
M32 v[128:143],a[204:207],a[132:135],0
s_waitcnt vmcnt(23) lgkmcnt(6)
M32 v[16:31],a[208:211],a[136:139],v[16:31]
DTR a[192:193],v3 offset:2048
DTR a[194:195],v3 offset:6144
AWR a4,0
s_waitcnt vmcnt(22)
M32 v[80:95],a[208:211],a[140:143],v[80:95]
DTR a[196:197],v3 offset:2304
DTR a[198:199],v3 offset:6400
buffer_load_dwordx4 a[128:131], v4, s[8:11], s62 offen offset:0
s_waitcnt lgkmcnt(8)
M32 v[32:47],a[212:215],a[136:139],v[32:47]
DTR a[200:201],v3 offset:2560
AWR a5,0
M32 v[96:111],a[212:215],a[140:143],v[96:111]
DTR a[202:203],v3 offset:6656
DTR a[204:205],v3 offset:2816
buffer_load_dwordx4 v14, s[12:15], s65 offen offset:2048 lds
s_waitcnt lgkmcnt(9)
M32 v[48:63],a[216:219],a[136:139],v[48:63]
DTR a[206:207],v3 offset:6912
buffer_load_dwordx4 a[132:135], v4, s[8:11], s63 offen offset:0
AWR a6,0
M32 v[112:127],a[216:219],a[140:143],v[112:127]
s_waitcnt lgkmcnt(8)
M32 v[64:79],a[220:223],a[136:139],v[64:79]
AWR a7,0
M32 v[128:143],a[220:223],a[140:143],v[128:143]
s_waitcnt vmcnt(24) lgkmcnt(6)
M32 v[16:31],a[192:195],a[144:147],v[16:31]
DTR a[208:209],v3 offset:3072
DTR a[210:211],v3 offset:7168
AWR a8,0
s_waitcnt vmcnt(23)
M32 v[80:95],a[192:195],a[148:151],v[80:95]
DTR a[212:213],v3 offset:3328
DTR a[214:215],v3 offset:7424
buffer_load_dwordx4 a[136:139], v4, s[8:11], s62 offen offset:1024
s_waitcnt lgkmcnt(8)
M32 v[32:47],a[196:199],a[144:147],v[32:47]
DTR a[216:217],v3 offset:3584
AWR a9,0
M32 v[96:111],a[196:199],a[148:151],v[96:111]
DTR a[218:219],v3 offset:7680
DTR a[220:221],v3 offset:3840
buffer_load_dwordx4 v15, s[12:15], s65 offen offset:3072 lds
s_waitcnt lgkmcnt(9)
M32 v[48:63],a[200:203],a[144:147],v[48:63]
DTR a[222:223],v3 offset:7936
buffer_load_dwordx4 a[140:143], v4, s[8:11], s63 offen offset:1024
AWR a10,0
M32 v[112:127],a[200:203],a[148:151],v[112:127]
s_waitcnt lgkmcnt(8)
M32 v[64:79],a[204:207],a[144:147],v[64:79]
AWR a11,0
M32 v[128:143],a[204:207],a[148:151],v[128:143]
s_waitcnt lgkmcnt(0)
s_waitcnt vmcnt(22)
s_barrier
s_waitcnt vmcnt(21)
M32 v[16:31],a[208:211],a[152:155],v[16:31]
DTR a[192:193],v3 offset:16384
DTR a[194:195],v3 offset:20480
AWR a12,0
s_waitcnt vmcnt(20)
M32 v[80:95],a[208:211],a[156:159],v[80:95]
DTR a[196:197],v3 offset:16640
DTR a[198:199],v3 offset:20736
buffer_load_dwordx4 a[144:147], v4, s[8:11], s62 offen offset:2048
M32 v[32:47],a[212:215],a[152:155],v[32:47]
DTR a[200:201],v3 offset:16896
AWR a13,0
M32 v[96:111],a[212:215],a[156:159],v[96:111]
DTR a[202:203],v3 offset:20992
DTR a[204:205],v3 offset:17152
s_add_u32 m0, s58, 98304
M32 v[48:63],a[216:219],a[152:155],v[48:63]
DTR a[206:207],v3 offset:21248
buffer_load_dwordx4 a[148:151], v4, s[8:11], s63 offen offset:2048
s_mov_b32 s65, 2097152
M32 v[112:127],a[216:219],a[156:159],v[112:127]
buffer_load_dwordx4 v12, s[12:15], s65 offen offset:0 lds
AWR a14,0
M32 v[64:79],a[220:223],a[152:155],v[64:79]
AWR a15,0
M32 v[128:143],a[220:223],a[156:159],v[128:143]
s_waitcnt vmcnt(22) lgkmcnt(6)
M32 v[16:31],a[192:195],a[160:163],v[16:31]
DTR a[208:209],v3 offset:17408
DTR a[210:211],v3 offset:21504
AWR a16,0
s_waitcnt vmcnt(21)
M32 v[80:95],a[192:195],a[164:167],v[80:95]
DTR a[212:213],v3 offset:17664
DTR a[214:215],v3 offset:21760
buffer_load_dwordx4 a[152:155], v4, s[8:11], s62 offen offset:3072
s_waitcnt lgkmcnt(8)
M32 v[32:47],a[196:199],a[160:163],v[32:47]
DTR a[216:217],v3 offset:17920
AWR a17,0
M32 v[96:111],a[196:199],a[164:167],v[96:111]
DTR a[218:219],v3 offset:22016
DTR a[220:221],v3 offset:18176
buffer_load_dwordx4 a[156:159], v4, s[8:11], s63 offen offset:3072
s_waitcnt lgkmcnt(9)
M32 v[48:63],a[200:203],a[160:163],v[48:63]
DTR a[222:223],v3 offset:22272
buffer_load_dwordx4 v13, s[12:15], s65 offen offset:1024 lds
AWR a18,0
M32 v[112:127],a[200:203],a[164:167],v[112:127]
s_add_u32 s62, s62, 4096
s_waitcnt lgkmcnt(8)
M32 v[64:79],a[204:207],a[160:163],v[64:79]
s_add_u32 s63, s63, 4096
AWR a19,0
M32 v[128:143],a[204:207],a[164:167],v[128:143]
s_waitcnt vmcnt(23) lgkmcnt(6)
M32 v[16:31],a[208:211],a[168:171],v[16:31]
DTR a[192:193],v3 offset:18432
DTR a[194:195],v3 offset:22528
AWR a20,0
s_waitcnt vmcnt(22)
M32 v[80:95],a[208:211],a[172:175],v[80:95]
DTR a[196:197],v3 offset:18688
DTR a[198:199],v3 offset:22784
buffer_load_dwordx4 a[160:163], v4, s[8:11], s62 offen offset:0
s_waitcnt lgkmcnt(8)
M32 v[32:47],a[212:215],a[168:171],v[32:47]
DTR a[200:201],v3 offset:18944
AWR a21,0
M32 v[96:111],a[212:215],a[172:175],v[96:111]
DTR a[202:203],v3 offset:23040
DTR a[204:205],v3 offset:19200
buffer_load_dwordx4 v14, s[12:15], s65 offen offset:2048 lds
s_waitcnt lgkmcnt(9)
M32 v[48:63],a[216:219],a[168:171],v[48:63]
DTR a[206:207],v3 offset:23296
buffer_load_dwordx4 a[164:167], v4, s[8:11], s63 offen offset:0
AWR a22,0
M32 v[112:127],a[216:219],a[172:175],v[112:127]
s_waitcnt lgkmcnt(8)
M32 v[64:79],a[220:223],a[168:171],v[64:79]
AWR a23,0
M32 v[128:143],a[220:223],a[172:175],v[128:143]
s_waitcnt vmcnt(24) lgkmcnt(6)
M32 v[16:31],a[192:195],a[176:179],v[16:31]
DTR a[208:209],v3 offset:19456
DTR a[210:211],v3 offset:23552
AWR a24,0
s_waitcnt vmcnt(23)
M32 v[80:95],a[192:195],a[180:183],v[80:95]
DTR a[212:213],v3 offset:19712
DTR a[214:215],v3 offset:23808
buffer_load_dwordx4 a[168:171], v4, s[8:11], s62 offen offset:1024
s_waitcnt lgkmcnt(8)
M32 v[32:47],a[196:199],a[176:179],v[32:47]
DTR a[216:217],v3 offset:19968
AWR a25,0
M32 v[96:111],a[196:199],a[180:183],v[96:111]
DTR a[218:219],v3 offset:24064
DTR a[220:221],v3 offset:20224
buffer_load_dwordx4 v15, s[12:15], s65 offen offset:3072 lds
s_waitcnt lgkmcnt(9)
M32 v[48:63],a[200:203],a[176:179],v[48:63]
DTR a[222:223],v3 offset:24320
buffer_load_dwordx4 a[172:175], v4, s[8:11], s63 offen offset:1024
AWR a26,0
M32 v[112:127],a[200:203],a[180:183],v[112:127]
s_waitcnt lgkmcnt(8)
M32 v[64:79],a[204:207],a[176:179],v[64:79]
AWR a27,0
M32 v[128:143],a[204:207],a[180:183],v[128:143]
s_waitcnt lgkmcnt(0)
s_waitcnt vmcnt(22)
s_barrier
s_waitcnt vmcnt(21)
M32 v[16:31],a[208:211],a[184:187],v[16:31]
DTR a[192:193],v3 offset:32768
DTR a[194:195],v3 offset:36864
AWR a28,0
s_waitcnt vmcnt(20)
M32 v[80:95],a[208:211],a[188:191],v[80:95]
DTR a[196:197],v3 offset:33024
DTR a[198:199],v3 offset:37120
buffer_load_dwordx4 a[176:179], v4, s[8:11], s62 offen offset:2048
M32 v[32:47],a[212:215],a[184:187],v[32:47]
DTR a[200:201],v3 offset:33280
AWR a29,0
M32 v[96:111],a[212:215],a[188:191],v[96:111]
DTR a[202:203],v3 offset:37376
DTR a[204:205],v3 offset:33536
s_add_u32 m0, s58, 114688
M32 v[48:63],a[216:219],a[184:187],v[48:63]
DTR a[206:207],v3 offset:37632
buffer_load_dwordx4 a[180:183], v4, s[8:11], s63 offen offset:2048
s_mov_b32 s65, 2621440
M32 v[112:127],a[216:219],a[188:191],v[112:127]
buffer_load_dwordx4 v12, s[12:15], s65 offen offset:0 lds
AWR a30,0
M32 v[64:79],a[220:223],a[184:187],v[64:79]
AWR a31,0
M32 v[128:143],a[220:223],a[188:191],v[128:143]
s_waitcnt vmcnt(20) lgkmcnt(6)
M32 v[16:31],a[192:195],a[128:131],v[16:31]
DTR a[208:209],v3 offset:33792
DTR a[210:211],v3 offset:37888
AWR a32,0
s_waitcnt vmcnt(18)
M32 v[80:95],a[192:195],a[132:135],v[80:95]
DTR a[212:213],v3 offset:34048
DTR a[214:215],v3 offset:38144
buffer_load_dwordx4 a[184:187], v4, s[8:11], s62 offen offset:3072
s_waitcnt lgkmcnt(8)
M32 v[32:47],a[196:199],a[128:131],v[32:47]
DTR a[216:217],v3 offset:34304
AWR a33,0
M32 v[96:111],a[196:199],a[132:135],v[96:111]
DTR a[218:219],v3 offset:38400
DTR a[220:221],v3 offset:34560
buffer_load_dwordx4 a[188:191], v4, s[8:11], s63 offen offset:3072
s_waitcnt lgkmcnt(9)
M32 v[48:63],a[200:203],a[128:131],v[48:63]
DTR a[222:223],v3 offset:38656
buffer_load_dwordx4 v13, s[12:15], s65 offen offset:1024 lds
AWR a34,0
M32 v[112:127],a[200:203],a[132:135],v[112:127]
s_add_u32 s62, s62, 4096
s_waitcnt lgkmcnt(8)
M32 v[64:79],a[204:207],a[128:131],v[64:79]
s_add_u32 s63, s63, 4096
AWR a35,0
M32 v[128:143],a[204:207],a[132:135],v[128:143]
s_waitcnt vmcnt(20) lgkmcnt(6)
M32 v[16:31],a[208:211],a[136:139],v[16:31]
DTR a[192:193],v3 offset:34816
DTR a[194:195],v3 offset:38912
AWR a36,0
s_waitcnt vmcnt(18)
M32 v[80:95],a[208:211],a[140:143],v[80:95]
DTR a[196:197],v3 offset:35072
DTR a[198:199],v3 offset:39168
buffer_load_dwordx4 a[128:131], v4, s[8:11], s62 offen offset:0
s_waitcnt lgkmcnt(8)
M32 v[32:47],a[212:215],a[136:139],v[32:47]
DTR a[200:201],v3 offset:35328
AWR a37,0
M32 v[96:111],a[212:215],a[140:143],v[96:111]
DTR a[202:203],v3 offset:39424
DTR a[204:205],v3 offset:35584
buffer_load_dwordx4 v14, s[12:15], s65 offen offset:2048 lds
s_waitcnt lgkmcnt(9)
M32 v[48:63],a[216:219],a[136:139],v[48:63]
DTR a[206:207],v3 offset:39680
buffer_load_dwordx4 a[132:135], v4, s[8:11], s63 offen offset:0
AWR a38,0
M32 v[112:127],a[216:219],a[140:143],v[112:127]
s_waitcnt lgkmcnt(8)
M32 v[64:79],a[220:223],a[136:139],v[64:79]
AWR a39,0
M32 v[128:143],a[220:223],a[140:143],v[128:143]
s_waitcnt vmcnt(20) lgkmcnt(6)
M32 v[16:31],a[192:195],a[144:147],v[16:31]
DTR a[208:209],v3 offset:35840
DTR a[210:211],v3 offset:39936
AWR a40,0
s_waitcnt vmcnt(19)
M32 v[80:95],a[192:195],a[148:151],v[80:95]
DTR a[212:213],v3 offset:36096
DTR a[214:215],v3 offset:40192
buffer_load_dwordx4 a[136:139], v4, s[8:11], s62 offen offset:1024
s_waitcnt lgkmcnt(8)
M32 v[32:47],a[196:199],a[144:147],v[32:47]
DTR a[216:217],v3 offset:36352
AWR a41,0
M32 v[96:111],a[196:199],a[148:151],v[96:111]
DTR a[218:219],v3 offset:40448
DTR a[220:221],v3 offset:36608
buffer_load_dwordx4 v15, s[12:15], s65 offen offset:3072 lds
s_waitcnt lgkmcnt(9)
M32 v[48:63],a[200:203],a[144:147],v[48:63]
DTR a[222:223],v3 offset:40704
buffer_load_dwordx4 a[140:143], v4, s[8:11], s63 offen offset:1024
AWR a42,0
M32 v[112:127],a[200:203],a[148:151],v[112:127]
s_waitcnt lgkmcnt(8)
M32 v[64:79],a[204:207],a[144:147],v[64:79]
AWR a43,0
M32 v[128:143],a[204:207],a[148:151],v[128:143]
s_waitcnt lgkmcnt(0)
s_barrier
s_waitcnt vmcnt(20)
M32 v[16:31],a[208:211],a[152:155],v[16:31]
DTR a[192:193],v3 offset:49152
DTR a[194:195],v3 offset:53248
AWR a44,0
s_waitcnt vmcnt(19)
M32 v[80:95],a[208:211],a[156:159],v[80:95]
DTR a[196:197],v3 offset:49408
DTR a[198:199],v3 offset:53504
buffer_load_dwordx4 a[144:147], v4, s[8:11], s62 offen offset:2048
M32 v[32:47],a[212:215],a[152:155],v[32:47]
DTR a[200:201],v3 offset:49664
AWR a45,0
M32 v[96:111],a[212:215],a[156:159],v[96:111]
DTR a[202:203],v3 offset:53760
DTR a[204:205],v3 offset:49920
s_add_u32 m0, s58, 131072
M32 v[48:63],a[216:219],a[152:155],v[48:63]
DTR a[206:207],v3 offset:54016
buffer_load_dwordx4 a[148:151], v4, s[8:11], s63 offen offset:2048
s_mov_b32 s65, 3145728
M32 v[112:127],a[216:219],a[156:159],v[112:127]
buffer_load_dwordx4 v12, s[12:15], s65 offen offset:0 lds
AWR a46,0
M32 v[64:79],a[220:223],a[152:155],v[64:79]
AWR a47,0
M32 v[128:143],a[220:223],a[156:159],v[128:143]
s_waitcnt vmcnt(20) lgkmcnt(6)
M32 v[16:31],a[192:195],a[160:163],v[16:31]
DTR a[208:209],v3 offset:50176
DTR a[210:211],v3 offset:54272
AWR a48,0
s_waitcnt vmcnt(18)
M32 v[80:95],a[192:195],a[164:167],v[80:95]
DTR a[212:213],v3 offset:50432
DTR a[214:215],v3 offset:54528
buffer_load_dwordx4 a[152:155], v4, s[8:11], s62 offen offset:3072
s_waitcnt lgkmcnt(8)
M32 v[32:47],a[196:199],a[160:163],v[32:47]
DTR a[216:217],v3 offset:50688
AWR a49,0
M32 v[96:111],a[196:199],a[164:167],v[96:111]
DTR a[218:219],v3 offset:54784
DTR a[220:221],v3 offset:50944
buffer_load_dwordx4 a[156:159], v4, s[8:11], s63 offen offset:3072
s_waitcnt lgkmcnt(9)
M32 v[48:63],a[200:203],a[160:163],v[48:63]
DTR a[222:223],v3 offset:55040
buffer_load_dwordx4 v13, s[12:15], s65 offen offset:1024 lds
AWR a50,0
M32 v[112:127],a[200:203],a[164:167],v[112:127]
s_add_u32 s62, s62, 4096
s_waitcnt lgkmcnt(8)
M32 v[64:79],a[204:207],a[160:163],v[64:79]
s_add_u32 s63, s63, 4096
AWR a51,0
M32 v[128:143],a[204:207],a[164:167],v[128:143]
s_waitcnt vmcnt(20) lgkmcnt(6)
M32 v[16:31],a[208:211],a[168:171],v[16:31]
DTR a[192:193],v3 offset:51200
DTR a[194:195],v3 offset:55296
AWR a52,0
s_waitcnt vmcnt(18)
M32 v[80:95],a[208:211],a[172:175],v[80:95]
DTR a[196:197],v3 offset:51456
DTR a[198:199],v3 offset:55552
buffer_load_dwordx4 a[160:163], v4, s[8:11], s62 offen offset:0
s_waitcnt lgkmcnt(8)
M32 v[32:47],a[212:215],a[168:171],v[32:47]
DTR a[200:201],v3 offset:51712
AWR a53,0
M32 v[96:111],a[212:215],a[172:175],v[96:111]
DTR a[202:203],v3 offset:55808
DTR a[204:205],v3 offset:51968
buffer_load_dwordx4 v14, s[12:15], s65 offen offset:2048 lds
s_waitcnt lgkmcnt(9)
M32 v[48:63],a[216:219],a[168:171],v[48:63]
DTR a[206:207],v3 offset:56064
buffer_load_dwordx4 a[164:167], v4, s[8:11], s63 offen offset:0
AWR a54,0
M32 v[112:127],a[216:219],a[172:175],v[112:127]
s_waitcnt lgkmcnt(8)
M32 v[64:79],a[220:223],a[168:171],v[64:79]
AWR a55,0
M32 v[128:143],a[220:223],a[172:175],v[128:143]
s_waitcnt vmcnt(20) lgkmcnt(6)
M32 v[16:31],a[192:195],a[176:179],v[16:31]
DTR a[208:209],v3 offset:52224
DTR a[210:211],v3 offset:56320
AWR a56,0
s_waitcnt vmcnt(19)
M32 v[80:95],a[192:195],a[180:183],v[80:95]
DTR a[212:213],v3 offset:52480
DTR a[214:215],v3 offset:56576
buffer_load_dwordx4 a[168:171], v4, s[8:11], s62 offen offset:1024
s_waitcnt lgkmcnt(8)
M32 v[32:47],a[196:199],a[176:179],v[32:47]
DTR a[216:217],v3 offset:52736
AWR a57,0
M32 v[96:111],a[196:199],a[180:183],v[96:111]
DTR a[218:219],v3 offset:56832
DTR a[220:221],v3 offset:52992
buffer_load_dwordx4 v15, s[12:15], s65 offen offset:3072 lds
s_waitcnt lgkmcnt(9)
M32 v[48:63],a[200:203],a[176:179],v[48:63]
DTR a[222:223],v3 offset:57088
buffer_load_dwordx4 a[172:175], v4, s[8:11], s63 offen offset:1024
AWR a58,0
M32 v[112:127],a[200:203],a[180:183],v[112:127]
s_waitcnt lgkmcnt(8)
M32 v[64:79],a[204:207],a[176:179],v[64:79]
AWR a59,0
M32 v[128:143],a[204:207],a[180:183],v[128:143]
s_waitcnt lgkmcnt(0)
s_barrier
s_waitcnt vmcnt(20)
M32 v[16:31],a[208:211],a[184:187],v[16:31]
DTR a[192:193],v3 offset:0
DTR a[194:195],v3 offset:4096
AWR a60,0
s_waitcnt vmcnt(19)
M32 v[80:95],a[208:211],a[188:191],v[80:95]
DTR a[196:197],v3 offset:256
DTR a[198:199],v3 offset:4352
buffer_load_dwordx4 a[176:179], v4, s[8:11], s62 offen offset:2048
M32 v[32:47],a[212:215],a[184:187],v[32:47]
DTR a[200:201],v3 offset:512
AWR a61,0
M32 v[96:111],a[212:215],a[188:191],v[96:111]
DTR a[202:203],v3 offset:4608
DTR a[204:205],v3 offset:768
s_add_u32 m0, s58, 147456
M32 v[48:63],a[216:219],a[184:187],v[48:63]
DTR a[206:207],v3 offset:4864
buffer_load_dwordx4 a[180:183], v4, s[8:11], s63 offen offset:2048
s_mov_b32 s65, 3670016
M32 v[112:127],a[216:219],a[188:191],v[112:127]
buffer_load_dwordx4 v12, s[12:15], s65 offen offset:0 lds
AWR a62,0
M32 v[64:79],a[220:223],a[184:187],v[64:79]
AWR a63,0
M32 v[128:143],a[220:223],a[188:191],v[128:143]
s_waitcnt vmcnt(20) lgkmcnt(6)
M32 v[16:31],a[192:195],a[128:131],v[16:31]
DTR a[208:209],v3 offset:1024
DTR a[210:211],v3 offset:5120
AWR a64,0
s_waitcnt vmcnt(18)
M32 v[80:95],a[192:195],a[132:135],v[80:95]
DTR a[212:213],v3 offset:1280
DTR a[214:215],v3 offset:5376
buffer_load_dwordx4 a[184:187], v4, s[8:11], s62 offen offset:3072
s_waitcnt lgkmcnt(8)
M32 v[32:47],a[196:199],a[128:131],v[32:47]
DTR a[216:217],v3 offset:1536
AWR a65,0
M32 v[96:111],a[196:199],a[132:135],v[96:111]
DTR a[218:219],v3 offset:5632
DTR a[220:221],v3 offset:1792
buffer_load_dwordx4 a[188:191], v4, s[8:11], s63 offen offset:3072
s_waitcnt lgkmcnt(9)
M32 v[48:63],a[200:203],a[128:131],v[48:63]
DTR a[222:223],v3 offset:5888
buffer_load_dwordx4 v13, s[12:15], s65 offen offset:1024 lds
AWR a66,0
M32 v[112:127],a[200:203],a[132:135],v[112:127]
s_add_u32 s62, s62, 4096
s_waitcnt lgkmcnt(8)
M32 v[64:79],a[204:207],a[128:131],v[64:79]
s_add_u32 s63, s63, 4096
AWR a67,0
M32 v[128:143],a[204:207],a[132:135],v[128:143]
s_waitcnt vmcnt(20) lgkmcnt(6)
M32 v[16:31],a[208:211],a[136:139],v[16:31]
DTR a[192:193],v3 offset:2048
DTR a[194:195],v3 offset:6144
AWR a68,0
s_waitcnt vmcnt(18)
M32 v[80:95],a[208:211],a[140:143],v[80:95]
DTR a[196:197],v3 offset:2304
DTR a[198:199],v3 offset:6400
buffer_load_dwordx4 a[128:131], v4, s[8:11], s62 offen offset:0
s_waitcnt lgkmcnt(8)
M32 v[32:47],a[212:215],a[136:139],v[32:47]
DTR a[200:201],v3 offset:2560
AWR a69,0
M32 v[96:111],a[212:215],a[140:143],v[96:111]
DTR a[202:203],v3 offset:6656
DTR a[204:205],v3 offset:2816
buffer_load_dwordx4 v14, s[12:15], s65 offen offset:2048 lds
s_waitcnt lgkmcnt(9)
M32 v[48:63],a[216:219],a[136:139],v[48:63]
DTR a[206:207],v3 offset:6912
buffer_load_dwordx4 a[132:135], v4, s[8:11], s63 offen offset:0
AWR a70,0
M32 v[112:127],a[216:219],a[140:143],v[112:127]
s_waitcnt lgkmcnt(8)
M32 v[64:79],a[220:223],a[136:139],v[64:79]
AWR a71,0
M32 v[128:143],a[220:223],a[140:143],v[128:143]
s_waitcnt vmcnt(20) lgkmcnt(6)
M32 v[16:31],a[192:195],a[144:147],v[16:31]
DTR a[208:209],v3 offset:3072
DTR a[210:211],v3 offset:7168
AWR a72,0
s_waitcnt vmcnt(19)
M32 v[80:95],a[192:195],a[148:151],v[80:95]
DTR a[212:213],v3 offset:3328
DTR a[214:215],v3 offset:7424
buffer_load_dwordx4 a[136:139], v4, s[8:11], s62 offen offset:1024
s_waitcnt lgkmcnt(8)
M32 v[32:47],a[196:199],a[144:147],v[32:47]
DTR a[216:217],v3 offset:3584
AWR a73,0
M32 v[96:111],a[196:199],a[148:151],v[96:111]
DTR a[218:219],v3 offset:7680
DTR a[220:221],v3 offset:3840
buffer_load_dwordx4 v15, s[12:15], s65 offen offset:3072 lds
s_waitcnt lgkmcnt(9)
M32 v[48:63],a[200:203],a[144:147],v[48:63]
DTR a[222:223],v3 offset:7936
buffer_load_dwordx4 a[140:143], v4, s[8:11], s63 offen offset:1024
AWR a74,0
M32 v[112:127],a[200:203],a[148:151],v[112:127]
s_waitcnt lgkmcnt(8)
M32 v[64:79],a[204:207],a[144:147],v[64:79]
AWR a75,0
M32 v[128:143],a[204:207],a[148:151],v[128:143]
s_waitcnt lgkmcnt(0)
s_barrier
s_waitcnt vmcnt(20)
M32 v[16:31],a[208:211],a[152:155],v[16:31]
DTR a[192:193],v3 offset:16384
DTR a[194:195],v3 offset:20480
AWR a76,0
s_waitcnt vmcnt(19)
M32 v[80:95],a[208:211],a[156:159],v[80:95]
DTR a[196:197],v3 offset:16640
DTR a[198:199],v3 offset:20736
buffer_load_dwordx4 a[144:147], v4, s[8:11], s62 offen offset:2048
M32 v[32:47],a[212:215],a[152:155],v[32:47]
DTR a[200:201],v3 offset:16896
AWR a77,0
M32 v[96:111],a[212:215],a[156:159],v[96:111]
DTR a[202:203],v3 offset:20992
DTR a[204:205],v3 offset:17152
s_add_u32 m0, s58, 98304
M32 v[48:63],a[216:219],a[152:155],v[48:63]
DTR a[206:207],v3 offset:21248
buffer_load_dwordx4 a[148:151], v4, s[8:11], s63 offen offset:2048
s_mov_b32 s65, 4194304
M32 v[112:127],a[216:219],a[156:159],v[112:127]
buffer_load_dwordx4 v12, s[12:15], s65 offen offset:0 lds
AWR a78,0
M32 v[64:79],a[220:223],a[152:155],v[64:79]
AWR a79,0
M32 v[128:143],a[220:223],a[156:159],v[128:143]
s_waitcnt vmcnt(20) lgkmcnt(6)
M32 v[16:31],a[192:195],a[160:163],v[16:31]
DTR a[208:209],v3 offset:17408
DTR a[210:211],v3 offset:21504
AWR a80,0
s_waitcnt vmcnt(18)
M32 v[80:95],a[192:195],a[164:167],v[80:95]
DTR a[212:213],v3 offset:17664
DTR a[214:215],v3 offset:21760
buffer_load_dwordx4 a[152:155], v4, s[8:11], s62 offen offset:3072
s_waitcnt lgkmcnt(8)
M32 v[32:47],a[196:199],a[160:163],v[32:47]
DTR a[216:217],v3 offset:17920
AWR a81,0
M32 v[96:111],a[196:199],a[164:167],v[96:111]
DTR a[218:219],v3 offset:22016
DTR a[220:221],v3 offset:18176
buffer_load_dwordx4 a[156:159], v4, s[8:11], s63 offen offset:3072
s_waitcnt lgkmcnt(9)
M32 v[48:63],a[200:203],a[160:163],v[48:63]
DTR a[222:223],v3 offset:22272
buffer_load_dwordx4 v13, s[12:15], s65 offen offset:1024 lds
AWR a82,0
M32 v[112:127],a[200:203],a[164:167],v[112:127]
s_add_u32 s62, s62, 4096
s_waitcnt lgkmcnt(8)
M32 v[64:79],a[204:207],a[160:163],v[64:79]
s_add_u32 s63, s63, 4096
AWR a83,0
M32 v[128:143],a[204:207],a[164:167],v[128:143]
s_waitcnt vmcnt(20) lgkmcnt(6)
M32 v[16:31],a[208:211],a[168:171],v[16:31]
DTR a[192:193],v3 offset:18432
DTR a[194:195],v3 offset:22528
AWR a84,0
s_waitcnt vmcnt(18)
M32 v[80:95],a[208:211],a[172:175],v[80:95]
DTR a[196:197],v3 offset:18688
DTR a[198:199],v3 offset:22784
buffer_load_dwordx4 a[160:163], v4, s[8:11], s62 offen offset:0
s_waitcnt lgkmcnt(8)
M32 v[32:47],a[212:215],a[168:171],v[32:47]
DTR a[200:201],v3 offset:18944
AWR a85,0
M32 v[96:111],a[212:215],a[172:175],v[96:111]
DTR a[202:203],v3 offset:23040
DTR a[204:205],v3 offset:19200
buffer_load_dwordx4 v14, s[12:15], s65 offen offset:2048 lds
s_waitcnt lgkmcnt(9)
M32 v[48:63],a[216:219],a[168:171],v[48:63]
DTR a[206:207],v3 offset:23296
buffer_load_dwordx4 a[164:167], v4, s[8:11], s63 offen offset:0
AWR a86,0
M32 v[112:127],a[216:219],a[172:175],v[112:127]
s_waitcnt lgkmcnt(8)
M32 v[64:79],a[220:223],a[168:171],v[64:79]
AWR a87,0
M32 v[128:143],a[220:223],a[172:175],v[128:143]
s_waitcnt vmcnt(20) lgkmcnt(6)
M32 v[16:31],a[192:195],a[176:179],v[16:31]
DTR a[208:209],v3 offset:19456
DTR a[210:211],v3 offset:23552
AWR a88,0
s_waitcnt vmcnt(19)
M32 v[80:95],a[192:195],a[180:183],v[80:95]
DTR a[212:213],v3 offset:19712
DTR a[214:215],v3 offset:23808
buffer_load_dwordx4 a[168:171], v4, s[8:11], s62 offen offset:1024
s_waitcnt lgkmcnt(8)
M32 v[32:47],a[196:199],a[176:179],v[32:47]
DTR a[216:217],v3 offset:19968
AWR a89,0
M32 v[96:111],a[196:199],a[180:183],v[96:111]
DTR a[218:219],v3 offset:24064
DTR a[220:221],v3 offset:20224
buffer_load_dwordx4 v15, s[12:15], s65 offen offset:3072 lds
s_waitcnt lgkmcnt(9)
M32 v[48:63],a[200:203],a[176:179],v[48:63]
DTR a[222:223],v3 offset:24320
buffer_load_dwordx4 a[172:175], v4, s[8:11], s63 offen offset:1024
AWR a90,0
M32 v[112:127],a[200:203],a[180:183],v[112:127]
s_waitcnt lgkmcnt(8)
M32 v[64:79],a[204:207],a[176:179],v[64:79]
AWR a91,0
M32 v[128:143],a[204:207],a[180:183],v[128:143]
s_waitcnt lgkmcnt(0)
s_barrier
s_waitcnt vmcnt(20)
M32 v[16:31],a[208:211],a[184:187],v[16:31]
DTR a[192:193],v3 offset:32768
DTR a[194:195],v3 offset:36864
AWR a92,0
s_waitcnt vmcnt(19)
M32 v[80:95],a[208:211],a[188:191],v[80:95]
DTR a[196:197],v3 offset:33024
DTR a[198:199],v3 offset:37120
buffer_load_dwordx4 a[176:179], v4, s[8:11], s62 offen offset:2048
M32 v[32:47],a[212:215],a[184:187],v[32:47]
DTR a[200:201],v3 offset:33280
AWR a93,0
M32 v[96:111],a[212:215],a[188:191],v[96:111]
DTR a[202:203],v3 offset:37376
DTR a[204:205],v3 offset:33536
s_add_u32 m0, s58, 114688
M32 v[48:63],a[216:219],a[184:187],v[48:63]
DTR a[206:207],v3 offset:37632
buffer_load_dwordx4 a[180:183], v4, s[8:11], s63 offen offset:2048
s_mov_b32 s65, 4718592
M32 v[112:127],a[216:219],a[188:191],v[112:127]
buffer_load_dwordx4 v12, s[12:15], s65 offen offset:0 lds
AWR a94,0
M32 v[64:79],a[220:223],a[184:187],v[64:79]
AWR a95,0
M32 v[128:143],a[220:223],a[188:191],v[128:143]
s_waitcnt vmcnt(20) lgkmcnt(6)
M32 v[16:31],a[192:195],a[128:131],v[16:31]
DTR a[208:209],v3 offset:33792
DTR a[210:211],v3 offset:37888
AWR a96,0
s_waitcnt vmcnt(18)
M32 v[80:95],a[192:195],a[132:135],v[80:95]
DTR a[212:213],v3 offset:34048
DTR a[214:215],v3 offset:38144
buffer_load_dwordx4 a[184:187], v4, s[8:11], s62 offen offset:3072
s_waitcnt lgkmcnt(8)
M32 v[32:47],a[196:199],a[128:131],v[32:47]
DTR a[216:217],v3 offset:34304
AWR a97,0
M32 v[96:111],a[196:199],a[132:135],v[96:111]
DTR a[218:219],v3 offset:38400
DTR a[220:221],v3 offset:34560
buffer_load_dwordx4 a[188:191], v4, s[8:11], s63 offen offset:3072
s_waitcnt lgkmcnt(9)
M32 v[48:63],a[200:203],a[128:131],v[48:63]
DTR a[222:223],v3 offset:38656
buffer_load_dwordx4 v13, s[12:15], s65 offen offset:1024 lds
AWR a98,0
M32 v[112:127],a[200:203],a[132:135],v[112:127]
s_add_u32 s62, s62, 4096
s_waitcnt lgkmcnt(8)
M32 v[64:79],a[204:207],a[128:131],v[64:79]
s_add_u32 s63, s63, 4096
AWR a99,0
M32 v[128:143],a[204:207],a[132:135],v[128:143]
s_waitcnt vmcnt(20) lgkmcnt(6)
M32 v[16:31],a[208:211],a[136:139],v[16:31]
DTR a[192:193],v3 offset:34816
DTR a[194:195],v3 offset:38912
AWR a100,0
s_waitcnt vmcnt(18)
M32 v[80:95],a[208:211],a[140:143],v[80:95]
DTR a[196:197],v3 offset:35072
DTR a[198:199],v3 offset:39168
buffer_load_dwordx4 a[128:131], v4, s[8:11], s62 offen offset:0
s_waitcnt lgkmcnt(8)
M32 v[32:47],a[212:215],a[136:139],v[32:47]
DTR a[200:201],v3 offset:35328
AWR a101,0
M32 v[96:111],a[212:215],a[140:143],v[96:111]
DTR a[202:203],v3 offset:39424
DTR a[204:205],v3 offset:35584
buffer_load_dwordx4 v14, s[12:15], s65 offen offset:2048 lds
s_waitcnt lgkmcnt(9)
M32 v[48:63],a[216:219],a[136:139],v[48:63]
DTR a[206:207],v3 offset:39680
buffer_load_dwordx4 a[132:135], v4, s[8:11], s63 offen offset:0
AWR a102,0
M32 v[112:127],a[216:219],a[140:143],v[112:127]
s_waitcnt lgkmcnt(8)
M32 v[64:79],a[220:223],a[136:139],v[64:79]
AWR a103,0
M32 v[128:143],a[220:223],a[140:143],v[128:143]
s_waitcnt vmcnt(20) lgkmcnt(6)
M32 v[16:31],a[192:195],a[144:147],v[16:31]
DTR a[208:209],v3 offset:35840
DTR a[210:211],v3 offset:39936
AWR a104,0
s_waitcnt vmcnt(19)
M32 v[80:95],a[192:195],a[148:151],v[80:95]
DTR a[212:213],v3 offset:36096
DTR a[214:215],v3 offset:40192
buffer_load_dwordx4 a[136:139], v4, s[8:11], s62 offen offset:1024
s_waitcnt lgkmcnt(8)
M32 v[32:47],a[196:199],a[144:147],v[32:47]
DTR a[216:217],v3 offset:36352
AWR a105,0
M32 v[96:111],a[196:199],a[148:151],v[96:111]
DTR a[218:219],v3 offset:40448
DTR a[220:221],v3 offset:36608
buffer_load_dwordx4 v15, s[12:15], s65 offen offset:3072 lds
s_waitcnt lgkmcnt(9)
M32 v[48:63],a[200:203],a[144:147],v[48:63]
DTR a[222:223],v3 offset:40704
buffer_load_dwordx4 a[140:143], v4, s[8:11], s63 offen offset:1024
AWR a106,0
M32 v[112:127],a[200:203],a[148:151],v[112:127]
s_waitcnt lgkmcnt(8)
M32 v[64:79],a[204:207],a[144:147],v[64:79]
AWR a107,0
M32 v[128:143],a[204:207],a[148:151],v[128:143]
s_waitcnt lgkmcnt(0)
s_barrier
s_waitcnt vmcnt(20)
M32 v[16:31],a[208:211],a[152:155],v[16:31]
DTR a[192:193],v3 offset:49152
DTR a[194:195],v3 offset:53248
AWR a108,0
s_waitcnt vmcnt(19)
M32 v[80:95],a[208:211],a[156:159],v[80:95]
DTR a[196:197],v3 offset:49408
DTR a[198:199],v3 offset:53504
buffer_load_dwordx4 a[144:147], v4, s[8:11], s62 offen offset:2048
M32 v[32:47],a[212:215],a[152:155],v[32:47]
DTR a[200:201],v3 offset:49664
AWR a109,0
M32 v[96:111],a[212:215],a[156:159],v[96:111]
DTR a[202:203],v3 offset:53760
DTR a[204:205],v3 offset:49920
s_add_u32 m0, s58, 131072
M32 v[48:63],a[216:219],a[152:155],v[48:63]
DTR a[206:207],v3 offset:54016
buffer_load_dwordx4 a[148:151], v4, s[8:11], s63 offen offset:2048
s_mov_b32 s65, 5242880
M32 v[112:127],a[216:219],a[156:159],v[112:127]
buffer_load_dwordx4 v12, s[12:15], s65 offen offset:0 lds
AWR a110,0
M32 v[64:79],a[220:223],a[152:155],v[64:79]
AWR a111,0
M32 v[128:143],a[220:223],a[156:159],v[128:143]
s_waitcnt vmcnt(20) lgkmcnt(6)
M32 v[16:31],a[192:195],a[160:163],v[16:31]
DTR a[208:209],v3 offset:50176
DTR a[210:211],v3 offset:54272
AWR a112,0
s_waitcnt vmcnt(18)
M32 v[80:95],a[192:195],a[164:167],v[80:95]
DTR a[212:213],v3 offset:50432
DTR a[214:215],v3 offset:54528
buffer_load_dwordx4 a[152:155], v4, s[8:11], s62 offen offset:3072
s_waitcnt lgkmcnt(8)
M32 v[32:47],a[196:199],a[160:163],v[32:47]
DTR a[216:217],v3 offset:50688
AWR a113,0
M32 v[96:111],a[196:199],a[164:167],v[96:111]
DTR a[218:219],v3 offset:54784
DTR a[220:221],v3 offset:50944
buffer_load_dwordx4 a[156:159], v4, s[8:11], s63 offen offset:3072
s_waitcnt lgkmcnt(9)
M32 v[48:63],a[200:203],a[160:163],v[48:63]
DTR a[222:223],v3 offset:55040
buffer_load_dwordx4 v13, s[12:15], s65 offen offset:1024 lds
AWR a114,0
M32 v[112:127],a[200:203],a[164:167],v[112:127]
s_add_u32 s62, s62, 4096
s_waitcnt lgkmcnt(8)
M32 v[64:79],a[204:207],a[160:163],v[64:79]
s_add_u32 s63, s63, 4096
AWR a115,0
M32 v[128:143],a[204:207],a[164:167],v[128:143]
s_waitcnt vmcnt(20) lgkmcnt(6)
M32 v[16:31],a[208:211],a[168:171],v[16:31]
DTR a[192:193],v3 offset:51200
DTR a[194:195],v3 offset:55296
AWR a116,0
s_waitcnt vmcnt(18)
M32 v[80:95],a[208:211],a[172:175],v[80:95]
DTR a[196:197],v3 offset:51456
DTR a[198:199],v3 offset:55552
buffer_load_dwordx4 a[160:163], v4, s[8:11], s62 offen offset:0
s_waitcnt lgkmcnt(8)
M32 v[32:47],a[212:215],a[168:171],v[32:47]
DTR a[200:201],v3 offset:51712
AWR a117,0
M32 v[96:111],a[212:215],a[172:175],v[96:111]
DTR a[202:203],v3 offset:55808
DTR a[204:205],v3 offset:51968
buffer_load_dwordx4 v14, s[12:15], s65 offen offset:2048 lds
s_waitcnt lgkmcnt(9)
M32 v[48:63],a[216:219],a[168:171],v[48:63]
DTR a[206:207],v3 offset:56064
buffer_load_dwordx4 a[164:167], v4, s[8:11], s63 offen offset:0
AWR a118,0
M32 v[112:127],a[216:219],a[172:175],v[112:127]
s_waitcnt lgkmcnt(8)
M32 v[64:79],a[220:223],a[168:171],v[64:79]
AWR a119,0
M32 v[128:143],a[220:223],a[172:175],v[128:143]
s_waitcnt vmcnt(20) lgkmcnt(6)
M32 v[16:31],a[192:195],a[176:179],v[16:31]
DTR a[208:209],v3 offset:52224
DTR a[210:211],v3 offset:56320
AWR a120,0
s_waitcnt vmcnt(19)
M32 v[80:95],a[192:195],a[180:183],v[80:95]
DTR a[212:213],v3 offset:52480
DTR a[214:215],v3 offset:56576
buffer_load_dwordx4 a[168:171], v4, s[8:11], s62 offen offset:1024
s_waitcnt lgkmcnt(8)
M32 v[32:47],a[196:199],a[176:179],v[32:47]
DTR a[216:217],v3 offset:52736
AWR a121,0
M32 v[96:111],a[196:199],a[180:183],v[96:111]
DTR a[218:219],v3 offset:56832
DTR a[220:221],v3 offset:52992
buffer_load_dwordx4 v15, s[12:15], s65 offen offset:3072 lds
s_waitcnt lgkmcnt(9)
M32 v[48:63],a[200:203],a[176:179],v[48:63]
DTR a[222:223],v3 offset:57088
buffer_load_dwordx4 a[172:175], v4, s[8:11], s63 offen offset:1024
AWR a122,0
M32 v[112:127],a[200:203],a[180:183],v[112:127]
s_waitcnt lgkmcnt(8)
M32 v[64:79],a[204:207],a[176:179],v[64:79]
AWR a123,0
M32 v[128:143],a[204:207],a[180:183],v[128:143]
s_waitcnt lgkmcnt(0)
s_barrier
s_waitcnt vmcnt(20)
M32 v[16:31],a[208:211],a[184:187],v[16:31]
DTR a[192:193],v3 offset:0
DTR a[194:195],v3 offset:4096
AWR a124,0
s_waitcnt vmcnt(19)
M32 v[80:95],a[208:211],a[188:191],v[80:95]
DTR a[196:197],v3 offset:256
DTR a[198:199],v3 offset:4352
buffer_load_dwordx4 a[176:179], v4, s[8:11], s62 offen offset:2048
M32 v[32:47],a[212:215],a[184:187],v[32:47]
DTR a[200:201],v3 offset:512
AWR a125,0
M32 v[96:111],a[212:215],a[188:191],v[96:111]
DTR a[202:203],v3 offset:4608
DTR a[204:205],v3 offset:768
s_add_u32 m0, s58, 147456
M32 v[48:63],a[216:219],a[184:187],v[48:63]
DTR a[206:207],v3 offset:4864
buffer_load_dwordx4 a[180:183], v4, s[8:11], s63 offen offset:2048
s_mov_b32 s65, 5767168
M32 v[112:127],a[216:219],a[188:191],v[112:127]
buffer_load_dwordx4 v12, s[12:15], s65 offen offset:0 lds
AWR a126,0
M32 v[64:79],a[220:223],a[184:187],v[64:79]
AWR a127,0
M32 v[128:143],a[220:223],a[188:191],v[128:143]
s_waitcnt vmcnt(20) lgkmcnt(6)
M32 v[16:31],a[192:195],a[128:131],v[16:31]
DTR a[208:209],v3 offset:1024
DTR a[210:211],v3 offset:5120
s_waitcnt vmcnt(18)
M32 v[80:95],a[192:195],a[132:135],v[80:95]
DTR a[212:213],v3 offset:1280
DTR a[214:215],v3 offset:5376
buffer_load_dwordx4 a[184:187], v4, s[8:11], s62 offen offset:3072
s_waitcnt lgkmcnt(8)
M32 v[32:47],a[196:199],a[128:131],v[32:47]
DTR a[216:217],v3 offset:1536
M32 v[96:111],a[196:199],a[132:135],v[96:111]
DTR a[218:219],v3 offset:5632
DTR a[220:221],v3 offset:1792
buffer_load_dwordx4 a[188:191], v4, s[8:11], s63 offen offset:3072
s_waitcnt lgkmcnt(9)
M32 v[48:63],a[200:203],a[128:131],v[48:63]
DTR a[222:223],v3 offset:5888
buffer_load_dwordx4 v13, s[12:15], s65 offen offset:1024 lds
M32 v[112:127],a[200:203],a[132:135],v[112:127]
s_add_u32 s62, s62, 4096
s_waitcnt lgkmcnt(8)
M32 v[64:79],a[204:207],a[128:131],v[64:79]
s_add_u32 s63, s63, 4096
M32 v[128:143],a[204:207],a[132:135],v[128:143]
s_waitcnt vmcnt(20) lgkmcnt(6)
M32 v[16:31],a[208:211],a[136:139],v[16:31]
DTR a[192:193],v3 offset:2048
DTR a[194:195],v3 offset:6144
s_waitcnt vmcnt(18)
M32 v[80:95],a[208:211],a[140:143],v[80:95]
DTR a[196:197],v3 offset:2304
DTR a[198:199],v3 offset:6400
buffer_load_dwordx4 a[128:131], v4, s[8:11], s62 offen offset:0
s_waitcnt lgkmcnt(8)
M32 v[32:47],a[212:215],a[136:139],v[32:47]
DTR a[200:201],v3 offset:2560
M32 v[96:111],a[212:215],a[140:143],v[96:111]
DTR a[202:203],v3 offset:6656
DTR a[204:205],v3 offset:2816
buffer_load_dwordx4 v14, s[12:15], s65 offen offset:2048 lds
s_waitcnt lgkmcnt(9)
M32 v[48:63],a[216:219],a[136:139],v[48:63]
DTR a[206:207],v3 offset:6912
buffer_load_dwordx4 a[132:135], v4, s[8:11], s63 offen offset:0
M32 v[112:127],a[216:219],a[140:143],v[112:127]
s_waitcnt lgkmcnt(8)
M32 v[64:79],a[220:223],a[136:139],v[64:79]
M32 v[128:143],a[220:223],a[140:143],v[128:143]
s_waitcnt vmcnt(20) lgkmcnt(6)
M32 v[16:31],a[192:195],a[144:147],v[16:31]
DTR a[208:209],v3 offset:3072
DTR a[210:211],v3 offset:7168
s_waitcnt vmcnt(19)
M32 v[80:95],a[192:195],a[148:151],v[80:95]
DTR a[212:213],v3 offset:3328
DTR a[214:215],v3 offset:7424
buffer_load_dwordx4 a[136:139], v4, s[8:11], s62 offen offset:1024
s_waitcnt lgkmcnt(8)
M32 v[32:47],a[196:199],a[144:147],v[32:47]
DTR a[216:217],v3 offset:3584
M32 v[96:111],a[196:199],a[148:151],v[96:111]
DTR a[218:219],v3 offset:7680
DTR a[220:221],v3 offset:3840
buffer_load_dwordx4 v15, s[12:15], s65 offen offset:3072 lds
s_waitcnt lgkmcnt(9)
M32 v[48:63],a[200:203],a[144:147],v[48:63]
DTR a[222:223],v3 offset:7936
buffer_load_dwordx4 a[140:143], v4, s[8:11], s63 offen offset:1024
M32 v[112:127],a[200:203],a[148:151],v[112:127]
s_waitcnt lgkmcnt(8)
M32 v[64:79],a[204:207],a[144:147],v[64:79]
M32 v[128:143],a[204:207],a[148:151],v[128:143]
s_waitcnt lgkmcnt(0)
s_barrier
s_waitcnt vmcnt(20)
M32 v[16:31],a[208:211],a[152:155],v[16:31]
DTR a[192:193],v3 offset:16384
DTR a[194:195],v3 offset:20480
s_waitcnt vmcnt(19)
M32 v[80:95],a[208:211],a[156:159],v[80:95]
DTR a[196:197],v3 offset:16640
DTR a[198:199],v3 offset:20736
buffer_load_dwordx4 a[144:147], v4, s[8:11], s62 offen offset:2048
M32 v[32:47],a[212:215],a[152:155],v[32:47]
DTR a[200:201],v3 offset:16896
M32 v[96:111],a[212:215],a[156:159],v[96:111]
DTR a[202:203],v3 offset:20992
DTR a[204:205],v3 offset:17152
s_add_u32 m0, s58, 98304
M32 v[48:63],a[216:219],a[152:155],v[48:63]
DTR a[206:207],v3 offset:21248
buffer_load_dwordx4 a[148:151], v4, s[8:11], s63 offen offset:2048
s_mov_b32 s65, 6291456
M32 v[112:127],a[216:219],a[156:159],v[112:127]
buffer_load_dwordx4 v12, s[12:15], s65 offen offset:0 lds
M32 v[64:79],a[220:223],a[152:155],v[64:79]
M32 v[128:143],a[220:223],a[156:159],v[128:143]
s_waitcnt vmcnt(20) lgkmcnt(6)
M32 v[16:31],a[192:195],a[160:163],v[16:31]
DTR a[208:209],v3 offset:17408
DTR a[210:211],v3 offset:21504
s_waitcnt vmcnt(18)
M32 v[80:95],a[192:195],a[164:167],v[80:95]
DTR a[212:213],v3 offset:17664
DTR a[214:215],v3 offset:21760
buffer_load_dwordx4 a[152:155], v4, s[8:11], s62 offen offset:3072
s_waitcnt lgkmcnt(8)
M32 v[32:47],a[196:199],a[160:163],v[32:47]
DTR a[216:217],v3 offset:17920
M32 v[96:111],a[196:199],a[164:167],v[96:111]
DTR a[218:219],v3 offset:22016
DTR a[220:221],v3 offset:18176
buffer_load_dwordx4 a[156:159], v4, s[8:11], s63 offen offset:3072
s_waitcnt lgkmcnt(9)
M32 v[48:63],a[200:203],a[160:163],v[48:63]
DTR a[222:223],v3 offset:22272
buffer_load_dwordx4 v13, s[12:15], s65 offen offset:1024 lds
M32 v[112:127],a[200:203],a[164:167],v[112:127]
s_add_u32 s62, s62, 4096
s_waitcnt lgkmcnt(8)
M32 v[64:79],a[204:207],a[160:163],v[64:79]
s_add_u32 s63, s63, 4096
M32 v[128:143],a[204:207],a[164:167],v[128:143]
s_waitcnt vmcnt(20) lgkmcnt(6)
M32 v[16:31],a[208:211],a[168:171],v[16:31]
DTR a[192:193],v3 offset:18432
DTR a[194:195],v3 offset:22528
s_waitcnt vmcnt(18)
M32 v[80:95],a[208:211],a[172:175],v[80:95]
DTR a[196:197],v3 offset:18688
DTR a[198:199],v3 offset:22784
buffer_load_dwordx4 a[160:163], v4, s[8:11], s62 offen offset:0
s_waitcnt lgkmcnt(8)
M32 v[32:47],a[212:215],a[168:171],v[32:47]
DTR a[200:201],v3 offset:18944
M32 v[96:111],a[212:215],a[172:175],v[96:111]
DTR a[202:203],v3 offset:23040
DTR a[204:205],v3 offset:19200
buffer_load_dwordx4 v14, s[12:15], s65 offen offset:2048 lds
s_waitcnt lgkmcnt(9)
M32 v[48:63],a[216:219],a[168:171],v[48:63]
DTR a[206:207],v3 offset:23296
buffer_load_dwordx4 a[164:167], v4, s[8:11], s63 offen offset:0
M32 v[112:127],a[216:219],a[172:175],v[112:127]
s_waitcnt lgkmcnt(8)
M32 v[64:79],a[220:223],a[168:171],v[64:79]
M32 v[128:143],a[220:223],a[172:175],v[128:143]
s_waitcnt vmcnt(20) lgkmcnt(6)
M32 v[16:31],a[192:195],a[176:179],v[16:31]
DTR a[208:209],v3 offset:19456
DTR a[210:211],v3 offset:23552
s_waitcnt vmcnt(19)
M32 v[80:95],a[192:195],a[180:183],v[80:95]
DTR a[212:213],v3 offset:19712
DTR a[214:215],v3 offset:23808
buffer_load_dwordx4 a[168:171], v4, s[8:11], s62 offen offset:1024
s_waitcnt lgkmcnt(8)
M32 v[32:47],a[196:199],a[176:179],v[32:47]
DTR a[216:217],v3 offset:19968
M32 v[96:111],a[196:199],a[180:183],v[96:111]
DTR a[218:219],v3 offset:24064
DTR a[220:221],v3 offset:20224
buffer_load_dwordx4 v15, s[12:15], s65 offen offset:3072 lds
s_waitcnt lgkmcnt(9)
M32 v[48:63],a[200:203],a[176:179],v[48:63]
DTR a[222:223],v3 offset:24320
buffer_load_dwordx4 a[172:175], v4, s[8:11], s63 offen offset:1024
M32 v[112:127],a[200:203],a[180:183],v[112:127]
s_waitcnt lgkmcnt(8)
M32 v[64:79],a[204:207],a[176:179],v[64:79]
M32 v[128:143],a[204:207],a[180:183],v[128:143]
s_waitcnt lgkmcnt(0)
s_barrier
s_waitcnt vmcnt(20)
M32 v[16:31],a[208:211],a[184:187],v[16:31]
DTR a[192:193],v3 offset:32768
DTR a[194:195],v3 offset:36864
s_waitcnt vmcnt(19)
M32 v[80:95],a[208:211],a[188:191],v[80:95]
DTR a[196:197],v3 offset:33024
DTR a[198:199],v3 offset:37120
buffer_load_dwordx4 a[176:179], v4, s[8:11], s62 offen offset:2048
M32 v[32:47],a[212:215],a[184:187],v[32:47]
DTR a[200:201],v3 offset:33280
M32 v[96:111],a[212:215],a[188:191],v[96:111]
DTR a[202:203],v3 offset:37376
DTR a[204:205],v3 offset:33536
s_add_u32 m0, s58, 114688
M32 v[48:63],a[216:219],a[184:187],v[48:63]
DTR a[206:207],v3 offset:37632
buffer_load_dwordx4 a[180:183], v4, s[8:11], s63 offen offset:2048
s_mov_b32 s65, 6815744
M32 v[112:127],a[216:219],a[188:191],v[112:127]
buffer_load_dwordx4 v12, s[12:15], s65 offen offset:0 lds
M32 v[64:79],a[220:223],a[184:187],v[64:79]
M32 v[128:143],a[220:223],a[188:191],v[128:143]
s_waitcnt vmcnt(20) lgkmcnt(6)
M32 v[16:31],a[192:195],a[128:131],v[16:31]
DTR a[208:209],v3 offset:33792
DTR a[210:211],v3 offset:37888
s_waitcnt vmcnt(18)
M32 v[80:95],a[192:195],a[132:135],v[80:95]
DTR a[212:213],v3 offset:34048
DTR a[214:215],v3 offset:38144
buffer_load_dwordx4 a[184:187], v4, s[8:11], s62 offen offset:3072
s_waitcnt lgkmcnt(8)
M32 v[32:47],a[196:199],a[128:131],v[32:47]
DTR a[216:217],v3 offset:34304
M32 v[96:111],a[196:199],a[132:135],v[96:111]
DTR a[218:219],v3 offset:38400
DTR a[220:221],v3 offset:34560
buffer_load_dwordx4 a[188:191], v4, s[8:11], s63 offen offset:3072
s_waitcnt lgkmcnt(9)
M32 v[48:63],a[200:203],a[128:131],v[48:63]
DTR a[222:223],v3 offset:38656
buffer_load_dwordx4 v13, s[12:15], s65 offen offset:1024 lds
M32 v[112:127],a[200:203],a[132:135],v[112:127]
s_add_u32 s62, s62, 4096
s_waitcnt lgkmcnt(8)
M32 v[64:79],a[204:207],a[128:131],v[64:79]
s_add_u32 s63, s63, 4096
M32 v[128:143],a[204:207],a[132:135],v[128:143]
s_waitcnt vmcnt(20) lgkmcnt(6)
M32 v[16:31],a[208:211],a[136:139],v[16:31]
DTR a[192:193],v3 offset:34816
DTR a[194:195],v3 offset:38912
s_waitcnt vmcnt(18)
M32 v[80:95],a[208:211],a[140:143],v[80:95]
DTR a[196:197],v3 offset:35072
DTR a[198:199],v3 offset:39168
buffer_load_dwordx4 a[128:131], v4, s[8:11], s62 offen offset:0
s_waitcnt lgkmcnt(8)
M32 v[32:47],a[212:215],a[136:139],v[32:47]
DTR a[200:201],v3 offset:35328
M32 v[96:111],a[212:215],a[140:143],v[96:111]
DTR a[202:203],v3 offset:39424
DTR a[204:205],v3 offset:35584
buffer_load_dwordx4 v14, s[12:15], s65 offen offset:2048 lds
s_waitcnt lgkmcnt(9)
M32 v[48:63],a[216:219],a[136:139],v[48:63]
DTR a[206:207],v3 offset:39680
buffer_load_dwordx4 a[132:135], v4, s[8:11], s63 offen offset:0
M32 v[112:127],a[216:219],a[140:143],v[112:127]
s_waitcnt lgkmcnt(8)
M32 v[64:79],a[220:223],a[136:139],v[64:79]
M32 v[128:143],a[220:223],a[140:143],v[128:143]
s_waitcnt vmcnt(20) lgkmcnt(6)
M32 v[16:31],a[192:195],a[144:147],v[16:31]
DTR a[208:209],v3 offset:35840
DTR a[210:211],v3 offset:39936
s_waitcnt vmcnt(19)
M32 v[80:95],a[192:195],a[148:151],v[80:95]
DTR a[212:213],v3 offset:36096
DTR a[214:215],v3 offset:40192
buffer_load_dwordx4 a[136:139], v4, s[8:11], s62 offen offset:1024
s_waitcnt lgkmcnt(8)
M32 v[32:47],a[196:199],a[144:147],v[32:47]
DTR a[216:217],v3 offset:36352
M32 v[96:111],a[196:199],a[148:151],v[96:111]
DTR a[218:219],v3 offset:40448
DTR a[220:221],v3 offset:36608
buffer_load_dwordx4 v15, s[12:15], s65 offen offset:3072 lds
s_waitcnt lgkmcnt(9)
M32 v[48:63],a[200:203],a[144:147],v[48:63]
DTR a[222:223],v3 offset:40704
buffer_load_dwordx4 a[140:143], v4, s[8:11], s63 offen offset:1024
M32 v[112:127],a[200:203],a[148:151],v[112:127]
s_waitcnt lgkmcnt(8)
M32 v[64:79],a[204:207],a[144:147],v[64:79]
M32 v[128:143],a[204:207],a[148:151],v[128:143]
s_waitcnt lgkmcnt(0)
s_barrier
s_waitcnt vmcnt(20)
M32 v[16:31],a[208:211],a[152:155],v[16:31]
DTR a[192:193],v3 offset:49152
DTR a[194:195],v3 offset:53248
s_waitcnt vmcnt(19)
M32 v[80:95],a[208:211],a[156:159],v[80:95]
DTR a[196:197],v3 offset:49408
DTR a[198:199],v3 offset:53504
buffer_load_dwordx4 a[144:147], v4, s[8:11], s62 offen offset:2048
M32 v[32:47],a[212:215],a[152:155],v[32:47]
DTR a[200:201],v3 offset:49664
M32 v[96:111],a[212:215],a[156:159],v[96:111]
DTR a[202:203],v3 offset:53760
DTR a[204:205],v3 offset:49920
s_add_u32 m0, s58, 131072
M32 v[48:63],a[216:219],a[152:155],v[48:63]
DTR a[206:207],v3 offset:54016
buffer_load_dwordx4 a[148:151], v4, s[8:11], s63 offen offset:2048
s_mov_b32 s65, 7340032
M32 v[112:127],a[216:219],a[156:159],v[112:127]
buffer_load_dwordx4 v12, s[12:15], s65 offen offset:0 lds
M32 v[64:79],a[220:223],a[152:155],v[64:79]
M32 v[128:143],a[220:223],a[156:159],v[128:143]
s_waitcnt vmcnt(20) lgkmcnt(6)
M32 v[16:31],a[192:195],a[160:163],v[16:31]
DTR a[208:209],v3 offset:50176
DTR a[210:211],v3 offset:54272
s_waitcnt vmcnt(18)
M32 v[80:95],a[192:195],a[164:167],v[80:95]
DTR a[212:213],v3 offset:50432
DTR a[214:215],v3 offset:54528
buffer_load_dwordx4 a[152:155], v4, s[8:11], s62 offen offset:3072
s_waitcnt lgkmcnt(8)
M32 v[32:47],a[196:199],a[160:163],v[32:47]
DTR a[216:217],v3 offset:50688
M32 v[96:111],a[196:199],a[164:167],v[96:111]
DTR a[218:219],v3 offset:54784
DTR a[220:221],v3 offset:50944
buffer_load_dwordx4 a[156:159], v4, s[8:11], s63 offen offset:3072
s_waitcnt lgkmcnt(9)
M32 v[48:63],a[200:203],a[160:163],v[48:63]
DTR a[222:223],v3 offset:55040
buffer_load_dwordx4 v13, s[12:15], s65 offen offset:1024 lds
M32 v[112:127],a[200:203],a[164:167],v[112:127]
s_add_u32 s62, s62, 4096
s_waitcnt lgkmcnt(8)
M32 v[64:79],a[204:207],a[160:163],v[64:79]
s_add_u32 s63, s63, 4096
M32 v[128:143],a[204:207],a[164:167],v[128:143]
s_waitcnt vmcnt(20) lgkmcnt(6)
M32 v[16:31],a[208:211],a[168:171],v[16:31]
DTR a[192:193],v3 offset:51200
DTR a[194:195],v3 offset:55296
s_waitcnt vmcnt(18)
M32 v[80:95],a[208:211],a[172:175],v[80:95]
DTR a[196:197],v3 offset:51456
DTR a[198:199],v3 offset:55552
buffer_load_dwordx4 a[160:163], v4, s[8:11], s62 offen offset:0
s_waitcnt lgkmcnt(8)
M32 v[32:47],a[212:215],a[168:171],v[32:47]
DTR a[200:201],v3 offset:51712
M32 v[96:111],a[212:215],a[172:175],v[96:111]
DTR a[202:203],v3 offset:55808
DTR a[204:205],v3 offset:51968
buffer_load_dwordx4 v14, s[12:15], s65 offen offset:2048 lds
s_waitcnt lgkmcnt(9)
M32 v[48:63],a[216:219],a[168:171],v[48:63]
DTR a[206:207],v3 offset:56064
buffer_load_dwordx4 a[164:167], v4, s[8:11], s63 offen offset:0
M32 v[112:127],a[216:219],a[172:175],v[112:127]
s_waitcnt lgkmcnt(8)
M32 v[64:79],a[220:223],a[168:171],v[64:79]
M32 v[128:143],a[220:223],a[172:175],v[128:143]
s_waitcnt vmcnt(20) lgkmcnt(6)
M32 v[16:31],a[192:195],a[176:179],v[16:31]
DTR a[208:209],v3 offset:52224
DTR a[210:211],v3 offset:56320
s_waitcnt vmcnt(19)
M32 v[80:95],a[192:195],a[180:183],v[80:95]
DTR a[212:213],v3 offset:52480
DTR a[214:215],v3 offset:56576
buffer_load_dwordx4 a[168:171], v4, s[8:11], s62 offen offset:1024
s_waitcnt lgkmcnt(8)
M32 v[32:47],a[196:199],a[176:179],v[32:47]
DTR a[216:217],v3 offset:52736
M32 v[96:111],a[196:199],a[180:183],v[96:111]
DTR a[218:219],v3 offset:56832
DTR a[220:221],v3 offset:52992
buffer_load_dwordx4 v15, s[12:15], s65 offen offset:3072 lds
s_waitcnt lgkmcnt(9)
M32 v[48:63],a[200:203],a[176:179],v[48:63]
DTR a[222:223],v3 offset:57088
buffer_load_dwordx4 a[172:175], v4, s[8:11], s63 offen offset:1024
M32 v[112:127],a[200:203],a[180:183],v[112:127]
s_waitcnt lgkmcnt(8)
M32 v[64:79],a[204:207],a[176:179],v[64:79]
M32 v[128:143],a[204:207],a[180:183],v[128:143]
s_waitcnt lgkmcnt(0)
s_barrier
s_waitcnt vmcnt(20)
M32 v[16:31],a[208:211],a[184:187],v[16:31]
DTR a[192:193],v3 offset:0
DTR a[194:195],v3 offset:4096
s_waitcnt vmcnt(19)
M32 v[80:95],a[208:211],a[188:191],v[80:95]
DTR a[196:197],v3 offset:256
DTR a[198:199],v3 offset:4352
buffer_load_dwordx4 a[176:179], v4, s[8:11], s62 offen offset:2048
M32 v[32:47],a[212:215],a[184:187],v[32:47]
DTR a[200:201],v3 offset:512
M32 v[96:111],a[212:215],a[188:191],v[96:111]
DTR a[202:203],v3 offset:4608
DTR a[204:205],v3 offset:768
s_add_u32 m0, s58, 147456
M32 v[48:63],a[216:219],a[184:187],v[48:63]
DTR a[206:207],v3 offset:4864
buffer_load_dwordx4 a[180:183], v4, s[8:11], s63 offen offset:2048
s_mov_b32 s65, 7864320
M32 v[112:127],a[216:219],a[188:191],v[112:127]
buffer_load_dwordx4 v12, s[12:15], s65 offen offset:0 lds
M32 v[64:79],a[220:223],a[184:187],v[64:79]
M32 v[128:143],a[220:223],a[188:191],v[128:143]
s_waitcnt vmcnt(20) lgkmcnt(6)
M32 v[16:31],a[192:195],a[128:131],v[16:31]
DTR a[208:209],v3 offset:1024
DTR a[210:211],v3 offset:5120
s_waitcnt vmcnt(18)
M32 v[80:95],a[192:195],a[132:135],v[80:95]
DTR a[212:213],v3 offset:1280
DTR a[214:215],v3 offset:5376
buffer_load_dwordx4 a[184:187], v4, s[8:11], s62 offen offset:3072
s_waitcnt lgkmcnt(8)
M32 v[32:47],a[196:199],a[128:131],v[32:47]
DTR a[216:217],v3 offset:1536
M32 v[96:111],a[196:199],a[132:135],v[96:111]
DTR a[218:219],v3 offset:5632
DTR a[220:221],v3 offset:1792
buffer_load_dwordx4 a[188:191], v4, s[8:11], s63 offen offset:3072
s_waitcnt lgkmcnt(9)
M32 v[48:63],a[200:203],a[128:131],v[48:63]
DTR a[222:223],v3 offset:5888
buffer_load_dwordx4 v13, s[12:15], s65 offen offset:1024 lds
M32 v[112:127],a[200:203],a[132:135],v[112:127]
s_add_u32 s62, s62, 4096
s_waitcnt lgkmcnt(8)
M32 v[64:79],a[204:207],a[128:131],v[64:79]
s_add_u32 s63, s63, 4096
M32 v[128:143],a[204:207],a[132:135],v[128:143]
s_waitcnt vmcnt(20) lgkmcnt(6)
M32 v[16:31],a[208:211],a[136:139],v[16:31]
DTR a[192:193],v3 offset:2048
DTR a[194:195],v3 offset:6144
s_waitcnt vmcnt(18)
M32 v[80:95],a[208:211],a[140:143],v[80:95]
DTR a[196:197],v3 offset:2304
DTR a[198:199],v3 offset:6400
buffer_load_dwordx4 a[128:131], v4, s[8:11], s62 offen offset:0
s_waitcnt lgkmcnt(8)
M32 v[32:47],a[212:215],a[136:139],v[32:47]
DTR a[200:201],v3 offset:2560
M32 v[96:111],a[212:215],a[140:143],v[96:111]
DTR a[202:203],v3 offset:6656
DTR a[204:205],v3 offset:2816
buffer_load_dwordx4 v14, s[12:15], s65 offen offset:2048 lds
s_waitcnt lgkmcnt(9)
M32 v[48:63],a[216:219],a[136:139],v[48:63]
DTR a[206:207],v3 offset:6912
buffer_load_dwordx4 a[132:135], v4, s[8:11], s63 offen offset:0
M32 v[112:127],a[216:219],a[140:143],v[112:127]
s_waitcnt lgkmcnt(8)
M32 v[64:79],a[220:223],a[136:139],v[64:79]
M32 v[128:143],a[220:223],a[140:143],v[128:143]
s_waitcnt vmcnt(20) lgkmcnt(6)
M32 v[16:31],a[192:195],a[144:147],v[16:31]
DTR a[208:209],v3 offset:3072
DTR a[210:211],v3 offset:7168
s_waitcnt vmcnt(19)
M32 v[80:95],a[192:195],a[148:151],v[80:95]
DTR a[212:213],v3 offset:3328
DTR a[214:215],v3 offset:7424
buffer_load_dwordx4 a[136:139], v4, s[8:11], s62 offen offset:1024
s_waitcnt lgkmcnt(8)
M32 v[32:47],a[196:199],a[144:147],v[32:47]
DTR a[216:217],v3 offset:3584
M32 v[96:111],a[196:199],a[148:151],v[96:111]
DTR a[218:219],v3 offset:7680
DTR a[220:221],v3 offset:3840
buffer_load_dwordx4 v15, s[12:15], s65 offen offset:3072 lds
s_waitcnt lgkmcnt(9)
M32 v[48:63],a[200:203],a[144:147],v[48:63]
DTR a[222:223],v3 offset:7936
buffer_load_dwordx4 a[140:143], v4, s[8:11], s63 offen offset:1024
M32 v[112:127],a[200:203],a[148:151],v[112:127]
s_waitcnt lgkmcnt(8)
M32 v[64:79],a[204:207],a[144:147],v[64:79]
M32 v[128:143],a[204:207],a[148:151],v[128:143]
s_waitcnt lgkmcnt(0)
s_barrier
s_waitcnt vmcnt(20)
M32 v[16:31],a[208:211],a[152:155],v[16:31]
DTR a[192:193],v3 offset:16384
DTR a[194:195],v3 offset:20480
s_waitcnt vmcnt(19)
M32 v[80:95],a[208:211],a[156:159],v[80:95]
DTR a[196:197],v3 offset:16640
DTR a[198:199],v3 offset:20736
buffer_load_dwordx4 a[144:147], v4, s[8:11], s62 offen offset:2048
M32 v[32:47],a[212:215],a[152:155],v[32:47]
DTR a[200:201],v3 offset:16896
M32 v[96:111],a[212:215],a[156:159],v[96:111]
DTR a[202:203],v3 offset:20992
DTR a[204:205],v3 offset:17152
M32 v[48:63],a[216:219],a[152:155],v[48:63]
DTR a[206:207],v3 offset:21248
buffer_load_dwordx4 a[148:151], v4, s[8:11], s63 offen offset:2048
M32 v[112:127],a[216:219],a[156:159],v[112:127]
M32 v[64:79],a[220:223],a[152:155],v[64:79]
M32 v[128:143],a[220:223],a[156:159],v[128:143]
s_waitcnt vmcnt(19) lgkmcnt(6)
M32 v[16:31],a[192:195],a[160:163],v[16:31]
DTR a[208:209],v3 offset:17408
DTR a[210:211],v3 offset:21504
s_waitcnt vmcnt(17)
M32 v[80:95],a[192:195],a[164:167],v[80:95]
DTR a[212:213],v3 offset:17664
DTR a[214:215],v3 offset:21760
buffer_load_dwordx4 a[152:155], v4, s[8:11], s62 offen offset:3072
s_waitcnt lgkmcnt(8)
M32 v[32:47],a[196:199],a[160:163],v[32:47]
DTR a[216:217],v3 offset:17920
M32 v[96:111],a[196:199],a[164:167],v[96:111]
DTR a[218:219],v3 offset:22016
DTR a[220:221],v3 offset:18176
buffer_load_dwordx4 a[156:159], v4, s[8:11], s63 offen offset:3072
s_waitcnt lgkmcnt(9)
M32 v[48:63],a[200:203],a[160:163],v[48:63]
DTR a[222:223],v3 offset:22272
s_add_u32 m0, s58, 0
s_nop 0
buffer_load_dwordx4 v6, s[16:19], s60 offen offset:0 lds
M32 v[112:127],a[200:203],a[164:167],v[112:127]
s_add_u32 s62, s62, 4096
s_waitcnt lgkmcnt(8)
M32 v[64:79],a[204:207],a[160:163],v[64:79]
s_add_u32 s63, s63, 4096
buffer_load_dwordx4 v6, s[16:19], s60 offen offset:1024 lds
M32 v[128:143],a[204:207],a[164:167],v[128:143]
s_waitcnt vmcnt(20) lgkmcnt(6)
M32 v[16:31],a[208:211],a[168:171],v[16:31]
DTR a[192:193],v3 offset:18432
DTR a[194:195],v3 offset:22528
s_waitcnt vmcnt(18)
M32 v[80:95],a[208:211],a[172:175],v[80:95]
DTR a[196:197],v3 offset:18688
DTR a[198:199],v3 offset:22784
buffer_load_dwordx4 a[160:163], v4, s[8:11], s62 offen offset:0
s_waitcnt lgkmcnt(8)
M32 v[32:47],a[212:215],a[168:171],v[32:47]
DTR a[200:201],v3 offset:18944
M32 v[96:111],a[212:215],a[172:175],v[96:111]
DTR a[202:203],v3 offset:23040
DTR a[204:205],v3 offset:19200
buffer_load_dwordx4 v6, s[16:19], s60 offen offset:2048 lds
s_waitcnt lgkmcnt(9)
M32 v[48:63],a[216:219],a[168:171],v[48:63]
DTR a[206:207],v3 offset:23296
buffer_load_dwordx4 a[164:167], v4, s[8:11], s63 offen offset:0
M32 v[112:127],a[216:219],a[172:175],v[112:127]
buffer_load_dwordx4 v6, s[16:19], s60 offen offset:3072 lds
s_waitcnt lgkmcnt(8)
M32 v[64:79],a[220:223],a[168:171],v[64:79]
M32 v[128:143],a[220:223],a[172:175],v[128:143]
s_add_u32 s60, s60, 32768
s_waitcnt vmcnt(21) lgkmcnt(6)
M32 v[16:31],a[192:195],a[176:179],v[16:31]
DTR a[208:209],v3 offset:19456
DTR a[210:211],v3 offset:23552
s_waitcnt vmcnt(20)
M32 v[80:95],a[192:195],a[180:183],v[80:95]
DTR a[212:213],v3 offset:19712
DTR a[214:215],v3 offset:23808
buffer_load_dwordx4 a[168:171], v4, s[8:11], s62 offen offset:1024
s_waitcnt lgkmcnt(8)
M32 v[32:47],a[196:199],a[176:179],v[32:47]
DTR a[216:217],v3 offset:19968
M32 v[96:111],a[196:199],a[180:183],v[96:111]
DTR a[218:219],v3 offset:24064
DTR a[220:221],v3 offset:20224
s_add_u32 m0, s58, 65536
s_waitcnt lgkmcnt(9)
M32 v[48:63],a[200:203],a[176:179],v[48:63]
DTR a[222:223],v3 offset:24320
buffer_load_dwordx4 a[172:175], v4, s[8:11], s63 offen offset:1024
M32 v[112:127],a[200:203],a[180:183],v[112:127]
buffer_load_dwordx4 v6, s[16:19], s61 offen offset:0 lds
s_waitcnt lgkmcnt(8)
M32 v[64:79],a[204:207],a[176:179],v[64:79]
buffer_load_dwordx4 v6, s[16:19], s61 offen offset:1024 lds
M32 v[128:143],a[204:207],a[180:183],v[128:143]
s_waitcnt lgkmcnt(0)
s_barrier
s_waitcnt vmcnt(22)
M32 v[16:31],a[208:211],a[184:187],v[16:31]
DTR a[192:193],v3 offset:32768
DTR a[194:195],v3 offset:36864
s_waitcnt vmcnt(21)
M32 v[80:95],a[208:211],a[188:191],v[80:95]
DTR a[196:197],v3 offset:33024
DTR a[198:199],v3 offset:37120
buffer_load_dwordx4 a[176:179], v4, s[8:11], s62 offen offset:2048
M32 v[32:47],a[212:215],a[184:187],v[32:47]
DTR a[200:201],v3 offset:33280
M32 v[96:111],a[212:215],a[188:191],v[96:111]
DTR a[202:203],v3 offset:37376
DTR a[204:205],v3 offset:33536
buffer_load_dwordx4 v6, s[16:19], s61 offen offset:2048 lds
M32 v[48:63],a[216:219],a[184:187],v[48:63]
DTR a[206:207],v3 offset:37632
buffer_load_dwordx4 a[180:183], v4, s[8:11], s63 offen offset:2048
M32 v[112:127],a[216:219],a[188:191],v[112:127]
buffer_load_dwordx4 v6, s[16:19], s61 offen offset:3072 lds
M32 v[64:79],a[220:223],a[184:187],v[64:79]
M32 v[128:143],a[220:223],a[188:191],v[128:143]
s_add_u32 s61, s61, 32768
s_waitcnt vmcnt(23) lgkmcnt(6)
M32 v[16:31],a[192:195],a[128:131],v[16:31]
DTR a[208:209],v3 offset:33792
DTR a[210:211],v3 offset:37888
s_waitcnt vmcnt(21)
M32 v[80:95],a[192:195],a[132:135],v[80:95]
DTR a[212:213],v3 offset:34048
DTR a[214:215],v3 offset:38144
buffer_load_dwordx4 a[184:187], v4, s[8:11], s62 offen offset:3072
s_waitcnt lgkmcnt(8)
M32 v[32:47],a[196:199],a[128:131],v[32:47]
DTR a[216:217],v3 offset:34304
M32 v[96:111],a[196:199],a[132:135],v[96:111]
DTR a[218:219],v3 offset:38400
DTR a[220:221],v3 offset:34560
buffer_load_dwordx4 a[188:191], v4, s[8:11], s63 offen offset:3072
s_waitcnt lgkmcnt(9)
M32 v[48:63],a[200:203],a[128:131],v[48:63]
DTR a[222:223],v3 offset:38656
s_add_u32 m0, s58, 32768
s_nop 0
buffer_load_dwordx4 v6, s[16:19], s60 offen offset:0 lds
M32 v[112:127],a[200:203],a[132:135],v[112:127]
s_add_u32 s62, s62, 4096
s_waitcnt lgkmcnt(8)
M32 v[64:79],a[204:207],a[128:131],v[64:79]
s_add_u32 s63, s63, 4096
buffer_load_dwordx4 v6, s[16:19], s60 offen offset:1024 lds
M32 v[128:143],a[204:207],a[132:135],v[128:143]
s_waitcnt vmcnt(24) lgkmcnt(6)
M32 v[16:31],a[208:211],a[136:139],v[16:31]
DTR a[192:193],v3 offset:34816
DTR a[194:195],v3 offset:38912
s_waitcnt vmcnt(22)
M32 v[80:95],a[208:211],a[140:143],v[80:95]
DTR a[196:197],v3 offset:35072
DTR a[198:199],v3 offset:39168
s_waitcnt lgkmcnt(8)
M32 v[32:47],a[212:215],a[136:139],v[32:47]
DTR a[200:201],v3 offset:35328
M32 v[96:111],a[212:215],a[140:143],v[96:111]
DTR a[202:203],v3 offset:39424
DTR a[204:205],v3 offset:35584
buffer_load_dwordx4 v6, s[16:19], s60 offen offset:2048 lds
s_waitcnt lgkmcnt(9)
M32 v[48:63],a[216:219],a[136:139],v[48:63]
DTR a[206:207],v3 offset:39680
M32 v[112:127],a[216:219],a[140:143],v[112:127]
buffer_load_dwordx4 v6, s[16:19], s60 offen offset:3072 lds
s_waitcnt lgkmcnt(8)
M32 v[64:79],a[220:223],a[136:139],v[64:79]
M32 v[128:143],a[220:223],a[140:143],v[128:143]
s_add_u32 s60, s60, 32768
s_waitcnt vmcnt(23) lgkmcnt(6)
M32 v[16:31],a[192:195],a[144:147],v[16:31]
DTR a[208:209],v3 offset:35840
DTR a[210:211],v3 offset:39936
s_waitcnt vmcnt(22)
M32 v[80:95],a[192:195],a[148:151],v[80:95]
DTR a[212:213],v3 offset:36096
DTR a[214:215],v3 offset:40192
s_waitcnt lgkmcnt(8)
M32 v[32:47],a[196:199],a[144:147],v[32:47]
DTR a[216:217],v3 offset:36352
M32 v[96:111],a[196:199],a[148:151],v[96:111]
DTR a[218:219],v3 offset:40448
DTR a[220:221],v3 offset:36608
s_waitcnt lgkmcnt(9)
M32 v[48:63],a[200:203],a[144:147],v[48:63]
DTR a[222:223],v3 offset:40704
M32 v[112:127],a[200:203],a[148:151],v[112:127]
s_waitcnt lgkmcnt(8)
M32 v[64:79],a[204:207],a[144:147],v[64:79]
M32 v[128:143],a[204:207],a[148:151],v[128:143]
s_waitcnt lgkmcnt(0)
s_barrier
s_waitcnt vmcnt(21)
M32 v[16:31],a[208:211],a[152:155],v[16:31]
DTR a[192:193],v3 offset:49152
DTR a[194:195],v3 offset:53248
s_waitcnt vmcnt(20)
M32 v[80:95],a[208:211],a[156:159],v[80:95]
DTR a[196:197],v3 offset:49408
DTR a[198:199],v3 offset:53504
M32 v[32:47],a[212:215],a[152:155],v[32:47]
DTR a[200:201],v3 offset:49664
M32 v[96:111],a[212:215],a[156:159],v[96:111]
DTR a[202:203],v3 offset:53760
DTR a[204:205],v3 offset:49920
M32 v[48:63],a[216:219],a[152:155],v[48:63]
DTR a[206:207],v3 offset:54016
M32 v[112:127],a[216:219],a[156:159],v[112:127]
M32 v[64:79],a[220:223],a[152:155],v[64:79]
M32 v[128:143],a[220:223],a[156:159],v[128:143]
s_waitcnt vmcnt(17) lgkmcnt(6)
M32 v[16:31],a[192:195],a[160:163],v[16:31]
DTR a[208:209],v3 offset:50176
DTR a[210:211],v3 offset:54272
s_waitcnt vmcnt(15)
M32 v[80:95],a[192:195],a[164:167],v[80:95]
DTR a[212:213],v3 offset:50432
DTR a[214:215],v3 offset:54528
s_waitcnt lgkmcnt(8)
M32 v[32:47],a[196:199],a[160:163],v[32:47]
DTR a[216:217],v3 offset:50688
M32 v[96:111],a[196:199],a[164:167],v[96:111]
DTR a[218:219],v3 offset:54784
DTR a[220:221],v3 offset:50944
s_waitcnt lgkmcnt(9)
M32 v[48:63],a[200:203],a[160:163],v[48:63]
DTR a[222:223],v3 offset:55040
M32 v[112:127],a[200:203],a[164:167],v[112:127]
s_waitcnt lgkmcnt(8)
M32 v[64:79],a[204:207],a[160:163],v[64:79]
M32 v[128:143],a[204:207],a[164:167],v[128:143]
s_waitcnt vmcnt(13) lgkmcnt(6)
M32 v[16:31],a[208:211],a[168:171],v[16:31]
DTR a[192:193],v3 offset:51200
DTR a[194:195],v3 offset:55296
s_waitcnt vmcnt(12)
M32 v[80:95],a[208:211],a[172:175],v[80:95]
DTR a[196:197],v3 offset:51456
DTR a[198:199],v3 offset:55552
s_waitcnt lgkmcnt(8)
M32 v[32:47],a[212:215],a[168:171],v[32:47]
DTR a[200:201],v3 offset:51712
M32 v[96:111],a[212:215],a[172:175],v[96:111]
DTR a[202:203],v3 offset:55808
DTR a[204:205],v3 offset:51968
s_waitcnt lgkmcnt(9)
M32 v[48:63],a[216:219],a[168:171],v[48:63]
DTR a[206:207],v3 offset:56064
M32 v[112:127],a[216:219],a[172:175],v[112:127]
s_waitcnt lgkmcnt(8)
M32 v[64:79],a[220:223],a[168:171],v[64:79]
M32 v[128:143],a[220:223],a[172:175],v[128:143]
s_waitcnt vmcnt(9) lgkmcnt(6)
M32 v[16:31],a[192:195],a[176:179],v[16:31]
DTR a[208:209],v3 offset:52224
DTR a[210:211],v3 offset:56320
s_waitcnt vmcnt(7)
M32 v[80:95],a[192:195],a[180:183],v[80:95]
DTR a[212:213],v3 offset:52480
DTR a[214:215],v3 offset:56576
s_waitcnt lgkmcnt(8)
M32 v[32:47],a[196:199],a[176:179],v[32:47]
DTR a[216:217],v3 offset:52736
M32 v[96:111],a[196:199],a[180:183],v[96:111]
DTR a[218:219],v3 offset:56832
DTR a[220:221],v3 offset:52992
s_waitcnt lgkmcnt(9)
M32 v[48:63],a[200:203],a[176:179],v[48:63]
DTR a[222:223],v3 offset:57088
M32 v[112:127],a[200:203],a[180:183],v[112:127]
s_waitcnt lgkmcnt(8)
M32 v[64:79],a[204:207],a[176:179],v[64:79]
M32 v[128:143],a[204:207],a[180:183],v[128:143]
s_waitcnt vmcnt(5) lgkmcnt(6)
M32 v[16:31],a[208:211],a[184:187],v[16:31]
s_waitcnt vmcnt(4)
M32 v[80:95],a[208:211],a[188:191],v[80:95]
s_waitcnt lgkmcnt(4)
M32 v[32:47],a[212:215],a[184:187],v[32:47]
M32 v[96:111],a[212:215],a[188:191],v[96:111]
s_waitcnt lgkmcnt(2)
M32 v[48:63],a[216:219],a[184:187],v[48:63]
M32 v[112:127],a[216:219],a[188:191],v[112:127]
s_waitcnt lgkmcnt(0)
M32 v[64:79],a[220:223],a[184:187],v[64:79]
M32 v[128:143],a[220:223],a[188:191],v[128:143]
s_waitcnt vmcnt(0)
s_barrier
DR4 a[192:195],v4 offset:0
DR4 a[196:199],v4 offset:1024
DR4 a[200:203],v4 offset:2048
DR4 a[204:207],v4 offset:3072
s_mov_b32 s26, 8388608
s_mov_b32 s27, 0x20000
s_mov_b32 s30, 7340032
s_mov_b32 s31, 0x20000
v_lshlrev_b32 v15, 6, v1
v_cmp_gt_u32 vcc, 32, v1
s_nop 1
CND v15,v250,v15,vcc
s_lshl_b32 s56, s2, 2
s_add_u32 s56, s56, s3
s_lshl_b32 s54, s56, 13
s_mul_i32 s55, s56, 7168
s_mov_b32 s35, s55
s_mov_b32 s34, 0
CVT v176,v16,v17
CVT v177,v18,v19
CVT v178,v20,v21
CVT v179,v22,v23
CVT v180,v24,v25
CVT v181,v26,v27
CVT v182,v28,v29
CVT v183,v30,v31
CVT v184,v32,v33
CVT v185,v34,v35
CVT v186,v36,v37
CVT v187,v38,v39
CVT v188,v40,v41
CVT v189,v42,v43
CVT v190,v44,v45
CVT v191,v46,v47
CVT v192,v48,v49
CVT v193,v50,v51
CVT v194,v52,v53
CVT v195,v54,v55
CVT v196,v56,v57
CVT v197,v58,v59
CVT v198,v60,v61
CVT v199,v62,v63
CVT v200,v64,v65
CVT v201,v66,v67
CVT v202,v68,v69
CVT v203,v70,v71
CVT v204,v72,v73
CVT v205,v74,v75
CVT v206,v76,v77
CVT v207,v78,v79
CVT v208,v80,v81
CVT v209,v82,v83
CVT v210,v84,v85
CVT v211,v86,v87
CVT v212,v88,v89
CVT v213,v90,v91
CVT v214,v92,v93
CVT v215,v94,v95
CVT v216,v96,v97
CVT v217,v98,v99
CVT v218,v100,v101
CVT v219,v102,v103
CVT v220,v104,v105
CVT v221,v106,v107
CVT v222,v108,v109
CVT v223,v110,v111
CVT v224,v112,v113
CVT v225,v114,v115
CVT v226,v116,v117
CVT v227,v118,v119
CVT v228,v120,v121
CVT v229,v122,v123
CVT v230,v124,v125
CVT v231,v126,v127
CVT v232,v128,v129
CVT v233,v130,v131
CVT v234,v132,v133
CVT v235,v134,v135
CVT v236,v136,v137
CVT v237,v138,v139
CVT v238,v140,v141
CVT v239,v142,v143
s_waitcnt lgkmcnt(3)
M32 v[16:31],a[192:195],v[176:179],0
DR4 a[208:211],v4 offset:4096
M32 v[48:63],a[192:195],v[208:211],0
s_waitcnt lgkmcnt(3)
M32 v[16:31],a[196:199],v[180:183],v[16:31]
DR4 a[212:215],v4 offset:5120
M32 v[48:63],a[196:199],v[212:215],v[48:63]
s_waitcnt lgkmcnt(2)
M32 v[16:31],a[200:203],v[184:187],v[16:31]
DR4 a[216:219],v4 offset:6144
M32 v[48:63],a[200:203],v[216:219],v[48:63]
M32 v[16:31],a[204:207],v[188:191],v[16:31]
DR4 a[220:223],v4 offset:7168
M32 v[48:63],a[204:207],v[220:223],v[48:63]
s_waitcnt lgkmcnt(2)
M32 v[16:31],a[208:211],v[192:195],v[16:31]
DR4 a[224:227],v4 offset:8192
M32 v[48:63],a[208:211],v[224:227],v[48:63]
M32 v[16:31],a[212:215],v[196:199],v[16:31]
DR4 a[228:231],v4 offset:9216
M32 v[48:63],a[212:215],v[228:231],v[48:63]
s_waitcnt lgkmcnt(2)
M32 v[16:31],a[216:219],v[200:203],v[16:31]
DR4 a[232:235],v4 offset:10240
M32 v[48:63],a[216:219],v[232:235],v[48:63]
M32 v[16:31],a[220:223],v[204:207],v[16:31]
DR4 a[236:239],v4 offset:11264
M32 v[48:63],a[220:223],v[236:239],v[48:63]
s_waitcnt lgkmcnt(2)
M32 v[32:47],a[224:227],v[176:179],0
DR4 a[240:243],v4 offset:12288
M32 v[64:79],a[224:227],v[208:211],0
M32 v[32:47],a[228:231],v[180:183],v[32:47]
DR4 a[244:247],v4 offset:13312
M32 v[64:79],a[228:231],v[212:215],v[64:79]
s_waitcnt lgkmcnt(2)
M32 v[32:47],a[232:235],v[184:187],v[32:47]
DR4 a[248:251],v4 offset:14336
M32 v[64:79],a[232:235],v[216:219],v[64:79]
M32 v[32:47],a[236:239],v[188:191],v[32:47]
DR4 a[252:255],v4 offset:15360
M32 v[64:79],a[236:239],v[220:223],v[64:79]
s_waitcnt lgkmcnt(2)
M32 v[32:47],a[240:243],v[192:195],v[32:47]
M32 v[64:79],a[240:243],v[224:227],v[64:79]
DR4 a[192:195],v4 offset:32768
M32 v[32:47],a[244:247],v[196:199],v[32:47]
DR4 a[196:199],v4 offset:33792
M32 v[64:79],a[244:247],v[228:231],v[64:79]
s_waitcnt lgkmcnt(2)
DR4 a[200:203],v4 offset:34816
M32 v[32:47],a[248:251],v[200:203],v[32:47]
DR4 a[204:207],v4 offset:35840
M32 v[64:79],a[248:251],v[232:235],v[64:79]
M32 v[32:47],a[252:255],v[204:207],v[32:47]
M32 v[64:79],a[252:255],v[236:239],v[64:79]
v_cmp_le_i32 s[36:37], 0, v2
v_cmp_le_i32 s[38:39], 1, v2
v_cmp_le_i32 s[40:41], 2, v2
v_cmp_le_i32 s[42:43], 3, v2
CND v48,v250,v48,s[36:37]
CND v49,v250,v49,s[38:39]
CND v50,v250,v50,s[40:41]
CND v51,v250,v51,s[42:43]
v_cmp_le_i32 s[36:37], 16, v2
v_cmp_le_i32 s[38:39], 17, v2
v_cmp_le_i32 s[40:41], 18, v2
v_cmp_le_i32 s[42:43], 19, v2
CND v52,v250,v52,s[36:37]
CND v53,v250,v53,s[38:39]
CND v54,v250,v54,s[40:41]
CND v55,v250,v55,s[42:43]
v_cmp_le_i32 s[36:37], 8, v2
v_cmp_le_i32 s[38:39], 9, v2
v_cmp_le_i32 s[40:41], 10, v2
v_cmp_le_i32 s[42:43], 11, v2
CND v56,v250,v56,s[36:37]
CND v57,v250,v57,s[38:39]
CND v58,v250,v58,s[40:41]
CND v59,v250,v59,s[42:43]
v_cmp_le_i32 s[36:37], 24, v2
v_cmp_le_i32 s[38:39], 25, v2
v_cmp_le_i32 s[40:41], 26, v2
v_cmp_le_i32 s[42:43], 27, v2
CND v60,v250,v60,s[36:37]
CND v61,v250,v61,s[38:39]
CND v62,v250,v62,s[40:41]
CND v63,v250,v63,s[42:43]
v_cmp_le_i32 s[36:37], 32, v2
v_cmp_le_i32 s[38:39], 33, v2
v_cmp_le_i32 s[40:41], 34, v2
v_cmp_le_i32 s[42:43], 35, v2
CND v64,v250,v64,s[36:37]
CND v65,v250,v65,s[38:39]
CND v66,v250,v66,s[40:41]
CND v67,v250,v67,s[42:43]
v_cmp_le_i32 s[36:37], 48, v2
v_cmp_le_i32 s[38:39], 49, v2
v_cmp_le_i32 s[40:41], 50, v2
v_cmp_le_i32 s[42:43], 51, v2
CND v68,v250,v68,s[36:37]
CND v69,v250,v69,s[38:39]
CND v70,v250,v70,s[40:41]
CND v71,v250,v71,s[42:43]
v_cmp_le_i32 s[36:37], 40, v2
v_cmp_le_i32 s[38:39], 41, v2
v_cmp_le_i32 s[40:41], 42, v2
v_cmp_le_i32 s[42:43], 43, v2
CND v72,v250,v72,s[36:37]
CND v73,v250,v73,s[38:39]
CND v74,v250,v74,s[40:41]
CND v75,v250,v75,s[42:43]
v_cmp_le_i32 s[36:37], 56, v2
v_cmp_le_i32 s[38:39], 57, v2
v_cmp_le_i32 s[40:41], 58, v2
v_cmp_le_i32 s[42:43], 59, v2
CND v76,v250,v76,s[36:37]
CND v77,v250,v77,s[38:39]
CND v78,v250,v78,s[40:41]
CND v79,v250,v79,s[42:43]
v_max3_f32 v251, v16, v17, v18
v_max3_f32 v251, v251, v19, v20
v_max3_f32 v251, v251, v21, v22
v_max3_f32 v251, v251, v23, v24
v_max3_f32 v251, v251, v25, v26
v_max3_f32 v251, v251, v27, v28
v_max3_f32 v251, v251, v29, v30
v_max3_f32 v251, v251, v31, v32
v_max3_f32 v251, v251, v33, v34
v_max3_f32 v251, v251, v35, v36
v_max3_f32 v251, v251, v37, v38
v_max3_f32 v251, v251, v39, v40
v_max3_f32 v251, v251, v41, v42
v_max3_f32 v251, v251, v43, v44
v_max3_f32 v251, v251, v45, v46
v_max_f32 v251, v251, v47
v_max3_f32 v252, v48, v49, v50
v_max3_f32 v252, v252, v51, v52
v_max3_f32 v252, v252, v53, v54
v_max3_f32 v252, v252, v55, v56
v_max3_f32 v252, v252, v57, v58
v_max3_f32 v252, v252, v59, v60
v_max3_f32 v252, v252, v61, v62
v_max3_f32 v252, v252, v63, v64
v_max3_f32 v252, v252, v65, v66
v_max3_f32 v252, v252, v67, v68
v_max3_f32 v252, v252, v69, v70
v_max3_f32 v252, v252, v71, v72
v_max3_f32 v252, v252, v73, v74
v_max3_f32 v252, v252, v75, v76
v_max3_f32 v252, v252, v77, v78
v_max_f32 v252, v252, v79
v_mov_b32 v253, v251
s_nop 1
v_permlane32_swap_b32 v251, v253
v_max_f32 v251, v251, v253
v_mov_b32 v240, v251
FSB v144,0,v251
FSB v145,0,v251
FSB v146,0,v251
FSB v147,0,v251
FSB v148,0,v251
FSB v149,0,v251
FSB v150,0,v251
FSB v151,0,v251
FSB v152,0,v251
FSB v153,0,v251
FSB v154,0,v251
FSB v155,0,v251
FSB v156,0,v251
FSB v157,0,v251
FSB v158,0,v251
FSB v159,0,v251
FSB v16,v16,v251
FSB v17,v17,v251
FSB v18,v18,v251
FSB v19,v19,v251
FSB v20,v20,v251
FSB v21,v21,v251
FSB v22,v22,v251
FSB v23,v23,v251
FSB v24,v24,v251
FSB v25,v25,v251
FSB v26,v26,v251
FSB v27,v27,v251
FSB v28,v28,v251
FSB v29,v29,v251
FSB v30,v30,v251
FSB v31,v31,v251
FSB v32,v32,v251
FSB v33,v33,v251
FSB v34,v34,v251
FSB v35,v35,v251
FSB v36,v36,v251
FSB v37,v37,v251
FSB v38,v38,v251
FSB v39,v39,v251
FSB v40,v40,v251
FSB v41,v41,v251
FSB v42,v42,v251
FSB v43,v43,v251
FSB v44,v44,v251
FSB v45,v45,v251
FSB v46,v46,v251
FSB v47,v47,v251
v_mov_b32 v253, v252
s_nop 1
v_permlane32_swap_b32 v252, v253
v_max_f32 v252, v252, v253
v_mov_b32 v241, v252
FSB v160,0,v252
FSB v161,0,v252
FSB v162,0,v252
FSB v163,0,v252
FSB v164,0,v252
FSB v165,0,v252
FSB v166,0,v252
FSB v167,0,v252
FSB v168,0,v252
FSB v169,0,v252
FSB v170,0,v252
FSB v171,0,v252
FSB v172,0,v252
FSB v173,0,v252
FSB v174,0,v252
FSB v175,0,v252
FSB v48,v48,v252
FSB v49,v49,v252
FSB v50,v50,v252
FSB v51,v51,v252
FSB v52,v52,v252
FSB v53,v53,v252
FSB v54,v54,v252
FSB v55,v55,v252
FSB v56,v56,v252
FSB v57,v57,v252
FSB v58,v58,v252
FSB v59,v59,v252
FSB v60,v60,v252
FSB v61,v61,v252
FSB v62,v62,v252
FSB v63,v63,v252
FSB v64,v64,v252
FSB v65,v65,v252
FSB v66,v66,v252
FSB v67,v67,v252
FSB v68,v68,v252
FSB v69,v69,v252
FSB v70,v70,v252
FSB v71,v71,v252
FSB v72,v72,v252
FSB v73,v73,v252
FSB v74,v74,v252
FSB v75,v75,v252
FSB v76,v76,v252
FSB v77,v77,v252
FSB v78,v78,v252
FSB v79,v79,v252
s_barrier
s_cmp_eq_u32 s51, 0
s_cbranch_scc1 L_Cp
s_sub_u32 s64, s51, 1
L_A:
M32 v[80:95],a[192:195],v[176:179],v[144:159]
DR4 a[208:211],v4 offset:36864
EXP v16,v16
EXP v17,v17
M32 v[112:127],a[192:195],v[208:211],v[160:175]
EXP v18,v18
FAD v244,v16,v17
EXP v19,v19
CVT v16,v16,v17
M32 v[80:95],a[196:199],v[180:183],v[80:95]
DR4 a[212:215],v4 offset:37888
s_add_u32 m0, s58, 0
s_nop 0
buffer_load_dwordx4 v6, s[16:19], s60 offen offset:0 lds
EXP v20,v20
M32 v[112:127],a[196:199],v[212:215],v[112:127]
FAD v245,v18,v19
EXP v21,v21
CVT v17,v18,v19
EXP v22,v22
M32 v[80:95],a[200:203],v[184:187],v[80:95]
DR4 a[216:219],v4 offset:38912
buffer_load_dwordx4 v6, s[16:19], s60 offen offset:1024 lds
FAD v244,v244,v20
EXP v23,v23
M32 v[112:127],a[200:203],v[216:219],v[112:127]
FAD v245,v245,v21
CVT v18,v20,v21
EXP v24,v24
FAD v244,v244,v22
M32 v[80:95],a[204:207],v[188:191],v[80:95]
DR4 a[220:223],v4 offset:39936
buffer_load_dwordx4 v6, s[16:19], s60 offen offset:2048 lds
EXP v25,v25
FAD v245,v245,v23
M32 v[112:127],a[204:207],v[220:223],v[112:127]
s_waitcnt lgkmcnt(2)
CVT v19,v22,v23
EXP v26,v26
FAD v244,v244,v24
EXP v27,v27
M32 v[80:95],a[208:211],v[192:195],v[80:95]
DR4 a[224:227],v4 offset:40960
FAD v245,v245,v25
CVT v20,v24,v25
EXP v28,v28
FAD v244,v244,v26
M32 v[112:127],a[208:211],v[224:227],v[112:127]
buffer_load_dwordx4 v6, s[16:19], s60 offen offset:3072 lds
s_add_u32 s60, s60, 32768
EXP v29,v29
FAD v245,v245,v27
M32 v[80:95],a[212:215],v[196:199],v[80:95]
DR4 a[228:231],v4 offset:41984
CVT v21,v26,v27
EXP v30,v30
FAD v244,v244,v28
M32 v[112:127],a[212:215],v[228:231],v[112:127]
s_waitcnt lgkmcnt(2)
buffer_load_dword a128, v15, s[24:27], s54 offen
s_add_u32 s54, s54, 2048
EXP v31,v31
FAD v245,v245,v29
M32 v[80:95],a[216:219],v[200:203],v[80:95]
DR4 a[232:235],v4 offset:43008
CVT v22,v28,v29
EXP v48,v48
FAD v244,v244,v30
M32 v[112:127],a[216:219],v[232:235],v[112:127]
EXP v49,v49
FAD v245,v245,v31
CVT v23,v30,v31
EXP v50,v50
M32 v[80:95],a[220:223],v[204:207],v[80:95]
DR4 a[236:239],v4 offset:44032
s_add_u32 s34, s34, 1
s_cmp_eq_u32 s34, 4
s_cselect_b32 s24, s32, s24
s_cselect_b32 s25, s33, s25
s_cselect_b32 s26, s30, s26
s_cselect_b32 s54, s35, s54
M32 v[112:127],a[220:223],v[236:239],v[112:127]
s_waitcnt lgkmcnt(2)
FAD v246,v48,v49
EXP v51,v51
CVT v48,v48,v49
EXP v52,v52
M32 v[96:111],a[224:227],v[176:179],v[144:159]
DR4 a[240:243],v4 offset:45056
s_add_u32 m0, s58, 98304
s_nop 0
buffer_load_dwordx4 v6, s[16:19], s61 offen offset:0 lds
FAD v247,v50,v51
M32 v[128:143],a[224:227],v[208:211],v[160:175]
EXP v53,v53
CVT v49,v50,v51
EXP v54,v54
FAD v246,v246,v52
M32 v[96:111],a[228:231],v[180:183],v[96:111]
DR4 a[244:247],v4 offset:46080
buffer_load_dwordx4 v6, s[16:19], s61 offen offset:1024 lds
EXP v55,v55
FAD v247,v247,v53
M32 v[128:143],a[228:231],v[212:215],v[128:143]
s_waitcnt lgkmcnt(2)
CVT v50,v52,v53
EXP v56,v56
FAD v246,v246,v54
EXP v57,v57
M32 v[96:111],a[232:235],v[184:187],v[96:111]
DR4 a[248:251],v4 offset:47104
FAD v247,v247,v55
CVT v51,v54,v55
EXP v58,v58
FAD v246,v246,v56
M32 v[128:143],a[232:235],v[216:219],v[128:143]
buffer_load_dwordx4 v6, s[16:19], s61 offen offset:2048 lds
EXP v59,v59
FAD v247,v247,v57
CVT v52,v56,v57
M32 v[96:111],a[236:239],v[188:191],v[96:111]
DR4 a[252:255],v4 offset:48128
EXP v60,v60
FAD v246,v246,v58
EXP v61,v61
M32 v[128:143],a[236:239],v[220:223],v[128:143]
s_waitcnt lgkmcnt(2)
buffer_load_dwordx4 v6, s[16:19], s61 offen offset:3072 lds
s_add_u32 s61, s61, 32768
FAD v247,v247,v59
CVT v53,v58,v59
M32 v[96:111],a[240:243],v[192:195],v[96:111]
EXP v62,v62
FAD v246,v246,v60
EXP v63,v63
FAD v247,v247,v61
M32 v[128:143],a[240:243],v[224:227],v[128:143]
CVT v54,v60,v61
EXP v32,v32
FAD v246,v246,v62
EXP v33,v33
M32 v[96:111],a[244:247],v[196:199],v[96:111]
s_waitcnt lgkmcnt(0)
s_waitcnt vmcnt(9)
s_barrier
DR4 a[192:195],v5 offset:0
FAD v247,v247,v63
CVT v55,v62,v63
EXP v34,v34
M32 v[128:143],a[244:247],v[228:231],v[128:143]
DR4 a[196:199],v5 offset:4096
FAD v244,v244,v32
EXP v35,v35
FAD v245,v245,v33
CVT v24,v32,v33
M32 v[96:111],a[248:251],v[200:203],v[96:111]
DR4 a[200:203],v5 offset:8192
EXP v36,v36
FAD v244,v244,v34
EXP v37,v37
M32 v[128:143],a[248:251],v[232:235],v[128:143]
DR4 a[204:207],v5 offset:12288
FAD v245,v245,v35
CVT v25,v34,v35
EXP v38,v38
FAD v244,v244,v36
M32 v[96:111],a[252:255],v[204:207],v[96:111]
EXP v39,v39
FAD v245,v245,v37
CVT v26,v36,v37
EXP v40,v40
M32 v[128:143],a[252:255],v[236:239],v[128:143]
s_waitcnt lgkmcnt(2)
FAD v244,v244,v38
EXP v41,v41
FAD v245,v245,v39
CVT v27,v38,v39
EXP v42,v42
FAD v244,v244,v40
EXP v43,v43
FAD v245,v245,v41
CVT v28,v40,v41
EXP v44,v44
FAD v244,v244,v42
EXP v45,v45
FAD v245,v245,v43
CVT v29,v42,v43
EXP v46,v46
FAD v244,v244,v44
EXP v47,v47
FAD v245,v245,v45
CVT v30,v44,v45
EXP v64,v64
FAD v244,v244,v46
EXP v65,v65
FAD v245,v245,v47
CVT v31,v46,v47
EXP v66,v66
FAD v246,v246,v64
EXP v67,v67
FAD v247,v247,v65
CVT v56,v64,v65
EXP v68,v68
FAD v246,v246,v66
EXP v69,v69
FAD v247,v247,v67
CVT v57,v66,v67
EXP v70,v70
FAD v246,v246,v68
EXP v71,v71
FAD v247,v247,v69
CVT v58,v68,v69
EXP v72,v72
FAD v246,v246,v70
EXP v73,v73
FAD v247,v247,v71
CVT v59,v70,v71
EXP v74,v74
FAD v246,v246,v72
EXP v75,v75
FAD v247,v247,v73
CVT v60,v72,v73
EXP v76,v76
FAD v246,v246,v74
EXP v77,v77
FAD v247,v247,v75
CVT v61,v74,v75
EXP v78,v78
FAD v246,v246,v76
EXP v79,v79
FAD v247,v247,v77
CVT v62,v76,v77
FAD v246,v246,v78
FAD v247,v247,v79
CVT v63,v78,v79
FAD v244,v244,v245
FAD v246,v246,v247
v_max_f32 v251, v244, v246
v_cmp_nle_f32 vcc, v251, v255
s_waitcnt lgkmcnt(0)
s_cbranch_vccnz L_A_rare
L_A_back:
FAD v242,v242,v244
FAD v243,v243,v246
s_add_u32 s59, s59, 32768
L_B1:
M32 a[0:15],a[192:195],v[16:19],a[0:15]
DR4 a[208:211],v5 offset:1024
EXP v80,v80
EXP v81,v81
M32 a[64:79],a[192:195],v[48:51],a[64:79]
EXP v82,v82
FAD v244,v80,v81
EXP v83,v83
M32 a[16:31],a[196:199],v[16:19],a[16:31]
DR4 a[212:215],v5 offset:5120
s_add_u32 m0, s58, 32768
s_nop 0
buffer_load_dwordx4 v6, s[16:19], s60 offen offset:0 lds
CVT v80,v80,v81
M32 a[80:95],a[196:199],v[48:51],a[80:95]
EXP v84,v84
FAD v245,v82,v83
EXP v85,v85
M32 a[32:47],a[200:203],v[16:19],a[32:47]
DR4 a[216:219],v5 offset:9216
CVT v81,v82,v83
EXP v86,v86
M32 a[96:111],a[200:203],v[48:51],a[96:111]
FAD v244,v244,v84
EXP v87,v87
FAD v245,v245,v85
M32 a[48:63],a[204:207],v[16:19],a[48:63]
DR4 a[220:223],v5 offset:13312
CVT v82,v84,v85
EXP v88,v88
FAD v244,v244,v86
M32 a[112:127],a[204:207],v[48:51],a[112:127]
s_waitcnt lgkmcnt(2)
EXP v89,v89
FAD v245,v245,v87
M32 a[0:15],a[208:211],v[20:23],a[0:15]
DR4 a[224:227],v5 offset:2048
buffer_load_dwordx4 v6, s[16:19], s60 offen offset:1024 lds
CVT v83,v86,v87
EXP v90,v90
M32 a[64:79],a[208:211],v[52:55],a[64:79]
FAD v244,v244,v88
EXP v91,v91
FAD v245,v245,v89
M32 a[16:31],a[212:215],v[20:23],a[16:31]
DR4 a[228:231],v5 offset:6144
CVT v84,v88,v89
EXP v92,v92
FAD v244,v244,v90
M32 a[80:95],a[212:215],v[52:55],a[80:95]
s_waitcnt lgkmcnt(2)
EXP v93,v93
FAD v245,v245,v91
CVT v85,v90,v91
M32 a[32:47],a[216:219],v[20:23],a[32:47]
DR4 a[232:235],v5 offset:10240
EXP v94,v94
FAD v244,v244,v92
M32 a[96:111],a[216:219],v[52:55],a[96:111]
EXP v95,v95
FAD v245,v245,v93
CVT v86,v92,v93
M32 a[48:63],a[220:223],v[20:23],a[48:63]
DR4 a[236:239],v5 offset:14336
buffer_load_dwordx4 v6, s[16:19], s60 offen offset:2048 lds
EXP v112,v112
FAD v244,v244,v94
M32 a[112:127],a[220:223],v[52:55],a[112:127]
s_waitcnt lgkmcnt(2)
EXP v113,v113
FAD v245,v245,v95
CVT v87,v94,v95
M32 a[0:15],a[224:227],v[24:27],a[0:15]
DR4 a[240:243],v5 offset:3072
EXP v114,v114
FAD v246,v112,v113
EXP v115,v115
M32 a[64:79],a[224:227],v[56:59],a[64:79]
CVT v112,v112,v113
EXP v116,v116
M32 a[16:31],a[228:231],v[24:27],a[16:31]
DR4 a[244:247],v5 offset:7168
FAD v247,v114,v115
EXP v117,v117
M32 a[80:95],a[228:231],v[56:59],a[80:95]
s_waitcnt lgkmcnt(2)
CVT v113,v114,v115
EXP v118,v118
M32 a[32:47],a[232:235],v[24:27],a[32:47]
DR4 a[248:251],v5 offset:11264
buffer_load_dwordx4 v6, s[16:19], s60 offen offset:3072 lds
s_add_u32 s60, s60, 32768
FAD v246,v246,v116
M32 a[96:111],a[232:235],v[56:59],a[96:111]
EXP v119,v119
FAD v247,v247,v117
CVT v114,v116,v117
EXP v120,v120
M32 a[48:63],a[236:239],v[24:27],a[48:63]
DR4 a[252:255],v5 offset:15360
FAD v246,v246,v118
EXP v121,v121
FAD v247,v247,v119
M32 a[112:127],a[236:239],v[56:59],a[112:127]
s_waitcnt lgkmcnt(2)
CVT v115,v118,v119
EXP v122,v122
FAD v246,v246,v120
M32 a[0:15],a[240:243],v[28:31],a[0:15]
EXP v123,v123
FAD v247,v247,v121
M32 a[64:79],a[240:243],v[60:63],a[64:79]
CVT v116,v120,v121
EXP v124,v124
FAD v246,v246,v122
M32 a[16:31],a[244:247],v[28:31],a[16:31]
s_waitcnt lgkmcnt(0)
s_waitcnt vmcnt(9)
s_barrier
DR4 a[192:195],v4 offset:0
EXP v125,v125
FAD v247,v247,v123
CVT v117,v122,v123
M32 a[80:95],a[244:247],v[60:63],a[80:95]
DR4 a[196:199],v4 offset:1024
EXP v126,v126
FAD v246,v246,v124
M32 a[32:47],a[248:251],v[28:31],a[32:47]
DR4 a[200:203],v4 offset:2048
EXP v127,v127
FAD v247,v247,v125
CVT v118,v124,v125
M32 a[96:111],a[248:251],v[60:63],a[96:111]
DR4 a[204:207],v4 offset:3072
EXP v96,v96
FAD v246,v246,v126
M32 a[48:63],a[252:255],v[28:31],a[48:63]
EXP v97,v97
FAD v247,v247,v127
CVT v119,v126,v127
M32 a[112:127],a[252:255],v[60:63],a[112:127]
s_waitcnt lgkmcnt(2)
EXP v98,v98
FAD v244,v244,v96
M32 v[16:31],a[192:195],v[176:179],v[144:159]
DR4 a[208:211],v4 offset:4096
EXP v99,v99
FAD v245,v245,v97
CVT v88,v96,v97
M32 v[48:63],a[192:195],v[208:211],v[160:175]
EXP v100,v100
FAD v244,v244,v98
M32 v[16:31],a[196:199],v[180:183],v[16:31]
DR4 a[212:215],v4 offset:5120
s_waitcnt vmcnt(8)
buffer_load_dword a128, v15, s[28:31], s55 offen
s_add_u32 s55, s55, 2048
EXP v101,v101
M32 v[48:63],a[196:199],v[212:215],v[48:63]
s_waitcnt lgkmcnt(2)
FAD v245,v245,v99
CVT v89,v98,v99
EXP v102,v102
FAD v244,v244,v100
M32 v[16:31],a[200:203],v[184:187],v[16:31]
DR4 a[216:219],v4 offset:6144
EXP v103,v103
FAD v245,v245,v101
CVT v90,v100,v101
M32 v[48:63],a[200:203],v[216:219],v[48:63]
EXP v104,v104
FAD v244,v244,v102
M32 v[16:31],a[204:207],v[188:191],v[16:31]
DR4 a[220:223],v4 offset:7168
s_cmp_ge_u32 s34, 4
s_cselect_b32 s55, 0x1000000, s55
EXP v105,v105
FAD v245,v245,v103
M32 v[48:63],a[204:207],v[220:223],v[48:63]
s_waitcnt lgkmcnt(2)
CVT v91,v102,v103
EXP v106,v106
FAD v244,v244,v104
M32 v[16:31],a[208:211],v[192:195],v[16:31]
DR4 a[224:227],v4 offset:8192
EXP v107,v107
FAD v245,v245,v105
M32 v[48:63],a[208:211],v[224:227],v[48:63]
CVT v92,v104,v105
EXP v108,v108
FAD v244,v244,v106
M32 v[16:31],a[212:215],v[196:199],v[16:31]
DR4 a[228:231],v4 offset:9216
s_add_u32 m0, s58, 65536
s_nop 0
buffer_load_dwordx4 v6, s[16:19], s61 offen offset:0 lds
EXP v109,v109
M32 v[48:63],a[212:215],v[228:231],v[48:63]
s_waitcnt lgkmcnt(2)
FAD v245,v245,v107
CVT v93,v106,v107
EXP v110,v110
M32 v[16:31],a[216:219],v[200:203],v[16:31]
DR4 a[232:235],v4 offset:10240
FAD v244,v244,v108
EXP v111,v111
FAD v245,v245,v109
M32 v[48:63],a[216:219],v[232:235],v[48:63]
CVT v94,v108,v109
EXP v128,v128
M32 v[16:31],a[220:223],v[204:207],v[16:31]
DR4 a[236:239],v4 offset:11264
buffer_load_dwordx4 v6, s[16:19], s61 offen offset:1024 lds
FAD v244,v244,v110
EXP v129,v129
M32 v[48:63],a[220:223],v[236:239],v[48:63]
s_waitcnt lgkmcnt(2)
FAD v245,v245,v111
CVT v95,v110,v111
EXP v130,v130
M32 v[32:47],a[224:227],v[176:179],v[144:159]
DR4 a[240:243],v4 offset:12288
FAD v246,v246,v128
EXP v131,v131
M32 v[64:79],a[224:227],v[208:211],v[160:175]
FAD v247,v247,v129
CVT v120,v128,v129
EXP v132,v132
M32 v[32:47],a[228:231],v[180:183],v[32:47]
DR4 a[244:247],v4 offset:13312
buffer_load_dwordx4 v6, s[16:19], s61 offen offset:2048 lds
FAD v246,v246,v130
EXP v133,v133
M32 v[64:79],a[228:231],v[212:215],v[64:79]
s_waitcnt lgkmcnt(2)
FAD v247,v247,v131
CVT v121,v130,v131
EXP v134,v134
M32 v[32:47],a[232:235],v[184:187],v[32:47]
DR4 a[248:251],v4 offset:14336
FAD v246,v246,v132
EXP v135,v135
M32 v[64:79],a[232:235],v[216:219],v[64:79]
FAD v247,v247,v133
CVT v122,v132,v133
EXP v136,v136
M32 v[32:47],a[236:239],v[188:191],v[32:47]
DR4 a[252:255],v4 offset:15360
buffer_load_dwordx4 v6, s[16:19], s61 offen offset:3072 lds
s_add_u32 s61, s61, 32768
FAD v246,v246,v134
M32 v[64:79],a[236:239],v[220:223],v[64:79]
s_waitcnt lgkmcnt(2)
EXP v137,v137
FAD v247,v247,v135
CVT v123,v134,v135
EXP v138,v138
M32 v[32:47],a[240:243],v[192:195],v[32:47]
FAD v246,v246,v136
EXP v139,v139
M32 v[64:79],a[240:243],v[224:227],v[64:79]
FAD v247,v247,v137
CVT v124,v136,v137
EXP v140,v140
M32 v[32:47],a[244:247],v[196:199],v[32:47]
s_waitcnt lgkmcnt(0)
s_waitcnt vmcnt(9)
s_barrier
DR4 a[192:195],v5 offset:32768
FAD v246,v246,v138
EXP v141,v141
M32 v[64:79],a[244:247],v[228:231],v[64:79]
DR4 a[196:199],v5 offset:36864
FAD v247,v247,v139
CVT v125,v138,v139
EXP v142,v142
M32 v[32:47],a[248:251],v[200:203],v[32:47]
DR4 a[200:203],v5 offset:40960
FAD v246,v246,v140
EXP v143,v143
M32 v[64:79],a[248:251],v[232:235],v[64:79]
DR4 a[204:207],v5 offset:45056
FAD v247,v247,v141
CVT v126,v140,v141
FAD v246,v246,v142
M32 v[32:47],a[252:255],v[204:207],v[32:47]
FAD v247,v247,v143
CVT v127,v142,v143
FAD v244,v244,v245
M32 v[64:79],a[252:255],v[236:239],v[64:79]
s_waitcnt lgkmcnt(2)
FAD v246,v246,v247
v_max_f32 v251, v244, v246
v_cmp_nle_f32 vcc, v251, v255
s_waitcnt lgkmcnt(0)
s_cbranch_vccnz L_B1_rare
L_B1_back:
FAD v242,v242,v244
FAD v243,v243,v246
s_add_u32 s59, s59, 32768
s_cmp_eq_u32 s64, 0
s_cbranch_scc1 L_C
s_sub_u32 s64, s64, 1
L_B0:
M32 a[0:15],a[192:195],v[80:83],a[0:15]
DR4 a[208:211],v5 offset:33792
EXP v16,v16
EXP v17,v17
M32 a[64:79],a[192:195],v[112:115],a[64:79]
EXP v18,v18
FAD v244,v16,v17
EXP v19,v19
M32 a[16:31],a[196:199],v[80:83],a[16:31]
DR4 a[212:215],v5 offset:37888
s_add_u32 m0, s58, 0
s_nop 0
buffer_load_dwordx4 v6, s[16:19], s60 offen offset:0 lds
CVT v16,v16,v17
M32 a[80:95],a[196:199],v[112:115],a[80:95]
EXP v20,v20
FAD v245,v18,v19
EXP v21,v21
M32 a[32:47],a[200:203],v[80:83],a[32:47]
DR4 a[216:219],v5 offset:41984
CVT v17,v18,v19
EXP v22,v22
M32 a[96:111],a[200:203],v[112:115],a[96:111]
FAD v244,v244,v20
EXP v23,v23
FAD v245,v245,v21
M32 a[48:63],a[204:207],v[80:83],a[48:63]
DR4 a[220:223],v5 offset:46080
CVT v18,v20,v21
EXP v24,v24
FAD v244,v244,v22
M32 a[112:127],a[204:207],v[112:115],a[112:127]
s_waitcnt lgkmcnt(2)
EXP v25,v25
FAD v245,v245,v23
M32 a[0:15],a[208:211],v[84:87],a[0:15]
DR4 a[224:227],v5 offset:34816
buffer_load_dwordx4 v6, s[16:19], s60 offen offset:1024 lds
CVT v19,v22,v23
EXP v26,v26
M32 a[64:79],a[208:211],v[116:119],a[64:79]
FAD v244,v244,v24
EXP v27,v27
FAD v245,v245,v25
M32 a[16:31],a[212:215],v[84:87],a[16:31]
DR4 a[228:231],v5 offset:38912
CVT v20,v24,v25
EXP v28,v28
FAD v244,v244,v26
M32 a[80:95],a[212:215],v[116:119],a[80:95]
s_waitcnt lgkmcnt(2)
EXP v29,v29
FAD v245,v245,v27
CVT v21,v26,v27
M32 a[32:47],a[216:219],v[84:87],a[32:47]
DR4 a[232:235],v5 offset:43008
EXP v30,v30
FAD v244,v244,v28
M32 a[96:111],a[216:219],v[116:119],a[96:111]
EXP v31,v31
FAD v245,v245,v29
CVT v22,v28,v29
M32 a[48:63],a[220:223],v[84:87],a[48:63]
DR4 a[236:239],v5 offset:47104
buffer_load_dwordx4 v6, s[16:19], s60 offen offset:2048 lds
EXP v48,v48
FAD v244,v244,v30
M32 a[112:127],a[220:223],v[116:119],a[112:127]
s_waitcnt lgkmcnt(2)
EXP v49,v49
FAD v245,v245,v31
CVT v23,v30,v31
M32 a[0:15],a[224:227],v[88:91],a[0:15]
DR4 a[240:243],v5 offset:35840
EXP v50,v50
FAD v246,v48,v49
EXP v51,v51
M32 a[64:79],a[224:227],v[120:123],a[64:79]
CVT v48,v48,v49
EXP v52,v52
M32 a[16:31],a[228:231],v[88:91],a[16:31]
DR4 a[244:247],v5 offset:39936
FAD v247,v50,v51
EXP v53,v53
M32 a[80:95],a[228:231],v[120:123],a[80:95]
s_waitcnt lgkmcnt(2)
CVT v49,v50,v51
EXP v54,v54
M32 a[32:47],a[232:235],v[88:91],a[32:47]
DR4 a[248:251],v5 offset:44032
buffer_load_dwordx4 v6, s[16:19], s60 offen offset:3072 lds
s_add_u32 s60, s60, 32768
FAD v246,v246,v52
M32 a[96:111],a[232:235],v[120:123],a[96:111]
EXP v55,v55
FAD v247,v247,v53
CVT v50,v52,v53
EXP v56,v56
M32 a[48:63],a[236:239],v[88:91],a[48:63]
DR4 a[252:255],v5 offset:48128
FAD v246,v246,v54
EXP v57,v57
FAD v247,v247,v55
M32 a[112:127],a[236:239],v[120:123],a[112:127]
s_waitcnt lgkmcnt(2)
CVT v51,v54,v55
EXP v58,v58
FAD v246,v246,v56
M32 a[0:15],a[240:243],v[92:95],a[0:15]
EXP v59,v59
FAD v247,v247,v57
M32 a[64:79],a[240:243],v[124:127],a[64:79]
CVT v52,v56,v57
EXP v60,v60
FAD v246,v246,v58
M32 a[16:31],a[244:247],v[92:95],a[16:31]
s_waitcnt lgkmcnt(0)
s_waitcnt vmcnt(9)
s_barrier
DR4 a[192:195],v4 offset:32768
EXP v61,v61
FAD v247,v247,v59
CVT v53,v58,v59
M32 a[80:95],a[244:247],v[124:127],a[80:95]
DR4 a[196:199],v4 offset:33792
EXP v62,v62
FAD v246,v246,v60
M32 a[32:47],a[248:251],v[92:95],a[32:47]
DR4 a[200:203],v4 offset:34816
EXP v63,v63
FAD v247,v247,v61
CVT v54,v60,v61
M32 a[96:111],a[248:251],v[124:127],a[96:111]
DR4 a[204:207],v4 offset:35840
EXP v32,v32
FAD v246,v246,v62
M32 a[48:63],a[252:255],v[92:95],a[48:63]
EXP v33,v33
FAD v247,v247,v63
CVT v55,v62,v63
M32 a[112:127],a[252:255],v[124:127],a[112:127]
s_waitcnt lgkmcnt(2)
EXP v34,v34
FAD v244,v244,v32
M32 v[80:95],a[192:195],v[176:179],v[144:159]
DR4 a[208:211],v4 offset:36864
EXP v35,v35
FAD v245,v245,v33
CVT v24,v32,v33
M32 v[112:127],a[192:195],v[208:211],v[160:175]
EXP v36,v36
FAD v244,v244,v34
M32 v[80:95],a[196:199],v[180:183],v[80:95]
DR4 a[212:215],v4 offset:37888
s_waitcnt vmcnt(8)
buffer_load_dword a128, v15, s[24:27], s54 offen
s_add_u32 s54, s54, 2048
EXP v37,v37
M32 v[112:127],a[196:199],v[212:215],v[112:127]
s_waitcnt lgkmcnt(2)
FAD v245,v245,v35
CVT v25,v34,v35
EXP v38,v38
FAD v244,v244,v36
M32 v[80:95],a[200:203],v[184:187],v[80:95]
DR4 a[216:219],v4 offset:38912
EXP v39,v39
FAD v245,v245,v37
CVT v26,v36,v37
M32 v[112:127],a[200:203],v[216:219],v[112:127]
EXP v40,v40
FAD v244,v244,v38
M32 v[80:95],a[204:207],v[188:191],v[80:95]
DR4 a[220:223],v4 offset:39936
s_add_u32 s34, s34, 1
s_cmp_eq_u32 s34, 4
s_cselect_b32 s24, s32, s24
s_cselect_b32 s25, s33, s25
s_cselect_b32 s26, s30, s26
s_cselect_b32 s54, s35, s54
M32 v[112:127],a[204:207],v[220:223],v[112:127]
s_waitcnt lgkmcnt(2)
EXP v41,v41
FAD v245,v245,v39
CVT v27,v38,v39
EXP v42,v42
M32 v[80:95],a[208:211],v[192:195],v[80:95]
DR4 a[224:227],v4 offset:40960
FAD v244,v244,v40
EXP v43,v43
FAD v245,v245,v41
M32 v[112:127],a[208:211],v[224:227],v[112:127]
CVT v28,v40,v41
EXP v44,v44
FAD v244,v244,v42
M32 v[80:95],a[212:215],v[196:199],v[80:95]
DR4 a[228:231],v4 offset:41984
s_add_u32 m0, s58, 98304
s_nop 0
buffer_load_dwordx4 v6, s[16:19], s61 offen offset:0 lds
EXP v45,v45
M32 v[112:127],a[212:215],v[228:231],v[112:127]
s_waitcnt lgkmcnt(2)
FAD v245,v245,v43
CVT v29,v42,v43
EXP v46,v46
M32 v[80:95],a[216:219],v[200:203],v[80:95]
DR4 a[232:235],v4 offset:43008
FAD v244,v244,v44
EXP v47,v47
FAD v245,v245,v45
M32 v[112:127],a[216:219],v[232:235],v[112:127]
CVT v30,v44,v45
EXP v64,v64
M32 v[80:95],a[220:223],v[204:207],v[80:95]
DR4 a[236:239],v4 offset:44032
buffer_load_dwordx4 v6, s[16:19], s61 offen offset:1024 lds
FAD v244,v244,v46
EXP v65,v65
M32 v[112:127],a[220:223],v[236:239],v[112:127]
s_waitcnt lgkmcnt(2)
FAD v245,v245,v47
CVT v31,v46,v47
EXP v66,v66
M32 v[96:111],a[224:227],v[176:179],v[144:159]
DR4 a[240:243],v4 offset:45056
FAD v246,v246,v64
EXP v67,v67
M32 v[128:143],a[224:227],v[208:211],v[160:175]
FAD v247,v247,v65
CVT v56,v64,v65
EXP v68,v68
M32 v[96:111],a[228:231],v[180:183],v[96:111]
DR4 a[244:247],v4 offset:46080
buffer_load_dwordx4 v6, s[16:19], s61 offen offset:2048 lds
FAD v246,v246,v66
EXP v69,v69
M32 v[128:143],a[228:231],v[212:215],v[128:143]
s_waitcnt lgkmcnt(2)
FAD v247,v247,v67
CVT v57,v66,v67
EXP v70,v70
M32 v[96:111],a[232:235],v[184:187],v[96:111]
DR4 a[248:251],v4 offset:47104
FAD v246,v246,v68
EXP v71,v71
M32 v[128:143],a[232:235],v[216:219],v[128:143]
FAD v247,v247,v69
CVT v58,v68,v69
EXP v72,v72
M32 v[96:111],a[236:239],v[188:191],v[96:111]
DR4 a[252:255],v4 offset:48128
buffer_load_dwordx4 v6, s[16:19], s61 offen offset:3072 lds
s_add_u32 s61, s61, 32768
FAD v246,v246,v70
M32 v[128:143],a[236:239],v[220:223],v[128:143]
s_waitcnt lgkmcnt(2)
EXP v73,v73
FAD v247,v247,v71
CVT v59,v70,v71
EXP v74,v74
M32 v[96:111],a[240:243],v[192:195],v[96:111]
FAD v246,v246,v72
EXP v75,v75
M32 v[128:143],a[240:243],v[224:227],v[128:143]
FAD v247,v247,v73
CVT v60,v72,v73
EXP v76,v76
M32 v[96:111],a[244:247],v[196:199],v[96:111]
s_waitcnt lgkmcnt(0)
s_waitcnt vmcnt(9)
s_barrier
DR4 a[192:195],v5 offset:0
FAD v246,v246,v74
EXP v77,v77
M32 v[128:143],a[244:247],v[228:231],v[128:143]
DR4 a[196:199],v5 offset:4096
FAD v247,v247,v75
CVT v61,v74,v75
EXP v78,v78
M32 v[96:111],a[248:251],v[200:203],v[96:111]
DR4 a[200:203],v5 offset:8192
FAD v246,v246,v76
EXP v79,v79
M32 v[128:143],a[248:251],v[232:235],v[128:143]
DR4 a[204:207],v5 offset:12288
FAD v247,v247,v77
CVT v62,v76,v77
FAD v246,v246,v78
M32 v[96:111],a[252:255],v[204:207],v[96:111]
FAD v247,v247,v79
CVT v63,v78,v79
FAD v244,v244,v245
M32 v[128:143],a[252:255],v[236:239],v[128:143]
s_waitcnt lgkmcnt(2)
FAD v246,v246,v247
v_max_f32 v251, v244, v246
v_cmp_nle_f32 vcc, v251, v255
s_waitcnt lgkmcnt(0)
s_cbranch_vccnz L_B0_rare
L_B0_back:
FAD v242,v242,v244
FAD v243,v243,v246
s_add_u32 s59, s59, 32768
s_branch L_B1
L_Cp:
M32 v[80:95],a[192:195],v[176:179],v[144:159]
DR4 a[208:211],v4 offset:36864
EXP v16,v16
EXP v17,v17
M32 v[112:127],a[192:195],v[208:211],v[160:175]
EXP v18,v18
FAD v244,v16,v17
EXP v19,v19
CVT v16,v16,v17
M32 v[80:95],a[196:199],v[180:183],v[80:95]
DR4 a[212:215],v4 offset:37888
s_add_u32 m0, s58, 0
s_nop 0
buffer_load_dwordx4 v6, s[16:19], s60 offen offset:0 lds
EXP v20,v20
M32 v[112:127],a[196:199],v[212:215],v[112:127]
buffer_load_dwordx4 v6, s[16:19], s60 offen offset:1024 lds
FAD v245,v18,v19
EXP v21,v21
CVT v17,v18,v19
M32 v[80:95],a[200:203],v[184:187],v[80:95]
DR4 a[216:219],v4 offset:38912
EXP v22,v22
FAD v244,v244,v20
EXP v23,v23
M32 v[112:127],a[200:203],v[216:219],v[112:127]
buffer_load_dwordx4 v6, s[16:19], s60 offen offset:2048 lds
FAD v245,v245,v21
CVT v18,v20,v21
EXP v24,v24
M32 v[80:95],a[204:207],v[188:191],v[80:95]
DR4 a[220:223],v4 offset:39936
FAD v244,v244,v22
EXP v25,v25
FAD v245,v245,v23
CVT v19,v22,v23
M32 v[112:127],a[204:207],v[220:223],v[112:127]
s_waitcnt lgkmcnt(2)
buffer_load_dwordx4 v6, s[16:19], s60 offen offset:3072 lds
s_add_u32 s60, s60, 32768
EXP v26,v26
FAD v244,v244,v24
M32 v[80:95],a[208:211],v[192:195],v[80:95]
DR4 a[224:227],v4 offset:40960
s_add_u32 m0, s58, 16384
s_nop 0
buffer_load_dwordx4 v6, s[16:19], s60 offen offset:0 lds
EXP v27,v27
M32 v[112:127],a[208:211],v[224:227],v[112:127]
FAD v245,v245,v25
CVT v20,v24,v25
EXP v28,v28
FAD v244,v244,v26
M32 v[80:95],a[212:215],v[196:199],v[80:95]
DR4 a[228:231],v4 offset:41984
buffer_load_dwordx4 v6, s[16:19], s60 offen offset:1024 lds
EXP v29,v29
FAD v245,v245,v27
M32 v[112:127],a[212:215],v[228:231],v[112:127]
s_waitcnt lgkmcnt(2)
CVT v21,v26,v27
EXP v30,v30
FAD v244,v244,v28
EXP v31,v31
M32 v[80:95],a[216:219],v[200:203],v[80:95]
DR4 a[232:235],v4 offset:43008
buffer_load_dwordx4 v6, s[16:19], s60 offen offset:2048 lds
FAD v245,v245,v29
CVT v22,v28,v29
M32 v[112:127],a[216:219],v[232:235],v[112:127]
EXP v48,v48
FAD v244,v244,v30
EXP v49,v49
FAD v245,v245,v31
M32 v[80:95],a[220:223],v[204:207],v[80:95]
DR4 a[236:239],v4 offset:44032
buffer_load_dwordx4 v6, s[16:19], s60 offen offset:3072 lds
s_add_u32 s60, s60, 32768
CVT v23,v30,v31
M32 v[112:127],a[220:223],v[236:239],v[112:127]
s_waitcnt lgkmcnt(2)
s_waitcnt vmcnt(12)
buffer_load_dword a128, v15, s[24:27], s54 offen
s_add_u32 s54, s54, 2048
EXP v50,v50
FAD v246,v48,v49
M32 v[96:111],a[224:227],v[176:179],v[144:159]
DR4 a[240:243],v4 offset:45056
EXP v51,v51
CVT v48,v48,v49
EXP v52,v52
M32 v[128:143],a[224:227],v[208:211],v[160:175]
s_add_u32 s34, s34, 1
s_cmp_eq_u32 s34, 4
s_cselect_b32 s24, s32, s24
s_cselect_b32 s25, s33, s25
s_cselect_b32 s26, s30, s26
s_cselect_b32 s54, s35, s54
M32 v[96:111],a[228:231],v[180:183],v[96:111]
DR4 a[244:247],v4 offset:46080
FAD v247,v50,v51
EXP v53,v53
CVT v49,v50,v51
M32 v[128:143],a[228:231],v[212:215],v[128:143]
s_waitcnt lgkmcnt(2)
s_add_u32 m0, s58, 98304
s_nop 0
buffer_load_dwordx4 v6, s[16:19], s61 offen offset:0 lds
EXP v54,v54
FAD v246,v246,v52
M32 v[96:111],a[232:235],v[184:187],v[96:111]
DR4 a[248:251],v4 offset:47104
buffer_load_dwordx4 v6, s[16:19], s61 offen offset:1024 lds
EXP v55,v55
FAD v247,v247,v53
M32 v[128:143],a[232:235],v[216:219],v[128:143]
CVT v50,v52,v53
EXP v56,v56
FAD v246,v246,v54
EXP v57,v57
M32 v[96:111],a[236:239],v[188:191],v[96:111]
DR4 a[252:255],v4 offset:48128
buffer_load_dwordx4 v6, s[16:19], s61 offen offset:2048 lds
FAD v247,v247,v55
CVT v51,v54,v55
M32 v[128:143],a[236:239],v[220:223],v[128:143]
s_waitcnt lgkmcnt(2)
EXP v58,v58
FAD v246,v246,v56
EXP v59,v59
FAD v247,v247,v57
M32 v[96:111],a[240:243],v[192:195],v[96:111]
buffer_load_dwordx4 v6, s[16:19], s61 offen offset:3072 lds
s_add_u32 s61, s61, 32768
CVT v52,v56,v57
EXP v60,v60
M32 v[128:143],a[240:243],v[224:227],v[128:143]
FAD v246,v246,v58
EXP v61,v61
FAD v247,v247,v59
CVT v53,v58,v59
M32 v[96:111],a[244:247],v[196:199],v[96:111]
s_waitcnt lgkmcnt(0)
s_waitcnt vmcnt(13)
s_barrier
DR4 a[192:195],v5 offset:0
EXP v62,v62
FAD v246,v246,v60
M32 v[128:143],a[244:247],v[228:231],v[128:143]
DR4 a[196:199],v5 offset:4096
EXP v63,v63
FAD v247,v247,v61
CVT v54,v60,v61
M32 v[96:111],a[248:251],v[200:203],v[96:111]
DR4 a[200:203],v5 offset:8192
EXP v32,v32
FAD v246,v246,v62
EXP v33,v33
M32 v[128:143],a[248:251],v[232:235],v[128:143]
DR4 a[204:207],v5 offset:12288
FAD v247,v247,v63
CVT v55,v62,v63
EXP v34,v34
FAD v244,v244,v32
M32 v[96:111],a[252:255],v[204:207],v[96:111]
EXP v35,v35
FAD v245,v245,v33
CVT v24,v32,v33
EXP v36,v36
M32 v[128:143],a[252:255],v[236:239],v[128:143]
s_waitcnt lgkmcnt(2)
FAD v244,v244,v34
EXP v37,v37
FAD v245,v245,v35
CVT v25,v34,v35
EXP v38,v38
FAD v244,v244,v36
EXP v39,v39
FAD v245,v245,v37
CVT v26,v36,v37
EXP v40,v40
FAD v244,v244,v38
EXP v41,v41
FAD v245,v245,v39
CVT v27,v38,v39
EXP v42,v42
FAD v244,v244,v40
EXP v43,v43
FAD v245,v245,v41
CVT v28,v40,v41
EXP v44,v44
FAD v244,v244,v42
EXP v45,v45
FAD v245,v245,v43
CVT v29,v42,v43
EXP v46,v46
FAD v244,v244,v44
EXP v47,v47
FAD v245,v245,v45
CVT v30,v44,v45
EXP v64,v64
FAD v244,v244,v46
EXP v65,v65
FAD v245,v245,v47
CVT v31,v46,v47
EXP v66,v66
FAD v246,v246,v64
EXP v67,v67
FAD v247,v247,v65
CVT v56,v64,v65
EXP v68,v68
FAD v246,v246,v66
EXP v69,v69
FAD v247,v247,v67
CVT v57,v66,v67
EXP v70,v70
FAD v246,v246,v68
EXP v71,v71
FAD v247,v247,v69
CVT v58,v68,v69
EXP v72,v72
FAD v246,v246,v70
EXP v73,v73
FAD v247,v247,v71
CVT v59,v70,v71
EXP v74,v74
FAD v246,v246,v72
EXP v75,v75
FAD v247,v247,v73
CVT v60,v72,v73
EXP v76,v76
FAD v246,v246,v74
EXP v77,v77
FAD v247,v247,v75
CVT v61,v74,v75
EXP v78,v78
FAD v246,v246,v76
EXP v79,v79
FAD v247,v247,v77
CVT v62,v76,v77
FAD v246,v246,v78
FAD v247,v247,v79
CVT v63,v78,v79
FAD v244,v244,v245
FAD v246,v246,v247
v_max_f32 v251, v244, v246
v_cmp_nle_f32 vcc, v251, v255
s_waitcnt lgkmcnt(0)
s_cbranch_vccnz L_Cp_rare
L_Cp_back:
FAD v242,v242,v244
FAD v243,v243,v246
s_add_u32 s59, s59, 32768
s_branch L_D
L_C:
M32 a[0:15],a[192:195],v[80:83],a[0:15]
DR4 a[208:211],v5 offset:33792
EXP v16,v16
EXP v17,v17
M32 a[64:79],a[192:195],v[112:115],a[64:79]
EXP v18,v18
FAD v244,v16,v17
EXP v19,v19
CVT v16,v16,v17
M32 a[16:31],a[196:199],v[80:83],a[16:31]
DR4 a[212:215],v5 offset:37888
s_add_u32 m0, s58, 0
s_nop 0
buffer_load_dwordx4 v6, s[16:19], s60 offen offset:0 lds
EXP v20,v20
M32 a[80:95],a[196:199],v[112:115],a[80:95]
FAD v245,v18,v19
EXP v21,v21
CVT v17,v18,v19
EXP v22,v22
M32 a[32:47],a[200:203],v[80:83],a[32:47]
DR4 a[216:219],v5 offset:41984
FAD v244,v244,v20
EXP v23,v23
FAD v245,v245,v21
CVT v18,v20,v21
M32 a[96:111],a[200:203],v[112:115],a[96:111]
buffer_load_dwordx4 v6, s[16:19], s60 offen offset:1024 lds
EXP v24,v24
FAD v244,v244,v22
M32 a[48:63],a[204:207],v[80:83],a[48:63]
DR4 a[220:223],v5 offset:46080
EXP v25,v25
FAD v245,v245,v23
CVT v19,v22,v23
M32 a[112:127],a[204:207],v[112:115],a[112:127]
s_waitcnt lgkmcnt(2)
EXP v26,v26
FAD v244,v244,v24
EXP v27,v27
FAD v245,v245,v25
M32 a[0:15],a[208:211],v[84:87],a[0:15]
DR4 a[224:227],v5 offset:34816
buffer_load_dwordx4 v6, s[16:19], s60 offen offset:2048 lds
CVT v20,v24,v25
EXP v28,v28
M32 a[64:79],a[208:211],v[116:119],a[64:79]
FAD v244,v244,v26
EXP v29,v29
FAD v245,v245,v27
CVT v21,v26,v27
M32 a[16:31],a[212:215],v[84:87],a[16:31]
DR4 a[228:231],v5 offset:38912
EXP v30,v30
FAD v244,v244,v28
EXP v31,v31
M32 a[80:95],a[212:215],v[116:119],a[80:95]
s_waitcnt lgkmcnt(2)
buffer_load_dwordx4 v6, s[16:19], s60 offen offset:3072 lds
s_add_u32 s60, s60, 32768
FAD v245,v245,v29
CVT v22,v28,v29
v_cmp_le_i32 s[36:37], 0, v248
M32 a[32:47],a[216:219],v[84:87],a[32:47]
DR4 a[232:235],v5 offset:43008
v_cmp_le_i32 s[38:39], 1, v248
v_cmp_le_i32 s[40:41], 2, v248
v_cmp_le_i32 s[42:43], 3, v248
CND v48,v250,v48,s[36:37]
CND v49,v250,v49,s[38:39]
M32 a[96:111],a[216:219],v[116:119],a[96:111]
CND v50,v250,v50,s[40:41]
CND v51,v250,v51,s[42:43]
v_cmp_le_i32 s[36:37], 16, v248
v_cmp_le_i32 s[38:39], 17, v248
v_cmp_le_i32 s[40:41], 18, v248
v_cmp_le_i32 s[42:43], 19, v248
M32 a[48:63],a[220:223],v[84:87],a[48:63]
DR4 a[236:239],v5 offset:47104
s_add_u32 m0, s58, 16384
s_nop 0
buffer_load_dwordx4 v6, s[16:19], s60 offen offset:0 lds
CND v52,v250,v52,s[36:37]
CND v53,v250,v53,s[38:39]
M32 a[112:127],a[220:223],v[116:119],a[112:127]
s_waitcnt lgkmcnt(2)
CND v54,v250,v54,s[40:41]
CND v55,v250,v55,s[42:43]
v_cmp_le_i32 s[36:37], 8, v248
v_cmp_le_i32 s[38:39], 9, v248
v_cmp_le_i32 s[40:41], 10, v248
v_cmp_le_i32 s[42:43], 11, v248
M32 a[0:15],a[224:227],v[88:91],a[0:15]
DR4 a[240:243],v5 offset:35840
CND v56,v250,v56,s[36:37]
CND v57,v250,v57,s[38:39]
CND v58,v250,v58,s[40:41]
CND v59,v250,v59,s[42:43]
v_cmp_le_i32 s[36:37], 24, v248
M32 a[64:79],a[224:227],v[120:123],a[64:79]
buffer_load_dwordx4 v6, s[16:19], s60 offen offset:1024 lds
v_cmp_le_i32 s[38:39], 25, v248
v_cmp_le_i32 s[40:41], 26, v248
v_cmp_le_i32 s[42:43], 27, v248
CND v60,v250,v60,s[36:37]
M32 a[16:31],a[228:231],v[88:91],a[16:31]
DR4 a[244:247],v5 offset:39936
CND v61,v250,v61,s[38:39]
CND v62,v250,v62,s[40:41]
CND v63,v250,v63,s[42:43]
EXP v48,v48
M32 a[80:95],a[228:231],v[120:123],a[80:95]
s_waitcnt lgkmcnt(2)
FAD v244,v244,v30
EXP v49,v49
FAD v245,v245,v31
CVT v23,v30,v31
M32 a[32:47],a[232:235],v[88:91],a[32:47]
DR4 a[248:251],v5 offset:44032
buffer_load_dwordx4 v6, s[16:19], s60 offen offset:2048 lds
EXP v50,v50
FAD v246,v48,v49
M32 a[96:111],a[232:235],v[120:123],a[96:111]
EXP v51,v51
CVT v48,v48,v49
EXP v52,v52
FAD v247,v50,v51
M32 a[48:63],a[236:239],v[88:91],a[48:63]
DR4 a[252:255],v5 offset:48128
EXP v53,v53
CVT v49,v50,v51
EXP v54,v54
M32 a[112:127],a[236:239],v[120:123],a[112:127]
s_waitcnt lgkmcnt(2)
buffer_load_dwordx4 v6, s[16:19], s60 offen offset:3072 lds
s_add_u32 s60, s60, 32768
FAD v246,v246,v52
EXP v55,v55
M32 a[0:15],a[240:243],v[92:95],a[0:15]
FAD v247,v247,v53
CVT v50,v52,v53
EXP v56,v56
FAD v246,v246,v54
M32 a[64:79],a[240:243],v[124:127],a[64:79]
EXP v57,v57
FAD v247,v247,v55
CVT v51,v54,v55
EXP v58,v58
M32 a[16:31],a[244:247],v[92:95],a[16:31]
s_waitcnt lgkmcnt(0)
s_waitcnt vmcnt(13)
s_barrier
DR4 a[192:195],v4 offset:32768
FAD v246,v246,v56
EXP v59,v59
FAD v247,v247,v57
M32 a[80:95],a[244:247],v[124:127],a[80:95]
DR4 a[196:199],v4 offset:33792
CVT v52,v56,v57
EXP v60,v60
FAD v246,v246,v58
M32 a[32:47],a[248:251],v[92:95],a[32:47]
DR4 a[200:203],v4 offset:34816
EXP v61,v61
FAD v247,v247,v59
CVT v53,v58,v59
M32 a[96:111],a[248:251],v[124:127],a[96:111]
DR4 a[204:207],v4 offset:35840
EXP v62,v62
FAD v246,v246,v60
EXP v63,v63
M32 a[48:63],a[252:255],v[92:95],a[48:63]
FAD v247,v247,v61
CVT v54,v60,v61
EXP v32,v32
FAD v246,v246,v62
M32 a[112:127],a[252:255],v[124:127],a[112:127]
s_waitcnt lgkmcnt(2)
EXP v33,v33
FAD v247,v247,v63
CVT v55,v62,v63
EXP v34,v34
FAD v244,v244,v32
M32 v[80:95],a[192:195],v[176:179],v[144:159]
DR4 a[208:211],v4 offset:36864
EXP v35,v35
FAD v245,v245,v33
CVT v24,v32,v33
M32 v[112:127],a[192:195],v[208:211],v[160:175]
EXP v36,v36
FAD v244,v244,v34
EXP v37,v37
M32 v[80:95],a[196:199],v[180:183],v[80:95]
DR4 a[212:215],v4 offset:37888
s_waitcnt vmcnt(12)
buffer_load_dword a128, v15, s[24:27], s54 offen
s_add_u32 s54, s54, 2048
FAD v245,v245,v35
CVT v25,v34,v35
M32 v[112:127],a[196:199],v[212:215],v[112:127]
s_waitcnt lgkmcnt(2)
EXP v38,v38
FAD v244,v244,v36
EXP v39,v39
FAD v245,v245,v37
M32 v[80:95],a[200:203],v[184:187],v[80:95]
DR4 a[216:219],v4 offset:38912
CVT v26,v36,v37
EXP v40,v40
FAD v244,v244,v38
M32 v[112:127],a[200:203],v[216:219],v[112:127]
EXP v41,v41
FAD v245,v245,v39
CVT v27,v38,v39
EXP v42,v42
M32 v[80:95],a[204:207],v[188:191],v[80:95]
DR4 a[220:223],v4 offset:39936
s_add_u32 s34, s34, 1
s_cmp_eq_u32 s34, 4
s_cselect_b32 s24, s32, s24
s_cselect_b32 s25, s33, s25
s_cselect_b32 s26, s30, s26
s_cselect_b32 s54, s35, s54
M32 v[112:127],a[204:207],v[220:223],v[112:127]
s_waitcnt lgkmcnt(2)
FAD v244,v244,v40
EXP v43,v43
FAD v245,v245,v41
CVT v28,v40,v41
M32 v[80:95],a[208:211],v[192:195],v[80:95]
DR4 a[224:227],v4 offset:40960
EXP v44,v44
FAD v244,v244,v42
EXP v45,v45
M32 v[112:127],a[208:211],v[224:227],v[112:127]
FAD v245,v245,v43
CVT v29,v42,v43
EXP v46,v46
FAD v244,v244,v44
M32 v[80:95],a[212:215],v[196:199],v[80:95]
DR4 a[228:231],v4 offset:41984
s_add_u32 m0, s58, 98304
s_nop 0
buffer_load_dwordx4 v6, s[16:19], s61 offen offset:0 lds
EXP v47,v47
M32 v[112:127],a[212:215],v[228:231],v[112:127]
s_waitcnt lgkmcnt(2)
FAD v245,v245,v45
CVT v30,v44,v45
v_cmp_le_i32 s[36:37], 32, v248
v_cmp_le_i32 s[38:39], 33, v248
v_cmp_le_i32 s[40:41], 34, v248
v_cmp_le_i32 s[42:43], 35, v248
M32 v[80:95],a[216:219],v[200:203],v[80:95]
DR4 a[232:235],v4 offset:43008
CND v64,v250,v64,s[36:37]
CND v65,v250,v65,s[38:39]
CND v66,v250,v66,s[40:41]
CND v67,v250,v67,s[42:43]
v_cmp_le_i32 s[36:37], 48, v248
M32 v[112:127],a[216:219],v[232:235],v[112:127]
v_cmp_le_i32 s[38:39], 49, v248
v_cmp_le_i32 s[40:41], 50, v248
v_cmp_le_i32 s[42:43], 51, v248
CND v68,v250,v68,s[36:37]
CND v69,v250,v69,s[38:39]
CND v70,v250,v70,s[40:41]
M32 v[80:95],a[220:223],v[204:207],v[80:95]
DR4 a[236:239],v4 offset:44032
buffer_load_dwordx4 v6, s[16:19], s61 offen offset:1024 lds
CND v71,v250,v71,s[42:43]
v_cmp_le_i32 s[36:37], 40, v248
v_cmp_le_i32 s[38:39], 41, v248
M32 v[112:127],a[220:223],v[236:239],v[112:127]
s_waitcnt lgkmcnt(2)
v_cmp_le_i32 s[40:41], 42, v248
v_cmp_le_i32 s[42:43], 43, v248
CND v72,v250,v72,s[36:37]
CND v73,v250,v73,s[38:39]
CND v74,v250,v74,s[40:41]
CND v75,v250,v75,s[42:43]
M32 v[96:111],a[224:227],v[176:179],v[144:159]
DR4 a[240:243],v4 offset:45056
v_cmp_le_i32 s[36:37], 56, v248
v_cmp_le_i32 s[38:39], 57, v248
v_cmp_le_i32 s[40:41], 58, v248
v_cmp_le_i32 s[42:43], 59, v248
CND v76,v250,v76,s[36:37]
M32 v[128:143],a[224:227],v[208:211],v[160:175]
CND v77,v250,v77,s[38:39]
CND v78,v250,v78,s[40:41]
CND v79,v250,v79,s[42:43]
EXP v64,v64
M32 v[96:111],a[228:231],v[180:183],v[96:111]
DR4 a[244:247],v4 offset:46080
buffer_load_dwordx4 v6, s[16:19], s61 offen offset:2048 lds
FAD v244,v244,v46
EXP v65,v65
M32 v[128:143],a[228:231],v[212:215],v[128:143]
s_waitcnt lgkmcnt(2)
FAD v245,v245,v47
CVT v31,v46,v47
EXP v66,v66
FAD v246,v246,v64
M32 v[96:111],a[232:235],v[184:187],v[96:111]
DR4 a[248:251],v4 offset:47104
EXP v67,v67
FAD v247,v247,v65
CVT v56,v64,v65
M32 v[128:143],a[232:235],v[216:219],v[128:143]
EXP v68,v68
FAD v246,v246,v66
EXP v69,v69
M32 v[96:111],a[236:239],v[188:191],v[96:111]
DR4 a[252:255],v4 offset:48128
buffer_load_dwordx4 v6, s[16:19], s61 offen offset:3072 lds
s_add_u32 s61, s61, 32768
FAD v247,v247,v67
CVT v57,v66,v67
M32 v[128:143],a[236:239],v[220:223],v[128:143]
s_waitcnt lgkmcnt(2)
EXP v70,v70
FAD v246,v246,v68
EXP v71,v71
FAD v247,v247,v69
M32 v[96:111],a[240:243],v[192:195],v[96:111]
CVT v58,v68,v69
EXP v72,v72
FAD v246,v246,v70
EXP v73,v73
M32 v[128:143],a[240:243],v[224:227],v[128:143]
FAD v247,v247,v71
CVT v59,v70,v71
EXP v74,v74
M32 v[96:111],a[244:247],v[196:199],v[96:111]
s_waitcnt lgkmcnt(0)
s_waitcnt vmcnt(13)
s_barrier
DR4 a[192:195],v5 offset:0
FAD v246,v246,v72
EXP v75,v75
FAD v247,v247,v73
M32 v[128:143],a[244:247],v[228:231],v[128:143]
DR4 a[196:199],v5 offset:4096
CVT v60,v72,v73
EXP v76,v76
FAD v246,v246,v74
M32 v[96:111],a[248:251],v[200:203],v[96:111]
DR4 a[200:203],v5 offset:8192
EXP v77,v77
FAD v247,v247,v75
CVT v61,v74,v75
M32 v[128:143],a[248:251],v[232:235],v[128:143]
DR4 a[204:207],v5 offset:12288
EXP v78,v78
FAD v246,v246,v76
EXP v79,v79
M32 v[96:111],a[252:255],v[204:207],v[96:111]
FAD v247,v247,v77
CVT v62,v76,v77
FAD v246,v246,v78
FAD v247,v247,v79
CVT v63,v78,v79
M32 v[128:143],a[252:255],v[236:239],v[128:143]
s_waitcnt lgkmcnt(2)
FAD v244,v244,v245
FAD v246,v246,v247
v_max_f32 v251, v244, v246
v_cmp_nle_f32 vcc, v251, v255
s_waitcnt lgkmcnt(0)
s_cbranch_vccnz L_C_rare
L_C_back:
FAD v242,v242,v244
FAD v243,v243,v246
s_add_u32 s59, s59, 32768
L_D:
M32 a[0:15],a[192:195],v[16:19],a[0:15]
DR4 a[208:211],v5 offset:1024
EXP v80,v80
EXP v81,v81
M32 a[64:79],a[192:195],v[48:51],a[64:79]
EXP v82,v82
FAD v244,v80,v81
EXP v83,v83
CVT v80,v80,v81
M32 a[16:31],a[196:199],v[16:19],a[16:31]
DR4 a[212:215],v5 offset:5120
s_add_u32 m0, s58, 32768
s_nop 0
buffer_load_dwordx4 v6, s[16:19], s60 offen offset:0 lds
EXP v84,v84
M32 a[80:95],a[196:199],v[48:51],a[80:95]
FAD v245,v82,v83
EXP v85,v85
CVT v81,v82,v83
EXP v86,v86
M32 a[32:47],a[200:203],v[16:19],a[32:47]
DR4 a[216:219],v5 offset:9216
FAD v244,v244,v84
EXP v87,v87
FAD v245,v245,v85
CVT v82,v84,v85
M32 a[96:111],a[200:203],v[48:51],a[96:111]
buffer_load_dwordx4 v6, s[16:19], s60 offen offset:1024 lds
EXP v88,v88
FAD v244,v244,v86
M32 a[48:63],a[204:207],v[16:19],a[48:63]
DR4 a[220:223],v5 offset:13312
EXP v89,v89
FAD v245,v245,v87
CVT v83,v86,v87
M32 a[112:127],a[204:207],v[48:51],a[112:127]
s_waitcnt lgkmcnt(2)
EXP v90,v90
FAD v244,v244,v88
EXP v91,v91
FAD v245,v245,v89
M32 a[0:15],a[208:211],v[20:23],a[0:15]
DR4 a[224:227],v5 offset:2048
buffer_load_dwordx4 v6, s[16:19], s60 offen offset:2048 lds
CVT v84,v88,v89
EXP v92,v92
M32 a[64:79],a[208:211],v[52:55],a[64:79]
FAD v244,v244,v90
EXP v93,v93
FAD v245,v245,v91
CVT v85,v90,v91
M32 a[16:31],a[212:215],v[20:23],a[16:31]
DR4 a[228:231],v5 offset:6144
EXP v94,v94
FAD v244,v244,v92
EXP v95,v95
M32 a[80:95],a[212:215],v[52:55],a[80:95]
s_waitcnt lgkmcnt(2)
buffer_load_dwordx4 v6, s[16:19], s60 offen offset:3072 lds
s_add_u32 s60, s60, 32768
FAD v245,v245,v93
CVT v86,v92,v93
v_cmp_le_i32 s[36:37], 0, v249
M32 a[32:47],a[216:219],v[20:23],a[32:47]
DR4 a[232:235],v5 offset:10240
v_cmp_le_i32 s[38:39], 1, v249
v_cmp_le_i32 s[40:41], 2, v249
v_cmp_le_i32 s[42:43], 3, v249
CND v112,v250,v112,s[36:37]
CND v113,v250,v113,s[38:39]
M32 a[96:111],a[216:219],v[52:55],a[96:111]
CND v114,v250,v114,s[40:41]
CND v115,v250,v115,s[42:43]
v_cmp_le_i32 s[36:37], 16, v249
v_cmp_le_i32 s[38:39], 17, v249
v_cmp_le_i32 s[40:41], 18, v249
v_cmp_le_i32 s[42:43], 19, v249
M32 a[48:63],a[220:223],v[20:23],a[48:63]
DR4 a[236:239],v5 offset:14336
s_add_u32 m0, s58, 49152
s_nop 0
buffer_load_dwordx4 v6, s[16:19], s60 offen offset:0 lds
CND v116,v250,v116,s[36:37]
CND v117,v250,v117,s[38:39]
M32 a[112:127],a[220:223],v[52:55],a[112:127]
s_waitcnt lgkmcnt(2)
CND v118,v250,v118,s[40:41]
CND v119,v250,v119,s[42:43]
v_cmp_le_i32 s[36:37], 8, v249
v_cmp_le_i32 s[38:39], 9, v249
v_cmp_le_i32 s[40:41], 10, v249
v_cmp_le_i32 s[42:43], 11, v249
M32 a[0:15],a[224:227],v[24:27],a[0:15]
DR4 a[240:243],v5 offset:3072
CND v120,v250,v120,s[36:37]
CND v121,v250,v121,s[38:39]
CND v122,v250,v122,s[40:41]
CND v123,v250,v123,s[42:43]
v_cmp_le_i32 s[36:37], 24, v249
M32 a[64:79],a[224:227],v[56:59],a[64:79]
buffer_load_dwordx4 v6, s[16:19], s60 offen offset:1024 lds
v_cmp_le_i32 s[38:39], 25, v249
v_cmp_le_i32 s[40:41], 26, v249
v_cmp_le_i32 s[42:43], 27, v249
CND v124,v250,v124,s[36:37]
M32 a[16:31],a[228:231],v[24:27],a[16:31]
DR4 a[244:247],v5 offset:7168
CND v125,v250,v125,s[38:39]
CND v126,v250,v126,s[40:41]
CND v127,v250,v127,s[42:43]
EXP v112,v112
M32 a[80:95],a[228:231],v[56:59],a[80:95]
s_waitcnt lgkmcnt(2)
FAD v244,v244,v94
EXP v113,v113
FAD v245,v245,v95
CVT v87,v94,v95
M32 a[32:47],a[232:235],v[24:27],a[32:47]
DR4 a[248:251],v5 offset:11264
buffer_load_dwordx4 v6, s[16:19], s60 offen offset:2048 lds
EXP v114,v114
FAD v246,v112,v113
M32 a[96:111],a[232:235],v[56:59],a[96:111]
EXP v115,v115
CVT v112,v112,v113
EXP v116,v116
FAD v247,v114,v115
M32 a[48:63],a[236:239],v[24:27],a[48:63]
DR4 a[252:255],v5 offset:15360
EXP v117,v117
CVT v113,v114,v115
EXP v118,v118
M32 a[112:127],a[236:239],v[56:59],a[112:127]
s_waitcnt lgkmcnt(2)
buffer_load_dwordx4 v6, s[16:19], s60 offen offset:3072 lds
s_add_u32 s60, s60, 32768
FAD v246,v246,v116
EXP v119,v119
M32 a[0:15],a[240:243],v[28:31],a[0:15]
FAD v247,v247,v117
CVT v114,v116,v117
EXP v120,v120
FAD v246,v246,v118
M32 a[64:79],a[240:243],v[60:63],a[64:79]
EXP v121,v121
FAD v247,v247,v119
CVT v115,v118,v119
EXP v122,v122
M32 a[16:31],a[244:247],v[28:31],a[16:31]
s_waitcnt lgkmcnt(0)
s_waitcnt vmcnt(13)
s_barrier
DR4 a[192:195],v4 offset:0
DR4 a[196:199],v4 offset:16384
FAD v246,v246,v120
EXP v123,v123
M32 a[80:95],a[244:247],v[60:63],a[80:95]
DR4 a[200:203],v4 offset:1024
DR4 a[204:207],v4 offset:17408
FAD v247,v247,v121
CVT v116,v120,v121
EXP v124,v124
M32 a[32:47],a[248:251],v[28:31],a[32:47]
DR4 a[208:211],v4 offset:2048
FAD v246,v246,v122
EXP v125,v125
FAD v247,v247,v123
CVT v117,v122,v123
M32 a[96:111],a[248:251],v[60:63],a[96:111]
DR4 a[212:215],v4 offset:18432
DR4 a[216:219],v4 offset:3072
EXP v126,v126
FAD v246,v246,v124
M32 a[48:63],a[252:255],v[28:31],a[48:63]
DR4 a[220:223],v4 offset:19456
EXP v127,v127
FAD v247,v247,v125
CVT v118,v124,v125
M32 a[112:127],a[252:255],v[60:63],a[112:127]
s_waitcnt lgkmcnt(4)
EXP v96,v96
FAD v246,v246,v126
EXP v97,v97
FAD v247,v247,v127
CVT v119,v126,v127
EXP v98,v98
FAD v244,v244,v96
M32 v[16:31],a[192:195],v[176:179],v[144:159]
DR4 a[224:227],v4 offset:4096
EXP v99,v99
FAD v245,v245,v97
CVT v88,v96,v97
M32 v[48:63],a[196:199],v[176:179],v[144:159]
DR4 a[228:231],v4 offset:20480
EXP v100,v100
FAD v244,v244,v98
EXP v101,v101
M32 v[16:31],a[200:203],v[180:183],v[16:31]
DR4 a[232:235],v4 offset:5120
s_waitcnt vmcnt(12)
buffer_load_dword a128, v15, s[28:31], s55 offen
s_add_u32 s55, s55, 2048
FAD v245,v245,v99
CVT v89,v98,v99
M32 v[48:63],a[204:207],v[180:183],v[48:63]
s_waitcnt lgkmcnt(3)
DR4 a[236:239],v4 offset:21504
EXP v102,v102
FAD v244,v244,v100
EXP v103,v103
M32 v[16:31],a[208:211],v[184:187],v[16:31]
DR4 a[240:243],v4 offset:6144
s_cmp_ge_u32 s34, 4
s_cselect_b32 s55, 0x1000000, s55
FAD v245,v245,v101
CVT v90,v100,v101
M32 v[48:63],a[212:215],v[184:187],v[48:63]
DR4 a[244:247],v4 offset:22528
EXP v104,v104
FAD v244,v244,v102
EXP v105,v105
M32 v[16:31],a[216:219],v[188:191],v[16:31]
DR4 a[248:251],v4 offset:7168
s_add_u32 m0, s58, 65536
s_nop 0
buffer_load_dwordx4 v6, s[16:19], s61 offen offset:0 lds
FAD v245,v245,v103
CVT v91,v102,v103
M32 v[48:63],a[220:223],v[188:191],v[48:63]
s_waitcnt lgkmcnt(3)
DR4 a[252:255],v4 offset:23552
EXP v106,v106
FAD v244,v244,v104
EXP v107,v107
M32 v[16:31],a[224:227],v[192:195],v[16:31]
DR4 a[192:195],v4 offset:8192
FAD v245,v245,v105
CVT v92,v104,v105
EXP v108,v108
FAD v244,v244,v106
M32 v[48:63],a[228:231],v[192:195],v[48:63]
DR4 a[196:199],v4 offset:24576
buffer_load_dwordx4 v6, s[16:19], s61 offen offset:1024 lds
EXP v109,v109
FAD v245,v245,v107
M32 v[16:31],a[232:235],v[196:199],v[16:31]
DR4 a[200:203],v4 offset:9216
CVT v93,v106,v107
EXP v110,v110
FAD v244,v244,v108
M32 v[48:63],a[236:239],v[196:199],v[48:63]
s_waitcnt lgkmcnt(3)
DR4 a[204:207],v4 offset:25600
buffer_load_dwordx4 v6, s[16:19], s61 offen offset:2048 lds
EXP v111,v111
FAD v245,v245,v109
M32 v[16:31],a[240:243],v[200:203],v[16:31]
DR4 a[208:211],v4 offset:10240
CVT v94,v108,v109
v_cmp_le_i32 s[36:37], 32, v249
v_cmp_le_i32 s[38:39], 33, v249
v_cmp_le_i32 s[40:41], 34, v249
v_cmp_le_i32 s[42:43], 35, v249
M32 v[48:63],a[244:247],v[200:203],v[48:63]
DR4 a[212:215],v4 offset:26624
CND v128,v250,v128,s[36:37]
CND v129,v250,v129,s[38:39]
CND v130,v250,v130,s[40:41]
CND v131,v250,v131,s[42:43]
v_cmp_le_i32 s[36:37], 48, v249
M32 v[16:31],a[248:251],v[204:207],v[16:31]
DR4 a[216:219],v4 offset:11264
buffer_load_dwordx4 v6, s[16:19], s61 offen offset:3072 lds
s_add_u32 s61, s61, 32768
v_cmp_le_i32 s[38:39], 49, v249
v_cmp_le_i32 s[40:41], 50, v249
M32 v[48:63],a[252:255],v[204:207],v[48:63]
s_waitcnt lgkmcnt(3)
DR4 a[220:223],v4 offset:27648
v_cmp_le_i32 s[42:43], 51, v249
CND v132,v250,v132,s[36:37]
CND v133,v250,v133,s[38:39]
CND v134,v250,v134,s[40:41]
CND v135,v250,v135,s[42:43]
M32 v[32:47],a[192:195],v[176:179],v[144:159]
DR4 a[224:227],v4 offset:12288
s_add_u32 m0, s58, 81920
s_nop 0
buffer_load_dwordx4 v6, s[16:19], s61 offen offset:0 lds
v_cmp_le_i32 s[36:37], 40, v249
v_cmp_le_i32 s[38:39], 41, v249
M32 v[64:79],a[196:199],v[176:179],v[144:159]
DR4 a[228:231],v4 offset:28672
v_cmp_le_i32 s[40:41], 42, v249
v_cmp_le_i32 s[42:43], 43, v249
CND v136,v250,v136,s[36:37]
CND v137,v250,v137,s[38:39]
CND v138,v250,v138,s[40:41]
M32 v[32:47],a[200:203],v[180:183],v[32:47]
DR4 a[232:235],v4 offset:13312
buffer_load_dwordx4 v6, s[16:19], s61 offen offset:1024 lds
CND v139,v250,v139,s[42:43]
v_cmp_le_i32 s[36:37], 56, v249
v_cmp_le_i32 s[38:39], 57, v249
M32 v[64:79],a[204:207],v[180:183],v[64:79]
s_waitcnt lgkmcnt(3)
DR4 a[236:239],v4 offset:29696
v_cmp_le_i32 s[40:41], 58, v249
v_cmp_le_i32 s[42:43], 59, v249
CND v140,v250,v140,s[36:37]
CND v141,v250,v141,s[38:39]
CND v142,v250,v142,s[40:41]
M32 v[32:47],a[208:211],v[184:187],v[32:47]
DR4 a[240:243],v4 offset:14336
CND v143,v250,v143,s[42:43]
EXP v128,v128
FAD v244,v244,v110
M32 v[64:79],a[212:215],v[184:187],v[64:79]
DR4 a[244:247],v4 offset:30720
buffer_load_dwordx4 v6, s[16:19], s61 offen offset:2048 lds
EXP v129,v129
FAD v245,v245,v111
M32 v[32:47],a[216:219],v[188:191],v[32:47]
DR4 a[248:251],v4 offset:15360
CVT v95,v110,v111
EXP v130,v130
FAD v246,v246,v128
M32 v[64:79],a[220:223],v[188:191],v[64:79]
s_waitcnt lgkmcnt(3)
DR4 a[252:255],v4 offset:31744
buffer_load_dwordx4 v6, s[16:19], s61 offen offset:3072 lds
s_add_u32 s61, s61, 32768
EXP v131,v131
M32 v[32:47],a[224:227],v[192:195],v[32:47]
FAD v247,v247,v129
CVT v120,v128,v129
EXP v132,v132
FAD v246,v246,v130
M32 v[64:79],a[228:231],v[192:195],v[64:79]
EXP v133,v133
FAD v247,v247,v131
CVT v121,v130,v131
EXP v134,v134
M32 v[32:47],a[232:235],v[196:199],v[32:47]
s_waitcnt lgkmcnt(0)
s_waitcnt vmcnt(17)
s_barrier
DR4 a[192:195],v5 offset:32768
FAD v246,v246,v132
EXP v135,v135
FAD v247,v247,v133
M32 v[64:79],a[236:239],v[196:199],v[64:79]
DR4 a[196:199],v5 offset:36864
CVT v122,v132,v133
EXP v136,v136
FAD v246,v246,v134
M32 v[32:47],a[240:243],v[200:203],v[32:47]
DR4 a[200:203],v5 offset:40960
EXP v137,v137
FAD v247,v247,v135
CVT v123,v134,v135
M32 v[64:79],a[244:247],v[200:203],v[64:79]
DR4 a[204:207],v5 offset:45056
EXP v138,v138
FAD v246,v246,v136
EXP v139,v139
M32 v[32:47],a[248:251],v[204:207],v[32:47]
FAD v247,v247,v137
CVT v124,v136,v137
EXP v140,v140
FAD v246,v246,v138
M32 v[64:79],a[252:255],v[204:207],v[64:79]
s_waitcnt lgkmcnt(2)
EXP v141,v141
FAD v247,v247,v139
CVT v125,v138,v139
EXP v142,v142
FAD v246,v246,v140
EXP v143,v143
FAD v247,v247,v141
CVT v126,v140,v141
FAD v246,v246,v142
FAD v247,v247,v143
CVT v127,v142,v143
FAD v244,v244,v245
FAD v246,v246,v247
v_max_f32 v251, v244, v246
v_cmp_nle_f32 vcc, v251, v255
s_waitcnt lgkmcnt(0)
s_cbranch_vccnz L_D_rare
L_D_back:
FAD v242,v242,v244
FAD v243,v243,v246
s_add_u32 s59, s59, 32768
s_cmp_eq_u32 s51, 7
s_cbranch_scc1 L_Gp
s_sub_u32 s64, 6, s51
L_E:
M32 a[0:15],a[192:195],v[80:83],a[0:15]
DR4 a[208:211],v5 offset:33792
EXP v16,v16
EXP v17,v17
M32 a[64:79],a[192:195],v[112:115],a[64:79]
EXP v18,v18
FAD v244,v16,v17
EXP v19,v19
M32 a[16:31],a[196:199],v[80:83],a[16:31]
DR4 a[212:215],v5 offset:37888
s_add_u32 m0, s58, 0
s_nop 0
buffer_load_dwordx4 v6, s[16:19], s60 offen offset:0 lds
CVT v16,v16,v17
M32 a[80:95],a[196:199],v[112:115],a[80:95]
EXP v20,v20
FAD v245,v18,v19
EXP v21,v21
M32 a[32:47],a[200:203],v[80:83],a[32:47]
DR4 a[216:219],v5 offset:41984
CVT v17,v18,v19
EXP v22,v22
M32 a[96:111],a[200:203],v[112:115],a[96:111]
buffer_load_dwordx4 v6, s[16:19], s60 offen offset:1024 lds
FAD v244,v244,v20
EXP v23,v23
FAD v245,v245,v21
M32 a[48:63],a[204:207],v[80:83],a[48:63]
DR4 a[220:223],v5 offset:46080
CVT v18,v20,v21
EXP v24,v24
FAD v244,v244,v22
M32 a[112:127],a[204:207],v[112:115],a[112:127]
s_waitcnt lgkmcnt(2)
EXP v25,v25
FAD v245,v245,v23
M32 a[0:15],a[208:211],v[84:87],a[0:15]
DR4 a[224:227],v5 offset:34816
buffer_load_dwordx4 v6, s[16:19], s60 offen offset:2048 lds
CVT v19,v22,v23
EXP v26,v26
M32 a[64:79],a[208:211],v[116:119],a[64:79]
FAD v244,v244,v24
EXP v27,v27
FAD v245,v245,v25
M32 a[16:31],a[212:215],v[84:87],a[16:31]
DR4 a[228:231],v5 offset:38912
CVT v20,v24,v25
EXP v28,v28
FAD v244,v244,v26
M32 a[80:95],a[212:215],v[116:119],a[80:95]
s_waitcnt lgkmcnt(2)
buffer_load_dwordx4 v6, s[16:19], s60 offen offset:3072 lds
s_add_u32 s60, s60, 32768
EXP v29,v29
FAD v245,v245,v27
M32 a[32:47],a[216:219],v[84:87],a[32:47]
DR4 a[232:235],v5 offset:43008
CVT v21,v26,v27
EXP v30,v30
FAD v244,v244,v28
M32 a[96:111],a[216:219],v[116:119],a[96:111]
EXP v31,v31
FAD v245,v245,v29
CVT v22,v28,v29
M32 a[48:63],a[220:223],v[84:87],a[48:63]
DR4 a[236:239],v5 offset:47104
s_add_u32 m0, s58, 16384
s_nop 0
buffer_load_dwordx4 v6, s[16:19], s60 offen offset:0 lds
EXP v48,v48
M32 a[112:127],a[220:223],v[116:119],a[112:127]
s_waitcnt lgkmcnt(2)
FAD v244,v244,v30
EXP v49,v49
FAD v245,v245,v31
CVT v23,v30,v31
M32 a[0:15],a[224:227],v[88:91],a[0:15]
DR4 a[240:243],v5 offset:35840
EXP v50,v50
FAD v246,v48,v49
EXP v51,v51
M32 a[64:79],a[224:227],v[120:123],a[64:79]
buffer_load_dwordx4 v6, s[16:19], s60 offen offset:1024 lds
CVT v48,v48,v49
EXP v52,v52
M32 a[16:31],a[228:231],v[88:91],a[16:31]
DR4 a[244:247],v5 offset:39936
FAD v247,v50,v51
EXP v53,v53
M32 a[80:95],a[228:231],v[120:123],a[80:95]
s_waitcnt lgkmcnt(2)
CVT v49,v50,v51
EXP v54,v54
M32 a[32:47],a[232:235],v[88:91],a[32:47]
DR4 a[248:251],v5 offset:44032
buffer_load_dwordx4 v6, s[16:19], s60 offen offset:2048 lds
FAD v246,v246,v52
EXP v55,v55
M32 a[96:111],a[232:235],v[120:123],a[96:111]
FAD v247,v247,v53
CVT v50,v52,v53
EXP v56,v56
FAD v246,v246,v54
M32 a[48:63],a[236:239],v[88:91],a[48:63]
DR4 a[252:255],v5 offset:48128
EXP v57,v57
FAD v247,v247,v55
M32 a[112:127],a[236:239],v[120:123],a[112:127]
s_waitcnt lgkmcnt(2)
buffer_load_dwordx4 v6, s[16:19], s60 offen offset:3072 lds
s_add_u32 s60, s60, 32768
CVT v51,v54,v55
EXP v58,v58
M32 a[0:15],a[240:243],v[92:95],a[0:15]
FAD v246,v246,v56
EXP v59,v59
FAD v247,v247,v57
M32 a[64:79],a[240:243],v[124:127],a[64:79]
CVT v52,v56,v57
EXP v60,v60
FAD v246,v246,v58
M32 a[16:31],a[244:247],v[92:95],a[16:31]
s_waitcnt lgkmcnt(0)
s_waitcnt vmcnt(17)
s_barrier
DR4 a[192:195],v4 offset:32768
DR4 a[196:199],v4 offset:49152
EXP v61,v61
FAD v247,v247,v59
M32 a[80:95],a[244:247],v[124:127],a[80:95]
DR4 a[200:203],v4 offset:33792
DR4 a[204:207],v4 offset:50176
CVT v53,v58,v59
EXP v62,v62
FAD v246,v246,v60
M32 a[32:47],a[248:251],v[92:95],a[32:47]
DR4 a[208:211],v4 offset:34816
EXP v63,v63
FAD v247,v247,v61
CVT v54,v60,v61
M32 a[96:111],a[248:251],v[124:127],a[96:111]
DR4 a[212:215],v4 offset:51200
DR4 a[216:219],v4 offset:35840
EXP v32,v32
FAD v246,v246,v62
M32 a[48:63],a[252:255],v[92:95],a[48:63]
DR4 a[220:223],v4 offset:52224
EXP v33,v33
FAD v247,v247,v63
CVT v55,v62,v63
M32 a[112:127],a[252:255],v[124:127],a[112:127]
s_waitcnt lgkmcnt(4)
EXP v34,v34
FAD v244,v244,v32
M32 v[80:95],a[192:195],v[176:179],v[144:159]
DR4 a[224:227],v4 offset:36864
EXP v35,v35
FAD v245,v245,v33
CVT v24,v32,v33
M32 v[112:127],a[196:199],v[176:179],v[144:159]
DR4 a[228:231],v4 offset:53248
EXP v36,v36
FAD v244,v244,v34
M32 v[80:95],a[200:203],v[180:183],v[80:95]
DR4 a[232:235],v4 offset:37888
s_waitcnt vmcnt(16)
buffer_load_dword a128, v15, s[24:27], s54 offen
s_add_u32 s54, s54, 2048
EXP v37,v37
M32 v[112:127],a[204:207],v[180:183],v[112:127]
s_waitcnt lgkmcnt(3)
DR4 a[236:239],v4 offset:54272
FAD v245,v245,v35
CVT v25,v34,v35
EXP v38,v38
FAD v244,v244,v36
M32 v[80:95],a[208:211],v[184:187],v[80:95]
DR4 a[240:243],v4 offset:38912
s_add_u32 s34, s34, 1
s_cmp_eq_u32 s34, 4
s_cselect_b32 s24, s32, s24
s_cselect_b32 s25, s33, s25
s_cselect_b32 s26, s30, s26
s_cselect_b32 s54, s35, s54
M32 v[112:127],a[212:215],v[184:187],v[112:127]
DR4 a[244:247],v4 offset:55296
EXP v39,v39
FAD v245,v245,v37
CVT v26,v36,v37
M32 v[80:95],a[216:219],v[188:191],v[80:95]
DR4 a[248:251],v4 offset:39936
s_add_u32 m0, s58, 98304
s_nop 0
buffer_load_dwordx4 v6, s[16:19], s61 offen offset:0 lds
EXP v40,v40
M32 v[112:127],a[220:223],v[188:191],v[112:127]
s_waitcnt lgkmcnt(3)
DR4 a[252:255],v4 offset:56320
FAD v244,v244,v38
EXP v41,v41
FAD v245,v245,v39
CVT v27,v38,v39
M32 v[80:95],a[224:227],v[192:195],v[80:95]
DR4 a[192:195],v4 offset:40960
EXP v42,v42
FAD v244,v244,v40
EXP v43,v43
M32 v[112:127],a[228:231],v[192:195],v[112:127]
DR4 a[196:199],v4 offset:57344
buffer_load_dwordx4 v6, s[16:19], s61 offen offset:1024 lds
FAD v245,v245,v41
CVT v28,v40,v41
M32 v[80:95],a[232:235],v[196:199],v[80:95]
DR4 a[200:203],v4 offset:41984
EXP v44,v44
FAD v244,v244,v42
EXP v45,v45
M32 v[112:127],a[236:239],v[196:199],v[112:127]
s_waitcnt lgkmcnt(3)
DR4 a[204:207],v4 offset:58368
buffer_load_dwordx4 v6, s[16:19], s61 offen offset:2048 lds
FAD v245,v245,v43
CVT v29,v42,v43
M32 v[80:95],a[240:243],v[200:203],v[80:95]
DR4 a[208:211],v4 offset:43008
EXP v46,v46
FAD v244,v244,v44
EXP v47,v47
M32 v[112:127],a[244:247],v[200:203],v[112:127]
DR4 a[212:215],v4 offset:59392
FAD v245,v245,v45
CVT v30,v44,v45
EXP v64,v64
M32 v[80:95],a[248:251],v[204:207],v[80:95]
DR4 a[216:219],v4 offset:44032
buffer_load_dwordx4 v6, s[16:19], s61 offen offset:3072 lds
s_add_u32 s61, s61, 32768
FAD v244,v244,v46
M32 v[112:127],a[252:255],v[204:207],v[112:127]
s_waitcnt lgkmcnt(3)
DR4 a[220:223],v4 offset:60416
EXP v65,v65
FAD v245,v245,v47
CVT v31,v46,v47
M32 v[96:111],a[192:195],v[176:179],v[144:159]
DR4 a[224:227],v4 offset:45056
s_add_u32 m0, s58, 114688
s_nop 0
buffer_load_dwordx4 v6, s[16:19], s61 offen offset:0 lds
EXP v66,v66
M32 v[128:143],a[196:199],v[176:179],v[144:159]
DR4 a[228:231],v4 offset:61440
FAD v246,v246,v64
EXP v67,v67
FAD v247,v247,v65
CVT v56,v64,v65
M32 v[96:111],a[200:203],v[180:183],v[96:111]
DR4 a[232:235],v4 offset:46080
buffer_load_dwordx4 v6, s[16:19], s61 offen offset:1024 lds
EXP v68,v68
FAD v246,v246,v66
M32 v[128:143],a[204:207],v[180:183],v[128:143]
s_waitcnt lgkmcnt(3)
DR4 a[236:239],v4 offset:62464
EXP v69,v69
FAD v247,v247,v67
CVT v57,v66,v67
M32 v[96:111],a[208:211],v[184:187],v[96:111]
DR4 a[240:243],v4 offset:47104
EXP v70,v70
FAD v246,v246,v68
EXP v71,v71
M32 v[128:143],a[212:215],v[184:187],v[128:143]
DR4 a[244:247],v4 offset:63488
buffer_load_dwordx4 v6, s[16:19], s61 offen offset:2048 lds
FAD v247,v247,v69
CVT v58,v68,v69
M32 v[96:111],a[216:219],v[188:191],v[96:111]
DR4 a[248:251],v4 offset:48128
EXP v72,v72
FAD v246,v246,v70
EXP v73,v73
M32 v[128:143],a[220:223],v[188:191],v[128:143]
s_waitcnt lgkmcnt(3)
DR4 a[252:255],v4 offset:64512
buffer_load_dwordx4 v6, s[16:19], s61 offen offset:3072 lds
s_add_u32 s61, s61, 32768
FAD v247,v247,v71
CVT v59,v70,v71
M32 v[96:111],a[224:227],v[192:195],v[96:111]
EXP v74,v74
FAD v246,v246,v72
EXP v75,v75
M32 v[128:143],a[228:231],v[192:195],v[128:143]
FAD v247,v247,v73
CVT v60,v72,v73
EXP v76,v76
M32 v[96:111],a[232:235],v[196:199],v[96:111]
s_waitcnt lgkmcnt(0)
s_waitcnt vmcnt(17)
s_barrier
DR4 a[192:195],v5 offset:0
DR4 a[196:199],v5 offset:16384
FAD v246,v246,v74
EXP v77,v77
M32 v[128:143],a[236:239],v[196:199],v[128:143]
DR4 a[200:203],v5 offset:4096
DR4 a[204:207],v5 offset:20480
FAD v247,v247,v75
CVT v61,v74,v75
EXP v78,v78
M32 v[96:111],a[240:243],v[200:203],v[96:111]
DR4 a[208:211],v5 offset:8192
FAD v246,v246,v76
EXP v79,v79
M32 v[128:143],a[244:247],v[200:203],v[128:143]
DR4 a[212:215],v5 offset:24576
DR4 a[216:219],v5 offset:12288
FAD v247,v247,v77
CVT v62,v76,v77
FAD v246,v246,v78
M32 v[96:111],a[248:251],v[204:207],v[96:111]
DR4 a[220:223],v5 offset:28672
FAD v247,v247,v79
CVT v63,v78,v79
FAD v244,v244,v245
M32 v[128:143],a[252:255],v[204:207],v[128:143]
s_waitcnt lgkmcnt(4)
FAD v246,v246,v247
v_max_f32 v251, v244, v246
v_cmp_nle_f32 vcc, v251, v255
s_waitcnt lgkmcnt(0)
s_cbranch_vccnz L_E_rare
L_E_back:
FAD v242,v242,v244
FAD v242,v242,v246
s_add_u32 s59, s59, 65536
L_F1:
M32 a[0:15],a[192:195],v[16:19],a[0:15]
DR4 a[224:227],v5 offset:1024
EXP v80,v80
EXP v81,v81
M32 a[0:15],a[196:199],v[48:51],a[0:15]
DR4 a[228:231],v5 offset:17408
EXP v82,v82
FAD v244,v80,v81
EXP v83,v83
M32 a[16:31],a[200:203],v[16:19],a[16:31]
DR4 a[232:235],v5 offset:5120
s_add_u32 m0, s58, 32768
s_nop 0
buffer_load_dwordx4 v6, s[16:19], s60 offen offset:0 lds
CVT v80,v80,v81
M32 a[16:31],a[204:207],v[48:51],a[16:31]
DR4 a[236:239],v5 offset:21504
EXP v84,v84
FAD v245,v82,v83
EXP v85,v85
M32 a[32:47],a[208:211],v[16:19],a[32:47]
DR4 a[240:243],v5 offset:9216
CVT v81,v82,v83
EXP v86,v86
M32 a[32:47],a[212:215],v[48:51],a[32:47]
DR4 a[244:247],v5 offset:25600
buffer_load_dwordx4 v6, s[16:19], s60 offen offset:1024 lds
FAD v244,v244,v84
EXP v87,v87
M32 a[48:63],a[216:219],v[16:19],a[48:63]
DR4 a[248:251],v5 offset:13312
FAD v245,v245,v85
CVT v82,v84,v85
EXP v88,v88
FAD v244,v244,v86
M32 a[48:63],a[220:223],v[48:51],a[48:63]
s_waitcnt lgkmcnt(3)
DR4 a[252:255],v5 offset:29696
EXP v89,v89
FAD v245,v245,v87
M32 a[0:15],a[224:227],v[20:23],a[0:15]
DR4 a[192:195],v5 offset:2048
buffer_load_dwordx4 v6, s[16:19], s60 offen offset:2048 lds
CVT v83,v86,v87
EXP v90,v90
M32 a[0:15],a[228:231],v[52:55],a[0:15]
DR4 a[196:199],v5 offset:18432
FAD v244,v244,v88
EXP v91,v91
FAD v245,v245,v89
M32 a[16:31],a[232:235],v[20:23],a[16:31]
DR4 a[200:203],v5 offset:6144
CVT v84,v88,v89
EXP v92,v92
FAD v244,v244,v90
M32 a[16:31],a[236:239],v[52:55],a[16:31]
s_waitcnt lgkmcnt(3)
DR4 a[204:207],v5 offset:22528
buffer_load_dwordx4 v6, s[16:19], s60 offen offset:3072 lds
s_add_u32 s60, s60, 32768
EXP v93,v93
M32 a[32:47],a[240:243],v[20:23],a[32:47]
DR4 a[208:211],v5 offset:10240
FAD v245,v245,v91
CVT v85,v90,v91
EXP v94,v94
FAD v244,v244,v92
M32 a[32:47],a[244:247],v[52:55],a[32:47]
DR4 a[212:215],v5 offset:26624
EXP v95,v95
FAD v245,v245,v93
CVT v86,v92,v93
M32 a[48:63],a[248:251],v[20:23],a[48:63]
DR4 a[216:219],v5 offset:14336
s_add_u32 m0, s58, 49152
s_nop 0
buffer_load_dwordx4 v6, s[16:19], s60 offen offset:0 lds
EXP v112,v112
M32 a[48:63],a[252:255],v[52:55],a[48:63]
s_waitcnt lgkmcnt(3)
DR4 a[220:223],v5 offset:30720
FAD v244,v244,v94
EXP v113,v113
FAD v245,v245,v95
CVT v87,v94,v95
M32 a[0:15],a[192:195],v[24:27],a[0:15]
DR4 a[224:227],v5 offset:3072
EXP v114,v114
FAD v246,v112,v113
EXP v115,v115
M32 a[0:15],a[196:199],v[56:59],a[0:15]
DR4 a[228:231],v5 offset:19456
buffer_load_dwordx4 v6, s[16:19], s60 offen offset:1024 lds
CVT v112,v112,v113
EXP v116,v116
M32 a[16:31],a[200:203],v[24:27],a[16:31]
DR4 a[232:235],v5 offset:7168
FAD v247,v114,v115
EXP v117,v117
M32 a[16:31],a[204:207],v[56:59],a[16:31]
s_waitcnt lgkmcnt(3)
DR4 a[236:239],v5 offset:23552
CVT v113,v114,v115
EXP v118,v118
M32 a[32:47],a[208:211],v[24:27],a[32:47]
DR4 a[240:243],v5 offset:11264
buffer_load_dwordx4 v6, s[16:19], s60 offen offset:2048 lds
FAD v246,v246,v116
EXP v119,v119
M32 a[32:47],a[212:215],v[56:59],a[32:47]
DR4 a[244:247],v5 offset:27648
FAD v247,v247,v117
CVT v114,v116,v117
EXP v120,v120
FAD v246,v246,v118
M32 a[48:63],a[216:219],v[24:27],a[48:63]
DR4 a[248:251],v5 offset:15360
EXP v121,v121
FAD v247,v247,v119
M32 a[48:63],a[220:223],v[56:59],a[48:63]
s_waitcnt lgkmcnt(3)
DR4 a[252:255],v5 offset:31744
buffer_load_dwordx4 v6, s[16:19], s60 offen offset:3072 lds
s_add_u32 s60, s60, 32768
CVT v115,v118,v119
M32 a[0:15],a[224:227],v[28:31],a[0:15]
EXP v122,v122
FAD v246,v246,v120
EXP v123,v123
FAD v247,v247,v121
M32 a[0:15],a[228:231],v[60:63],a[0:15]
CVT v116,v120,v121
EXP v124,v124
FAD v246,v246,v122
M32 a[16:31],a[232:235],v[28:31],a[16:31]
s_waitcnt lgkmcnt(0)
s_waitcnt vmcnt(17)
s_barrier
DR4 a[192:195],v4 offset:0
DR4 a[196:199],v4 offset:16384
EXP v125,v125
FAD v247,v247,v123
M32 a[16:31],a[236:239],v[60:63],a[16:31]
DR4 a[200:203],v4 offset:1024
DR4 a[204:207],v4 offset:17408
CVT v117,v122,v123
EXP v126,v126
FAD v246,v246,v124
M32 a[32:47],a[240:243],v[28:31],a[32:47]
DR4 a[208:211],v4 offset:2048
EXP v127,v127
FAD v247,v247,v125
CVT v118,v124,v125
M32 a[32:47],a[244:247],v[60:63],a[32:47]
DR4 a[212:215],v4 offset:18432
DR4 a[216:219],v4 offset:3072
EXP v96,v96
FAD v246,v246,v126
M32 a[48:63],a[248:251],v[28:31],a[48:63]
DR4 a[220:223],v4 offset:19456
EXP v97,v97
FAD v247,v247,v127
CVT v119,v126,v127
M32 a[48:63],a[252:255],v[60:63],a[48:63]
s_waitcnt lgkmcnt(4)
EXP v98,v98
FAD v244,v244,v96
M32 v[16:31],a[192:195],v[176:179],v[144:159]
DR4 a[224:227],v4 offset:4096
EXP v99,v99
FAD v245,v245,v97
CVT v88,v96,v97
M32 v[48:63],a[196:199],v[176:179],v[144:159]
DR4 a[228:231],v4 offset:20480
EXP v100,v100
FAD v244,v244,v98
M32 v[16:31],a[200:203],v[180:183],v[16:31]
DR4 a[232:235],v4 offset:5120
s_waitcnt vmcnt(16)
buffer_load_dword a128, v15, s[28:31], s55 offen
s_add_u32 s55, s55, 2048
EXP v101,v101
M32 v[48:63],a[204:207],v[180:183],v[48:63]
s_waitcnt lgkmcnt(3)
DR4 a[236:239],v4 offset:21504
FAD v245,v245,v99
CVT v89,v98,v99
EXP v102,v102
FAD v244,v244,v100
M32 v[16:31],a[208:211],v[184:187],v[16:31]
DR4 a[240:243],v4 offset:6144
s_cmp_ge_u32 s34, 4
s_cselect_b32 s55, 0x1000000, s55
EXP v103,v103
FAD v245,v245,v101
M32 v[48:63],a[212:215],v[184:187],v[48:63]
DR4 a[244:247],v4 offset:22528
CVT v90,v100,v101
EXP v104,v104
FAD v244,v244,v102
M32 v[16:31],a[216:219],v[188:191],v[16:31]
DR4 a[248:251],v4 offset:7168
s_add_u32 m0, s58, 65536
s_nop 0
buffer_load_dwordx4 v6, s[16:19], s61 offen offset:0 lds
EXP v105,v105
M32 v[48:63],a[220:223],v[188:191],v[48:63]
s_waitcnt lgkmcnt(3)
DR4 a[252:255],v4 offset:23552
FAD v245,v245,v103
CVT v91,v102,v103
EXP v106,v106
FAD v244,v244,v104
M32 v[16:31],a[224:227],v[192:195],v[16:31]
DR4 a[192:195],v4 offset:8192
EXP v107,v107
FAD v245,v245,v105
M32 v[48:63],a[228:231],v[192:195],v[48:63]
DR4 a[196:199],v4 offset:24576
buffer_load_dwordx4 v6, s[16:19], s61 offen offset:1024 lds
CVT v92,v104,v105
EXP v108,v108
M32 v[16:31],a[232:235],v[196:199],v[16:31]
DR4 a[200:203],v4 offset:9216
FAD v244,v244,v106
EXP v109,v109
FAD v245,v245,v107
M32 v[48:63],a[236:239],v[196:199],v[48:63]
s_waitcnt lgkmcnt(3)
DR4 a[204:207],v4 offset:25600
buffer_load_dwordx4 v6, s[16:19], s61 offen offset:2048 lds
CVT v93,v106,v107
EXP v110,v110
M32 v[16:31],a[240:243],v[200:203],v[16:31]
DR4 a[208:211],v4 offset:10240
FAD v244,v244,v108
EXP v111,v111
FAD v245,v245,v109
M32 v[48:63],a[244:247],v[200:203],v[48:63]
DR4 a[212:215],v4 offset:26624
CVT v94,v108,v109
EXP v128,v128
M32 v[16:31],a[248:251],v[204:207],v[16:31]
DR4 a[216:219],v4 offset:11264
buffer_load_dwordx4 v6, s[16:19], s61 offen offset:3072 lds
s_add_u32 s61, s61, 32768
FAD v244,v244,v110
M32 v[48:63],a[252:255],v[204:207],v[48:63]
s_waitcnt lgkmcnt(3)
DR4 a[220:223],v4 offset:27648
EXP v129,v129
FAD v245,v245,v111
CVT v95,v110,v111
M32 v[32:47],a[192:195],v[176:179],v[144:159]
DR4 a[224:227],v4 offset:12288
s_add_u32 m0, s58, 81920
s_nop 0
buffer_load_dwordx4 v6, s[16:19], s61 offen offset:0 lds
EXP v130,v130
M32 v[64:79],a[196:199],v[176:179],v[144:159]
DR4 a[228:231],v4 offset:28672
FAD v246,v246,v128
EXP v131,v131
FAD v247,v247,v129
CVT v120,v128,v129
M32 v[32:47],a[200:203],v[180:183],v[32:47]
DR4 a[232:235],v4 offset:13312
buffer_load_dwordx4 v6, s[16:19], s61 offen offset:1024 lds
EXP v132,v132
FAD v246,v246,v130
M32 v[64:79],a[204:207],v[180:183],v[64:79]
s_waitcnt lgkmcnt(3)
DR4 a[236:239],v4 offset:29696
EXP v133,v133
FAD v247,v247,v131
CVT v121,v130,v131
M32 v[32:47],a[208:211],v[184:187],v[32:47]
DR4 a[240:243],v4 offset:14336
EXP v134,v134
FAD v246,v246,v132
EXP v135,v135
M32 v[64:79],a[212:215],v[184:187],v[64:79]
DR4 a[244:247],v4 offset:30720
buffer_load_dwordx4 v6, s[16:19], s61 offen offset:2048 lds
FAD v247,v247,v133
CVT v122,v132,v133
M32 v[32:47],a[216:219],v[188:191],v[32:47]
DR4 a[248:251],v4 offset:15360
EXP v136,v136
FAD v246,v246,v134
EXP v137,v137
M32 v[64:79],a[220:223],v[188:191],v[64:79]
s_waitcnt lgkmcnt(3)
DR4 a[252:255],v4 offset:31744
buffer_load_dwordx4 v6, s[16:19], s61 offen offset:3072 lds
s_add_u32 s61, s61, 32768
FAD v247,v247,v135
CVT v123,v134,v135
M32 v[32:47],a[224:227],v[192:195],v[32:47]
EXP v138,v138
FAD v246,v246,v136
EXP v139,v139
M32 v[64:79],a[228:231],v[192:195],v[64:79]
FAD v247,v247,v137
CVT v124,v136,v137
EXP v140,v140
M32 v[32:47],a[232:235],v[196:199],v[32:47]
s_waitcnt lgkmcnt(0)
s_waitcnt vmcnt(17)
s_barrier
DR4 a[192:195],v5 offset:32768
DR4 a[196:199],v5 offset:49152
FAD v246,v246,v138
EXP v141,v141
M32 v[64:79],a[236:239],v[196:199],v[64:79]
DR4 a[200:203],v5 offset:36864
DR4 a[204:207],v5 offset:53248
FAD v247,v247,v139
CVT v125,v138,v139
EXP v142,v142
M32 v[32:47],a[240:243],v[200:203],v[32:47]
DR4 a[208:211],v5 offset:40960
FAD v246,v246,v140
EXP v143,v143
M32 v[64:79],a[244:247],v[200:203],v[64:79]
DR4 a[212:215],v5 offset:57344
DR4 a[216:219],v5 offset:45056
FAD v247,v247,v141
CVT v126,v140,v141
FAD v246,v246,v142
M32 v[32:47],a[248:251],v[204:207],v[32:47]
DR4 a[220:223],v5 offset:61440
FAD v247,v247,v143
CVT v127,v142,v143
FAD v244,v244,v245
M32 v[64:79],a[252:255],v[204:207],v[64:79]
s_waitcnt lgkmcnt(4)
FAD v246,v246,v247
v_max_f32 v251, v244, v246
v_cmp_nle_f32 vcc, v251, v255
s_waitcnt lgkmcnt(0)
s_cbranch_vccnz L_F1_rare
L_F1_back:
FAD v242,v242,v244
FAD v242,v242,v246
s_add_u32 s59, s59, 65536
s_cmp_eq_u32 s64, 0
s_cbranch_scc1 L_G
s_sub_u32 s64, s64, 1
L_F0:
M32 a[0:15],a[192:195],v[80:83],a[0:15]
DR4 a[224:227],v5 offset:33792
EXP v16,v16
EXP v17,v17
M32 a[0:15],a[196:199],v[112:115],a[0:15]
DR4 a[228:231],v5 offset:50176
EXP v18,v18
FAD v244,v16,v17
EXP v19,v19
M32 a[16:31],a[200:203],v[80:83],a[16:31]
DR4 a[232:235],v5 offset:37888
s_add_u32 m0, s58, 0
s_nop 0
buffer_load_dwordx4 v6, s[16:19], s60 offen offset:0 lds
CVT v16,v16,v17
M32 a[16:31],a[204:207],v[112:115],a[16:31]
DR4 a[236:239],v5 offset:54272
EXP v20,v20
FAD v245,v18,v19
EXP v21,v21
M32 a[32:47],a[208:211],v[80:83],a[32:47]
DR4 a[240:243],v5 offset:41984
CVT v17,v18,v19
EXP v22,v22
M32 a[32:47],a[212:215],v[112:115],a[32:47]
DR4 a[244:247],v5 offset:58368
buffer_load_dwordx4 v6, s[16:19], s60 offen offset:1024 lds
FAD v244,v244,v20
EXP v23,v23
M32 a[48:63],a[216:219],v[80:83],a[48:63]
DR4 a[248:251],v5 offset:46080
FAD v245,v245,v21
CVT v18,v20,v21
EXP v24,v24
FAD v244,v244,v22
M32 a[48:63],a[220:223],v[112:115],a[48:63]
s_waitcnt lgkmcnt(3)
DR4 a[252:255],v5 offset:62464
EXP v25,v25
FAD v245,v245,v23
M32 a[0:15],a[224:227],v[84:87],a[0:15]
DR4 a[192:195],v5 offset:34816
buffer_load_dwordx4 v6, s[16:19], s60 offen offset:2048 lds
CVT v19,v22,v23
EXP v26,v26
M32 a[0:15],a[228:231],v[116:119],a[0:15]
DR4 a[196:199],v5 offset:51200
FAD v244,v244,v24
EXP v27,v27
FAD v245,v245,v25
M32 a[16:31],a[232:235],v[84:87],a[16:31]
DR4 a[200:203],v5 offset:38912
CVT v20,v24,v25
EXP v28,v28
FAD v244,v244,v26
M32 a[16:31],a[236:239],v[116:119],a[16:31]
s_waitcnt lgkmcnt(3)
DR4 a[204:207],v5 offset:55296
buffer_load_dwordx4 v6, s[16:19], s60 offen offset:3072 lds
s_add_u32 s60, s60, 32768
EXP v29,v29
M32 a[32:47],a[240:243],v[84:87],a[32:47]
DR4 a[208:211],v5 offset:43008
FAD v245,v245,v27
CVT v21,v26,v27
EXP v30,v30
FAD v244,v244,v28
M32 a[32:47],a[244:247],v[116:119],a[32:47]
DR4 a[212:215],v5 offset:59392
EXP v31,v31
FAD v245,v245,v29
CVT v22,v28,v29
M32 a[48:63],a[248:251],v[84:87],a[48:63]
DR4 a[216:219],v5 offset:47104
s_add_u32 m0, s58, 16384
s_nop 0
buffer_load_dwordx4 v6, s[16:19], s60 offen offset:0 lds
EXP v48,v48
M32 a[48:63],a[252:255],v[116:119],a[48:63]
s_waitcnt lgkmcnt(3)
DR4 a[220:223],v5 offset:63488
FAD v244,v244,v30
EXP v49,v49
FAD v245,v245,v31
CVT v23,v30,v31
M32 a[0:15],a[192:195],v[88:91],a[0:15]
DR4 a[224:227],v5 offset:35840
EXP v50,v50
FAD v246,v48,v49
EXP v51,v51
M32 a[0:15],a[196:199],v[120:123],a[0:15]
DR4 a[228:231],v5 offset:52224
buffer_load_dwordx4 v6, s[16:19], s60 offen offset:1024 lds
CVT v48,v48,v49
EXP v52,v52
M32 a[16:31],a[200:203],v[88:91],a[16:31]
DR4 a[232:235],v5 offset:39936
FAD v247,v50,v51
EXP v53,v53
M32 a[16:31],a[204:207],v[120:123],a[16:31]
s_waitcnt lgkmcnt(3)
DR4 a[236:239],v5 offset:56320
CVT v49,v50,v51
EXP v54,v54
M32 a[32:47],a[208:211],v[88:91],a[32:47]
DR4 a[240:243],v5 offset:44032
buffer_load_dwordx4 v6, s[16:19], s60 offen offset:2048 lds
FAD v246,v246,v52
EXP v55,v55
M32 a[32:47],a[212:215],v[120:123],a[32:47]
DR4 a[244:247],v5 offset:60416
FAD v247,v247,v53
CVT v50,v52,v53
EXP v56,v56
FAD v246,v246,v54
M32 a[48:63],a[216:219],v[88:91],a[48:63]
DR4 a[248:251],v5 offset:48128
EXP v57,v57
FAD v247,v247,v55
M32 a[48:63],a[220:223],v[120:123],a[48:63]
s_waitcnt lgkmcnt(3)
DR4 a[252:255],v5 offset:64512
buffer_load_dwordx4 v6, s[16:19], s60 offen offset:3072 lds
s_add_u32 s60, s60, 32768
CVT v51,v54,v55
M32 a[0:15],a[224:227],v[92:95],a[0:15]
EXP v58,v58
FAD v246,v246,v56
EXP v59,v59
FAD v247,v247,v57
M32 a[0:15],a[228:231],v[124:127],a[0:15]
CVT v52,v56,v57
EXP v60,v60
FAD v246,v246,v58
M32 a[16:31],a[232:235],v[92:95],a[16:31]
s_waitcnt lgkmcnt(0)
s_waitcnt vmcnt(17)
s_barrier
DR4 a[192:195],v4 offset:32768
DR4 a[196:199],v4 offset:49152
EXP v61,v61
FAD v247,v247,v59
M32 a[16:31],a[236:239],v[124:127],a[16:31]
DR4 a[200:203],v4 offset:33792
DR4 a[204:207],v4 offset:50176
CVT v53,v58,v59
EXP v62,v62
FAD v246,v246,v60
M32 a[32:47],a[240:243],v[92:95],a[32:47]
DR4 a[208:211],v4 offset:34816
EXP v63,v63
FAD v247,v247,v61
CVT v54,v60,v61
M32 a[32:47],a[244:247],v[124:127],a[32:47]
DR4 a[212:215],v4 offset:51200
DR4 a[216:219],v4 offset:35840
EXP v32,v32
FAD v246,v246,v62
M32 a[48:63],a[248:251],v[92:95],a[48:63]
DR4 a[220:223],v4 offset:52224
EXP v33,v33
FAD v247,v247,v63
CVT v55,v62,v63
M32 a[48:63],a[252:255],v[124:127],a[48:63]
s_waitcnt lgkmcnt(4)
EXP v34,v34
FAD v244,v244,v32
M32 v[80:95],a[192:195],v[176:179],v[144:159]
DR4 a[224:227],v4 offset:36864
EXP v35,v35
FAD v245,v245,v33
CVT v24,v32,v33
M32 v[112:127],a[196:199],v[176:179],v[144:159]
DR4 a[228:231],v4 offset:53248
EXP v36,v36
FAD v244,v244,v34
M32 v[80:95],a[200:203],v[180:183],v[80:95]
DR4 a[232:235],v4 offset:37888
s_waitcnt vmcnt(16)
buffer_load_dword a128, v15, s[24:27], s54 offen
s_add_u32 s54, s54, 2048
EXP v37,v37
M32 v[112:127],a[204:207],v[180:183],v[112:127]
s_waitcnt lgkmcnt(3)
DR4 a[236:239],v4 offset:54272
FAD v245,v245,v35
CVT v25,v34,v35
EXP v38,v38
FAD v244,v244,v36
M32 v[80:95],a[208:211],v[184:187],v[80:95]
DR4 a[240:243],v4 offset:38912
s_add_u32 s34, s34, 1
s_cmp_eq_u32 s34, 4
s_cselect_b32 s24, s32, s24
s_cselect_b32 s25, s33, s25
s_cselect_b32 s26, s30, s26
s_cselect_b32 s54, s35, s54
M32 v[112:127],a[212:215],v[184:187],v[112:127]
DR4 a[244:247],v4 offset:55296
EXP v39,v39
FAD v245,v245,v37
CVT v26,v36,v37
M32 v[80:95],a[216:219],v[188:191],v[80:95]
DR4 a[248:251],v4 offset:39936
s_add_u32 m0, s58, 98304
s_nop 0
buffer_load_dwordx4 v6, s[16:19], s61 offen offset:0 lds
EXP v40,v40
M32 v[112:127],a[220:223],v[188:191],v[112:127]
s_waitcnt lgkmcnt(3)
DR4 a[252:255],v4 offset:56320
FAD v244,v244,v38
EXP v41,v41
FAD v245,v245,v39
CVT v27,v38,v39
M32 v[80:95],a[224:227],v[192:195],v[80:95]
DR4 a[192:195],v4 offset:40960
EXP v42,v42
FAD v244,v244,v40
EXP v43,v43
M32 v[112:127],a[228:231],v[192:195],v[112:127]
DR4 a[196:199],v4 offset:57344
buffer_load_dwordx4 v6, s[16:19], s61 offen offset:1024 lds
FAD v245,v245,v41
CVT v28,v40,v41
M32 v[80:95],a[232:235],v[196:199],v[80:95]
DR4 a[200:203],v4 offset:41984
EXP v44,v44
FAD v244,v244,v42
EXP v45,v45
M32 v[112:127],a[236:239],v[196:199],v[112:127]
s_waitcnt lgkmcnt(3)
DR4 a[204:207],v4 offset:58368
buffer_load_dwordx4 v6, s[16:19], s61 offen offset:2048 lds
FAD v245,v245,v43
CVT v29,v42,v43
M32 v[80:95],a[240:243],v[200:203],v[80:95]
DR4 a[208:211],v4 offset:43008
EXP v46,v46
FAD v244,v244,v44
EXP v47,v47
M32 v[112:127],a[244:247],v[200:203],v[112:127]
DR4 a[212:215],v4 offset:59392
FAD v245,v245,v45
CVT v30,v44,v45
EXP v64,v64
M32 v[80:95],a[248:251],v[204:207],v[80:95]
DR4 a[216:219],v4 offset:44032
buffer_load_dwordx4 v6, s[16:19], s61 offen offset:3072 lds
s_add_u32 s61, s61, 32768
FAD v244,v244,v46
M32 v[112:127],a[252:255],v[204:207],v[112:127]
s_waitcnt lgkmcnt(3)
DR4 a[220:223],v4 offset:60416
EXP v65,v65
FAD v245,v245,v47
CVT v31,v46,v47
M32 v[96:111],a[192:195],v[176:179],v[144:159]
DR4 a[224:227],v4 offset:45056
s_add_u32 m0, s58, 114688
s_nop 0
buffer_load_dwordx4 v6, s[16:19], s61 offen offset:0 lds
EXP v66,v66
M32 v[128:143],a[196:199],v[176:179],v[144:159]
DR4 a[228:231],v4 offset:61440
FAD v246,v246,v64
EXP v67,v67
FAD v247,v247,v65
CVT v56,v64,v65
M32 v[96:111],a[200:203],v[180:183],v[96:111]
DR4 a[232:235],v4 offset:46080
buffer_load_dwordx4 v6, s[16:19], s61 offen offset:1024 lds
EXP v68,v68
FAD v246,v246,v66
M32 v[128:143],a[204:207],v[180:183],v[128:143]
s_waitcnt lgkmcnt(3)
DR4 a[236:239],v4 offset:62464
EXP v69,v69
FAD v247,v247,v67
CVT v57,v66,v67
M32 v[96:111],a[208:211],v[184:187],v[96:111]
DR4 a[240:243],v4 offset:47104
EXP v70,v70
FAD v246,v246,v68
EXP v71,v71
M32 v[128:143],a[212:215],v[184:187],v[128:143]
DR4 a[244:247],v4 offset:63488
buffer_load_dwordx4 v6, s[16:19], s61 offen offset:2048 lds
FAD v247,v247,v69
CVT v58,v68,v69
M32 v[96:111],a[216:219],v[188:191],v[96:111]
DR4 a[248:251],v4 offset:48128
EXP v72,v72
FAD v246,v246,v70
EXP v73,v73
M32 v[128:143],a[220:223],v[188:191],v[128:143]
s_waitcnt lgkmcnt(3)
DR4 a[252:255],v4 offset:64512
buffer_load_dwordx4 v6, s[16:19], s61 offen offset:3072 lds
s_add_u32 s61, s61, 32768
FAD v247,v247,v71
CVT v59,v70,v71
M32 v[96:111],a[224:227],v[192:195],v[96:111]
EXP v74,v74
FAD v246,v246,v72
EXP v75,v75
M32 v[128:143],a[228:231],v[192:195],v[128:143]
FAD v247,v247,v73
CVT v60,v72,v73
EXP v76,v76
M32 v[96:111],a[232:235],v[196:199],v[96:111]
s_waitcnt lgkmcnt(0)
s_waitcnt vmcnt(17)
s_barrier
DR4 a[192:195],v5 offset:0
DR4 a[196:199],v5 offset:16384
FAD v246,v246,v74
EXP v77,v77
M32 v[128:143],a[236:239],v[196:199],v[128:143]
DR4 a[200:203],v5 offset:4096
DR4 a[204:207],v5 offset:20480
FAD v247,v247,v75
CVT v61,v74,v75
EXP v78,v78
M32 v[96:111],a[240:243],v[200:203],v[96:111]
DR4 a[208:211],v5 offset:8192
FAD v246,v246,v76
EXP v79,v79
M32 v[128:143],a[244:247],v[200:203],v[128:143]
DR4 a[212:215],v5 offset:24576
DR4 a[216:219],v5 offset:12288
FAD v247,v247,v77
CVT v62,v76,v77
FAD v246,v246,v78
M32 v[96:111],a[248:251],v[204:207],v[96:111]
DR4 a[220:223],v5 offset:28672
FAD v247,v247,v79
CVT v63,v78,v79
FAD v244,v244,v245
M32 v[128:143],a[252:255],v[204:207],v[128:143]
s_waitcnt lgkmcnt(4)
FAD v246,v246,v247
v_max_f32 v251, v244, v246
v_cmp_nle_f32 vcc, v251, v255
s_waitcnt lgkmcnt(0)
s_cbranch_vccnz L_F0_rare
L_F0_back:
FAD v242,v242,v244
FAD v242,v242,v246
s_add_u32 s59, s59, 65536
s_branch L_F1
L_Gp:
M32 a[0:15],a[192:195],v[80:83],a[0:15]
DR4 a[208:211],v5 offset:33792
v_cmp_le_i32 s[36:37], 0, v248
v_cmp_le_i32 s[38:39], 1, v248
v_cmp_le_i32 s[40:41], 2, v248
v_cmp_le_i32 s[42:43], 3, v248
CND v16,v250,v16,s[36:37]
M32 a[64:79],a[192:195],v[112:115],a[64:79]
CND v17,v250,v17,s[38:39]
CND v18,v250,v18,s[40:41]
CND v19,v250,v19,s[42:43]
v_cmp_le_i32 s[36:37], 16, v248
v_cmp_le_i32 s[38:39], 17, v248
v_cmp_le_i32 s[40:41], 18, v248
M32 a[16:31],a[196:199],v[80:83],a[16:31]
DR4 a[212:215],v5 offset:37888
v_cmp_le_i32 s[42:43], 19, v248
CND v20,v250,v20,s[36:37]
CND v21,v250,v21,s[38:39]
CND v22,v250,v22,s[40:41]
CND v23,v250,v23,s[42:43]
M32 a[80:95],a[196:199],v[112:115],a[80:95]
v_cmp_le_i32 s[36:37], 8, v248
v_cmp_le_i32 s[38:39], 9, v248
v_cmp_le_i32 s[40:41], 10, v248
v_cmp_le_i32 s[42:43], 11, v248
CND v24,v250,v24,s[36:37]
CND v25,v250,v25,s[38:39]
M32 a[32:47],a[200:203],v[80:83],a[32:47]
DR4 a[216:219],v5 offset:41984
CND v26,v250,v26,s[40:41]
CND v27,v250,v27,s[42:43]
v_cmp_le_i32 s[36:37], 24, v248
v_cmp_le_i32 s[38:39], 25, v248
v_cmp_le_i32 s[40:41], 26, v248
M32 a[96:111],a[200:203],v[112:115],a[96:111]
v_cmp_le_i32 s[42:43], 27, v248
CND v28,v250,v28,s[36:37]
CND v29,v250,v29,s[38:39]
CND v30,v250,v30,s[40:41]
CND v31,v250,v31,s[42:43]
M32 a[48:63],a[204:207],v[80:83],a[48:63]
DR4 a[220:223],v5 offset:46080
EXP v16,v16
EXP v17,v17
M32 a[112:127],a[204:207],v[112:115],a[112:127]
s_waitcnt lgkmcnt(2)
EXP v18,v18
FAD v244,v16,v17
EXP v19,v19
CVT v16,v16,v17
M32 a[0:15],a[208:211],v[84:87],a[0:15]
DR4 a[224:227],v5 offset:34816
EXP v20,v20
FAD v245,v18,v19
EXP v21,v21
M32 a[64:79],a[208:211],v[116:119],a[64:79]
CVT v17,v18,v19
EXP v22,v22
FAD v244,v244,v20
EXP v23,v23
M32 a[16:31],a[212:215],v[84:87],a[16:31]
DR4 a[228:231],v5 offset:38912
FAD v245,v245,v21
CVT v18,v20,v21
EXP v24,v24
FAD v244,v244,v22
M32 a[80:95],a[212:215],v[116:119],a[80:95]
s_waitcnt lgkmcnt(2)
EXP v25,v25
FAD v245,v245,v23
CVT v19,v22,v23
EXP v26,v26
M32 a[32:47],a[216:219],v[84:87],a[32:47]
DR4 a[232:235],v5 offset:43008
FAD v244,v244,v24
EXP v27,v27
FAD v245,v245,v25
CVT v20,v24,v25
M32 a[96:111],a[216:219],v[116:119],a[96:111]
EXP v28,v28
FAD v244,v244,v26
EXP v29,v29
FAD v245,v245,v27
M32 a[48:63],a[220:223],v[84:87],a[48:63]
DR4 a[236:239],v5 offset:47104
CVT v21,v26,v27
EXP v30,v30
FAD v244,v244,v28
M32 a[112:127],a[220:223],v[116:119],a[112:127]
s_waitcnt lgkmcnt(2)
EXP v31,v31
FAD v245,v245,v29
CVT v22,v28,v29
v_cmp_le_i32 s[36:37], 0, v249
v_cmp_le_i32 s[38:39], 1, v249
M32 a[0:15],a[224:227],v[88:91],a[0:15]
DR4 a[240:243],v5 offset:35840
v_cmp_le_i32 s[40:41], 2, v249
v_cmp_le_i32 s[42:43], 3, v249
CND v48,v250,v48,s[36:37]
CND v49,v250,v49,s[38:39]
CND v50,v250,v50,s[40:41]
M32 a[64:79],a[224:227],v[120:123],a[64:79]
CND v51,v250,v51,s[42:43]
v_cmp_le_i32 s[36:37], 16, v249
v_cmp_le_i32 s[38:39], 17, v249
v_cmp_le_i32 s[40:41], 18, v249
v_cmp_le_i32 s[42:43], 19, v249
CND v52,v250,v52,s[36:37]
M32 a[16:31],a[228:231],v[88:91],a[16:31]
DR4 a[244:247],v5 offset:39936
CND v53,v250,v53,s[38:39]
CND v54,v250,v54,s[40:41]
CND v55,v250,v55,s[42:43]
v_cmp_le_i32 s[36:37], 8, v249
v_cmp_le_i32 s[38:39], 9, v249
M32 a[80:95],a[228:231],v[120:123],a[80:95]
s_waitcnt lgkmcnt(2)
v_cmp_le_i32 s[40:41], 10, v249
v_cmp_le_i32 s[42:43], 11, v249
CND v56,v250,v56,s[36:37]
CND v57,v250,v57,s[38:39]
CND v58,v250,v58,s[40:41]
CND v59,v250,v59,s[42:43]
M32 a[32:47],a[232:235],v[88:91],a[32:47]
DR4 a[248:251],v5 offset:44032
v_cmp_le_i32 s[36:37], 24, v249
v_cmp_le_i32 s[38:39], 25, v249
v_cmp_le_i32 s[40:41], 26, v249
v_cmp_le_i32 s[42:43], 27, v249
CND v60,v250,v60,s[36:37]
M32 a[96:111],a[232:235],v[120:123],a[96:111]
CND v61,v250,v61,s[38:39]
CND v62,v250,v62,s[40:41]
CND v63,v250,v63,s[42:43]
EXP v48,v48
FAD v244,v244,v30
M32 a[48:63],a[236:239],v[88:91],a[48:63]
DR4 a[252:255],v5 offset:48128
EXP v49,v49
FAD v245,v245,v31
CVT v23,v30,v31
M32 a[112:127],a[236:239],v[120:123],a[112:127]
s_waitcnt lgkmcnt(2)
EXP v50,v50
FAD v246,v48,v49
EXP v51,v51
CVT v48,v48,v49
M32 a[0:15],a[240:243],v[92:95],a[0:15]
EXP v52,v52
FAD v247,v50,v51
EXP v53,v53
CVT v49,v50,v51
M32 a[64:79],a[240:243],v[124:127],a[64:79]
EXP v54,v54
FAD v246,v246,v52
EXP v55,v55
FAD v247,v247,v53
M32 a[16:31],a[244:247],v[92:95],a[16:31]
s_waitcnt lgkmcnt(0)
s_waitcnt vmcnt(0)
s_barrier
DR4 a[192:195],v5 offset:0
DR4 a[196:199],v5 offset:16384
CVT v50,v52,v53
EXP v56,v56
M32 a[80:95],a[244:247],v[124:127],a[80:95]
DR4 a[200:203],v5 offset:4096
DR4 a[204:207],v5 offset:20480
FAD v246,v246,v54
EXP v57,v57
FAD v247,v247,v55
M32 a[32:47],a[248:251],v[92:95],a[32:47]
DR4 a[208:211],v5 offset:8192
CVT v51,v54,v55
EXP v58,v58
FAD v246,v246,v56
M32 a[96:111],a[248:251],v[124:127],a[96:111]
DR4 a[212:215],v5 offset:24576
DR4 a[216:219],v5 offset:12288
EXP v59,v59
FAD v247,v247,v57
CVT v52,v56,v57
M32 a[48:63],a[252:255],v[92:95],a[48:63]
DR4 a[220:223],v5 offset:28672
EXP v60,v60
FAD v246,v246,v58
EXP v61,v61
M32 a[112:127],a[252:255],v[124:127],a[112:127]
s_waitcnt lgkmcnt(4)
FAD v247,v247,v59
CVT v53,v58,v59
EXP v62,v62
FAD v246,v246,v60
EXP v63,v63
FAD v247,v247,v61
CVT v54,v60,v61
v_cmp_le_i32 s[36:37], 32, v248
v_cmp_le_i32 s[38:39], 33, v248
v_cmp_le_i32 s[40:41], 34, v248
v_cmp_le_i32 s[42:43], 35, v248
CND v32,v250,v32,s[36:37]
CND v33,v250,v33,s[38:39]
CND v34,v250,v34,s[40:41]
CND v35,v250,v35,s[42:43]
v_cmp_le_i32 s[36:37], 48, v248
v_cmp_le_i32 s[38:39], 49, v248
v_cmp_le_i32 s[40:41], 50, v248
v_cmp_le_i32 s[42:43], 51, v248
CND v36,v250,v36,s[36:37]
CND v37,v250,v37,s[38:39]
CND v38,v250,v38,s[40:41]
CND v39,v250,v39,s[42:43]
v_cmp_le_i32 s[36:37], 40, v248
v_cmp_le_i32 s[38:39], 41, v248
v_cmp_le_i32 s[40:41], 42, v248
v_cmp_le_i32 s[42:43], 43, v248
CND v40,v250,v40,s[36:37]
CND v41,v250,v41,s[38:39]
CND v42,v250,v42,s[40:41]
CND v43,v250,v43,s[42:43]
v_cmp_le_i32 s[36:37], 56, v248
v_cmp_le_i32 s[38:39], 57, v248
v_cmp_le_i32 s[40:41], 58, v248
v_cmp_le_i32 s[42:43], 59, v248
CND v44,v250,v44,s[36:37]
CND v45,v250,v45,s[38:39]
CND v46,v250,v46,s[40:41]
CND v47,v250,v47,s[42:43]
EXP v32,v32
FAD v246,v246,v62
EXP v33,v33
FAD v247,v247,v63
CVT v55,v62,v63
EXP v34,v34
FAD v244,v244,v32
EXP v35,v35
FAD v245,v245,v33
CVT v24,v32,v33
EXP v36,v36
FAD v244,v244,v34
EXP v37,v37
FAD v245,v245,v35
CVT v25,v34,v35
EXP v38,v38
FAD v244,v244,v36
EXP v39,v39
FAD v245,v245,v37
CVT v26,v36,v37
EXP v40,v40
FAD v244,v244,v38
EXP v41,v41
FAD v245,v245,v39
CVT v27,v38,v39
EXP v42,v42
FAD v244,v244,v40
EXP v43,v43
FAD v245,v245,v41
CVT v28,v40,v41
EXP v44,v44
FAD v244,v244,v42
EXP v45,v45
FAD v245,v245,v43
CVT v29,v42,v43
EXP v46,v46
FAD v244,v244,v44
EXP v47,v47
FAD v245,v245,v45
CVT v30,v44,v45
v_cmp_le_i32 s[36:37], 32, v249
v_cmp_le_i32 s[38:39], 33, v249
v_cmp_le_i32 s[40:41], 34, v249
v_cmp_le_i32 s[42:43], 35, v249
CND v64,v250,v64,s[36:37]
CND v65,v250,v65,s[38:39]
CND v66,v250,v66,s[40:41]
CND v67,v250,v67,s[42:43]
v_cmp_le_i32 s[36:37], 48, v249
v_cmp_le_i32 s[38:39], 49, v249
v_cmp_le_i32 s[40:41], 50, v249
v_cmp_le_i32 s[42:43], 51, v249
CND v68,v250,v68,s[36:37]
CND v69,v250,v69,s[38:39]
CND v70,v250,v70,s[40:41]
CND v71,v250,v71,s[42:43]
v_cmp_le_i32 s[36:37], 40, v249
v_cmp_le_i32 s[38:39], 41, v249
v_cmp_le_i32 s[40:41], 42, v249
v_cmp_le_i32 s[42:43], 43, v249
CND v72,v250,v72,s[36:37]
CND v73,v250,v73,s[38:39]
CND v74,v250,v74,s[40:41]
CND v75,v250,v75,s[42:43]
v_cmp_le_i32 s[36:37], 56, v249
v_cmp_le_i32 s[38:39], 57, v249
v_cmp_le_i32 s[40:41], 58, v249
v_cmp_le_i32 s[42:43], 59, v249
CND v76,v250,v76,s[36:37]
CND v77,v250,v77,s[38:39]
CND v78,v250,v78,s[40:41]
CND v79,v250,v79,s[42:43]
EXP v64,v64
FAD v244,v244,v46
EXP v65,v65
FAD v245,v245,v47
CVT v31,v46,v47
EXP v66,v66
FAD v246,v246,v64
EXP v67,v67
FAD v247,v247,v65
CVT v56,v64,v65
EXP v68,v68
FAD v246,v246,v66
EXP v69,v69
FAD v247,v247,v67
CVT v57,v66,v67
EXP v70,v70
FAD v246,v246,v68
EXP v71,v71
FAD v247,v247,v69
CVT v58,v68,v69
EXP v72,v72
FAD v246,v246,v70
EXP v73,v73
FAD v247,v247,v71
CVT v59,v70,v71
EXP v74,v74
FAD v246,v246,v72
EXP v75,v75
FAD v247,v247,v73
CVT v60,v72,v73
EXP v76,v76
FAD v246,v246,v74
EXP v77,v77
FAD v247,v247,v75
CVT v61,v74,v75
EXP v78,v78
FAD v246,v246,v76
EXP v79,v79
FAD v247,v247,v77
CVT v62,v76,v77
FAD v246,v246,v78
FAD v247,v247,v79
CVT v63,v78,v79
FAD v244,v244,v245
FAD v246,v246,v247
v_max_f32 v251, v244, v246
v_cmp_nle_f32 vcc, v251, v255
s_waitcnt lgkmcnt(0)
s_cbranch_vccnz L_Gp_rare
L_Gp_back:
FAD v242,v242,v244
FAD v242,v242,v246
s_add_u32 s59, s59, 65536
s_branch L_fin
L_G:
M32 a[0:15],a[192:195],v[80:83],a[0:15]
DR4 a[224:227],v5 offset:33792
v_cmp_le_i32 s[36:37], 0, v248
v_cmp_le_i32 s[38:39], 1, v248
v_cmp_le_i32 s[40:41], 2, v248
v_cmp_le_i32 s[42:43], 3, v248
CND v16,v250,v16,s[36:37]
M32 a[0:15],a[196:199],v[112:115],a[0:15]
DR4 a[228:231],v5 offset:50176
CND v17,v250,v17,s[38:39]
CND v18,v250,v18,s[40:41]
CND v19,v250,v19,s[42:43]
v_cmp_le_i32 s[36:37], 16, v248
v_cmp_le_i32 s[38:39], 17, v248
M32 a[16:31],a[200:203],v[80:83],a[16:31]
DR4 a[232:235],v5 offset:37888
v_cmp_le_i32 s[40:41], 18, v248
v_cmp_le_i32 s[42:43], 19, v248
CND v20,v250,v20,s[36:37]
CND v21,v250,v21,s[38:39]
CND v22,v250,v22,s[40:41]
M32 a[16:31],a[204:207],v[112:115],a[16:31]
DR4 a[236:239],v5 offset:54272
CND v23,v250,v23,s[42:43]
v_cmp_le_i32 s[36:37], 8, v248
v_cmp_le_i32 s[38:39], 9, v248
v_cmp_le_i32 s[40:41], 10, v248
v_cmp_le_i32 s[42:43], 11, v248
M32 a[32:47],a[208:211],v[80:83],a[32:47]
DR4 a[240:243],v5 offset:41984
CND v24,v250,v24,s[36:37]
CND v25,v250,v25,s[38:39]
CND v26,v250,v26,s[40:41]
CND v27,v250,v27,s[42:43]
v_cmp_le_i32 s[36:37], 24, v248
M32 a[32:47],a[212:215],v[112:115],a[32:47]
DR4 a[244:247],v5 offset:58368
v_cmp_le_i32 s[38:39], 25, v248
v_cmp_le_i32 s[40:41], 26, v248
v_cmp_le_i32 s[42:43], 27, v248
CND v28,v250,v28,s[36:37]
CND v29,v250,v29,s[38:39]
M32 a[48:63],a[216:219],v[80:83],a[48:63]
DR4 a[248:251],v5 offset:46080
CND v30,v250,v30,s[40:41]
CND v31,v250,v31,s[42:43]
EXP v16,v16
M32 a[48:63],a[220:223],v[112:115],a[48:63]
s_waitcnt lgkmcnt(3)
DR4 a[252:255],v5 offset:62464
EXP v17,v17
EXP v18,v18
FAD v244,v16,v17
M32 a[0:15],a[224:227],v[84:87],a[0:15]
DR4 a[192:195],v5 offset:34816
EXP v19,v19
CVT v16,v16,v17
EXP v20,v20
M32 a[0:15],a[228:231],v[116:119],a[0:15]
DR4 a[196:199],v5 offset:51200
FAD v245,v18,v19
EXP v21,v21
CVT v17,v18,v19
M32 a[16:31],a[232:235],v[84:87],a[16:31]
DR4 a[200:203],v5 offset:38912
EXP v22,v22
FAD v244,v244,v20
EXP v23,v23
M32 a[16:31],a[236:239],v[116:119],a[16:31]
s_waitcnt lgkmcnt(3)
DR4 a[204:207],v5 offset:55296
FAD v245,v245,v21
CVT v18,v20,v21
EXP v24,v24
FAD v244,v244,v22
M32 a[32:47],a[240:243],v[84:87],a[32:47]
DR4 a[208:211],v5 offset:43008
EXP v25,v25
FAD v245,v245,v23
CVT v19,v22,v23
M32 a[32:47],a[244:247],v[116:119],a[32:47]
DR4 a[212:215],v5 offset:59392
EXP v26,v26
FAD v244,v244,v24
EXP v27,v27
M32 a[48:63],a[248:251],v[84:87],a[48:63]
DR4 a[216:219],v5 offset:47104
FAD v245,v245,v25
CVT v20,v24,v25
EXP v28,v28
FAD v244,v244,v26
M32 a[48:63],a[252:255],v[116:119],a[48:63]
s_waitcnt lgkmcnt(3)
DR4 a[220:223],v5 offset:63488
EXP v29,v29
FAD v245,v245,v27
CVT v21,v26,v27
M32 a[0:15],a[192:195],v[88:91],a[0:15]
DR4 a[224:227],v5 offset:35840
EXP v30,v30
FAD v244,v244,v28
EXP v31,v31
M32 a[0:15],a[196:199],v[120:123],a[0:15]
DR4 a[228:231],v5 offset:52224
FAD v245,v245,v29
CVT v22,v28,v29
v_cmp_le_i32 s[36:37], 0, v249
v_cmp_le_i32 s[38:39], 1, v249
v_cmp_le_i32 s[40:41], 2, v249
M32 a[16:31],a[200:203],v[88:91],a[16:31]
DR4 a[232:235],v5 offset:39936
v_cmp_le_i32 s[42:43], 3, v249
CND v48,v250,v48,s[36:37]
CND v49,v250,v49,s[38:39]
CND v50,v250,v50,s[40:41]
CND v51,v250,v51,s[42:43]
M32 a[16:31],a[204:207],v[120:123],a[16:31]
s_waitcnt lgkmcnt(3)
DR4 a[236:239],v5 offset:56320
v_cmp_le_i32 s[36:37], 16, v249
v_cmp_le_i32 s[38:39], 17, v249
v_cmp_le_i32 s[40:41], 18, v249
v_cmp_le_i32 s[42:43], 19, v249
CND v52,v250,v52,s[36:37]
M32 a[32:47],a[208:211],v[88:91],a[32:47]
DR4 a[240:243],v5 offset:44032
CND v53,v250,v53,s[38:39]
CND v54,v250,v54,s[40:41]
CND v55,v250,v55,s[42:43]
v_cmp_le_i32 s[36:37], 8, v249
v_cmp_le_i32 s[38:39], 9, v249
M32 a[32:47],a[212:215],v[120:123],a[32:47]
DR4 a[244:247],v5 offset:60416
v_cmp_le_i32 s[40:41], 10, v249
v_cmp_le_i32 s[42:43], 11, v249
CND v56,v250,v56,s[36:37]
CND v57,v250,v57,s[38:39]
CND v58,v250,v58,s[40:41]
M32 a[48:63],a[216:219],v[88:91],a[48:63]
DR4 a[248:251],v5 offset:48128
CND v59,v250,v59,s[42:43]
v_cmp_le_i32 s[36:37], 24, v249
v_cmp_le_i32 s[38:39], 25, v249
v_cmp_le_i32 s[40:41], 26, v249
v_cmp_le_i32 s[42:43], 27, v249
M32 a[48:63],a[220:223],v[120:123],a[48:63]
s_waitcnt lgkmcnt(3)
DR4 a[252:255],v5 offset:64512
CND v60,v250,v60,s[36:37]
CND v61,v250,v61,s[38:39]
CND v62,v250,v62,s[40:41]
CND v63,v250,v63,s[42:43]
M32 a[0:15],a[224:227],v[92:95],a[0:15]
EXP v48,v48
FAD v244,v244,v30
EXP v49,v49
FAD v245,v245,v31
M32 a[0:15],a[228:231],v[124:127],a[0:15]
CVT v23,v30,v31
EXP v50,v50
FAD v246,v48,v49
EXP v51,v51
M32 a[16:31],a[232:235],v[92:95],a[16:31]
s_waitcnt lgkmcnt(0)
s_waitcnt vmcnt(0)
s_barrier
DR4 a[192:195],v5 offset:0
DR4 a[196:199],v5 offset:16384
CVT v48,v48,v49
EXP v52,v52
M32 a[16:31],a[236:239],v[124:127],a[16:31]
DR4 a[200:203],v5 offset:4096
DR4 a[204:207],v5 offset:20480
FAD v247,v50,v51
EXP v53,v53
CVT v49,v50,v51
M32 a[32:47],a[240:243],v[92:95],a[32:47]
DR4 a[208:211],v5 offset:8192
EXP v54,v54
FAD v246,v246,v52
EXP v55,v55
M32 a[32:47],a[244:247],v[124:127],a[32:47]
DR4 a[212:215],v5 offset:24576
DR4 a[216:219],v5 offset:12288
FAD v247,v247,v53
CVT v50,v52,v53
EXP v56,v56
M32 a[48:63],a[248:251],v[92:95],a[48:63]
DR4 a[220:223],v5 offset:28672
FAD v246,v246,v54
EXP v57,v57
FAD v247,v247,v55
CVT v51,v54,v55
M32 a[48:63],a[252:255],v[124:127],a[48:63]
s_waitcnt lgkmcnt(4)
EXP v58,v58
FAD v246,v246,v56
EXP v59,v59
FAD v247,v247,v57
CVT v52,v56,v57
EXP v60,v60
FAD v246,v246,v58
EXP v61,v61
FAD v247,v247,v59
CVT v53,v58,v59
EXP v62,v62
FAD v246,v246,v60
EXP v63,v63
FAD v247,v247,v61
CVT v54,v60,v61
v_cmp_le_i32 s[36:37], 32, v248
v_cmp_le_i32 s[38:39], 33, v248
v_cmp_le_i32 s[40:41], 34, v248
v_cmp_le_i32 s[42:43], 35, v248
CND v32,v250,v32,s[36:37]
CND v33,v250,v33,s[38:39]
CND v34,v250,v34,s[40:41]
CND v35,v250,v35,s[42:43]
v_cmp_le_i32 s[36:37], 48, v248
v_cmp_le_i32 s[38:39], 49, v248
v_cmp_le_i32 s[40:41], 50, v248
v_cmp_le_i32 s[42:43], 51, v248
CND v36,v250,v36,s[36:37]
CND v37,v250,v37,s[38:39]
CND v38,v250,v38,s[40:41]
CND v39,v250,v39,s[42:43]
v_cmp_le_i32 s[36:37], 40, v248
v_cmp_le_i32 s[38:39], 41, v248
v_cmp_le_i32 s[40:41], 42, v248
v_cmp_le_i32 s[42:43], 43, v248
CND v40,v250,v40,s[36:37]
CND v41,v250,v41,s[38:39]
CND v42,v250,v42,s[40:41]
CND v43,v250,v43,s[42:43]
v_cmp_le_i32 s[36:37], 56, v248
v_cmp_le_i32 s[38:39], 57, v248
v_cmp_le_i32 s[40:41], 58, v248
v_cmp_le_i32 s[42:43], 59, v248
CND v44,v250,v44,s[36:37]
CND v45,v250,v45,s[38:39]
CND v46,v250,v46,s[40:41]
CND v47,v250,v47,s[42:43]
EXP v32,v32
FAD v246,v246,v62
EXP v33,v33
FAD v247,v247,v63
CVT v55,v62,v63
EXP v34,v34
FAD v244,v244,v32
EXP v35,v35
FAD v245,v245,v33
CVT v24,v32,v33
EXP v36,v36
FAD v244,v244,v34
EXP v37,v37
FAD v245,v245,v35
CVT v25,v34,v35
EXP v38,v38
FAD v244,v244,v36
EXP v39,v39
FAD v245,v245,v37
CVT v26,v36,v37
EXP v40,v40
FAD v244,v244,v38
EXP v41,v41
FAD v245,v245,v39
CVT v27,v38,v39
EXP v42,v42
FAD v244,v244,v40
EXP v43,v43
FAD v245,v245,v41
CVT v28,v40,v41
EXP v44,v44
FAD v244,v244,v42
EXP v45,v45
FAD v245,v245,v43
CVT v29,v42,v43
EXP v46,v46
FAD v244,v244,v44
EXP v47,v47
FAD v245,v245,v45
CVT v30,v44,v45
v_cmp_le_i32 s[36:37], 32, v249
v_cmp_le_i32 s[38:39], 33, v249
v_cmp_le_i32 s[40:41], 34, v249
v_cmp_le_i32 s[42:43], 35, v249
CND v64,v250,v64,s[36:37]
CND v65,v250,v65,s[38:39]
CND v66,v250,v66,s[40:41]
CND v67,v250,v67,s[42:43]
v_cmp_le_i32 s[36:37], 48, v249
v_cmp_le_i32 s[38:39], 49, v249
v_cmp_le_i32 s[40:41], 50, v249
v_cmp_le_i32 s[42:43], 51, v249
CND v68,v250,v68,s[36:37]
CND v69,v250,v69,s[38:39]
CND v70,v250,v70,s[40:41]
CND v71,v250,v71,s[42:43]
v_cmp_le_i32 s[36:37], 40, v249
v_cmp_le_i32 s[38:39], 41, v249
v_cmp_le_i32 s[40:41], 42, v249
v_cmp_le_i32 s[42:43], 43, v249
CND v72,v250,v72,s[36:37]
CND v73,v250,v73,s[38:39]
CND v74,v250,v74,s[40:41]
CND v75,v250,v75,s[42:43]
v_cmp_le_i32 s[36:37], 56, v249
v_cmp_le_i32 s[38:39], 57, v249
v_cmp_le_i32 s[40:41], 58, v249
v_cmp_le_i32 s[42:43], 59, v249
CND v76,v250,v76,s[36:37]
CND v77,v250,v77,s[38:39]
CND v78,v250,v78,s[40:41]
CND v79,v250,v79,s[42:43]
EXP v64,v64
FAD v244,v244,v46
EXP v65,v65
FAD v245,v245,v47
CVT v31,v46,v47
EXP v66,v66
FAD v246,v246,v64
EXP v67,v67
FAD v247,v247,v65
CVT v56,v64,v65
EXP v68,v68
FAD v246,v246,v66
EXP v69,v69
FAD v247,v247,v67
CVT v57,v66,v67
EXP v70,v70
FAD v246,v246,v68
EXP v71,v71
FAD v247,v247,v69
CVT v58,v68,v69
EXP v72,v72
FAD v246,v246,v70
EXP v73,v73
FAD v247,v247,v71
CVT v59,v70,v71
EXP v74,v74
FAD v246,v246,v72
EXP v75,v75
FAD v247,v247,v73
CVT v60,v72,v73
EXP v76,v76
FAD v246,v246,v74
EXP v77,v77
FAD v247,v247,v75
CVT v61,v74,v75
EXP v78,v78
FAD v246,v246,v76
EXP v79,v79
FAD v247,v247,v77
CVT v62,v76,v77
FAD v246,v246,v78
FAD v247,v247,v79
CVT v63,v78,v79
FAD v244,v244,v245
FAD v246,v246,v247
v_max_f32 v251, v244, v246
v_cmp_nle_f32 vcc, v251, v255
s_waitcnt lgkmcnt(0)
s_cbranch_vccnz L_G_rare
L_G_back:
FAD v242,v242,v244
FAD v242,v242,v246
s_add_u32 s59, s59, 65536
L_fin:
M32 a[0:15],a[192:195],v[16:19],a[0:15]
DR4 a[224:227],v5 offset:1024
v_mov_b32 v251, v243
s_nop 1
v_permlane32_swap_b32 v243, v251
FAD v243,v243,v251
v_rcp_f32 v244, v243
M32 a[0:15],a[196:199],v[48:51],a[0:15]
DR4 a[228:231],v5 offset:17408
v_mov_b32 v245, v244
ARD v144,a64
ARD v145,a65
ARD v146,a66
ARD v147,a67
M32 a[16:31],a[200:203],v[16:19],a[16:31]
DR4 a[232:235],v5 offset:5120
ARD v148,a68
ARD v149,a69
ARD v150,a70
ARD v151,a71
FML v144,v144,v244
M32 a[16:31],a[204:207],v[48:51],a[16:31]
DR4 a[236:239],v5 offset:21504
FML v145,v145,v244
FML v146,v146,v244
FML v147,v147,v244
FML v148,v148,v244
FML v149,v149,v244
M32 a[32:47],a[208:211],v[16:19],a[32:47]
DR4 a[240:243],v5 offset:9216
FML v150,v150,v244
FML v151,v151,v244
CVT v144,v144,v145
CVT v145,v146,v147
CVT v146,v148,v149
M32 a[32:47],a[212:215],v[48:51],a[32:47]
DR4 a[244:247],v5 offset:25600
CVT v147,v150,v151
buffer_store_dwordx4 v[144:147], v7, s[20:23], s67 offen offset:0 sc1
ARD v152,a72
ARD v153,a73
M32 a[48:63],a[216:219],v[16:19],a[48:63]
DR4 a[248:251],v5 offset:13312
ARD v154,a74
ARD v155,a75
ARD v156,a76
ARD v157,a77
ARD v158,a78
M32 a[48:63],a[220:223],v[48:51],a[48:63]
s_waitcnt lgkmcnt(3)
DR4 a[252:255],v5 offset:29696
ARD v159,a79
FML v152,v152,v244
FML v153,v153,v244
FML v154,v154,v244
FML v155,v155,v244
M32 a[0:15],a[224:227],v[20:23],a[0:15]
DR4 a[192:195],v5 offset:2048
FML v156,v156,v244
FML v157,v157,v244
FML v158,v158,v244
FML v159,v159,v244
CVT v152,v152,v153
M32 a[0:15],a[228:231],v[52:55],a[0:15]
DR4 a[196:199],v5 offset:18432
CVT v153,v154,v155
CVT v154,v156,v157
CVT v155,v158,v159
buffer_store_dwordx4 v[152:155], v7, s[20:23], s67 offen offset:512 sc1
M32 a[16:31],a[232:235],v[20:23],a[16:31]
DR4 a[200:203],v5 offset:6144
ARD v160,a80
ARD v161,a81
ARD v162,a82
ARD v163,a83
ARD v164,a84
M32 a[16:31],a[236:239],v[52:55],a[16:31]
s_waitcnt lgkmcnt(3)
DR4 a[204:207],v5 offset:22528
ARD v165,a85
ARD v166,a86
ARD v167,a87
FML v160,v160,v244
FML v161,v161,v244
M32 a[32:47],a[240:243],v[20:23],a[32:47]
DR4 a[208:211],v5 offset:10240
FML v162,v162,v244
FML v163,v163,v244
FML v164,v164,v244
FML v165,v165,v244
FML v166,v166,v244
M32 a[32:47],a[244:247],v[52:55],a[32:47]
DR4 a[212:215],v5 offset:26624
FML v167,v167,v244
CVT v160,v160,v161
CVT v161,v162,v163
CVT v162,v164,v165
CVT v163,v166,v167
M32 a[48:63],a[248:251],v[20:23],a[48:63]
DR4 a[216:219],v5 offset:14336
buffer_store_dwordx4 v[160:163], v7, s[20:23], s67 offen offset:1024 sc1
ARD v168,a88
ARD v169,a89
ARD v170,a90
M32 a[48:63],a[252:255],v[52:55],a[48:63]
s_waitcnt lgkmcnt(3)
DR4 a[220:223],v5 offset:30720
ARD v171,a91
ARD v172,a92
ARD v173,a93
ARD v174,a94
ARD v175,a95
M32 a[0:15],a[192:195],v[24:27],a[0:15]
DR4 a[224:227],v5 offset:3072
FML v168,v168,v244
FML v169,v169,v244
FML v170,v170,v244
FML v171,v171,v244
FML v172,v172,v244
M32 a[0:15],a[196:199],v[56:59],a[0:15]
DR4 a[228:231],v5 offset:19456
FML v173,v173,v244
FML v174,v174,v244
FML v175,v175,v244
CVT v168,v168,v169
CVT v169,v170,v171
M32 a[16:31],a[200:203],v[24:27],a[16:31]
DR4 a[232:235],v5 offset:7168
CVT v170,v172,v173
CVT v171,v174,v175
buffer_store_dwordx4 v[168:171], v7, s[20:23], s67 offen offset:1536 sc1
ARD v144,a96
M32 a[16:31],a[204:207],v[56:59],a[16:31]
s_waitcnt lgkmcnt(3)
DR4 a[236:239],v5 offset:23552
ARD v145,a97
ARD v146,a98
ARD v147,a99
ARD v148,a100
ARD v149,a101
M32 a[32:47],a[208:211],v[24:27],a[32:47]
DR4 a[240:243],v5 offset:11264
ARD v150,a102
ARD v151,a103
FML v144,v144,v244
FML v145,v145,v244
FML v146,v146,v244
M32 a[32:47],a[212:215],v[56:59],a[32:47]
DR4 a[244:247],v5 offset:27648
FML v147,v147,v244
FML v148,v148,v244
FML v149,v149,v244
FML v150,v150,v244
FML v151,v151,v244
M32 a[48:63],a[216:219],v[24:27],a[48:63]
DR4 a[248:251],v5 offset:15360
CVT v144,v144,v145
CVT v145,v146,v147
CVT v146,v148,v149
CVT v147,v150,v151
M32 a[48:63],a[220:223],v[56:59],a[48:63]
s_waitcnt lgkmcnt(3)
DR4 a[252:255],v5 offset:31744
buffer_store_dwordx4 v[144:147], v7, s[20:23], s67 offen offset:2048 sc1
ARD v152,a104
ARD v153,a105
ARD v154,a106
M32 a[0:15],a[224:227],v[28:31],a[0:15]
ARD v155,a107
ARD v156,a108
ARD v157,a109
ARD v158,a110
ARD v159,a111
FML v152,v152,v244
M32 a[0:15],a[228:231],v[60:63],a[0:15]
FML v153,v153,v244
FML v154,v154,v244
FML v155,v155,v244
FML v156,v156,v244
FML v157,v157,v244
FML v158,v158,v244
M32 a[16:31],a[232:235],v[28:31],a[16:31]
FML v159,v159,v244
CVT v152,v152,v153
CVT v153,v154,v155
CVT v154,v156,v157
CVT v155,v158,v159
M32 a[16:31],a[236:239],v[60:63],a[16:31]
s_waitcnt lgkmcnt(0)
buffer_store_dwordx4 v[152:155], v7, s[20:23], s67 offen offset:2560 sc1
ARD v160,a112
ARD v161,a113
ARD v162,a114
ARD v163,a115
M32 a[32:47],a[240:243],v[28:31],a[32:47]
ARD v164,a116
ARD v165,a117
ARD v166,a118
ARD v167,a119
FML v160,v160,v244
FML v161,v161,v244
M32 a[32:47],a[244:247],v[60:63],a[32:47]
FML v162,v162,v244
FML v163,v163,v244
FML v164,v164,v244
FML v165,v165,v244
FML v166,v166,v244
FML v167,v167,v244
M32 a[48:63],a[248:251],v[28:31],a[48:63]
CVT v160,v160,v161
CVT v161,v162,v163
CVT v162,v164,v165
CVT v163,v166,v167
buffer_store_dwordx4 v[160:163], v7, s[20:23], s67 offen offset:3072 sc1
M32 a[48:63],a[252:255],v[60:63],a[48:63]
ARD v168,a120
ARD v169,a121
ARD v170,a122
ARD v171,a123
ARD v172,a124
ARD v173,a125
ARD v174,a126
ARD v175,a127
FML v168,v168,v244
FML v169,v169,v244
FML v170,v170,v244
FML v171,v171,v244
FML v172,v172,v244
FML v173,v173,v244
FML v174,v174,v244
FML v175,v175,v244
CVT v168,v168,v169
CVT v169,v170,v171
CVT v170,v172,v173
CVT v171,v174,v175
buffer_store_dwordx4 v[168:171], v7, s[20:23], s67 offen offset:3584 sc1
v_mov_b32 v251, v242
s_nop 1
v_permlane32_swap_b32 v242, v251
FAD v242,v242,v251
v_rcp_f32 v244, v242
s_nop 0
v_mov_b32 v245, v244
ARD v144,a0
ARD v145,a1
ARD v146,a2
ARD v147,a3
ARD v148,a4
ARD v149,a5
ARD v150,a6
ARD v151,a7
FML v144,v144,v244
FML v145,v145,v244
FML v146,v146,v244
FML v147,v147,v244
FML v148,v148,v244
FML v149,v149,v244
FML v150,v150,v244
FML v151,v151,v244
CVT v144,v144,v145
CVT v145,v146,v147
CVT v146,v148,v149
CVT v147,v150,v151
buffer_store_dwordx4 v[144:147], v7, s[20:23], s68 offen offset:0 sc1
ARD v152,a8
ARD v153,a9
ARD v154,a10
ARD v155,a11
ARD v156,a12
ARD v157,a13
ARD v158,a14
ARD v159,a15
FML v152,v152,v244
FML v153,v153,v244
FML v154,v154,v244
FML v155,v155,v244
FML v156,v156,v244
FML v157,v157,v244
FML v158,v158,v244
FML v159,v159,v244
CVT v152,v152,v153
CVT v153,v154,v155
CVT v154,v156,v157
CVT v155,v158,v159
buffer_store_dwordx4 v[152:155], v7, s[20:23], s68 offen offset:512 sc1
ARD v160,a16
ARD v161,a17
ARD v162,a18
ARD v163,a19
ARD v164,a20
ARD v165,a21
ARD v166,a22
ARD v167,a23
FML v160,v160,v244
FML v161,v161,v244
FML v162,v162,v244
FML v163,v163,v244
FML v164,v164,v244
FML v165,v165,v244
FML v166,v166,v244
FML v167,v167,v244
CVT v160,v160,v161
CVT v161,v162,v163
CVT v162,v164,v165
CVT v163,v166,v167
buffer_store_dwordx4 v[160:163], v7, s[20:23], s68 offen offset:1024 sc1
ARD v168,a24
ARD v169,a25
ARD v170,a26
ARD v171,a27
ARD v172,a28
ARD v173,a29
ARD v174,a30
ARD v175,a31
FML v168,v168,v244
FML v169,v169,v244
FML v170,v170,v244
FML v171,v171,v244
FML v172,v172,v244
FML v173,v173,v244
FML v174,v174,v244
FML v175,v175,v244
CVT v168,v168,v169
CVT v169,v170,v171
CVT v170,v172,v173
CVT v171,v174,v175
buffer_store_dwordx4 v[168:171], v7, s[20:23], s68 offen offset:1536 sc1
ARD v144,a32
ARD v145,a33
ARD v146,a34
ARD v147,a35
ARD v148,a36
ARD v149,a37
ARD v150,a38
ARD v151,a39
FML v144,v144,v244
FML v145,v145,v244
FML v146,v146,v244
FML v147,v147,v244
FML v148,v148,v244
FML v149,v149,v244
FML v150,v150,v244
FML v151,v151,v244
CVT v144,v144,v145
CVT v145,v146,v147
CVT v146,v148,v149
CVT v147,v150,v151
buffer_store_dwordx4 v[144:147], v7, s[20:23], s68 offen offset:2048 sc1
ARD v152,a40
ARD v153,a41
ARD v154,a42
ARD v155,a43
ARD v156,a44
ARD v157,a45
ARD v158,a46
ARD v159,a47
FML v152,v152,v244
FML v153,v153,v244
FML v154,v154,v244
FML v155,v155,v244
FML v156,v156,v244
FML v157,v157,v244
FML v158,v158,v244
FML v159,v159,v244
CVT v152,v152,v153
CVT v153,v154,v155
CVT v154,v156,v157
CVT v155,v158,v159
buffer_store_dwordx4 v[152:155], v7, s[20:23], s68 offen offset:2560 sc1
ARD v160,a48
ARD v161,a49
ARD v162,a50
ARD v163,a51
ARD v164,a52
ARD v165,a53
ARD v166,a54
ARD v167,a55
FML v160,v160,v244
FML v161,v161,v244
FML v162,v162,v244
FML v163,v163,v244
FML v164,v164,v244
FML v165,v165,v244
FML v166,v166,v244
FML v167,v167,v244
CVT v160,v160,v161
CVT v161,v162,v163
CVT v162,v164,v165
CVT v163,v166,v167
buffer_store_dwordx4 v[160:163], v7, s[20:23], s68 offen offset:3072 sc1
ARD v168,a56
ARD v169,a57
ARD v170,a58
ARD v171,a59
ARD v172,a60
ARD v173,a61
ARD v174,a62
ARD v175,a63
FML v168,v168,v244
FML v169,v169,v244
FML v170,v170,v244
FML v171,v171,v244
FML v172,v172,v244
FML v173,v173,v244
FML v174,v174,v244
FML v175,v175,v244
CVT v168,v168,v169
CVT v169,v170,v171
CVT v170,v172,v173
CVT v171,v174,v175
buffer_store_dwordx4 v[168:171], v7, s[20:23], s68 offen offset:3584 sc1
s_endpgm
L_A_rare:
s_nop 12
s_mov_b32 s69, s59
buffer_load_dwordx4 a[128:131], v4, s[16:19], s69 offen offset:0
buffer_load_dwordx4 a[132:135], v4, s[16:19], s69 offen offset:1024
buffer_load_dwordx4 a[136:139], v4, s[16:19], s69 offen offset:2048
buffer_load_dwordx4 a[140:143], v4, s[16:19], s69 offen offset:3072
s_add_u32 s69, s69, 4096
buffer_load_dwordx4 a[144:147], v4, s[16:19], s69 offen offset:0
buffer_load_dwordx4 a[148:151], v4, s[16:19], s69 offen offset:1024
buffer_load_dwordx4 a[152:155], v4, s[16:19], s69 offen offset:2048
buffer_load_dwordx4 a[156:159], v4, s[16:19], s69 offen offset:3072
s_add_u32 s69, s69, 4096
buffer_load_dwordx4 a[160:163], v4, s[16:19], s69 offen offset:0
buffer_load_dwordx4 a[164:167], v4, s[16:19], s69 offen offset:1024
buffer_load_dwordx4 a[168:171], v4, s[16:19], s69 offen offset:2048
buffer_load_dwordx4 a[172:175], v4, s[16:19], s69 offen offset:3072
s_add_u32 s69, s69, 4096
buffer_load_dwordx4 a[176:179], v4, s[16:19], s69 offen offset:0
buffer_load_dwordx4 a[180:183], v4, s[16:19], s69 offen offset:1024
buffer_load_dwordx4 a[184:187], v4, s[16:19], s69 offen offset:2048
buffer_load_dwordx4 a[188:191], v4, s[16:19], s69 offen offset:3072
s_add_u32 s69, s69, 20480
s_waitcnt vmcnt(15)
M32 v[16:31],a[128:131],v[176:179],0
s_waitcnt vmcnt(14)
M32 v[16:31],a[132:135],v[180:183],v[16:31]
s_waitcnt vmcnt(13)
M32 v[16:31],a[136:139],v[184:187],v[16:31]
s_waitcnt vmcnt(12)
M32 v[16:31],a[140:143],v[188:191],v[16:31]
s_waitcnt vmcnt(11)
M32 v[16:31],a[144:147],v[192:195],v[16:31]
s_waitcnt vmcnt(10)
M32 v[16:31],a[148:151],v[196:199],v[16:31]
s_waitcnt vmcnt(9)
M32 v[16:31],a[152:155],v[200:203],v[16:31]
s_waitcnt vmcnt(8)
M32 v[16:31],a[156:159],v[204:207],v[16:31]
s_waitcnt vmcnt(7)
M32 v[32:47],a[160:163],v[176:179],0
s_waitcnt vmcnt(6)
M32 v[32:47],a[164:167],v[180:183],v[32:47]
s_waitcnt vmcnt(5)
M32 v[32:47],a[168:171],v[184:187],v[32:47]
s_waitcnt vmcnt(4)
M32 v[32:47],a[172:175],v[188:191],v[32:47]
s_waitcnt vmcnt(3)
M32 v[32:47],a[176:179],v[192:195],v[32:47]
s_waitcnt vmcnt(2)
M32 v[32:47],a[180:183],v[196:199],v[32:47]
s_waitcnt vmcnt(1)
M32 v[32:47],a[184:187],v[200:203],v[32:47]
s_waitcnt vmcnt(0)
M32 v[32:47],a[188:191],v[204:207],v[32:47]
M32 v[48:63],a[128:131],v[208:211],0
M32 v[48:63],a[132:135],v[212:215],v[48:63]
M32 v[48:63],a[136:139],v[216:219],v[48:63]
M32 v[48:63],a[140:143],v[220:223],v[48:63]
M32 v[48:63],a[144:147],v[224:227],v[48:63]
M32 v[48:63],a[148:151],v[228:231],v[48:63]
M32 v[48:63],a[152:155],v[232:235],v[48:63]
M32 v[48:63],a[156:159],v[236:239],v[48:63]
M32 v[64:79],a[160:163],v[208:211],0
M32 v[64:79],a[164:167],v[212:215],v[64:79]
M32 v[64:79],a[168:171],v[216:219],v[64:79]
M32 v[64:79],a[172:175],v[220:223],v[64:79]
M32 v[64:79],a[176:179],v[224:227],v[64:79]
M32 v[64:79],a[180:183],v[228:231],v[64:79]
M32 v[64:79],a[184:187],v[232:235],v[64:79]
M32 v[64:79],a[188:191],v[236:239],v[64:79]
v_max3_f32 v251, v16, v17, v18
v_max3_f32 v251, v251, v19, v20
v_max3_f32 v251, v251, v21, v22
v_max3_f32 v251, v251, v23, v24
v_max3_f32 v251, v251, v25, v26
v_max3_f32 v251, v251, v27, v28
v_max3_f32 v251, v251, v29, v30
v_max3_f32 v251, v251, v31, v32
v_max3_f32 v251, v251, v33, v34
v_max3_f32 v251, v251, v35, v36
v_max3_f32 v251, v251, v37, v38
v_max3_f32 v251, v251, v39, v40
v_max3_f32 v251, v251, v41, v42
v_max3_f32 v251, v251, v43, v44
v_max3_f32 v251, v251, v45, v46
v_max_f32 v251, v251, v47
v_max3_f32 v252, v48, v49, v50
v_max3_f32 v252, v252, v51, v52
v_max3_f32 v252, v252, v53, v54
v_max3_f32 v252, v252, v55, v56
v_max3_f32 v252, v252, v57, v58
v_max3_f32 v252, v252, v59, v60
v_max3_f32 v252, v252, v61, v62
v_max3_f32 v252, v252, v63, v64
v_max3_f32 v252, v252, v65, v66
v_max3_f32 v252, v252, v67, v68
v_max3_f32 v252, v252, v69, v70
v_max3_f32 v252, v252, v71, v72
v_max3_f32 v252, v252, v73, v74
v_max3_f32 v252, v252, v75, v76
v_max3_f32 v252, v252, v77, v78
v_max_f32 v252, v252, v79
v_mov_b32 v253, v251
s_nop 1
v_permlane32_swap_b32 v251, v253
v_max_f32 v251, v251, v253
v_max_f32 v251, v251, v240
FSB v253,v240,v251
EXP v254,v253
s_nop 0
FML v242,v242,v254
ARD v8,a0
ARD v9,a1
ARD v10,a2
ARD v11,a3
FML v8,v8,v254
FML v9,v9,v254
FML v10,v10,v254
FML v11,v11,v254
AWR a0,v8
AWR a1,v9
AWR a2,v10
AWR a3,v11
ARD v8,a4
ARD v9,a5
ARD v10,a6
ARD v11,a7
FML v8,v8,v254
FML v9,v9,v254
FML v10,v10,v254
FML v11,v11,v254
AWR a4,v8
AWR a5,v9
AWR a6,v10
AWR a7,v11
ARD v8,a8
ARD v9,a9
ARD v10,a10
ARD v11,a11
FML v8,v8,v254
FML v9,v9,v254
FML v10,v10,v254
FML v11,v11,v254
AWR a8,v8
AWR a9,v9
AWR a10,v10
AWR a11,v11
ARD v8,a12
ARD v9,a13
ARD v10,a14
ARD v11,a15
FML v8,v8,v254
FML v9,v9,v254
FML v10,v10,v254
FML v11,v11,v254
AWR a12,v8
AWR a13,v9
AWR a14,v10
AWR a15,v11
ARD v8,a16
ARD v9,a17
ARD v10,a18
ARD v11,a19
FML v8,v8,v254
FML v9,v9,v254
FML v10,v10,v254
FML v11,v11,v254
AWR a16,v8
AWR a17,v9
AWR a18,v10
AWR a19,v11
ARD v8,a20
ARD v9,a21
ARD v10,a22
ARD v11,a23
FML v8,v8,v254
FML v9,v9,v254
FML v10,v10,v254
FML v11,v11,v254
AWR a20,v8
AWR a21,v9
AWR a22,v10
AWR a23,v11
ARD v8,a24
ARD v9,a25
ARD v10,a26
ARD v11,a27
FML v8,v8,v254
FML v9,v9,v254
FML v10,v10,v254
FML v11,v11,v254
AWR a24,v8
AWR a25,v9
AWR a26,v10
AWR a27,v11
ARD v8,a28
ARD v9,a29
ARD v10,a30
ARD v11,a31
FML v8,v8,v254
FML v9,v9,v254
FML v10,v10,v254
FML v11,v11,v254
AWR a28,v8
AWR a29,v9
AWR a30,v10
AWR a31,v11
ARD v8,a32
ARD v9,a33
ARD v10,a34
ARD v11,a35
FML v8,v8,v254
FML v9,v9,v254
FML v10,v10,v254
FML v11,v11,v254
AWR a32,v8
AWR a33,v9
AWR a34,v10
AWR a35,v11
ARD v8,a36
ARD v9,a37
ARD v10,a38
ARD v11,a39
FML v8,v8,v254
FML v9,v9,v254
FML v10,v10,v254
FML v11,v11,v254
AWR a36,v8
AWR a37,v9
AWR a38,v10
AWR a39,v11
ARD v8,a40
ARD v9,a41
ARD v10,a42
ARD v11,a43
FML v8,v8,v254
FML v9,v9,v254
FML v10,v10,v254
FML v11,v11,v254
AWR a40,v8
AWR a41,v9
AWR a42,v10
AWR a43,v11
ARD v8,a44
ARD v9,a45
ARD v10,a46
ARD v11,a47
FML v8,v8,v254
FML v9,v9,v254
FML v10,v10,v254
FML v11,v11,v254
AWR a44,v8
AWR a45,v9
AWR a46,v10
AWR a47,v11
ARD v8,a48
ARD v9,a49
ARD v10,a50
ARD v11,a51
FML v8,v8,v254
FML v9,v9,v254
FML v10,v10,v254
FML v11,v11,v254
AWR a48,v8
AWR a49,v9
AWR a50,v10
AWR a51,v11
ARD v8,a52
ARD v9,a53
ARD v10,a54
ARD v11,a55
FML v8,v8,v254
FML v9,v9,v254
FML v10,v10,v254
FML v11,v11,v254
AWR a52,v8
AWR a53,v9
AWR a54,v10
AWR a55,v11
ARD v8,a56
ARD v9,a57
ARD v10,a58
ARD v11,a59
FML v8,v8,v254
FML v9,v9,v254
FML v10,v10,v254
FML v11,v11,v254
AWR a56,v8
AWR a57,v9
AWR a58,v10
AWR a59,v11
ARD v8,a60
ARD v9,a61
ARD v10,a62
ARD v11,a63
FML v8,v8,v254
FML v9,v9,v254
FML v10,v10,v254
FML v11,v11,v254
AWR a60,v8
AWR a61,v9
AWR a62,v10
AWR a63,v11
FAD v80,v80,v253
FAD v81,v81,v253
FAD v82,v82,v253
FAD v83,v83,v253
FAD v84,v84,v253
FAD v85,v85,v253
FAD v86,v86,v253
FAD v87,v87,v253
FAD v88,v88,v253
FAD v89,v89,v253
FAD v90,v90,v253
FAD v91,v91,v253
FAD v92,v92,v253
FAD v93,v93,v253
FAD v94,v94,v253
FAD v95,v95,v253
FAD v96,v96,v253
FAD v97,v97,v253
FAD v98,v98,v253
FAD v99,v99,v253
FAD v100,v100,v253
FAD v101,v101,v253
FAD v102,v102,v253
FAD v103,v103,v253
FAD v104,v104,v253
FAD v105,v105,v253
FAD v106,v106,v253
FAD v107,v107,v253
FAD v108,v108,v253
FAD v109,v109,v253
FAD v110,v110,v253
FAD v111,v111,v253
v_mov_b32 v240, v251
FSB v144,0,v251
FSB v145,0,v251
FSB v146,0,v251
FSB v147,0,v251
FSB v148,0,v251
FSB v149,0,v251
FSB v150,0,v251
FSB v151,0,v251
FSB v152,0,v251
FSB v153,0,v251
FSB v154,0,v251
FSB v155,0,v251
FSB v156,0,v251
FSB v157,0,v251
FSB v158,0,v251
FSB v159,0,v251
FSB v16,v16,v251
FSB v17,v17,v251
FSB v18,v18,v251
FSB v19,v19,v251
FSB v20,v20,v251
FSB v21,v21,v251
FSB v22,v22,v251
FSB v23,v23,v251
FSB v24,v24,v251
FSB v25,v25,v251
FSB v26,v26,v251
FSB v27,v27,v251
FSB v28,v28,v251
FSB v29,v29,v251
FSB v30,v30,v251
FSB v31,v31,v251
FSB v32,v32,v251
FSB v33,v33,v251
FSB v34,v34,v251
FSB v35,v35,v251
FSB v36,v36,v251
FSB v37,v37,v251
FSB v38,v38,v251
FSB v39,v39,v251
FSB v40,v40,v251
FSB v41,v41,v251
FSB v42,v42,v251
FSB v43,v43,v251
FSB v44,v44,v251
FSB v45,v45,v251
FSB v46,v46,v251
FSB v47,v47,v251
v_mov_b32 v253, v252
s_nop 1
v_permlane32_swap_b32 v252, v253
v_max_f32 v252, v252, v253
v_max_f32 v252, v252, v241
FSB v253,v241,v252
EXP v254,v253
s_nop 0
FML v243,v243,v254
ARD v8,a64
ARD v9,a65
ARD v10,a66
ARD v11,a67
FML v8,v8,v254
FML v9,v9,v254
FML v10,v10,v254
FML v11,v11,v254
AWR a64,v8
AWR a65,v9
AWR a66,v10
AWR a67,v11
ARD v8,a68
ARD v9,a69
ARD v10,a70
ARD v11,a71
FML v8,v8,v254
FML v9,v9,v254
FML v10,v10,v254
FML v11,v11,v254
AWR a68,v8
AWR a69,v9
AWR a70,v10
AWR a71,v11
ARD v8,a72
ARD v9,a73
ARD v10,a74
ARD v11,a75
FML v8,v8,v254
FML v9,v9,v254
FML v10,v10,v254
FML v11,v11,v254
AWR a72,v8
AWR a73,v9
AWR a74,v10
AWR a75,v11
ARD v8,a76
ARD v9,a77
ARD v10,a78
ARD v11,a79
FML v8,v8,v254
FML v9,v9,v254
FML v10,v10,v254
FML v11,v11,v254
AWR a76,v8
AWR a77,v9
AWR a78,v10
AWR a79,v11
ARD v8,a80
ARD v9,a81
ARD v10,a82
ARD v11,a83
FML v8,v8,v254
FML v9,v9,v254
FML v10,v10,v254
FML v11,v11,v254
AWR a80,v8
AWR a81,v9
AWR a82,v10
AWR a83,v11
ARD v8,a84
ARD v9,a85
ARD v10,a86
ARD v11,a87
FML v8,v8,v254
FML v9,v9,v254
FML v10,v10,v254
FML v11,v11,v254
AWR a84,v8
AWR a85,v9
AWR a86,v10
AWR a87,v11
ARD v8,a88
ARD v9,a89
ARD v10,a90
ARD v11,a91
FML v8,v8,v254
FML v9,v9,v254
FML v10,v10,v254
FML v11,v11,v254
AWR a88,v8
AWR a89,v9
AWR a90,v10
AWR a91,v11
ARD v8,a92
ARD v9,a93
ARD v10,a94
ARD v11,a95
FML v8,v8,v254
FML v9,v9,v254
FML v10,v10,v254
FML v11,v11,v254
AWR a92,v8
AWR a93,v9
AWR a94,v10
AWR a95,v11
ARD v8,a96
ARD v9,a97
ARD v10,a98
ARD v11,a99
FML v8,v8,v254
FML v9,v9,v254
FML v10,v10,v254
FML v11,v11,v254
AWR a96,v8
AWR a97,v9
AWR a98,v10
AWR a99,v11
ARD v8,a100
ARD v9,a101
ARD v10,a102
ARD v11,a103
FML v8,v8,v254
FML v9,v9,v254
FML v10,v10,v254
FML v11,v11,v254
AWR a100,v8
AWR a101,v9
AWR a102,v10
AWR a103,v11
ARD v8,a104
ARD v9,a105
ARD v10,a106
ARD v11,a107
FML v8,v8,v254
FML v9,v9,v254
FML v10,v10,v254
FML v11,v11,v254
AWR a104,v8
AWR a105,v9
AWR a106,v10
AWR a107,v11
ARD v8,a108
ARD v9,a109
ARD v10,a110
ARD v11,a111
FML v8,v8,v254
FML v9,v9,v254
FML v10,v10,v254
FML v11,v11,v254
AWR a108,v8
AWR a109,v9
AWR a110,v10
AWR a111,v11
ARD v8,a112
ARD v9,a113
ARD v10,a114
ARD v11,a115
FML v8,v8,v254
FML v9,v9,v254
FML v10,v10,v254
FML v11,v11,v254
AWR a112,v8
AWR a113,v9
AWR a114,v10
AWR a115,v11
ARD v8,a116
ARD v9,a117
ARD v10,a118
ARD v11,a119
FML v8,v8,v254
FML v9,v9,v254
FML v10,v10,v254
FML v11,v11,v254
AWR a116,v8
AWR a117,v9
AWR a118,v10
AWR a119,v11
ARD v8,a120
ARD v9,a121
ARD v10,a122
ARD v11,a123
FML v8,v8,v254
FML v9,v9,v254
FML v10,v10,v254
FML v11,v11,v254
AWR a120,v8
AWR a121,v9
AWR a122,v10
AWR a123,v11
ARD v8,a124
ARD v9,a125
ARD v10,a126
ARD v11,a127
FML v8,v8,v254
FML v9,v9,v254
FML v10,v10,v254
FML v11,v11,v254
AWR a124,v8
AWR a125,v9
AWR a126,v10
AWR a127,v11
FAD v112,v112,v253
FAD v113,v113,v253
FAD v114,v114,v253
FAD v115,v115,v253
FAD v116,v116,v253
FAD v117,v117,v253
FAD v118,v118,v253
FAD v119,v119,v253
FAD v120,v120,v253
FAD v121,v121,v253
FAD v122,v122,v253
FAD v123,v123,v253
FAD v124,v124,v253
FAD v125,v125,v253
FAD v126,v126,v253
FAD v127,v127,v253
FAD v128,v128,v253
FAD v129,v129,v253
FAD v130,v130,v253
FAD v131,v131,v253
FAD v132,v132,v253
FAD v133,v133,v253
FAD v134,v134,v253
FAD v135,v135,v253
FAD v136,v136,v253
FAD v137,v137,v253
FAD v138,v138,v253
FAD v139,v139,v253
FAD v140,v140,v253
FAD v141,v141,v253
FAD v142,v142,v253
FAD v143,v143,v253
v_mov_b32 v241, v252
FSB v160,0,v252
FSB v161,0,v252
FSB v162,0,v252
FSB v163,0,v252
FSB v164,0,v252
FSB v165,0,v252
FSB v166,0,v252
FSB v167,0,v252
FSB v168,0,v252
FSB v169,0,v252
FSB v170,0,v252
FSB v171,0,v252
FSB v172,0,v252
FSB v173,0,v252
FSB v174,0,v252
FSB v175,0,v252
FSB v48,v48,v252
FSB v49,v49,v252
FSB v50,v50,v252
FSB v51,v51,v252
FSB v52,v52,v252
FSB v53,v53,v252
FSB v54,v54,v252
FSB v55,v55,v252
FSB v56,v56,v252
FSB v57,v57,v252
FSB v58,v58,v252
FSB v59,v59,v252
FSB v60,v60,v252
FSB v61,v61,v252
FSB v62,v62,v252
FSB v63,v63,v252
FSB v64,v64,v252
FSB v65,v65,v252
FSB v66,v66,v252
FSB v67,v67,v252
FSB v68,v68,v252
FSB v69,v69,v252
FSB v70,v70,v252
FSB v71,v71,v252
FSB v72,v72,v252
FSB v73,v73,v252
FSB v74,v74,v252
FSB v75,v75,v252
FSB v76,v76,v252
FSB v77,v77,v252
FSB v78,v78,v252
FSB v79,v79,v252
EXP v16,v16
EXP v17,v17
EXP v18,v18
FAD v244,v16,v17
EXP v19,v19
CVT v16,v16,v17
EXP v20,v20
FAD v245,v18,v19
EXP v21,v21
CVT v17,v18,v19
EXP v22,v22
FAD v244,v244,v20
EXP v23,v23
FAD v245,v245,v21
CVT v18,v20,v21
EXP v24,v24
FAD v244,v244,v22
EXP v25,v25
FAD v245,v245,v23
CVT v19,v22,v23
EXP v26,v26
FAD v244,v244,v24
EXP v27,v27
FAD v245,v245,v25
CVT v20,v24,v25
EXP v28,v28
FAD v244,v244,v26
EXP v29,v29
FAD v245,v245,v27
CVT v21,v26,v27
EXP v30,v30
FAD v244,v244,v28
EXP v31,v31
FAD v245,v245,v29
CVT v22,v28,v29
EXP v48,v48
FAD v244,v244,v30
EXP v49,v49
FAD v245,v245,v31
CVT v23,v30,v31
EXP v50,v50
FAD v246,v48,v49
EXP v51,v51
CVT v48,v48,v49
EXP v52,v52
FAD v247,v50,v51
EXP v53,v53
CVT v49,v50,v51
EXP v54,v54
FAD v246,v246,v52
EXP v55,v55
FAD v247,v247,v53
CVT v50,v52,v53
EXP v56,v56
FAD v246,v246,v54
EXP v57,v57
FAD v247,v247,v55
CVT v51,v54,v55
EXP v58,v58
FAD v246,v246,v56
EXP v59,v59
FAD v247,v247,v57
CVT v52,v56,v57
EXP v60,v60
FAD v246,v246,v58
EXP v61,v61
FAD v247,v247,v59
CVT v53,v58,v59
EXP v62,v62
FAD v246,v246,v60
EXP v63,v63
FAD v247,v247,v61
CVT v54,v60,v61
EXP v32,v32
FAD v246,v246,v62
EXP v33,v33
FAD v247,v247,v63
CVT v55,v62,v63
EXP v34,v34
FAD v244,v244,v32
EXP v35,v35
FAD v245,v245,v33
CVT v24,v32,v33
EXP v36,v36
FAD v244,v244,v34
EXP v37,v37
FAD v245,v245,v35
CVT v25,v34,v35
EXP v38,v38
FAD v244,v244,v36
EXP v39,v39
FAD v245,v245,v37
CVT v26,v36,v37
EXP v40,v40
FAD v244,v244,v38
EXP v41,v41
FAD v245,v245,v39
CVT v27,v38,v39
EXP v42,v42
FAD v244,v244,v40
EXP v43,v43
FAD v245,v245,v41
CVT v28,v40,v41
EXP v44,v44
FAD v244,v244,v42
EXP v45,v45
FAD v245,v245,v43
CVT v29,v42,v43
EXP v46,v46
FAD v244,v244,v44
EXP v47,v47
FAD v245,v245,v45
CVT v30,v44,v45
EXP v64,v64
FAD v244,v244,v46
EXP v65,v65
FAD v245,v245,v47
CVT v31,v46,v47
EXP v66,v66
FAD v246,v246,v64
EXP v67,v67
FAD v247,v247,v65
CVT v56,v64,v65
EXP v68,v68
FAD v246,v246,v66
EXP v69,v69
FAD v247,v247,v67
CVT v57,v66,v67
EXP v70,v70
FAD v246,v246,v68
EXP v71,v71
FAD v247,v247,v69
CVT v58,v68,v69
EXP v72,v72
FAD v246,v246,v70
EXP v73,v73
FAD v247,v247,v71
CVT v59,v70,v71
EXP v74,v74
FAD v246,v246,v72
EXP v75,v75
FAD v247,v247,v73
CVT v60,v72,v73
EXP v76,v76
FAD v246,v246,v74
EXP v77,v77
FAD v247,v247,v75
CVT v61,v74,v75
EXP v78,v78
FAD v246,v246,v76
EXP v79,v79
FAD v247,v247,v77
CVT v62,v76,v77
FAD v246,v246,v78
FAD v247,v247,v79
CVT v63,v78,v79
FAD v244,v244,v245
FAD v246,v246,v247
v_max_f32 v251, v244, v246
v_cmp_nle_f32 vcc, v251, v255
s_nop 4
s_branch L_A_back
L_B1_rare:
s_nop 12
s_mov_b32 s69, s59
buffer_load_dwordx4 a[128:131], v4, s[16:19], s69 offen offset:0
buffer_load_dwordx4 a[132:135], v4, s[16:19], s69 offen offset:1024
buffer_load_dwordx4 a[136:139], v4, s[16:19], s69 offen offset:2048
buffer_load_dwordx4 a[140:143], v4, s[16:19], s69 offen offset:3072
s_add_u32 s69, s69, 4096
buffer_load_dwordx4 a[144:147], v4, s[16:19], s69 offen offset:0
buffer_load_dwordx4 a[148:151], v4, s[16:19], s69 offen offset:1024
buffer_load_dwordx4 a[152:155], v4, s[16:19], s69 offen offset:2048
buffer_load_dwordx4 a[156:159], v4, s[16:19], s69 offen offset:3072
s_add_u32 s69, s69, 4096
buffer_load_dwordx4 a[160:163], v4, s[16:19], s69 offen offset:0
buffer_load_dwordx4 a[164:167], v4, s[16:19], s69 offen offset:1024
buffer_load_dwordx4 a[168:171], v4, s[16:19], s69 offen offset:2048
buffer_load_dwordx4 a[172:175], v4, s[16:19], s69 offen offset:3072
s_add_u32 s69, s69, 4096
buffer_load_dwordx4 a[176:179], v4, s[16:19], s69 offen offset:0
buffer_load_dwordx4 a[180:183], v4, s[16:19], s69 offen offset:1024
buffer_load_dwordx4 a[184:187], v4, s[16:19], s69 offen offset:2048
buffer_load_dwordx4 a[188:191], v4, s[16:19], s69 offen offset:3072
s_add_u32 s69, s69, 20480
s_waitcnt vmcnt(15)
M32 v[80:95],a[128:131],v[176:179],0
s_waitcnt vmcnt(14)
M32 v[80:95],a[132:135],v[180:183],v[80:95]
s_waitcnt vmcnt(13)
M32 v[80:95],a[136:139],v[184:187],v[80:95]
s_waitcnt vmcnt(12)
M32 v[80:95],a[140:143],v[188:191],v[80:95]
s_waitcnt vmcnt(11)
M32 v[80:95],a[144:147],v[192:195],v[80:95]
s_waitcnt vmcnt(10)
M32 v[80:95],a[148:151],v[196:199],v[80:95]
s_waitcnt vmcnt(9)
M32 v[80:95],a[152:155],v[200:203],v[80:95]
s_waitcnt vmcnt(8)
M32 v[80:95],a[156:159],v[204:207],v[80:95]
s_waitcnt vmcnt(7)
M32 v[96:111],a[160:163],v[176:179],0
s_waitcnt vmcnt(6)
M32 v[96:111],a[164:167],v[180:183],v[96:111]
s_waitcnt vmcnt(5)
M32 v[96:111],a[168:171],v[184:187],v[96:111]
s_waitcnt vmcnt(4)
M32 v[96:111],a[172:175],v[188:191],v[96:111]
s_waitcnt vmcnt(3)
M32 v[96:111],a[176:179],v[192:195],v[96:111]
s_waitcnt vmcnt(2)
M32 v[96:111],a[180:183],v[196:199],v[96:111]
s_waitcnt vmcnt(1)
M32 v[96:111],a[184:187],v[200:203],v[96:111]
s_waitcnt vmcnt(0)
M32 v[96:111],a[188:191],v[204:207],v[96:111]
M32 v[112:127],a[128:131],v[208:211],0
M32 v[112:127],a[132:135],v[212:215],v[112:127]
M32 v[112:127],a[136:139],v[216:219],v[112:127]
M32 v[112:127],a[140:143],v[220:223],v[112:127]
M32 v[112:127],a[144:147],v[224:227],v[112:127]
M32 v[112:127],a[148:151],v[228:231],v[112:127]
M32 v[112:127],a[152:155],v[232:235],v[112:127]
M32 v[112:127],a[156:159],v[236:239],v[112:127]
M32 v[128:143],a[160:163],v[208:211],0
M32 v[128:143],a[164:167],v[212:215],v[128:143]
M32 v[128:143],a[168:171],v[216:219],v[128:143]
M32 v[128:143],a[172:175],v[220:223],v[128:143]
M32 v[128:143],a[176:179],v[224:227],v[128:143]
M32 v[128:143],a[180:183],v[228:231],v[128:143]
M32 v[128:143],a[184:187],v[232:235],v[128:143]
M32 v[128:143],a[188:191],v[236:239],v[128:143]
v_max3_f32 v251, v80, v81, v82
v_max3_f32 v251, v251, v83, v84
v_max3_f32 v251, v251, v85, v86
v_max3_f32 v251, v251, v87, v88
v_max3_f32 v251, v251, v89, v90
v_max3_f32 v251, v251, v91, v92
v_max3_f32 v251, v251, v93, v94
v_max3_f32 v251, v251, v95, v96
v_max3_f32 v251, v251, v97, v98
v_max3_f32 v251, v251, v99, v100
v_max3_f32 v251, v251, v101, v102
v_max3_f32 v251, v251, v103, v104
v_max3_f32 v251, v251, v105, v106
v_max3_f32 v251, v251, v107, v108
v_max3_f32 v251, v251, v109, v110
v_max_f32 v251, v251, v111
v_max3_f32 v252, v112, v113, v114
v_max3_f32 v252, v252, v115, v116
v_max3_f32 v252, v252, v117, v118
v_max3_f32 v252, v252, v119, v120
v_max3_f32 v252, v252, v121, v122
v_max3_f32 v252, v252, v123, v124
v_max3_f32 v252, v252, v125, v126
v_max3_f32 v252, v252, v127, v128
v_max3_f32 v252, v252, v129, v130
v_max3_f32 v252, v252, v131, v132
v_max3_f32 v252, v252, v133, v134
v_max3_f32 v252, v252, v135, v136
v_max3_f32 v252, v252, v137, v138
v_max3_f32 v252, v252, v139, v140
v_max3_f32 v252, v252, v141, v142
v_max_f32 v252, v252, v143
v_mov_b32 v253, v251
s_nop 1
v_permlane32_swap_b32 v251, v253
v_max_f32 v251, v251, v253
v_max_f32 v251, v251, v240
FSB v253,v240,v251
EXP v254,v253
s_nop 0
FML v242,v242,v254
ARD v8,a0
ARD v9,a1
ARD v10,a2
ARD v11,a3
FML v8,v8,v254
FML v9,v9,v254
FML v10,v10,v254
FML v11,v11,v254
AWR a0,v8
AWR a1,v9
AWR a2,v10
AWR a3,v11
ARD v8,a4
ARD v9,a5
ARD v10,a6
ARD v11,a7
FML v8,v8,v254
FML v9,v9,v254
FML v10,v10,v254
FML v11,v11,v254
AWR a4,v8
AWR a5,v9
AWR a6,v10
AWR a7,v11
ARD v8,a8
ARD v9,a9
ARD v10,a10
ARD v11,a11
FML v8,v8,v254
FML v9,v9,v254
FML v10,v10,v254
FML v11,v11,v254
AWR a8,v8
AWR a9,v9
AWR a10,v10
AWR a11,v11
ARD v8,a12
ARD v9,a13
ARD v10,a14
ARD v11,a15
FML v8,v8,v254
FML v9,v9,v254
FML v10,v10,v254
FML v11,v11,v254
AWR a12,v8
AWR a13,v9
AWR a14,v10
AWR a15,v11
ARD v8,a16
ARD v9,a17
ARD v10,a18
ARD v11,a19
FML v8,v8,v254
FML v9,v9,v254
FML v10,v10,v254
FML v11,v11,v254
AWR a16,v8
AWR a17,v9
AWR a18,v10
AWR a19,v11
ARD v8,a20
ARD v9,a21
ARD v10,a22
ARD v11,a23
FML v8,v8,v254
FML v9,v9,v254
FML v10,v10,v254
FML v11,v11,v254
AWR a20,v8
AWR a21,v9
AWR a22,v10
AWR a23,v11
ARD v8,a24
ARD v9,a25
ARD v10,a26
ARD v11,a27
FML v8,v8,v254
FML v9,v9,v254
FML v10,v10,v254
FML v11,v11,v254
AWR a24,v8
AWR a25,v9
AWR a26,v10
AWR a27,v11
ARD v8,a28
ARD v9,a29
ARD v10,a30
ARD v11,a31
FML v8,v8,v254
FML v9,v9,v254
FML v10,v10,v254
FML v11,v11,v254
AWR a28,v8
AWR a29,v9
AWR a30,v10
AWR a31,v11
ARD v8,a32
ARD v9,a33
ARD v10,a34
ARD v11,a35
FML v8,v8,v254
FML v9,v9,v254
FML v10,v10,v254
FML v11,v11,v254
AWR a32,v8
AWR a33,v9
AWR a34,v10
AWR a35,v11
ARD v8,a36
ARD v9,a37
ARD v10,a38
ARD v11,a39
FML v8,v8,v254
FML v9,v9,v254
FML v10,v10,v254
FML v11,v11,v254
AWR a36,v8
AWR a37,v9
AWR a38,v10
AWR a39,v11
ARD v8,a40
ARD v9,a41
ARD v10,a42
ARD v11,a43
FML v8,v8,v254
FML v9,v9,v254
FML v10,v10,v254
FML v11,v11,v254
AWR a40,v8
AWR a41,v9
AWR a42,v10
AWR a43,v11
ARD v8,a44
ARD v9,a45
ARD v10,a46
ARD v11,a47
FML v8,v8,v254
FML v9,v9,v254
FML v10,v10,v254
FML v11,v11,v254
AWR a44,v8
AWR a45,v9
AWR a46,v10
AWR a47,v11
ARD v8,a48
ARD v9,a49
ARD v10,a50
ARD v11,a51
FML v8,v8,v254
FML v9,v9,v254
FML v10,v10,v254
FML v11,v11,v254
AWR a48,v8
AWR a49,v9
AWR a50,v10
AWR a51,v11
ARD v8,a52
ARD v9,a53
ARD v10,a54
ARD v11,a55
FML v8,v8,v254
FML v9,v9,v254
FML v10,v10,v254
FML v11,v11,v254
AWR a52,v8
AWR a53,v9
AWR a54,v10
AWR a55,v11
ARD v8,a56
ARD v9,a57
ARD v10,a58
ARD v11,a59
FML v8,v8,v254
FML v9,v9,v254
FML v10,v10,v254
FML v11,v11,v254
AWR a56,v8
AWR a57,v9
AWR a58,v10
AWR a59,v11
ARD v8,a60
ARD v9,a61
ARD v10,a62
ARD v11,a63
FML v8,v8,v254
FML v9,v9,v254
FML v10,v10,v254
FML v11,v11,v254
AWR a60,v8
AWR a61,v9
AWR a62,v10
AWR a63,v11
FAD v16,v16,v253
FAD v17,v17,v253
FAD v18,v18,v253
FAD v19,v19,v253
FAD v20,v20,v253
FAD v21,v21,v253
FAD v22,v22,v253
FAD v23,v23,v253
FAD v24,v24,v253
FAD v25,v25,v253
FAD v26,v26,v253
FAD v27,v27,v253
FAD v28,v28,v253
FAD v29,v29,v253
FAD v30,v30,v253
FAD v31,v31,v253
FAD v32,v32,v253
FAD v33,v33,v253
FAD v34,v34,v253
FAD v35,v35,v253
FAD v36,v36,v253
FAD v37,v37,v253
FAD v38,v38,v253
FAD v39,v39,v253
FAD v40,v40,v253
FAD v41,v41,v253
FAD v42,v42,v253
FAD v43,v43,v253
FAD v44,v44,v253
FAD v45,v45,v253
FAD v46,v46,v253
FAD v47,v47,v253
v_mov_b32 v240, v251
FSB v144,0,v251
FSB v145,0,v251
FSB v146,0,v251
FSB v147,0,v251
FSB v148,0,v251
FSB v149,0,v251
FSB v150,0,v251
FSB v151,0,v251
FSB v152,0,v251
FSB v153,0,v251
FSB v154,0,v251
FSB v155,0,v251
FSB v156,0,v251
FSB v157,0,v251
FSB v158,0,v251
FSB v159,0,v251
FSB v80,v80,v251
FSB v81,v81,v251
FSB v82,v82,v251
FSB v83,v83,v251
FSB v84,v84,v251
FSB v85,v85,v251
FSB v86,v86,v251
FSB v87,v87,v251
FSB v88,v88,v251
FSB v89,v89,v251
FSB v90,v90,v251
FSB v91,v91,v251
FSB v92,v92,v251
FSB v93,v93,v251
FSB v94,v94,v251
FSB v95,v95,v251
FSB v96,v96,v251
FSB v97,v97,v251
FSB v98,v98,v251
FSB v99,v99,v251
FSB v100,v100,v251
FSB v101,v101,v251
FSB v102,v102,v251
FSB v103,v103,v251
FSB v104,v104,v251
FSB v105,v105,v251
FSB v106,v106,v251
FSB v107,v107,v251
FSB v108,v108,v251
FSB v109,v109,v251
FSB v110,v110,v251
FSB v111,v111,v251
v_mov_b32 v253, v252
s_nop 1
v_permlane32_swap_b32 v252, v253
v_max_f32 v252, v252, v253
v_max_f32 v252, v252, v241
FSB v253,v241,v252
EXP v254,v253
s_nop 0
FML v243,v243,v254
ARD v8,a64
ARD v9,a65
ARD v10,a66
ARD v11,a67
FML v8,v8,v254
FML v9,v9,v254
FML v10,v10,v254
FML v11,v11,v254
AWR a64,v8
AWR a65,v9
AWR a66,v10
AWR a67,v11
ARD v8,a68
ARD v9,a69
ARD v10,a70
ARD v11,a71
FML v8,v8,v254
FML v9,v9,v254
FML v10,v10,v254
FML v11,v11,v254
AWR a68,v8
AWR a69,v9
AWR a70,v10
AWR a71,v11
ARD v8,a72
ARD v9,a73
ARD v10,a74
ARD v11,a75
FML v8,v8,v254
FML v9,v9,v254
FML v10,v10,v254
FML v11,v11,v254
AWR a72,v8
AWR a73,v9
AWR a74,v10
AWR a75,v11
ARD v8,a76
ARD v9,a77
ARD v10,a78
ARD v11,a79
FML v8,v8,v254
FML v9,v9,v254
FML v10,v10,v254
FML v11,v11,v254
AWR a76,v8
AWR a77,v9
AWR a78,v10
AWR a79,v11
ARD v8,a80
ARD v9,a81
ARD v10,a82
ARD v11,a83
FML v8,v8,v254
FML v9,v9,v254
FML v10,v10,v254
FML v11,v11,v254
AWR a80,v8
AWR a81,v9
AWR a82,v10
AWR a83,v11
ARD v8,a84
ARD v9,a85
ARD v10,a86
ARD v11,a87
FML v8,v8,v254
FML v9,v9,v254
FML v10,v10,v254
FML v11,v11,v254
AWR a84,v8
AWR a85,v9
AWR a86,v10
AWR a87,v11
ARD v8,a88
ARD v9,a89
ARD v10,a90
ARD v11,a91
FML v8,v8,v254
FML v9,v9,v254
FML v10,v10,v254
FML v11,v11,v254
AWR a88,v8
AWR a89,v9
AWR a90,v10
AWR a91,v11
ARD v8,a92
ARD v9,a93
ARD v10,a94
ARD v11,a95
FML v8,v8,v254
FML v9,v9,v254
FML v10,v10,v254
FML v11,v11,v254
AWR a92,v8
AWR a93,v9
AWR a94,v10
AWR a95,v11
ARD v8,a96
ARD v9,a97
ARD v10,a98
ARD v11,a99
FML v8,v8,v254
FML v9,v9,v254
FML v10,v10,v254
FML v11,v11,v254
AWR a96,v8
AWR a97,v9
AWR a98,v10
AWR a99,v11
ARD v8,a100
ARD v9,a101
ARD v10,a102
ARD v11,a103
FML v8,v8,v254
FML v9,v9,v254
FML v10,v10,v254
FML v11,v11,v254
AWR a100,v8
AWR a101,v9
AWR a102,v10
AWR a103,v11
ARD v8,a104
ARD v9,a105
ARD v10,a106
ARD v11,a107
FML v8,v8,v254
FML v9,v9,v254
FML v10,v10,v254
FML v11,v11,v254
AWR a104,v8
AWR a105,v9
AWR a106,v10
AWR a107,v11
ARD v8,a108
ARD v9,a109
ARD v10,a110
ARD v11,a111
FML v8,v8,v254
FML v9,v9,v254
FML v10,v10,v254
FML v11,v11,v254
AWR a108,v8
AWR a109,v9
AWR a110,v10
AWR a111,v11
ARD v8,a112
ARD v9,a113
ARD v10,a114
ARD v11,a115
FML v8,v8,v254
FML v9,v9,v254
FML v10,v10,v254
FML v11,v11,v254
AWR a112,v8
AWR a113,v9
AWR a114,v10
AWR a115,v11
ARD v8,a116
ARD v9,a117
ARD v10,a118
ARD v11,a119
FML v8,v8,v254
FML v9,v9,v254
FML v10,v10,v254
FML v11,v11,v254
AWR a116,v8
AWR a117,v9
AWR a118,v10
AWR a119,v11
ARD v8,a120
ARD v9,a121
ARD v10,a122
ARD v11,a123
FML v8,v8,v254
FML v9,v9,v254
FML v10,v10,v254
FML v11,v11,v254
AWR a120,v8
AWR a121,v9
AWR a122,v10
AWR a123,v11
ARD v8,a124
ARD v9,a125
ARD v10,a126
ARD v11,a127
FML v8,v8,v254
FML v9,v9,v254
FML v10,v10,v254
FML v11,v11,v254
AWR a124,v8
AWR a125,v9
AWR a126,v10
AWR a127,v11
FAD v48,v48,v253
FAD v49,v49,v253
FAD v50,v50,v253
FAD v51,v51,v253
FAD v52,v52,v253
FAD v53,v53,v253
FAD v54,v54,v253
FAD v55,v55,v253
FAD v56,v56,v253
FAD v57,v57,v253
FAD v58,v58,v253
FAD v59,v59,v253
FAD v60,v60,v253
FAD v61,v61,v253
FAD v62,v62,v253
FAD v63,v63,v253
FAD v64,v64,v253
FAD v65,v65,v253
FAD v66,v66,v253
FAD v67,v67,v253
FAD v68,v68,v253
FAD v69,v69,v253
FAD v70,v70,v253
FAD v71,v71,v253
FAD v72,v72,v253
FAD v73,v73,v253
FAD v74,v74,v253
FAD v75,v75,v253
FAD v76,v76,v253
FAD v77,v77,v253
FAD v78,v78,v253
FAD v79,v79,v253
v_mov_b32 v241, v252
FSB v160,0,v252
FSB v161,0,v252
FSB v162,0,v252
FSB v163,0,v252
FSB v164,0,v252
FSB v165,0,v252
FSB v166,0,v252
FSB v167,0,v252
FSB v168,0,v252
FSB v169,0,v252
FSB v170,0,v252
FSB v171,0,v252
FSB v172,0,v252
FSB v173,0,v252
FSB v174,0,v252
FSB v175,0,v252
FSB v112,v112,v252
FSB v113,v113,v252
FSB v114,v114,v252
FSB v115,v115,v252
FSB v116,v116,v252
FSB v117,v117,v252
FSB v118,v118,v252
FSB v119,v119,v252
FSB v120,v120,v252
FSB v121,v121,v252
FSB v122,v122,v252
FSB v123,v123,v252
FSB v124,v124,v252
FSB v125,v125,v252
FSB v126,v126,v252
FSB v127,v127,v252
FSB v128,v128,v252
FSB v129,v129,v252
FSB v130,v130,v252
FSB v131,v131,v252
FSB v132,v132,v252
FSB v133,v133,v252
FSB v134,v134,v252
FSB v135,v135,v252
FSB v136,v136,v252
FSB v137,v137,v252
FSB v138,v138,v252
FSB v139,v139,v252
FSB v140,v140,v252
FSB v141,v141,v252
FSB v142,v142,v252
FSB v143,v143,v252
EXP v80,v80
EXP v81,v81
EXP v82,v82
FAD v244,v80,v81
EXP v83,v83
CVT v80,v80,v81
EXP v84,v84
FAD v245,v82,v83
EXP v85,v85
CVT v81,v82,v83
EXP v86,v86
FAD v244,v244,v84
EXP v87,v87
FAD v245,v245,v85
CVT v82,v84,v85
EXP v88,v88
FAD v244,v244,v86
EXP v89,v89
FAD v245,v245,v87
CVT v83,v86,v87
EXP v90,v90
FAD v244,v244,v88
EXP v91,v91
FAD v245,v245,v89
CVT v84,v88,v89
EXP v92,v92
FAD v244,v244,v90
EXP v93,v93
FAD v245,v245,v91
CVT v85,v90,v91
EXP v94,v94
FAD v244,v244,v92
EXP v95,v95
FAD v245,v245,v93
CVT v86,v92,v93
EXP v112,v112
FAD v244,v244,v94
EXP v113,v113
FAD v245,v245,v95
CVT v87,v94,v95
EXP v114,v114
FAD v246,v112,v113
EXP v115,v115
CVT v112,v112,v113
EXP v116,v116
FAD v247,v114,v115
EXP v117,v117
CVT v113,v114,v115
EXP v118,v118
FAD v246,v246,v116
EXP v119,v119
FAD v247,v247,v117
CVT v114,v116,v117
EXP v120,v120
FAD v246,v246,v118
EXP v121,v121
FAD v247,v247,v119
CVT v115,v118,v119
EXP v122,v122
FAD v246,v246,v120
EXP v123,v123
FAD v247,v247,v121
CVT v116,v120,v121
EXP v124,v124
FAD v246,v246,v122
EXP v125,v125
FAD v247,v247,v123
CVT v117,v122,v123
EXP v126,v126
FAD v246,v246,v124
EXP v127,v127
FAD v247,v247,v125
CVT v118,v124,v125
EXP v96,v96
FAD v246,v246,v126
EXP v97,v97
FAD v247,v247,v127
CVT v119,v126,v127
EXP v98,v98
FAD v244,v244,v96
EXP v99,v99
FAD v245,v245,v97
CVT v88,v96,v97
EXP v100,v100
FAD v244,v244,v98
EXP v101,v101
FAD v245,v245,v99
CVT v89,v98,v99
EXP v102,v102
FAD v244,v244,v100
EXP v103,v103
FAD v245,v245,v101
CVT v90,v100,v101
EXP v104,v104
FAD v244,v244,v102
EXP v105,v105
FAD v245,v245,v103
CVT v91,v102,v103
EXP v106,v106
FAD v244,v244,v104
EXP v107,v107
FAD v245,v245,v105
CVT v92,v104,v105
EXP v108,v108
FAD v244,v244,v106
EXP v109,v109
FAD v245,v245,v107
CVT v93,v106,v107
EXP v110,v110
FAD v244,v244,v108
EXP v111,v111
FAD v245,v245,v109
CVT v94,v108,v109
EXP v128,v128
FAD v244,v244,v110
EXP v129,v129
FAD v245,v245,v111
CVT v95,v110,v111
EXP v130,v130
FAD v246,v246,v128
EXP v131,v131
FAD v247,v247,v129
CVT v120,v128,v129
EXP v132,v132
FAD v246,v246,v130
EXP v133,v133
FAD v247,v247,v131
CVT v121,v130,v131
EXP v134,v134
FAD v246,v246,v132
EXP v135,v135
FAD v247,v247,v133
CVT v122,v132,v133
EXP v136,v136
FAD v246,v246,v134
EXP v137,v137
FAD v247,v247,v135
CVT v123,v134,v135
EXP v138,v138
FAD v246,v246,v136
EXP v139,v139
FAD v247,v247,v137
CVT v124,v136,v137
EXP v140,v140
FAD v246,v246,v138
EXP v141,v141
FAD v247,v247,v139
CVT v125,v138,v139
EXP v142,v142
FAD v246,v246,v140
EXP v143,v143
FAD v247,v247,v141
CVT v126,v140,v141
FAD v246,v246,v142
FAD v247,v247,v143
CVT v127,v142,v143
FAD v244,v244,v245
FAD v246,v246,v247
v_max_f32 v251, v244, v246
v_cmp_nle_f32 vcc, v251, v255
s_nop 4
s_branch L_B1_back
L_B0_rare:
s_nop 12
s_mov_b32 s69, s59
buffer_load_dwordx4 a[128:131], v4, s[16:19], s69 offen offset:0
buffer_load_dwordx4 a[132:135], v4, s[16:19], s69 offen offset:1024
buffer_load_dwordx4 a[136:139], v4, s[16:19], s69 offen offset:2048
buffer_load_dwordx4 a[140:143], v4, s[16:19], s69 offen offset:3072
s_add_u32 s69, s69, 4096
buffer_load_dwordx4 a[144:147], v4, s[16:19], s69 offen offset:0
buffer_load_dwordx4 a[148:151], v4, s[16:19], s69 offen offset:1024
buffer_load_dwordx4 a[152:155], v4, s[16:19], s69 offen offset:2048
buffer_load_dwordx4 a[156:159], v4, s[16:19], s69 offen offset:3072
s_add_u32 s69, s69, 4096
buffer_load_dwordx4 a[160:163], v4, s[16:19], s69 offen offset:0
buffer_load_dwordx4 a[164:167], v4, s[16:19], s69 offen offset:1024
buffer_load_dwordx4 a[168:171], v4, s[16:19], s69 offen offset:2048
buffer_load_dwordx4 a[172:175], v4, s[16:19], s69 offen offset:3072
s_add_u32 s69, s69, 4096
buffer_load_dwordx4 a[176:179], v4, s[16:19], s69 offen offset:0
buffer_load_dwordx4 a[180:183], v4, s[16:19], s69 offen offset:1024
buffer_load_dwordx4 a[184:187], v4, s[16:19], s69 offen offset:2048
buffer_load_dwordx4 a[188:191], v4, s[16:19], s69 offen offset:3072
s_add_u32 s69, s69, 20480
s_waitcnt vmcnt(15)
M32 v[16:31],a[128:131],v[176:179],0
s_waitcnt vmcnt(14)
M32 v[16:31],a[132:135],v[180:183],v[16:31]
s_waitcnt vmcnt(13)
M32 v[16:31],a[136:139],v[184:187],v[16:31]
s_waitcnt vmcnt(12)
M32 v[16:31],a[140:143],v[188:191],v[16:31]
s_waitcnt vmcnt(11)
M32 v[16:31],a[144:147],v[192:195],v[16:31]
s_waitcnt vmcnt(10)
M32 v[16:31],a[148:151],v[196:199],v[16:31]
s_waitcnt vmcnt(9)
M32 v[16:31],a[152:155],v[200:203],v[16:31]
s_waitcnt vmcnt(8)
M32 v[16:31],a[156:159],v[204:207],v[16:31]
s_waitcnt vmcnt(7)
M32 v[32:47],a[160:163],v[176:179],0
s_waitcnt vmcnt(6)
M32 v[32:47],a[164:167],v[180:183],v[32:47]
s_waitcnt vmcnt(5)
M32 v[32:47],a[168:171],v[184:187],v[32:47]
s_waitcnt vmcnt(4)
M32 v[32:47],a[172:175],v[188:191],v[32:47]
s_waitcnt vmcnt(3)
M32 v[32:47],a[176:179],v[192:195],v[32:47]
s_waitcnt vmcnt(2)
M32 v[32:47],a[180:183],v[196:199],v[32:47]
s_waitcnt vmcnt(1)
M32 v[32:47],a[184:187],v[200:203],v[32:47]
s_waitcnt vmcnt(0)
M32 v[32:47],a[188:191],v[204:207],v[32:47]
M32 v[48:63],a[128:131],v[208:211],0
M32 v[48:63],a[132:135],v[212:215],v[48:63]
M32 v[48:63],a[136:139],v[216:219],v[48:63]
M32 v[48:63],a[140:143],v[220:223],v[48:63]
M32 v[48:63],a[144:147],v[224:227],v[48:63]
M32 v[48:63],a[148:151],v[228:231],v[48:63]
M32 v[48:63],a[152:155],v[232:235],v[48:63]
M32 v[48:63],a[156:159],v[236:239],v[48:63]
M32 v[64:79],a[160:163],v[208:211],0
M32 v[64:79],a[164:167],v[212:215],v[64:79]
M32 v[64:79],a[168:171],v[216:219],v[64:79]
M32 v[64:79],a[172:175],v[220:223],v[64:79]
M32 v[64:79],a[176:179],v[224:227],v[64:79]
M32 v[64:79],a[180:183],v[228:231],v[64:79]
M32 v[64:79],a[184:187],v[232:235],v[64:79]
M32 v[64:79],a[188:191],v[236:239],v[64:79]
v_max3_f32 v251, v16, v17, v18
v_max3_f32 v251, v251, v19, v20
v_max3_f32 v251, v251, v21, v22
v_max3_f32 v251, v251, v23, v24
v_max3_f32 v251, v251, v25, v26
v_max3_f32 v251, v251, v27, v28
v_max3_f32 v251, v251, v29, v30
v_max3_f32 v251, v251, v31, v32
v_max3_f32 v251, v251, v33, v34
v_max3_f32 v251, v251, v35, v36
v_max3_f32 v251, v251, v37, v38
v_max3_f32 v251, v251, v39, v40
v_max3_f32 v251, v251, v41, v42
v_max3_f32 v251, v251, v43, v44
v_max3_f32 v251, v251, v45, v46
v_max_f32 v251, v251, v47
v_max3_f32 v252, v48, v49, v50
v_max3_f32 v252, v252, v51, v52
v_max3_f32 v252, v252, v53, v54
v_max3_f32 v252, v252, v55, v56
v_max3_f32 v252, v252, v57, v58
v_max3_f32 v252, v252, v59, v60
v_max3_f32 v252, v252, v61, v62
v_max3_f32 v252, v252, v63, v64
v_max3_f32 v252, v252, v65, v66
v_max3_f32 v252, v252, v67, v68
v_max3_f32 v252, v252, v69, v70
v_max3_f32 v252, v252, v71, v72
v_max3_f32 v252, v252, v73, v74
v_max3_f32 v252, v252, v75, v76
v_max3_f32 v252, v252, v77, v78
v_max_f32 v252, v252, v79
v_mov_b32 v253, v251
s_nop 1
v_permlane32_swap_b32 v251, v253
v_max_f32 v251, v251, v253
v_max_f32 v251, v251, v240
FSB v253,v240,v251
EXP v254,v253
s_nop 0
FML v242,v242,v254
ARD v8,a0
ARD v9,a1
ARD v10,a2
ARD v11,a3
FML v8,v8,v254
FML v9,v9,v254
FML v10,v10,v254
FML v11,v11,v254
AWR a0,v8
AWR a1,v9
AWR a2,v10
AWR a3,v11
ARD v8,a4
ARD v9,a5
ARD v10,a6
ARD v11,a7
FML v8,v8,v254
FML v9,v9,v254
FML v10,v10,v254
FML v11,v11,v254
AWR a4,v8
AWR a5,v9
AWR a6,v10
AWR a7,v11
ARD v8,a8
ARD v9,a9
ARD v10,a10
ARD v11,a11
FML v8,v8,v254
FML v9,v9,v254
FML v10,v10,v254
FML v11,v11,v254
AWR a8,v8
AWR a9,v9
AWR a10,v10
AWR a11,v11
ARD v8,a12
ARD v9,a13
ARD v10,a14
ARD v11,a15
FML v8,v8,v254
FML v9,v9,v254
FML v10,v10,v254
FML v11,v11,v254
AWR a12,v8
AWR a13,v9
AWR a14,v10
AWR a15,v11
ARD v8,a16
ARD v9,a17
ARD v10,a18
ARD v11,a19
FML v8,v8,v254
FML v9,v9,v254
FML v10,v10,v254
FML v11,v11,v254
AWR a16,v8
AWR a17,v9
AWR a18,v10
AWR a19,v11
ARD v8,a20
ARD v9,a21
ARD v10,a22
ARD v11,a23
FML v8,v8,v254
FML v9,v9,v254
FML v10,v10,v254
FML v11,v11,v254
AWR a20,v8
AWR a21,v9
AWR a22,v10
AWR a23,v11
ARD v8,a24
ARD v9,a25
ARD v10,a26
ARD v11,a27
FML v8,v8,v254
FML v9,v9,v254
FML v10,v10,v254
FML v11,v11,v254
AWR a24,v8
AWR a25,v9
AWR a26,v10
AWR a27,v11
ARD v8,a28
ARD v9,a29
ARD v10,a30
ARD v11,a31
FML v8,v8,v254
FML v9,v9,v254
FML v10,v10,v254
FML v11,v11,v254
AWR a28,v8
AWR a29,v9
AWR a30,v10
AWR a31,v11
ARD v8,a32
ARD v9,a33
ARD v10,a34
ARD v11,a35
FML v8,v8,v254
FML v9,v9,v254
FML v10,v10,v254
FML v11,v11,v254
AWR a32,v8
AWR a33,v9
AWR a34,v10
AWR a35,v11
ARD v8,a36
ARD v9,a37
ARD v10,a38
ARD v11,a39
FML v8,v8,v254
FML v9,v9,v254
FML v10,v10,v254
FML v11,v11,v254
AWR a36,v8
AWR a37,v9
AWR a38,v10
AWR a39,v11
ARD v8,a40
ARD v9,a41
ARD v10,a42
ARD v11,a43
FML v8,v8,v254
FML v9,v9,v254
FML v10,v10,v254
FML v11,v11,v254
AWR a40,v8
AWR a41,v9
AWR a42,v10
AWR a43,v11
ARD v8,a44
ARD v9,a45
ARD v10,a46
ARD v11,a47
FML v8,v8,v254
FML v9,v9,v254
FML v10,v10,v254
FML v11,v11,v254
AWR a44,v8
AWR a45,v9
AWR a46,v10
AWR a47,v11
ARD v8,a48
ARD v9,a49
ARD v10,a50
ARD v11,a51
FML v8,v8,v254
FML v9,v9,v254
FML v10,v10,v254
FML v11,v11,v254
AWR a48,v8
AWR a49,v9
AWR a50,v10
AWR a51,v11
ARD v8,a52
ARD v9,a53
ARD v10,a54
ARD v11,a55
FML v8,v8,v254
FML v9,v9,v254
FML v10,v10,v254
FML v11,v11,v254
AWR a52,v8
AWR a53,v9
AWR a54,v10
AWR a55,v11
ARD v8,a56
ARD v9,a57
ARD v10,a58
ARD v11,a59
FML v8,v8,v254
FML v9,v9,v254
FML v10,v10,v254
FML v11,v11,v254
AWR a56,v8
AWR a57,v9
AWR a58,v10
AWR a59,v11
ARD v8,a60
ARD v9,a61
ARD v10,a62
ARD v11,a63
FML v8,v8,v254
FML v9,v9,v254
FML v10,v10,v254
FML v11,v11,v254
AWR a60,v8
AWR a61,v9
AWR a62,v10
AWR a63,v11
FAD v80,v80,v253
FAD v81,v81,v253
FAD v82,v82,v253
FAD v83,v83,v253
FAD v84,v84,v253
FAD v85,v85,v253
FAD v86,v86,v253
FAD v87,v87,v253
FAD v88,v88,v253
FAD v89,v89,v253
FAD v90,v90,v253
FAD v91,v91,v253
FAD v92,v92,v253
FAD v93,v93,v253
FAD v94,v94,v253
FAD v95,v95,v253
FAD v96,v96,v253
FAD v97,v97,v253
FAD v98,v98,v253
FAD v99,v99,v253
FAD v100,v100,v253
FAD v101,v101,v253
FAD v102,v102,v253
FAD v103,v103,v253
FAD v104,v104,v253
FAD v105,v105,v253
FAD v106,v106,v253
FAD v107,v107,v253
FAD v108,v108,v253
FAD v109,v109,v253
FAD v110,v110,v253
FAD v111,v111,v253
v_mov_b32 v240, v251
FSB v144,0,v251
FSB v145,0,v251
FSB v146,0,v251
FSB v147,0,v251
FSB v148,0,v251
FSB v149,0,v251
FSB v150,0,v251
FSB v151,0,v251
FSB v152,0,v251
FSB v153,0,v251
FSB v154,0,v251
FSB v155,0,v251
FSB v156,0,v251
FSB v157,0,v251
FSB v158,0,v251
FSB v159,0,v251
FSB v16,v16,v251
FSB v17,v17,v251
FSB v18,v18,v251
FSB v19,v19,v251
FSB v20,v20,v251
FSB v21,v21,v251
FSB v22,v22,v251
FSB v23,v23,v251
FSB v24,v24,v251
FSB v25,v25,v251
FSB v26,v26,v251
FSB v27,v27,v251
FSB v28,v28,v251
FSB v29,v29,v251
FSB v30,v30,v251
FSB v31,v31,v251
FSB v32,v32,v251
FSB v33,v33,v251
FSB v34,v34,v251
FSB v35,v35,v251
FSB v36,v36,v251
FSB v37,v37,v251
FSB v38,v38,v251
FSB v39,v39,v251
FSB v40,v40,v251
FSB v41,v41,v251
FSB v42,v42,v251
FSB v43,v43,v251
FSB v44,v44,v251
FSB v45,v45,v251
FSB v46,v46,v251
FSB v47,v47,v251
v_mov_b32 v253, v252
s_nop 1
v_permlane32_swap_b32 v252, v253
v_max_f32 v252, v252, v253
v_max_f32 v252, v252, v241
FSB v253,v241,v252
EXP v254,v253
s_nop 0
FML v243,v243,v254
ARD v8,a64
ARD v9,a65
ARD v10,a66
ARD v11,a67
FML v8,v8,v254
FML v9,v9,v254
FML v10,v10,v254
FML v11,v11,v254
AWR a64,v8
AWR a65,v9
AWR a66,v10
AWR a67,v11
ARD v8,a68
ARD v9,a69
ARD v10,a70
ARD v11,a71
FML v8,v8,v254
FML v9,v9,v254
FML v10,v10,v254
FML v11,v11,v254
AWR a68,v8
AWR a69,v9
AWR a70,v10
AWR a71,v11
ARD v8,a72
ARD v9,a73
ARD v10,a74
ARD v11,a75
FML v8,v8,v254
FML v9,v9,v254
FML v10,v10,v254
FML v11,v11,v254
AWR a72,v8
AWR a73,v9
AWR a74,v10
AWR a75,v11
ARD v8,a76
ARD v9,a77
ARD v10,a78
ARD v11,a79
FML v8,v8,v254
FML v9,v9,v254
FML v10,v10,v254
FML v11,v11,v254
AWR a76,v8
AWR a77,v9
AWR a78,v10
AWR a79,v11
ARD v8,a80
ARD v9,a81
ARD v10,a82
ARD v11,a83
FML v8,v8,v254
FML v9,v9,v254
FML v10,v10,v254
FML v11,v11,v254
AWR a80,v8
AWR a81,v9
AWR a82,v10
AWR a83,v11
ARD v8,a84
ARD v9,a85
ARD v10,a86
ARD v11,a87
FML v8,v8,v254
FML v9,v9,v254
FML v10,v10,v254
FML v11,v11,v254
AWR a84,v8
AWR a85,v9
AWR a86,v10
AWR a87,v11
ARD v8,a88
ARD v9,a89
ARD v10,a90
ARD v11,a91
FML v8,v8,v254
FML v9,v9,v254
FML v10,v10,v254
FML v11,v11,v254
AWR a88,v8
AWR a89,v9
AWR a90,v10
AWR a91,v11
ARD v8,a92
ARD v9,a93
ARD v10,a94
ARD v11,a95
FML v8,v8,v254
FML v9,v9,v254
FML v10,v10,v254
FML v11,v11,v254
AWR a92,v8
AWR a93,v9
AWR a94,v10
AWR a95,v11
ARD v8,a96
ARD v9,a97
ARD v10,a98
ARD v11,a99
FML v8,v8,v254
FML v9,v9,v254
FML v10,v10,v254
FML v11,v11,v254
AWR a96,v8
AWR a97,v9
AWR a98,v10
AWR a99,v11
ARD v8,a100
ARD v9,a101
ARD v10,a102
ARD v11,a103
FML v8,v8,v254
FML v9,v9,v254
FML v10,v10,v254
FML v11,v11,v254
AWR a100,v8
AWR a101,v9
AWR a102,v10
AWR a103,v11
ARD v8,a104
ARD v9,a105
ARD v10,a106
ARD v11,a107
FML v8,v8,v254
FML v9,v9,v254
FML v10,v10,v254
FML v11,v11,v254
AWR a104,v8
AWR a105,v9
AWR a106,v10
AWR a107,v11
ARD v8,a108
ARD v9,a109
ARD v10,a110
ARD v11,a111
FML v8,v8,v254
FML v9,v9,v254
FML v10,v10,v254
FML v11,v11,v254
AWR a108,v8
AWR a109,v9
AWR a110,v10
AWR a111,v11
ARD v8,a112
ARD v9,a113
ARD v10,a114
ARD v11,a115
FML v8,v8,v254
FML v9,v9,v254
FML v10,v10,v254
FML v11,v11,v254
AWR a112,v8
AWR a113,v9
AWR a114,v10
AWR a115,v11
ARD v8,a116
ARD v9,a117
ARD v10,a118
ARD v11,a119
FML v8,v8,v254
FML v9,v9,v254
FML v10,v10,v254
FML v11,v11,v254
AWR a116,v8
AWR a117,v9
AWR a118,v10
AWR a119,v11
ARD v8,a120
ARD v9,a121
ARD v10,a122
ARD v11,a123
FML v8,v8,v254
FML v9,v9,v254
FML v10,v10,v254
FML v11,v11,v254
AWR a120,v8
AWR a121,v9
AWR a122,v10
AWR a123,v11
ARD v8,a124
ARD v9,a125
ARD v10,a126
ARD v11,a127
FML v8,v8,v254
FML v9,v9,v254
FML v10,v10,v254
FML v11,v11,v254
AWR a124,v8
AWR a125,v9
AWR a126,v10
AWR a127,v11
FAD v112,v112,v253
FAD v113,v113,v253
FAD v114,v114,v253
FAD v115,v115,v253
FAD v116,v116,v253
FAD v117,v117,v253
FAD v118,v118,v253
FAD v119,v119,v253
FAD v120,v120,v253
FAD v121,v121,v253
FAD v122,v122,v253
FAD v123,v123,v253
FAD v124,v124,v253
FAD v125,v125,v253
FAD v126,v126,v253
FAD v127,v127,v253
FAD v128,v128,v253
FAD v129,v129,v253
FAD v130,v130,v253
FAD v131,v131,v253
FAD v132,v132,v253
FAD v133,v133,v253
FAD v134,v134,v253
FAD v135,v135,v253
FAD v136,v136,v253
FAD v137,v137,v253
FAD v138,v138,v253
FAD v139,v139,v253
FAD v140,v140,v253
FAD v141,v141,v253
FAD v142,v142,v253
FAD v143,v143,v253
v_mov_b32 v241, v252
FSB v160,0,v252
FSB v161,0,v252
FSB v162,0,v252
FSB v163,0,v252
FSB v164,0,v252
FSB v165,0,v252
FSB v166,0,v252
FSB v167,0,v252
FSB v168,0,v252
FSB v169,0,v252
FSB v170,0,v252
FSB v171,0,v252
FSB v172,0,v252
FSB v173,0,v252
FSB v174,0,v252
FSB v175,0,v252
FSB v48,v48,v252
FSB v49,v49,v252
FSB v50,v50,v252
FSB v51,v51,v252
FSB v52,v52,v252
FSB v53,v53,v252
FSB v54,v54,v252
FSB v55,v55,v252
FSB v56,v56,v252
FSB v57,v57,v252
FSB v58,v58,v252
FSB v59,v59,v252
FSB v60,v60,v252
FSB v61,v61,v252
FSB v62,v62,v252
FSB v63,v63,v252
FSB v64,v64,v252
FSB v65,v65,v252
FSB v66,v66,v252
FSB v67,v67,v252
FSB v68,v68,v252
FSB v69,v69,v252
FSB v70,v70,v252
FSB v71,v71,v252
FSB v72,v72,v252
FSB v73,v73,v252
FSB v74,v74,v252
FSB v75,v75,v252
FSB v76,v76,v252
FSB v77,v77,v252
FSB v78,v78,v252
FSB v79,v79,v252
EXP v16,v16
EXP v17,v17
EXP v18,v18
FAD v244,v16,v17
EXP v19,v19
CVT v16,v16,v17
EXP v20,v20
FAD v245,v18,v19
EXP v21,v21
CVT v17,v18,v19
EXP v22,v22
FAD v244,v244,v20
EXP v23,v23
FAD v245,v245,v21
CVT v18,v20,v21
EXP v24,v24
FAD v244,v244,v22
EXP v25,v25
FAD v245,v245,v23
CVT v19,v22,v23
EXP v26,v26
FAD v244,v244,v24
EXP v27,v27
FAD v245,v245,v25
CVT v20,v24,v25
EXP v28,v28
FAD v244,v244,v26
EXP v29,v29
FAD v245,v245,v27
CVT v21,v26,v27
EXP v30,v30
FAD v244,v244,v28
EXP v31,v31
FAD v245,v245,v29
CVT v22,v28,v29
EXP v48,v48
FAD v244,v244,v30
EXP v49,v49
FAD v245,v245,v31
CVT v23,v30,v31
EXP v50,v50
FAD v246,v48,v49
EXP v51,v51
CVT v48,v48,v49
EXP v52,v52
FAD v247,v50,v51
EXP v53,v53
CVT v49,v50,v51
EXP v54,v54
FAD v246,v246,v52
EXP v55,v55
FAD v247,v247,v53
CVT v50,v52,v53
EXP v56,v56
FAD v246,v246,v54
EXP v57,v57
FAD v247,v247,v55
CVT v51,v54,v55
EXP v58,v58
FAD v246,v246,v56
EXP v59,v59
FAD v247,v247,v57
CVT v52,v56,v57
EXP v60,v60
FAD v246,v246,v58
EXP v61,v61
FAD v247,v247,v59
CVT v53,v58,v59
EXP v62,v62
FAD v246,v246,v60
EXP v63,v63
FAD v247,v247,v61
CVT v54,v60,v61
EXP v32,v32
FAD v246,v246,v62
EXP v33,v33
FAD v247,v247,v63
CVT v55,v62,v63
EXP v34,v34
FAD v244,v244,v32
EXP v35,v35
FAD v245,v245,v33
CVT v24,v32,v33
EXP v36,v36
FAD v244,v244,v34
EXP v37,v37
FAD v245,v245,v35
CVT v25,v34,v35
EXP v38,v38
FAD v244,v244,v36
EXP v39,v39
FAD v245,v245,v37
CVT v26,v36,v37
EXP v40,v40
FAD v244,v244,v38
EXP v41,v41
FAD v245,v245,v39
CVT v27,v38,v39
EXP v42,v42
FAD v244,v244,v40
EXP v43,v43
FAD v245,v245,v41
CVT v28,v40,v41
EXP v44,v44
FAD v244,v244,v42
EXP v45,v45
FAD v245,v245,v43
CVT v29,v42,v43
EXP v46,v46
FAD v244,v244,v44
EXP v47,v47
FAD v245,v245,v45
CVT v30,v44,v45
EXP v64,v64
FAD v244,v244,v46
EXP v65,v65
FAD v245,v245,v47
CVT v31,v46,v47
EXP v66,v66
FAD v246,v246,v64
EXP v67,v67
FAD v247,v247,v65
CVT v56,v64,v65
EXP v68,v68
FAD v246,v246,v66
EXP v69,v69
FAD v247,v247,v67
CVT v57,v66,v67
EXP v70,v70
FAD v246,v246,v68
EXP v71,v71
FAD v247,v247,v69
CVT v58,v68,v69
EXP v72,v72
FAD v246,v246,v70
EXP v73,v73
FAD v247,v247,v71
CVT v59,v70,v71
EXP v74,v74
FAD v246,v246,v72
EXP v75,v75
FAD v247,v247,v73
CVT v60,v72,v73
EXP v76,v76
FAD v246,v246,v74
EXP v77,v77
FAD v247,v247,v75
CVT v61,v74,v75
EXP v78,v78
FAD v246,v246,v76
EXP v79,v79
FAD v247,v247,v77
CVT v62,v76,v77
FAD v246,v246,v78
FAD v247,v247,v79
CVT v63,v78,v79
FAD v244,v244,v245
FAD v246,v246,v247
v_max_f32 v251, v244, v246
v_cmp_nle_f32 vcc, v251, v255
s_nop 4
s_branch L_B0_back
L_Cp_rare:
s_nop 12
s_mov_b32 s69, s59
buffer_load_dwordx4 a[128:131], v4, s[16:19], s69 offen offset:0
buffer_load_dwordx4 a[132:135], v4, s[16:19], s69 offen offset:1024
buffer_load_dwordx4 a[136:139], v4, s[16:19], s69 offen offset:2048
buffer_load_dwordx4 a[140:143], v4, s[16:19], s69 offen offset:3072
s_add_u32 s69, s69, 4096
buffer_load_dwordx4 a[144:147], v4, s[16:19], s69 offen offset:0
buffer_load_dwordx4 a[148:151], v4, s[16:19], s69 offen offset:1024
buffer_load_dwordx4 a[152:155], v4, s[16:19], s69 offen offset:2048
buffer_load_dwordx4 a[156:159], v4, s[16:19], s69 offen offset:3072
s_add_u32 s69, s69, 4096
buffer_load_dwordx4 a[160:163], v4, s[16:19], s69 offen offset:0
buffer_load_dwordx4 a[164:167], v4, s[16:19], s69 offen offset:1024
buffer_load_dwordx4 a[168:171], v4, s[16:19], s69 offen offset:2048
buffer_load_dwordx4 a[172:175], v4, s[16:19], s69 offen offset:3072
s_add_u32 s69, s69, 4096
buffer_load_dwordx4 a[176:179], v4, s[16:19], s69 offen offset:0
buffer_load_dwordx4 a[180:183], v4, s[16:19], s69 offen offset:1024
buffer_load_dwordx4 a[184:187], v4, s[16:19], s69 offen offset:2048
buffer_load_dwordx4 a[188:191], v4, s[16:19], s69 offen offset:3072
s_add_u32 s69, s69, 20480
s_waitcnt vmcnt(15)
M32 v[16:31],a[128:131],v[176:179],0
s_waitcnt vmcnt(14)
M32 v[16:31],a[132:135],v[180:183],v[16:31]
s_waitcnt vmcnt(13)
M32 v[16:31],a[136:139],v[184:187],v[16:31]
s_waitcnt vmcnt(12)
M32 v[16:31],a[140:143],v[188:191],v[16:31]
s_waitcnt vmcnt(11)
M32 v[16:31],a[144:147],v[192:195],v[16:31]
s_waitcnt vmcnt(10)
M32 v[16:31],a[148:151],v[196:199],v[16:31]
s_waitcnt vmcnt(9)
M32 v[16:31],a[152:155],v[200:203],v[16:31]
s_waitcnt vmcnt(8)
M32 v[16:31],a[156:159],v[204:207],v[16:31]
s_waitcnt vmcnt(7)
M32 v[32:47],a[160:163],v[176:179],0
s_waitcnt vmcnt(6)
M32 v[32:47],a[164:167],v[180:183],v[32:47]
s_waitcnt vmcnt(5)
M32 v[32:47],a[168:171],v[184:187],v[32:47]
s_waitcnt vmcnt(4)
M32 v[32:47],a[172:175],v[188:191],v[32:47]
s_waitcnt vmcnt(3)
M32 v[32:47],a[176:179],v[192:195],v[32:47]
s_waitcnt vmcnt(2)
M32 v[32:47],a[180:183],v[196:199],v[32:47]
s_waitcnt vmcnt(1)
M32 v[32:47],a[184:187],v[200:203],v[32:47]
s_waitcnt vmcnt(0)
M32 v[32:47],a[188:191],v[204:207],v[32:47]
M32 v[48:63],a[128:131],v[208:211],0
M32 v[48:63],a[132:135],v[212:215],v[48:63]
M32 v[48:63],a[136:139],v[216:219],v[48:63]
M32 v[48:63],a[140:143],v[220:223],v[48:63]
M32 v[48:63],a[144:147],v[224:227],v[48:63]
M32 v[48:63],a[148:151],v[228:231],v[48:63]
M32 v[48:63],a[152:155],v[232:235],v[48:63]
M32 v[48:63],a[156:159],v[236:239],v[48:63]
M32 v[64:79],a[160:163],v[208:211],0
M32 v[64:79],a[164:167],v[212:215],v[64:79]
M32 v[64:79],a[168:171],v[216:219],v[64:79]
M32 v[64:79],a[172:175],v[220:223],v[64:79]
M32 v[64:79],a[176:179],v[224:227],v[64:79]
M32 v[64:79],a[180:183],v[228:231],v[64:79]
M32 v[64:79],a[184:187],v[232:235],v[64:79]
M32 v[64:79],a[188:191],v[236:239],v[64:79]
v_max3_f32 v251, v16, v17, v18
v_max3_f32 v251, v251, v19, v20
v_max3_f32 v251, v251, v21, v22
v_max3_f32 v251, v251, v23, v24
v_max3_f32 v251, v251, v25, v26
v_max3_f32 v251, v251, v27, v28
v_max3_f32 v251, v251, v29, v30
v_max3_f32 v251, v251, v31, v32
v_max3_f32 v251, v251, v33, v34
v_max3_f32 v251, v251, v35, v36
v_max3_f32 v251, v251, v37, v38
v_max3_f32 v251, v251, v39, v40
v_max3_f32 v251, v251, v41, v42
v_max3_f32 v251, v251, v43, v44
v_max3_f32 v251, v251, v45, v46
v_max_f32 v251, v251, v47
v_max3_f32 v252, v48, v49, v50
v_max3_f32 v252, v252, v51, v52
v_max3_f32 v252, v252, v53, v54
v_max3_f32 v252, v252, v55, v56
v_max3_f32 v252, v252, v57, v58
v_max3_f32 v252, v252, v59, v60
v_max3_f32 v252, v252, v61, v62
v_max3_f32 v252, v252, v63, v64
v_max3_f32 v252, v252, v65, v66
v_max3_f32 v252, v252, v67, v68
v_max3_f32 v252, v252, v69, v70
v_max3_f32 v252, v252, v71, v72
v_max3_f32 v252, v252, v73, v74
v_max3_f32 v252, v252, v75, v76
v_max3_f32 v252, v252, v77, v78
v_max_f32 v252, v252, v79
v_mov_b32 v253, v251
s_nop 1
v_permlane32_swap_b32 v251, v253
v_max_f32 v251, v251, v253
v_max_f32 v251, v251, v240
FSB v253,v240,v251
EXP v254,v253
s_nop 0
FML v242,v242,v254
ARD v8,a0
ARD v9,a1
ARD v10,a2
ARD v11,a3
FML v8,v8,v254
FML v9,v9,v254
FML v10,v10,v254
FML v11,v11,v254
AWR a0,v8
AWR a1,v9
AWR a2,v10
AWR a3,v11
ARD v8,a4
ARD v9,a5
ARD v10,a6
ARD v11,a7
FML v8,v8,v254
FML v9,v9,v254
FML v10,v10,v254
FML v11,v11,v254
AWR a4,v8
AWR a5,v9
AWR a6,v10
AWR a7,v11
ARD v8,a8
ARD v9,a9
ARD v10,a10
ARD v11,a11
FML v8,v8,v254
FML v9,v9,v254
FML v10,v10,v254
FML v11,v11,v254
AWR a8,v8
AWR a9,v9
AWR a10,v10
AWR a11,v11
ARD v8,a12
ARD v9,a13
ARD v10,a14
ARD v11,a15
FML v8,v8,v254
FML v9,v9,v254
FML v10,v10,v254
FML v11,v11,v254
AWR a12,v8
AWR a13,v9
AWR a14,v10
AWR a15,v11
ARD v8,a16
ARD v9,a17
ARD v10,a18
ARD v11,a19
FML v8,v8,v254
FML v9,v9,v254
FML v10,v10,v254
FML v11,v11,v254
AWR a16,v8
AWR a17,v9
AWR a18,v10
AWR a19,v11
ARD v8,a20
ARD v9,a21
ARD v10,a22
ARD v11,a23
FML v8,v8,v254
FML v9,v9,v254
FML v10,v10,v254
FML v11,v11,v254
AWR a20,v8
AWR a21,v9
AWR a22,v10
AWR a23,v11
ARD v8,a24
ARD v9,a25
ARD v10,a26
ARD v11,a27
FML v8,v8,v254
FML v9,v9,v254
FML v10,v10,v254
FML v11,v11,v254
AWR a24,v8
AWR a25,v9
AWR a26,v10
AWR a27,v11
ARD v8,a28
ARD v9,a29
ARD v10,a30
ARD v11,a31
FML v8,v8,v254
FML v9,v9,v254
FML v10,v10,v254
FML v11,v11,v254
AWR a28,v8
AWR a29,v9
AWR a30,v10
AWR a31,v11
ARD v8,a32
ARD v9,a33
ARD v10,a34
ARD v11,a35
FML v8,v8,v254
FML v9,v9,v254
FML v10,v10,v254
FML v11,v11,v254
AWR a32,v8
AWR a33,v9
AWR a34,v10
AWR a35,v11
ARD v8,a36
ARD v9,a37
ARD v10,a38
ARD v11,a39
FML v8,v8,v254
FML v9,v9,v254
FML v10,v10,v254
FML v11,v11,v254
AWR a36,v8
AWR a37,v9
AWR a38,v10
AWR a39,v11
ARD v8,a40
ARD v9,a41
ARD v10,a42
ARD v11,a43
FML v8,v8,v254
FML v9,v9,v254
FML v10,v10,v254
FML v11,v11,v254
AWR a40,v8
AWR a41,v9
AWR a42,v10
AWR a43,v11
ARD v8,a44
ARD v9,a45
ARD v10,a46
ARD v11,a47
FML v8,v8,v254
FML v9,v9,v254
FML v10,v10,v254
FML v11,v11,v254
AWR a44,v8
AWR a45,v9
AWR a46,v10
AWR a47,v11
ARD v8,a48
ARD v9,a49
ARD v10,a50
ARD v11,a51
FML v8,v8,v254
FML v9,v9,v254
FML v10,v10,v254
FML v11,v11,v254
AWR a48,v8
AWR a49,v9
AWR a50,v10
AWR a51,v11
ARD v8,a52
ARD v9,a53
ARD v10,a54
ARD v11,a55
FML v8,v8,v254
FML v9,v9,v254
FML v10,v10,v254
FML v11,v11,v254
AWR a52,v8
AWR a53,v9
AWR a54,v10
AWR a55,v11
ARD v8,a56
ARD v9,a57
ARD v10,a58
ARD v11,a59
FML v8,v8,v254
FML v9,v9,v254
FML v10,v10,v254
FML v11,v11,v254
AWR a56,v8
AWR a57,v9
AWR a58,v10
AWR a59,v11
ARD v8,a60
ARD v9,a61
ARD v10,a62
ARD v11,a63
FML v8,v8,v254
FML v9,v9,v254
FML v10,v10,v254
FML v11,v11,v254
AWR a60,v8
AWR a61,v9
AWR a62,v10
AWR a63,v11
FAD v80,v80,v253
FAD v81,v81,v253
FAD v82,v82,v253
FAD v83,v83,v253
FAD v84,v84,v253
FAD v85,v85,v253
FAD v86,v86,v253
FAD v87,v87,v253
FAD v88,v88,v253
FAD v89,v89,v253
FAD v90,v90,v253
FAD v91,v91,v253
FAD v92,v92,v253
FAD v93,v93,v253
FAD v94,v94,v253
FAD v95,v95,v253
FAD v96,v96,v253
FAD v97,v97,v253
FAD v98,v98,v253
FAD v99,v99,v253
FAD v100,v100,v253
FAD v101,v101,v253
FAD v102,v102,v253
FAD v103,v103,v253
FAD v104,v104,v253
FAD v105,v105,v253
FAD v106,v106,v253
FAD v107,v107,v253
FAD v108,v108,v253
FAD v109,v109,v253
FAD v110,v110,v253
FAD v111,v111,v253
v_mov_b32 v240, v251
FSB v144,0,v251
FSB v145,0,v251
FSB v146,0,v251
FSB v147,0,v251
FSB v148,0,v251
FSB v149,0,v251
FSB v150,0,v251
FSB v151,0,v251
FSB v152,0,v251
FSB v153,0,v251
FSB v154,0,v251
FSB v155,0,v251
FSB v156,0,v251
FSB v157,0,v251
FSB v158,0,v251
FSB v159,0,v251
FSB v16,v16,v251
FSB v17,v17,v251
FSB v18,v18,v251
FSB v19,v19,v251
FSB v20,v20,v251
FSB v21,v21,v251
FSB v22,v22,v251
FSB v23,v23,v251
FSB v24,v24,v251
FSB v25,v25,v251
FSB v26,v26,v251
FSB v27,v27,v251
FSB v28,v28,v251
FSB v29,v29,v251
FSB v30,v30,v251
FSB v31,v31,v251
FSB v32,v32,v251
FSB v33,v33,v251
FSB v34,v34,v251
FSB v35,v35,v251
FSB v36,v36,v251
FSB v37,v37,v251
FSB v38,v38,v251
FSB v39,v39,v251
FSB v40,v40,v251
FSB v41,v41,v251
FSB v42,v42,v251
FSB v43,v43,v251
FSB v44,v44,v251
FSB v45,v45,v251
FSB v46,v46,v251
FSB v47,v47,v251
v_mov_b32 v253, v252
s_nop 1
v_permlane32_swap_b32 v252, v253
v_max_f32 v252, v252, v253
v_max_f32 v252, v252, v241
FSB v253,v241,v252
EXP v254,v253
s_nop 0
FML v243,v243,v254
ARD v8,a64
ARD v9,a65
ARD v10,a66
ARD v11,a67
FML v8,v8,v254
FML v9,v9,v254
FML v10,v10,v254
FML v11,v11,v254
AWR a64,v8
AWR a65,v9
AWR a66,v10
AWR a67,v11
ARD v8,a68
ARD v9,a69
ARD v10,a70
ARD v11,a71
FML v8,v8,v254
FML v9,v9,v254
FML v10,v10,v254
FML v11,v11,v254
AWR a68,v8
AWR a69,v9
AWR a70,v10
AWR a71,v11
ARD v8,a72
ARD v9,a73
ARD v10,a74
ARD v11,a75
FML v8,v8,v254
FML v9,v9,v254
FML v10,v10,v254
FML v11,v11,v254
AWR a72,v8
AWR a73,v9
AWR a74,v10
AWR a75,v11
ARD v8,a76
ARD v9,a77
ARD v10,a78
ARD v11,a79
FML v8,v8,v254
FML v9,v9,v254
FML v10,v10,v254
FML v11,v11,v254
AWR a76,v8
AWR a77,v9
AWR a78,v10
AWR a79,v11
ARD v8,a80
ARD v9,a81
ARD v10,a82
ARD v11,a83
FML v8,v8,v254
FML v9,v9,v254
FML v10,v10,v254
FML v11,v11,v254
AWR a80,v8
AWR a81,v9
AWR a82,v10
AWR a83,v11
ARD v8,a84
ARD v9,a85
ARD v10,a86
ARD v11,a87
FML v8,v8,v254
FML v9,v9,v254
FML v10,v10,v254
FML v11,v11,v254
AWR a84,v8
AWR a85,v9
AWR a86,v10
AWR a87,v11
ARD v8,a88
ARD v9,a89
ARD v10,a90
ARD v11,a91
FML v8,v8,v254
FML v9,v9,v254
FML v10,v10,v254
FML v11,v11,v254
AWR a88,v8
AWR a89,v9
AWR a90,v10
AWR a91,v11
ARD v8,a92
ARD v9,a93
ARD v10,a94
ARD v11,a95
FML v8,v8,v254
FML v9,v9,v254
FML v10,v10,v254
FML v11,v11,v254
AWR a92,v8
AWR a93,v9
AWR a94,v10
AWR a95,v11
ARD v8,a96
ARD v9,a97
ARD v10,a98
ARD v11,a99
FML v8,v8,v254
FML v9,v9,v254
FML v10,v10,v254
FML v11,v11,v254
AWR a96,v8
AWR a97,v9
AWR a98,v10
AWR a99,v11
ARD v8,a100
ARD v9,a101
ARD v10,a102
ARD v11,a103
FML v8,v8,v254
FML v9,v9,v254
FML v10,v10,v254
FML v11,v11,v254
AWR a100,v8
AWR a101,v9
AWR a102,v10
AWR a103,v11
ARD v8,a104
ARD v9,a105
ARD v10,a106
ARD v11,a107
FML v8,v8,v254
FML v9,v9,v254
FML v10,v10,v254
FML v11,v11,v254
AWR a104,v8
AWR a105,v9
AWR a106,v10
AWR a107,v11
ARD v8,a108
ARD v9,a109
ARD v10,a110
ARD v11,a111
FML v8,v8,v254
FML v9,v9,v254
FML v10,v10,v254
FML v11,v11,v254
AWR a108,v8
AWR a109,v9
AWR a110,v10
AWR a111,v11
ARD v8,a112
ARD v9,a113
ARD v10,a114
ARD v11,a115
FML v8,v8,v254
FML v9,v9,v254
FML v10,v10,v254
FML v11,v11,v254
AWR a112,v8
AWR a113,v9
AWR a114,v10
AWR a115,v11
ARD v8,a116
ARD v9,a117
ARD v10,a118
ARD v11,a119
FML v8,v8,v254
FML v9,v9,v254
FML v10,v10,v254
FML v11,v11,v254
AWR a116,v8
AWR a117,v9
AWR a118,v10
AWR a119,v11
ARD v8,a120
ARD v9,a121
ARD v10,a122
ARD v11,a123
FML v8,v8,v254
FML v9,v9,v254
FML v10,v10,v254
FML v11,v11,v254
AWR a120,v8
AWR a121,v9
AWR a122,v10
AWR a123,v11
ARD v8,a124
ARD v9,a125
ARD v10,a126
ARD v11,a127
FML v8,v8,v254
FML v9,v9,v254
FML v10,v10,v254
FML v11,v11,v254
AWR a124,v8
AWR a125,v9
AWR a126,v10
AWR a127,v11
FAD v112,v112,v253
FAD v113,v113,v253
FAD v114,v114,v253
FAD v115,v115,v253
FAD v116,v116,v253
FAD v117,v117,v253
FAD v118,v118,v253
FAD v119,v119,v253
FAD v120,v120,v253
FAD v121,v121,v253
FAD v122,v122,v253
FAD v123,v123,v253
FAD v124,v124,v253
FAD v125,v125,v253
FAD v126,v126,v253
FAD v127,v127,v253
FAD v128,v128,v253
FAD v129,v129,v253
FAD v130,v130,v253
FAD v131,v131,v253
FAD v132,v132,v253
FAD v133,v133,v253
FAD v134,v134,v253
FAD v135,v135,v253
FAD v136,v136,v253
FAD v137,v137,v253
FAD v138,v138,v253
FAD v139,v139,v253
FAD v140,v140,v253
FAD v141,v141,v253
FAD v142,v142,v253
FAD v143,v143,v253
v_mov_b32 v241, v252
FSB v160,0,v252
FSB v161,0,v252
FSB v162,0,v252
FSB v163,0,v252
FSB v164,0,v252
FSB v165,0,v252
FSB v166,0,v252
FSB v167,0,v252
FSB v168,0,v252
FSB v169,0,v252
FSB v170,0,v252
FSB v171,0,v252
FSB v172,0,v252
FSB v173,0,v252
FSB v174,0,v252
FSB v175,0,v252
FSB v48,v48,v252
FSB v49,v49,v252
FSB v50,v50,v252
FSB v51,v51,v252
FSB v52,v52,v252
FSB v53,v53,v252
FSB v54,v54,v252
FSB v55,v55,v252
FSB v56,v56,v252
FSB v57,v57,v252
FSB v58,v58,v252
FSB v59,v59,v252
FSB v60,v60,v252
FSB v61,v61,v252
FSB v62,v62,v252
FSB v63,v63,v252
FSB v64,v64,v252
FSB v65,v65,v252
FSB v66,v66,v252
FSB v67,v67,v252
FSB v68,v68,v252
FSB v69,v69,v252
FSB v70,v70,v252
FSB v71,v71,v252
FSB v72,v72,v252
FSB v73,v73,v252
FSB v74,v74,v252
FSB v75,v75,v252
FSB v76,v76,v252
FSB v77,v77,v252
FSB v78,v78,v252
FSB v79,v79,v252
EXP v16,v16
EXP v17,v17
EXP v18,v18
FAD v244,v16,v17
EXP v19,v19
CVT v16,v16,v17
EXP v20,v20
FAD v245,v18,v19
EXP v21,v21
CVT v17,v18,v19
EXP v22,v22
FAD v244,v244,v20
EXP v23,v23
FAD v245,v245,v21
CVT v18,v20,v21
EXP v24,v24
FAD v244,v244,v22
EXP v25,v25
FAD v245,v245,v23
CVT v19,v22,v23
EXP v26,v26
FAD v244,v244,v24
EXP v27,v27
FAD v245,v245,v25
CVT v20,v24,v25
EXP v28,v28
FAD v244,v244,v26
EXP v29,v29
FAD v245,v245,v27
CVT v21,v26,v27
EXP v30,v30
FAD v244,v244,v28
EXP v31,v31
FAD v245,v245,v29
CVT v22,v28,v29
EXP v48,v48
FAD v244,v244,v30
EXP v49,v49
FAD v245,v245,v31
CVT v23,v30,v31
EXP v50,v50
FAD v246,v48,v49
EXP v51,v51
CVT v48,v48,v49
EXP v52,v52
FAD v247,v50,v51
EXP v53,v53
CVT v49,v50,v51
EXP v54,v54
FAD v246,v246,v52
EXP v55,v55
FAD v247,v247,v53
CVT v50,v52,v53
EXP v56,v56
FAD v246,v246,v54
EXP v57,v57
FAD v247,v247,v55
CVT v51,v54,v55
EXP v58,v58
FAD v246,v246,v56
EXP v59,v59
FAD v247,v247,v57
CVT v52,v56,v57
EXP v60,v60
FAD v246,v246,v58
EXP v61,v61
FAD v247,v247,v59
CVT v53,v58,v59
EXP v62,v62
FAD v246,v246,v60
EXP v63,v63
FAD v247,v247,v61
CVT v54,v60,v61
EXP v32,v32
FAD v246,v246,v62
EXP v33,v33
FAD v247,v247,v63
CVT v55,v62,v63
EXP v34,v34
FAD v244,v244,v32
EXP v35,v35
FAD v245,v245,v33
CVT v24,v32,v33
EXP v36,v36
FAD v244,v244,v34
EXP v37,v37
FAD v245,v245,v35
CVT v25,v34,v35
EXP v38,v38
FAD v244,v244,v36
EXP v39,v39
FAD v245,v245,v37
CVT v26,v36,v37
EXP v40,v40
FAD v244,v244,v38
EXP v41,v41
FAD v245,v245,v39
CVT v27,v38,v39
EXP v42,v42
FAD v244,v244,v40
EXP v43,v43
FAD v245,v245,v41
CVT v28,v40,v41
EXP v44,v44
FAD v244,v244,v42
EXP v45,v45
FAD v245,v245,v43
CVT v29,v42,v43
EXP v46,v46
FAD v244,v244,v44
EXP v47,v47
FAD v245,v245,v45
CVT v30,v44,v45
EXP v64,v64
FAD v244,v244,v46
EXP v65,v65
FAD v245,v245,v47
CVT v31,v46,v47
EXP v66,v66
FAD v246,v246,v64
EXP v67,v67
FAD v247,v247,v65
CVT v56,v64,v65
EXP v68,v68
FAD v246,v246,v66
EXP v69,v69
FAD v247,v247,v67
CVT v57,v66,v67
EXP v70,v70
FAD v246,v246,v68
EXP v71,v71
FAD v247,v247,v69
CVT v58,v68,v69
EXP v72,v72
FAD v246,v246,v70
EXP v73,v73
FAD v247,v247,v71
CVT v59,v70,v71
EXP v74,v74
FAD v246,v246,v72
EXP v75,v75
FAD v247,v247,v73
CVT v60,v72,v73
EXP v76,v76
FAD v246,v246,v74
EXP v77,v77
FAD v247,v247,v75
CVT v61,v74,v75
EXP v78,v78
FAD v246,v246,v76
EXP v79,v79
FAD v247,v247,v77
CVT v62,v76,v77
FAD v246,v246,v78
FAD v247,v247,v79
CVT v63,v78,v79
FAD v244,v244,v245
FAD v246,v246,v247
v_max_f32 v251, v244, v246
v_cmp_nle_f32 vcc, v251, v255
s_nop 4
s_branch L_Cp_back
L_C_rare:
s_nop 12
s_mov_b32 s69, s59
buffer_load_dwordx4 a[128:131], v4, s[16:19], s69 offen offset:0
buffer_load_dwordx4 a[132:135], v4, s[16:19], s69 offen offset:1024
buffer_load_dwordx4 a[136:139], v4, s[16:19], s69 offen offset:2048
buffer_load_dwordx4 a[140:143], v4, s[16:19], s69 offen offset:3072
s_add_u32 s69, s69, 4096
buffer_load_dwordx4 a[144:147], v4, s[16:19], s69 offen offset:0
buffer_load_dwordx4 a[148:151], v4, s[16:19], s69 offen offset:1024
buffer_load_dwordx4 a[152:155], v4, s[16:19], s69 offen offset:2048
buffer_load_dwordx4 a[156:159], v4, s[16:19], s69 offen offset:3072
s_add_u32 s69, s69, 4096
buffer_load_dwordx4 a[160:163], v4, s[16:19], s69 offen offset:0
buffer_load_dwordx4 a[164:167], v4, s[16:19], s69 offen offset:1024
buffer_load_dwordx4 a[168:171], v4, s[16:19], s69 offen offset:2048
buffer_load_dwordx4 a[172:175], v4, s[16:19], s69 offen offset:3072
s_add_u32 s69, s69, 4096
buffer_load_dwordx4 a[176:179], v4, s[16:19], s69 offen offset:0
buffer_load_dwordx4 a[180:183], v4, s[16:19], s69 offen offset:1024
buffer_load_dwordx4 a[184:187], v4, s[16:19], s69 offen offset:2048
buffer_load_dwordx4 a[188:191], v4, s[16:19], s69 offen offset:3072
s_add_u32 s69, s69, 20480
s_waitcnt vmcnt(15)
M32 v[16:31],a[128:131],v[176:179],0
s_waitcnt vmcnt(14)
M32 v[16:31],a[132:135],v[180:183],v[16:31]
s_waitcnt vmcnt(13)
M32 v[16:31],a[136:139],v[184:187],v[16:31]
s_waitcnt vmcnt(12)
M32 v[16:31],a[140:143],v[188:191],v[16:31]
s_waitcnt vmcnt(11)
M32 v[16:31],a[144:147],v[192:195],v[16:31]
s_waitcnt vmcnt(10)
M32 v[16:31],a[148:151],v[196:199],v[16:31]
s_waitcnt vmcnt(9)
M32 v[16:31],a[152:155],v[200:203],v[16:31]
s_waitcnt vmcnt(8)
M32 v[16:31],a[156:159],v[204:207],v[16:31]
s_waitcnt vmcnt(7)
M32 v[32:47],a[160:163],v[176:179],0
s_waitcnt vmcnt(6)
M32 v[32:47],a[164:167],v[180:183],v[32:47]
s_waitcnt vmcnt(5)
M32 v[32:47],a[168:171],v[184:187],v[32:47]
s_waitcnt vmcnt(4)
M32 v[32:47],a[172:175],v[188:191],v[32:47]
s_waitcnt vmcnt(3)
M32 v[32:47],a[176:179],v[192:195],v[32:47]
s_waitcnt vmcnt(2)
M32 v[32:47],a[180:183],v[196:199],v[32:47]
s_waitcnt vmcnt(1)
M32 v[32:47],a[184:187],v[200:203],v[32:47]
s_waitcnt vmcnt(0)
M32 v[32:47],a[188:191],v[204:207],v[32:47]
M32 v[48:63],a[128:131],v[208:211],0
M32 v[48:63],a[132:135],v[212:215],v[48:63]
M32 v[48:63],a[136:139],v[216:219],v[48:63]
M32 v[48:63],a[140:143],v[220:223],v[48:63]
M32 v[48:63],a[144:147],v[224:227],v[48:63]
M32 v[48:63],a[148:151],v[228:231],v[48:63]
M32 v[48:63],a[152:155],v[232:235],v[48:63]
M32 v[48:63],a[156:159],v[236:239],v[48:63]
M32 v[64:79],a[160:163],v[208:211],0
M32 v[64:79],a[164:167],v[212:215],v[64:79]
M32 v[64:79],a[168:171],v[216:219],v[64:79]
M32 v[64:79],a[172:175],v[220:223],v[64:79]
M32 v[64:79],a[176:179],v[224:227],v[64:79]
M32 v[64:79],a[180:183],v[228:231],v[64:79]
M32 v[64:79],a[184:187],v[232:235],v[64:79]
M32 v[64:79],a[188:191],v[236:239],v[64:79]
v_cmp_le_i32 s[36:37], 0, v248
v_cmp_le_i32 s[38:39], 1, v248
v_cmp_le_i32 s[40:41], 2, v248
v_cmp_le_i32 s[42:43], 3, v248
CND v48,v250,v48,s[36:37]
CND v49,v250,v49,s[38:39]
CND v50,v250,v50,s[40:41]
CND v51,v250,v51,s[42:43]
v_cmp_le_i32 s[36:37], 16, v248
v_cmp_le_i32 s[38:39], 17, v248
v_cmp_le_i32 s[40:41], 18, v248
v_cmp_le_i32 s[42:43], 19, v248
CND v52,v250,v52,s[36:37]
CND v53,v250,v53,s[38:39]
CND v54,v250,v54,s[40:41]
CND v55,v250,v55,s[42:43]
v_cmp_le_i32 s[36:37], 8, v248
v_cmp_le_i32 s[38:39], 9, v248
v_cmp_le_i32 s[40:41], 10, v248
v_cmp_le_i32 s[42:43], 11, v248
CND v56,v250,v56,s[36:37]
CND v57,v250,v57,s[38:39]
CND v58,v250,v58,s[40:41]
CND v59,v250,v59,s[42:43]
v_cmp_le_i32 s[36:37], 24, v248
v_cmp_le_i32 s[38:39], 25, v248
v_cmp_le_i32 s[40:41], 26, v248
v_cmp_le_i32 s[42:43], 27, v248
CND v60,v250,v60,s[36:37]
CND v61,v250,v61,s[38:39]
CND v62,v250,v62,s[40:41]
CND v63,v250,v63,s[42:43]
v_cmp_le_i32 s[36:37], 32, v248
v_cmp_le_i32 s[38:39], 33, v248
v_cmp_le_i32 s[40:41], 34, v248
v_cmp_le_i32 s[42:43], 35, v248
CND v64,v250,v64,s[36:37]
CND v65,v250,v65,s[38:39]
CND v66,v250,v66,s[40:41]
CND v67,v250,v67,s[42:43]
v_cmp_le_i32 s[36:37], 48, v248
v_cmp_le_i32 s[38:39], 49, v248
v_cmp_le_i32 s[40:41], 50, v248
v_cmp_le_i32 s[42:43], 51, v248
CND v68,v250,v68,s[36:37]
CND v69,v250,v69,s[38:39]
CND v70,v250,v70,s[40:41]
CND v71,v250,v71,s[42:43]
v_cmp_le_i32 s[36:37], 40, v248
v_cmp_le_i32 s[38:39], 41, v248
v_cmp_le_i32 s[40:41], 42, v248
v_cmp_le_i32 s[42:43], 43, v248
CND v72,v250,v72,s[36:37]
CND v73,v250,v73,s[38:39]
CND v74,v250,v74,s[40:41]
CND v75,v250,v75,s[42:43]
v_cmp_le_i32 s[36:37], 56, v248
v_cmp_le_i32 s[38:39], 57, v248
v_cmp_le_i32 s[40:41], 58, v248
v_cmp_le_i32 s[42:43], 59, v248
CND v76,v250,v76,s[36:37]
CND v77,v250,v77,s[38:39]
CND v78,v250,v78,s[40:41]
CND v79,v250,v79,s[42:43]
v_max3_f32 v251, v16, v17, v18
v_max3_f32 v251, v251, v19, v20
v_max3_f32 v251, v251, v21, v22
v_max3_f32 v251, v251, v23, v24
v_max3_f32 v251, v251, v25, v26
v_max3_f32 v251, v251, v27, v28
v_max3_f32 v251, v251, v29, v30
v_max3_f32 v251, v251, v31, v32
v_max3_f32 v251, v251, v33, v34
v_max3_f32 v251, v251, v35, v36
v_max3_f32 v251, v251, v37, v38
v_max3_f32 v251, v251, v39, v40
v_max3_f32 v251, v251, v41, v42
v_max3_f32 v251, v251, v43, v44
v_max3_f32 v251, v251, v45, v46
v_max_f32 v251, v251, v47
v_max3_f32 v252, v48, v49, v50
v_max3_f32 v252, v252, v51, v52
v_max3_f32 v252, v252, v53, v54
v_max3_f32 v252, v252, v55, v56
v_max3_f32 v252, v252, v57, v58
v_max3_f32 v252, v252, v59, v60
v_max3_f32 v252, v252, v61, v62
v_max3_f32 v252, v252, v63, v64
v_max3_f32 v252, v252, v65, v66
v_max3_f32 v252, v252, v67, v68
v_max3_f32 v252, v252, v69, v70
v_max3_f32 v252, v252, v71, v72
v_max3_f32 v252, v252, v73, v74
v_max3_f32 v252, v252, v75, v76
v_max3_f32 v252, v252, v77, v78
v_max_f32 v252, v252, v79
v_mov_b32 v253, v251
s_nop 1
v_permlane32_swap_b32 v251, v253
v_max_f32 v251, v251, v253
v_max_f32 v251, v251, v240
FSB v253,v240,v251
EXP v254,v253
s_nop 0
FML v242,v242,v254
ARD v8,a0
ARD v9,a1
ARD v10,a2
ARD v11,a3
FML v8,v8,v254
FML v9,v9,v254
FML v10,v10,v254
FML v11,v11,v254
AWR a0,v8
AWR a1,v9
AWR a2,v10
AWR a3,v11
ARD v8,a4
ARD v9,a5
ARD v10,a6
ARD v11,a7
FML v8,v8,v254
FML v9,v9,v254
FML v10,v10,v254
FML v11,v11,v254
AWR a4,v8
AWR a5,v9
AWR a6,v10
AWR a7,v11
ARD v8,a8
ARD v9,a9
ARD v10,a10
ARD v11,a11
FML v8,v8,v254
FML v9,v9,v254
FML v10,v10,v254
FML v11,v11,v254
AWR a8,v8
AWR a9,v9
AWR a10,v10
AWR a11,v11
ARD v8,a12
ARD v9,a13
ARD v10,a14
ARD v11,a15
FML v8,v8,v254
FML v9,v9,v254
FML v10,v10,v254
FML v11,v11,v254
AWR a12,v8
AWR a13,v9
AWR a14,v10
AWR a15,v11
ARD v8,a16
ARD v9,a17
ARD v10,a18
ARD v11,a19
FML v8,v8,v254
FML v9,v9,v254
FML v10,v10,v254
FML v11,v11,v254
AWR a16,v8
AWR a17,v9
AWR a18,v10
AWR a19,v11
ARD v8,a20
ARD v9,a21
ARD v10,a22
ARD v11,a23
FML v8,v8,v254
FML v9,v9,v254
FML v10,v10,v254
FML v11,v11,v254
AWR a20,v8
AWR a21,v9
AWR a22,v10
AWR a23,v11
ARD v8,a24
ARD v9,a25
ARD v10,a26
ARD v11,a27
FML v8,v8,v254
FML v9,v9,v254
FML v10,v10,v254
FML v11,v11,v254
AWR a24,v8
AWR a25,v9
AWR a26,v10
AWR a27,v11
ARD v8,a28
ARD v9,a29
ARD v10,a30
ARD v11,a31
FML v8,v8,v254
FML v9,v9,v254
FML v10,v10,v254
FML v11,v11,v254
AWR a28,v8
AWR a29,v9
AWR a30,v10
AWR a31,v11
ARD v8,a32
ARD v9,a33
ARD v10,a34
ARD v11,a35
FML v8,v8,v254
FML v9,v9,v254
FML v10,v10,v254
FML v11,v11,v254
AWR a32,v8
AWR a33,v9
AWR a34,v10
AWR a35,v11
ARD v8,a36
ARD v9,a37
ARD v10,a38
ARD v11,a39
FML v8,v8,v254
FML v9,v9,v254
FML v10,v10,v254
FML v11,v11,v254
AWR a36,v8
AWR a37,v9
AWR a38,v10
AWR a39,v11
ARD v8,a40
ARD v9,a41
ARD v10,a42
ARD v11,a43
FML v8,v8,v254
FML v9,v9,v254
FML v10,v10,v254
FML v11,v11,v254
AWR a40,v8
AWR a41,v9
AWR a42,v10
AWR a43,v11
ARD v8,a44
ARD v9,a45
ARD v10,a46
ARD v11,a47
FML v8,v8,v254
FML v9,v9,v254
FML v10,v10,v254
FML v11,v11,v254
AWR a44,v8
AWR a45,v9
AWR a46,v10
AWR a47,v11
ARD v8,a48
ARD v9,a49
ARD v10,a50
ARD v11,a51
FML v8,v8,v254
FML v9,v9,v254
FML v10,v10,v254
FML v11,v11,v254
AWR a48,v8
AWR a49,v9
AWR a50,v10
AWR a51,v11
ARD v8,a52
ARD v9,a53
ARD v10,a54
ARD v11,a55
FML v8,v8,v254
FML v9,v9,v254
FML v10,v10,v254
FML v11,v11,v254
AWR a52,v8
AWR a53,v9
AWR a54,v10
AWR a55,v11
ARD v8,a56
ARD v9,a57
ARD v10,a58
ARD v11,a59
FML v8,v8,v254
FML v9,v9,v254
FML v10,v10,v254
FML v11,v11,v254
AWR a56,v8
AWR a57,v9
AWR a58,v10
AWR a59,v11
ARD v8,a60
ARD v9,a61
ARD v10,a62
ARD v11,a63
FML v8,v8,v254
FML v9,v9,v254
FML v10,v10,v254
FML v11,v11,v254
AWR a60,v8
AWR a61,v9
AWR a62,v10
AWR a63,v11
FAD v80,v80,v253
FAD v81,v81,v253
FAD v82,v82,v253
FAD v83,v83,v253
FAD v84,v84,v253
FAD v85,v85,v253
FAD v86,v86,v253
FAD v87,v87,v253
FAD v88,v88,v253
FAD v89,v89,v253
FAD v90,v90,v253
FAD v91,v91,v253
FAD v92,v92,v253
FAD v93,v93,v253
FAD v94,v94,v253
FAD v95,v95,v253
FAD v96,v96,v253
FAD v97,v97,v253
FAD v98,v98,v253
FAD v99,v99,v253
FAD v100,v100,v253
FAD v101,v101,v253
FAD v102,v102,v253
FAD v103,v103,v253
FAD v104,v104,v253
FAD v105,v105,v253
FAD v106,v106,v253
FAD v107,v107,v253
FAD v108,v108,v253
FAD v109,v109,v253
FAD v110,v110,v253
FAD v111,v111,v253
v_mov_b32 v240, v251
FSB v144,0,v251
FSB v145,0,v251
FSB v146,0,v251
FSB v147,0,v251
FSB v148,0,v251
FSB v149,0,v251
FSB v150,0,v251
FSB v151,0,v251
FSB v152,0,v251
FSB v153,0,v251
FSB v154,0,v251
FSB v155,0,v251
FSB v156,0,v251
FSB v157,0,v251
FSB v158,0,v251
FSB v159,0,v251
FSB v16,v16,v251
FSB v17,v17,v251
FSB v18,v18,v251
FSB v19,v19,v251
FSB v20,v20,v251
FSB v21,v21,v251
FSB v22,v22,v251
FSB v23,v23,v251
FSB v24,v24,v251
FSB v25,v25,v251
FSB v26,v26,v251
FSB v27,v27,v251
FSB v28,v28,v251
FSB v29,v29,v251
FSB v30,v30,v251
FSB v31,v31,v251
FSB v32,v32,v251
FSB v33,v33,v251
FSB v34,v34,v251
FSB v35,v35,v251
FSB v36,v36,v251
FSB v37,v37,v251
FSB v38,v38,v251
FSB v39,v39,v251
FSB v40,v40,v251
FSB v41,v41,v251
FSB v42,v42,v251
FSB v43,v43,v251
FSB v44,v44,v251
FSB v45,v45,v251
FSB v46,v46,v251
FSB v47,v47,v251
v_mov_b32 v253, v252
s_nop 1
v_permlane32_swap_b32 v252, v253
v_max_f32 v252, v252, v253
v_max_f32 v252, v252, v241
FSB v253,v241,v252
EXP v254,v253
s_nop 0
FML v243,v243,v254
ARD v8,a64
ARD v9,a65
ARD v10,a66
ARD v11,a67
FML v8,v8,v254
FML v9,v9,v254
FML v10,v10,v254
FML v11,v11,v254
AWR a64,v8
AWR a65,v9
AWR a66,v10
AWR a67,v11
ARD v8,a68
ARD v9,a69
ARD v10,a70
ARD v11,a71
FML v8,v8,v254
FML v9,v9,v254
FML v10,v10,v254
FML v11,v11,v254
AWR a68,v8
AWR a69,v9
AWR a70,v10
AWR a71,v11
ARD v8,a72
ARD v9,a73
ARD v10,a74
ARD v11,a75
FML v8,v8,v254
FML v9,v9,v254
FML v10,v10,v254
FML v11,v11,v254
AWR a72,v8
AWR a73,v9
AWR a74,v10
AWR a75,v11
ARD v8,a76
ARD v9,a77
ARD v10,a78
ARD v11,a79
FML v8,v8,v254
FML v9,v9,v254
FML v10,v10,v254
FML v11,v11,v254
AWR a76,v8
AWR a77,v9
AWR a78,v10
AWR a79,v11
ARD v8,a80
ARD v9,a81
ARD v10,a82
ARD v11,a83
FML v8,v8,v254
FML v9,v9,v254
FML v10,v10,v254
FML v11,v11,v254
AWR a80,v8
AWR a81,v9
AWR a82,v10
AWR a83,v11
ARD v8,a84
ARD v9,a85
ARD v10,a86
ARD v11,a87
FML v8,v8,v254
FML v9,v9,v254
FML v10,v10,v254
FML v11,v11,v254
AWR a84,v8
AWR a85,v9
AWR a86,v10
AWR a87,v11
ARD v8,a88
ARD v9,a89
ARD v10,a90
ARD v11,a91
FML v8,v8,v254
FML v9,v9,v254
FML v10,v10,v254
FML v11,v11,v254
AWR a88,v8
AWR a89,v9
AWR a90,v10
AWR a91,v11
ARD v8,a92
ARD v9,a93
ARD v10,a94
ARD v11,a95
FML v8,v8,v254
FML v9,v9,v254
FML v10,v10,v254
FML v11,v11,v254
AWR a92,v8
AWR a93,v9
AWR a94,v10
AWR a95,v11
ARD v8,a96
ARD v9,a97
ARD v10,a98
ARD v11,a99
FML v8,v8,v254
FML v9,v9,v254
FML v10,v10,v254
FML v11,v11,v254
AWR a96,v8
AWR a97,v9
AWR a98,v10
AWR a99,v11
ARD v8,a100
ARD v9,a101
ARD v10,a102
ARD v11,a103
FML v8,v8,v254
FML v9,v9,v254
FML v10,v10,v254
FML v11,v11,v254
AWR a100,v8
AWR a101,v9
AWR a102,v10
AWR a103,v11
ARD v8,a104
ARD v9,a105
ARD v10,a106
ARD v11,a107
FML v8,v8,v254
FML v9,v9,v254
FML v10,v10,v254
FML v11,v11,v254
AWR a104,v8
AWR a105,v9
AWR a106,v10
AWR a107,v11
ARD v8,a108
ARD v9,a109
ARD v10,a110
ARD v11,a111
FML v8,v8,v254
FML v9,v9,v254
FML v10,v10,v254
FML v11,v11,v254
AWR a108,v8
AWR a109,v9
AWR a110,v10
AWR a111,v11
ARD v8,a112
ARD v9,a113
ARD v10,a114
ARD v11,a115
FML v8,v8,v254
FML v9,v9,v254
FML v10,v10,v254
FML v11,v11,v254
AWR a112,v8
AWR a113,v9
AWR a114,v10
AWR a115,v11
ARD v8,a116
ARD v9,a117
ARD v10,a118
ARD v11,a119
FML v8,v8,v254
FML v9,v9,v254
FML v10,v10,v254
FML v11,v11,v254
AWR a116,v8
AWR a117,v9
AWR a118,v10
AWR a119,v11
ARD v8,a120
ARD v9,a121
ARD v10,a122
ARD v11,a123
FML v8,v8,v254
FML v9,v9,v254
FML v10,v10,v254
FML v11,v11,v254
AWR a120,v8
AWR a121,v9
AWR a122,v10
AWR a123,v11
ARD v8,a124
ARD v9,a125
ARD v10,a126
ARD v11,a127
FML v8,v8,v254
FML v9,v9,v254
FML v10,v10,v254
FML v11,v11,v254
AWR a124,v8
AWR a125,v9
AWR a126,v10
AWR a127,v11
FAD v112,v112,v253
FAD v113,v113,v253
FAD v114,v114,v253
FAD v115,v115,v253
FAD v116,v116,v253
FAD v117,v117,v253
FAD v118,v118,v253
FAD v119,v119,v253
FAD v120,v120,v253
FAD v121,v121,v253
FAD v122,v122,v253
FAD v123,v123,v253
FAD v124,v124,v253
FAD v125,v125,v253
FAD v126,v126,v253
FAD v127,v127,v253
FAD v128,v128,v253
FAD v129,v129,v253
FAD v130,v130,v253
FAD v131,v131,v253
FAD v132,v132,v253
FAD v133,v133,v253
FAD v134,v134,v253
FAD v135,v135,v253
FAD v136,v136,v253
FAD v137,v137,v253
FAD v138,v138,v253
FAD v139,v139,v253
FAD v140,v140,v253
FAD v141,v141,v253
FAD v142,v142,v253
FAD v143,v143,v253
v_mov_b32 v241, v252
FSB v160,0,v252
FSB v161,0,v252
FSB v162,0,v252
FSB v163,0,v252
FSB v164,0,v252
FSB v165,0,v252
FSB v166,0,v252
FSB v167,0,v252
FSB v168,0,v252
FSB v169,0,v252
FSB v170,0,v252
FSB v171,0,v252
FSB v172,0,v252
FSB v173,0,v252
FSB v174,0,v252
FSB v175,0,v252
FSB v48,v48,v252
FSB v49,v49,v252
FSB v50,v50,v252
FSB v51,v51,v252
FSB v52,v52,v252
FSB v53,v53,v252
FSB v54,v54,v252
FSB v55,v55,v252
FSB v56,v56,v252
FSB v57,v57,v252
FSB v58,v58,v252
FSB v59,v59,v252
FSB v60,v60,v252
FSB v61,v61,v252
FSB v62,v62,v252
FSB v63,v63,v252
FSB v64,v64,v252
FSB v65,v65,v252
FSB v66,v66,v252
FSB v67,v67,v252
FSB v68,v68,v252
FSB v69,v69,v252
FSB v70,v70,v252
FSB v71,v71,v252
FSB v72,v72,v252
FSB v73,v73,v252
FSB v74,v74,v252
FSB v75,v75,v252
FSB v76,v76,v252
FSB v77,v77,v252
FSB v78,v78,v252
FSB v79,v79,v252
EXP v16,v16
EXP v17,v17
EXP v18,v18
FAD v244,v16,v17
EXP v19,v19
CVT v16,v16,v17
EXP v20,v20
FAD v245,v18,v19
EXP v21,v21
CVT v17,v18,v19
EXP v22,v22
FAD v244,v244,v20
EXP v23,v23
FAD v245,v245,v21
CVT v18,v20,v21
EXP v24,v24
FAD v244,v244,v22
EXP v25,v25
FAD v245,v245,v23
CVT v19,v22,v23
EXP v26,v26
FAD v244,v244,v24
EXP v27,v27
FAD v245,v245,v25
CVT v20,v24,v25
EXP v28,v28
FAD v244,v244,v26
EXP v29,v29
FAD v245,v245,v27
CVT v21,v26,v27
EXP v30,v30
FAD v244,v244,v28
EXP v31,v31
FAD v245,v245,v29
CVT v22,v28,v29
EXP v48,v48
FAD v244,v244,v30
EXP v49,v49
FAD v245,v245,v31
CVT v23,v30,v31
EXP v50,v50
FAD v246,v48,v49
EXP v51,v51
CVT v48,v48,v49
EXP v52,v52
FAD v247,v50,v51
EXP v53,v53
CVT v49,v50,v51
EXP v54,v54
FAD v246,v246,v52
EXP v55,v55
FAD v247,v247,v53
CVT v50,v52,v53
EXP v56,v56
FAD v246,v246,v54
EXP v57,v57
FAD v247,v247,v55
CVT v51,v54,v55
EXP v58,v58
FAD v246,v246,v56
EXP v59,v59
FAD v247,v247,v57
CVT v52,v56,v57
EXP v60,v60
FAD v246,v246,v58
EXP v61,v61
FAD v247,v247,v59
CVT v53,v58,v59
EXP v62,v62
FAD v246,v246,v60
EXP v63,v63
FAD v247,v247,v61
CVT v54,v60,v61
EXP v32,v32
FAD v246,v246,v62
EXP v33,v33
FAD v247,v247,v63
CVT v55,v62,v63
EXP v34,v34
FAD v244,v244,v32
EXP v35,v35
FAD v245,v245,v33
CVT v24,v32,v33
EXP v36,v36
FAD v244,v244,v34
EXP v37,v37
FAD v245,v245,v35
CVT v25,v34,v35
EXP v38,v38
FAD v244,v244,v36
EXP v39,v39
FAD v245,v245,v37
CVT v26,v36,v37
EXP v40,v40
FAD v244,v244,v38
EXP v41,v41
FAD v245,v245,v39
CVT v27,v38,v39
EXP v42,v42
FAD v244,v244,v40
EXP v43,v43
FAD v245,v245,v41
CVT v28,v40,v41
EXP v44,v44
FAD v244,v244,v42
EXP v45,v45
FAD v245,v245,v43
CVT v29,v42,v43
EXP v46,v46
FAD v244,v244,v44
EXP v47,v47
FAD v245,v245,v45
CVT v30,v44,v45
EXP v64,v64
FAD v244,v244,v46
EXP v65,v65
FAD v245,v245,v47
CVT v31,v46,v47
EXP v66,v66
FAD v246,v246,v64
EXP v67,v67
FAD v247,v247,v65
CVT v56,v64,v65
EXP v68,v68
FAD v246,v246,v66
EXP v69,v69
FAD v247,v247,v67
CVT v57,v66,v67
EXP v70,v70
FAD v246,v246,v68
EXP v71,v71
FAD v247,v247,v69
CVT v58,v68,v69
EXP v72,v72
FAD v246,v246,v70
EXP v73,v73
FAD v247,v247,v71
CVT v59,v70,v71
EXP v74,v74
FAD v246,v246,v72
EXP v75,v75
FAD v247,v247,v73
CVT v60,v72,v73
EXP v76,v76
FAD v246,v246,v74
EXP v77,v77
FAD v247,v247,v75
CVT v61,v74,v75
EXP v78,v78
FAD v246,v246,v76
EXP v79,v79
FAD v247,v247,v77
CVT v62,v76,v77
FAD v246,v246,v78
FAD v247,v247,v79
CVT v63,v78,v79
FAD v244,v244,v245
FAD v246,v246,v247
v_max_f32 v251, v244, v246
v_cmp_nle_f32 vcc, v251, v255
s_nop 4
s_branch L_C_back
L_D_rare:
s_nop 12
s_mov_b32 s69, s59
buffer_load_dwordx4 a[128:131], v4, s[16:19], s69 offen offset:0
buffer_load_dwordx4 a[132:135], v4, s[16:19], s69 offen offset:1024
buffer_load_dwordx4 a[136:139], v4, s[16:19], s69 offen offset:2048
buffer_load_dwordx4 a[140:143], v4, s[16:19], s69 offen offset:3072
s_add_u32 s69, s69, 4096
buffer_load_dwordx4 a[144:147], v4, s[16:19], s69 offen offset:0
buffer_load_dwordx4 a[148:151], v4, s[16:19], s69 offen offset:1024
buffer_load_dwordx4 a[152:155], v4, s[16:19], s69 offen offset:2048
buffer_load_dwordx4 a[156:159], v4, s[16:19], s69 offen offset:3072
s_add_u32 s69, s69, 4096
buffer_load_dwordx4 a[160:163], v4, s[16:19], s69 offen offset:0
buffer_load_dwordx4 a[164:167], v4, s[16:19], s69 offen offset:1024
buffer_load_dwordx4 a[168:171], v4, s[16:19], s69 offen offset:2048
buffer_load_dwordx4 a[172:175], v4, s[16:19], s69 offen offset:3072
s_add_u32 s69, s69, 4096
buffer_load_dwordx4 a[176:179], v4, s[16:19], s69 offen offset:0
buffer_load_dwordx4 a[180:183], v4, s[16:19], s69 offen offset:1024
buffer_load_dwordx4 a[184:187], v4, s[16:19], s69 offen offset:2048
buffer_load_dwordx4 a[188:191], v4, s[16:19], s69 offen offset:3072
s_add_u32 s69, s69, 20480
s_waitcnt vmcnt(15)
M32 v[80:95],a[128:131],v[176:179],0
s_waitcnt vmcnt(14)
M32 v[80:95],a[132:135],v[180:183],v[80:95]
s_waitcnt vmcnt(13)
M32 v[80:95],a[136:139],v[184:187],v[80:95]
s_waitcnt vmcnt(12)
M32 v[80:95],a[140:143],v[188:191],v[80:95]
s_waitcnt vmcnt(11)
M32 v[80:95],a[144:147],v[192:195],v[80:95]
s_waitcnt vmcnt(10)
M32 v[80:95],a[148:151],v[196:199],v[80:95]
s_waitcnt vmcnt(9)
M32 v[80:95],a[152:155],v[200:203],v[80:95]
s_waitcnt vmcnt(8)
M32 v[80:95],a[156:159],v[204:207],v[80:95]
s_waitcnt vmcnt(7)
M32 v[96:111],a[160:163],v[176:179],0
s_waitcnt vmcnt(6)
M32 v[96:111],a[164:167],v[180:183],v[96:111]
s_waitcnt vmcnt(5)
M32 v[96:111],a[168:171],v[184:187],v[96:111]
s_waitcnt vmcnt(4)
M32 v[96:111],a[172:175],v[188:191],v[96:111]
s_waitcnt vmcnt(3)
M32 v[96:111],a[176:179],v[192:195],v[96:111]
s_waitcnt vmcnt(2)
M32 v[96:111],a[180:183],v[196:199],v[96:111]
s_waitcnt vmcnt(1)
M32 v[96:111],a[184:187],v[200:203],v[96:111]
s_waitcnt vmcnt(0)
M32 v[96:111],a[188:191],v[204:207],v[96:111]
M32 v[112:127],a[128:131],v[208:211],0
M32 v[112:127],a[132:135],v[212:215],v[112:127]
M32 v[112:127],a[136:139],v[216:219],v[112:127]
M32 v[112:127],a[140:143],v[220:223],v[112:127]
M32 v[112:127],a[144:147],v[224:227],v[112:127]
M32 v[112:127],a[148:151],v[228:231],v[112:127]
M32 v[112:127],a[152:155],v[232:235],v[112:127]
M32 v[112:127],a[156:159],v[236:239],v[112:127]
M32 v[128:143],a[160:163],v[208:211],0
M32 v[128:143],a[164:167],v[212:215],v[128:143]
M32 v[128:143],a[168:171],v[216:219],v[128:143]
M32 v[128:143],a[172:175],v[220:223],v[128:143]
M32 v[128:143],a[176:179],v[224:227],v[128:143]
M32 v[128:143],a[180:183],v[228:231],v[128:143]
M32 v[128:143],a[184:187],v[232:235],v[128:143]
M32 v[128:143],a[188:191],v[236:239],v[128:143]
v_cmp_le_i32 s[36:37], 0, v249
v_cmp_le_i32 s[38:39], 1, v249
v_cmp_le_i32 s[40:41], 2, v249
v_cmp_le_i32 s[42:43], 3, v249
CND v112,v250,v112,s[36:37]
CND v113,v250,v113,s[38:39]
CND v114,v250,v114,s[40:41]
CND v115,v250,v115,s[42:43]
v_cmp_le_i32 s[36:37], 16, v249
v_cmp_le_i32 s[38:39], 17, v249
v_cmp_le_i32 s[40:41], 18, v249
v_cmp_le_i32 s[42:43], 19, v249
CND v116,v250,v116,s[36:37]
CND v117,v250,v117,s[38:39]
CND v118,v250,v118,s[40:41]
CND v119,v250,v119,s[42:43]
v_cmp_le_i32 s[36:37], 8, v249
v_cmp_le_i32 s[38:39], 9, v249
v_cmp_le_i32 s[40:41], 10, v249
v_cmp_le_i32 s[42:43], 11, v249
CND v120,v250,v120,s[36:37]
CND v121,v250,v121,s[38:39]
CND v122,v250,v122,s[40:41]
CND v123,v250,v123,s[42:43]
v_cmp_le_i32 s[36:37], 24, v249
v_cmp_le_i32 s[38:39], 25, v249
v_cmp_le_i32 s[40:41], 26, v249
v_cmp_le_i32 s[42:43], 27, v249
CND v124,v250,v124,s[36:37]
CND v125,v250,v125,s[38:39]
CND v126,v250,v126,s[40:41]
CND v127,v250,v127,s[42:43]
v_cmp_le_i32 s[36:37], 32, v249
v_cmp_le_i32 s[38:39], 33, v249
v_cmp_le_i32 s[40:41], 34, v249
v_cmp_le_i32 s[42:43], 35, v249
CND v128,v250,v128,s[36:37]
CND v129,v250,v129,s[38:39]
CND v130,v250,v130,s[40:41]
CND v131,v250,v131,s[42:43]
v_cmp_le_i32 s[36:37], 48, v249
v_cmp_le_i32 s[38:39], 49, v249
v_cmp_le_i32 s[40:41], 50, v249
v_cmp_le_i32 s[42:43], 51, v249
CND v132,v250,v132,s[36:37]
CND v133,v250,v133,s[38:39]
CND v134,v250,v134,s[40:41]
CND v135,v250,v135,s[42:43]
v_cmp_le_i32 s[36:37], 40, v249
v_cmp_le_i32 s[38:39], 41, v249
v_cmp_le_i32 s[40:41], 42, v249
v_cmp_le_i32 s[42:43], 43, v249
CND v136,v250,v136,s[36:37]
CND v137,v250,v137,s[38:39]
CND v138,v250,v138,s[40:41]
CND v139,v250,v139,s[42:43]
v_cmp_le_i32 s[36:37], 56, v249
v_cmp_le_i32 s[38:39], 57, v249
v_cmp_le_i32 s[40:41], 58, v249
v_cmp_le_i32 s[42:43], 59, v249
CND v140,v250,v140,s[36:37]
CND v141,v250,v141,s[38:39]
CND v142,v250,v142,s[40:41]
CND v143,v250,v143,s[42:43]
v_max3_f32 v251, v80, v81, v82
v_max3_f32 v251, v251, v83, v84
v_max3_f32 v251, v251, v85, v86
v_max3_f32 v251, v251, v87, v88
v_max3_f32 v251, v251, v89, v90
v_max3_f32 v251, v251, v91, v92
v_max3_f32 v251, v251, v93, v94
v_max3_f32 v251, v251, v95, v96
v_max3_f32 v251, v251, v97, v98
v_max3_f32 v251, v251, v99, v100
v_max3_f32 v251, v251, v101, v102
v_max3_f32 v251, v251, v103, v104
v_max3_f32 v251, v251, v105, v106
v_max3_f32 v251, v251, v107, v108
v_max3_f32 v251, v251, v109, v110
v_max_f32 v251, v251, v111
v_max3_f32 v252, v112, v113, v114
v_max3_f32 v252, v252, v115, v116
v_max3_f32 v252, v252, v117, v118
v_max3_f32 v252, v252, v119, v120
v_max3_f32 v252, v252, v121, v122
v_max3_f32 v252, v252, v123, v124
v_max3_f32 v252, v252, v125, v126
v_max3_f32 v252, v252, v127, v128
v_max3_f32 v252, v252, v129, v130
v_max3_f32 v252, v252, v131, v132
v_max3_f32 v252, v252, v133, v134
v_max3_f32 v252, v252, v135, v136
v_max3_f32 v252, v252, v137, v138
v_max3_f32 v252, v252, v139, v140
v_max3_f32 v252, v252, v141, v142
v_max_f32 v252, v252, v143
v_mov_b32 v253, v251
s_nop 1
v_permlane32_swap_b32 v251, v253
v_max_f32 v251, v251, v253
v_max_f32 v251, v251, v240
FSB v253,v240,v251
EXP v254,v253
s_nop 0
FML v242,v242,v254
ARD v8,a0
ARD v9,a1
ARD v10,a2
ARD v11,a3
FML v8,v8,v254
FML v9,v9,v254
FML v10,v10,v254
FML v11,v11,v254
AWR a0,v8
AWR a1,v9
AWR a2,v10
AWR a3,v11
ARD v8,a4
ARD v9,a5
ARD v10,a6
ARD v11,a7
FML v8,v8,v254
FML v9,v9,v254
FML v10,v10,v254
FML v11,v11,v254
AWR a4,v8
AWR a5,v9
AWR a6,v10
AWR a7,v11
ARD v8,a8
ARD v9,a9
ARD v10,a10
ARD v11,a11
FML v8,v8,v254
FML v9,v9,v254
FML v10,v10,v254
FML v11,v11,v254
AWR a8,v8
AWR a9,v9
AWR a10,v10
AWR a11,v11
ARD v8,a12
ARD v9,a13
ARD v10,a14
ARD v11,a15
FML v8,v8,v254
FML v9,v9,v254
FML v10,v10,v254
FML v11,v11,v254
AWR a12,v8
AWR a13,v9
AWR a14,v10
AWR a15,v11
ARD v8,a16
ARD v9,a17
ARD v10,a18
ARD v11,a19
FML v8,v8,v254
FML v9,v9,v254
FML v10,v10,v254
FML v11,v11,v254
AWR a16,v8
AWR a17,v9
AWR a18,v10
AWR a19,v11
ARD v8,a20
ARD v9,a21
ARD v10,a22
ARD v11,a23
FML v8,v8,v254
FML v9,v9,v254
FML v10,v10,v254
FML v11,v11,v254
AWR a20,v8
AWR a21,v9
AWR a22,v10
AWR a23,v11
ARD v8,a24
ARD v9,a25
ARD v10,a26
ARD v11,a27
FML v8,v8,v254
FML v9,v9,v254
FML v10,v10,v254
FML v11,v11,v254
AWR a24,v8
AWR a25,v9
AWR a26,v10
AWR a27,v11
ARD v8,a28
ARD v9,a29
ARD v10,a30
ARD v11,a31
FML v8,v8,v254
FML v9,v9,v254
FML v10,v10,v254
FML v11,v11,v254
AWR a28,v8
AWR a29,v9
AWR a30,v10
AWR a31,v11
ARD v8,a32
ARD v9,a33
ARD v10,a34
ARD v11,a35
FML v8,v8,v254
FML v9,v9,v254
FML v10,v10,v254
FML v11,v11,v254
AWR a32,v8
AWR a33,v9
AWR a34,v10
AWR a35,v11
ARD v8,a36
ARD v9,a37
ARD v10,a38
ARD v11,a39
FML v8,v8,v254
FML v9,v9,v254
FML v10,v10,v254
FML v11,v11,v254
AWR a36,v8
AWR a37,v9
AWR a38,v10
AWR a39,v11
ARD v8,a40
ARD v9,a41
ARD v10,a42
ARD v11,a43
FML v8,v8,v254
FML v9,v9,v254
FML v10,v10,v254
FML v11,v11,v254
AWR a40,v8
AWR a41,v9
AWR a42,v10
AWR a43,v11
ARD v8,a44
ARD v9,a45
ARD v10,a46
ARD v11,a47
FML v8,v8,v254
FML v9,v9,v254
FML v10,v10,v254
FML v11,v11,v254
AWR a44,v8
AWR a45,v9
AWR a46,v10
AWR a47,v11
ARD v8,a48
ARD v9,a49
ARD v10,a50
ARD v11,a51
FML v8,v8,v254
FML v9,v9,v254
FML v10,v10,v254
FML v11,v11,v254
AWR a48,v8
AWR a49,v9
AWR a50,v10
AWR a51,v11
ARD v8,a52
ARD v9,a53
ARD v10,a54
ARD v11,a55
FML v8,v8,v254
FML v9,v9,v254
FML v10,v10,v254
FML v11,v11,v254
AWR a52,v8
AWR a53,v9
AWR a54,v10
AWR a55,v11
ARD v8,a56
ARD v9,a57
ARD v10,a58
ARD v11,a59
FML v8,v8,v254
FML v9,v9,v254
FML v10,v10,v254
FML v11,v11,v254
AWR a56,v8
AWR a57,v9
AWR a58,v10
AWR a59,v11
ARD v8,a60
ARD v9,a61
ARD v10,a62
ARD v11,a63
FML v8,v8,v254
FML v9,v9,v254
FML v10,v10,v254
FML v11,v11,v254
AWR a60,v8
AWR a61,v9
AWR a62,v10
AWR a63,v11
FAD v16,v16,v253
FAD v17,v17,v253
FAD v18,v18,v253
FAD v19,v19,v253
FAD v20,v20,v253
FAD v21,v21,v253
FAD v22,v22,v253
FAD v23,v23,v253
FAD v24,v24,v253
FAD v25,v25,v253
FAD v26,v26,v253
FAD v27,v27,v253
FAD v28,v28,v253
FAD v29,v29,v253
FAD v30,v30,v253
FAD v31,v31,v253
FAD v32,v32,v253
FAD v33,v33,v253
FAD v34,v34,v253
FAD v35,v35,v253
FAD v36,v36,v253
FAD v37,v37,v253
FAD v38,v38,v253
FAD v39,v39,v253
FAD v40,v40,v253
FAD v41,v41,v253
FAD v42,v42,v253
FAD v43,v43,v253
FAD v44,v44,v253
FAD v45,v45,v253
FAD v46,v46,v253
FAD v47,v47,v253
FAD v48,v48,v253
FAD v49,v49,v253
FAD v50,v50,v253
FAD v51,v51,v253
FAD v52,v52,v253
FAD v53,v53,v253
FAD v54,v54,v253
FAD v55,v55,v253
FAD v56,v56,v253
FAD v57,v57,v253
FAD v58,v58,v253
FAD v59,v59,v253
FAD v60,v60,v253
FAD v61,v61,v253
FAD v62,v62,v253
FAD v63,v63,v253
FAD v64,v64,v253
FAD v65,v65,v253
FAD v66,v66,v253
FAD v67,v67,v253
FAD v68,v68,v253
FAD v69,v69,v253
FAD v70,v70,v253
FAD v71,v71,v253
FAD v72,v72,v253
FAD v73,v73,v253
FAD v74,v74,v253
FAD v75,v75,v253
FAD v76,v76,v253
FAD v77,v77,v253
FAD v78,v78,v253
FAD v79,v79,v253
v_mov_b32 v240, v251
FSB v144,0,v251
FSB v145,0,v251
FSB v146,0,v251
FSB v147,0,v251
FSB v148,0,v251
FSB v149,0,v251
FSB v150,0,v251
FSB v151,0,v251
FSB v152,0,v251
FSB v153,0,v251
FSB v154,0,v251
FSB v155,0,v251
FSB v156,0,v251
FSB v157,0,v251
FSB v158,0,v251
FSB v159,0,v251
FSB v80,v80,v251
FSB v81,v81,v251
FSB v82,v82,v251
FSB v83,v83,v251
FSB v84,v84,v251
FSB v85,v85,v251
FSB v86,v86,v251
FSB v87,v87,v251
FSB v88,v88,v251
FSB v89,v89,v251
FSB v90,v90,v251
FSB v91,v91,v251
FSB v92,v92,v251
FSB v93,v93,v251
FSB v94,v94,v251
FSB v95,v95,v251
FSB v96,v96,v251
FSB v97,v97,v251
FSB v98,v98,v251
FSB v99,v99,v251
FSB v100,v100,v251
FSB v101,v101,v251
FSB v102,v102,v251
FSB v103,v103,v251
FSB v104,v104,v251
FSB v105,v105,v251
FSB v106,v106,v251
FSB v107,v107,v251
FSB v108,v108,v251
FSB v109,v109,v251
FSB v110,v110,v251
FSB v111,v111,v251
v_mov_b32 v253, v252
s_nop 1
v_permlane32_swap_b32 v252, v253
v_max_f32 v252, v252, v253
v_max_f32 v252, v252, v241
FSB v253,v241,v252
EXP v254,v253
s_nop 0
FML v243,v243,v254
ARD v8,a64
ARD v9,a65
ARD v10,a66
ARD v11,a67
FML v8,v8,v254
FML v9,v9,v254
FML v10,v10,v254
FML v11,v11,v254
AWR a64,v8
AWR a65,v9
AWR a66,v10
AWR a67,v11
ARD v8,a68
ARD v9,a69
ARD v10,a70
ARD v11,a71
FML v8,v8,v254
FML v9,v9,v254
FML v10,v10,v254
FML v11,v11,v254
AWR a68,v8
AWR a69,v9
AWR a70,v10
AWR a71,v11
ARD v8,a72
ARD v9,a73
ARD v10,a74
ARD v11,a75
FML v8,v8,v254
FML v9,v9,v254
FML v10,v10,v254
FML v11,v11,v254
AWR a72,v8
AWR a73,v9
AWR a74,v10
AWR a75,v11
ARD v8,a76
ARD v9,a77
ARD v10,a78
ARD v11,a79
FML v8,v8,v254
FML v9,v9,v254
FML v10,v10,v254
FML v11,v11,v254
AWR a76,v8
AWR a77,v9
AWR a78,v10
AWR a79,v11
ARD v8,a80
ARD v9,a81
ARD v10,a82
ARD v11,a83
FML v8,v8,v254
FML v9,v9,v254
FML v10,v10,v254
FML v11,v11,v254
AWR a80,v8
AWR a81,v9
AWR a82,v10
AWR a83,v11
ARD v8,a84
ARD v9,a85
ARD v10,a86
ARD v11,a87
FML v8,v8,v254
FML v9,v9,v254
FML v10,v10,v254
FML v11,v11,v254
AWR a84,v8
AWR a85,v9
AWR a86,v10
AWR a87,v11
ARD v8,a88
ARD v9,a89
ARD v10,a90
ARD v11,a91
FML v8,v8,v254
FML v9,v9,v254
FML v10,v10,v254
FML v11,v11,v254
AWR a88,v8
AWR a89,v9
AWR a90,v10
AWR a91,v11
ARD v8,a92
ARD v9,a93
ARD v10,a94
ARD v11,a95
FML v8,v8,v254
FML v9,v9,v254
FML v10,v10,v254
FML v11,v11,v254
AWR a92,v8
AWR a93,v9
AWR a94,v10
AWR a95,v11
ARD v8,a96
ARD v9,a97
ARD v10,a98
ARD v11,a99
FML v8,v8,v254
FML v9,v9,v254
FML v10,v10,v254
FML v11,v11,v254
AWR a96,v8
AWR a97,v9
AWR a98,v10
AWR a99,v11
ARD v8,a100
ARD v9,a101
ARD v10,a102
ARD v11,a103
FML v8,v8,v254
FML v9,v9,v254
FML v10,v10,v254
FML v11,v11,v254
AWR a100,v8
AWR a101,v9
AWR a102,v10
AWR a103,v11
ARD v8,a104
ARD v9,a105
ARD v10,a106
ARD v11,a107
FML v8,v8,v254
FML v9,v9,v254
FML v10,v10,v254
FML v11,v11,v254
AWR a104,v8
AWR a105,v9
AWR a106,v10
AWR a107,v11
ARD v8,a108
ARD v9,a109
ARD v10,a110
ARD v11,a111
FML v8,v8,v254
FML v9,v9,v254
FML v10,v10,v254
FML v11,v11,v254
AWR a108,v8
AWR a109,v9
AWR a110,v10
AWR a111,v11
ARD v8,a112
ARD v9,a113
ARD v10,a114
ARD v11,a115
FML v8,v8,v254
FML v9,v9,v254
FML v10,v10,v254
FML v11,v11,v254
AWR a112,v8
AWR a113,v9
AWR a114,v10
AWR a115,v11
ARD v8,a116
ARD v9,a117
ARD v10,a118
ARD v11,a119
FML v8,v8,v254
FML v9,v9,v254
FML v10,v10,v254
FML v11,v11,v254
AWR a116,v8
AWR a117,v9
AWR a118,v10
AWR a119,v11
ARD v8,a120
ARD v9,a121
ARD v10,a122
ARD v11,a123
FML v8,v8,v254
FML v9,v9,v254
FML v10,v10,v254
FML v11,v11,v254
AWR a120,v8
AWR a121,v9
AWR a122,v10
AWR a123,v11
ARD v8,a124
ARD v9,a125
ARD v10,a126
ARD v11,a127
FML v8,v8,v254
FML v9,v9,v254
FML v10,v10,v254
FML v11,v11,v254
AWR a124,v8
AWR a125,v9
AWR a126,v10
AWR a127,v11
v_mov_b32 v241, v252
FSB v160,0,v252
FSB v161,0,v252
FSB v162,0,v252
FSB v163,0,v252
FSB v164,0,v252
FSB v165,0,v252
FSB v166,0,v252
FSB v167,0,v252
FSB v168,0,v252
FSB v169,0,v252
FSB v170,0,v252
FSB v171,0,v252
FSB v172,0,v252
FSB v173,0,v252
FSB v174,0,v252
FSB v175,0,v252
FSB v112,v112,v252
FSB v113,v113,v252
FSB v114,v114,v252
FSB v115,v115,v252
FSB v116,v116,v252
FSB v117,v117,v252
FSB v118,v118,v252
FSB v119,v119,v252
FSB v120,v120,v252
FSB v121,v121,v252
FSB v122,v122,v252
FSB v123,v123,v252
FSB v124,v124,v252
FSB v125,v125,v252
FSB v126,v126,v252
FSB v127,v127,v252
FSB v128,v128,v252
FSB v129,v129,v252
FSB v130,v130,v252
FSB v131,v131,v252
FSB v132,v132,v252
FSB v133,v133,v252
FSB v134,v134,v252
FSB v135,v135,v252
FSB v136,v136,v252
FSB v137,v137,v252
FSB v138,v138,v252
FSB v139,v139,v252
FSB v140,v140,v252
FSB v141,v141,v252
FSB v142,v142,v252
FSB v143,v143,v252
EXP v80,v80
EXP v81,v81
EXP v82,v82
FAD v244,v80,v81
EXP v83,v83
CVT v80,v80,v81
EXP v84,v84
FAD v245,v82,v83
EXP v85,v85
CVT v81,v82,v83
EXP v86,v86
FAD v244,v244,v84
EXP v87,v87
FAD v245,v245,v85
CVT v82,v84,v85
EXP v88,v88
FAD v244,v244,v86
EXP v89,v89
FAD v245,v245,v87
CVT v83,v86,v87
EXP v90,v90
FAD v244,v244,v88
EXP v91,v91
FAD v245,v245,v89
CVT v84,v88,v89
EXP v92,v92
FAD v244,v244,v90
EXP v93,v93
FAD v245,v245,v91
CVT v85,v90,v91
EXP v94,v94
FAD v244,v244,v92
EXP v95,v95
FAD v245,v245,v93
CVT v86,v92,v93
EXP v112,v112
FAD v244,v244,v94
EXP v113,v113
FAD v245,v245,v95
CVT v87,v94,v95
EXP v114,v114
FAD v246,v112,v113
EXP v115,v115
CVT v112,v112,v113
EXP v116,v116
FAD v247,v114,v115
EXP v117,v117
CVT v113,v114,v115
EXP v118,v118
FAD v246,v246,v116
EXP v119,v119
FAD v247,v247,v117
CVT v114,v116,v117
EXP v120,v120
FAD v246,v246,v118
EXP v121,v121
FAD v247,v247,v119
CVT v115,v118,v119
EXP v122,v122
FAD v246,v246,v120
EXP v123,v123
FAD v247,v247,v121
CVT v116,v120,v121
EXP v124,v124
FAD v246,v246,v122
EXP v125,v125
FAD v247,v247,v123
CVT v117,v122,v123
EXP v126,v126
FAD v246,v246,v124
EXP v127,v127
FAD v247,v247,v125
CVT v118,v124,v125
EXP v96,v96
FAD v246,v246,v126
EXP v97,v97
FAD v247,v247,v127
CVT v119,v126,v127
EXP v98,v98
FAD v244,v244,v96
EXP v99,v99
FAD v245,v245,v97
CVT v88,v96,v97
EXP v100,v100
FAD v244,v244,v98
EXP v101,v101
FAD v245,v245,v99
CVT v89,v98,v99
EXP v102,v102
FAD v244,v244,v100
EXP v103,v103
FAD v245,v245,v101
CVT v90,v100,v101
EXP v104,v104
FAD v244,v244,v102
EXP v105,v105
FAD v245,v245,v103
CVT v91,v102,v103
EXP v106,v106
FAD v244,v244,v104
EXP v107,v107
FAD v245,v245,v105
CVT v92,v104,v105
EXP v108,v108
FAD v244,v244,v106
EXP v109,v109
FAD v245,v245,v107
CVT v93,v106,v107
EXP v110,v110
FAD v244,v244,v108
EXP v111,v111
FAD v245,v245,v109
CVT v94,v108,v109
EXP v128,v128
FAD v244,v244,v110
EXP v129,v129
FAD v245,v245,v111
CVT v95,v110,v111
EXP v130,v130
FAD v246,v246,v128
EXP v131,v131
FAD v247,v247,v129
CVT v120,v128,v129
EXP v132,v132
FAD v246,v246,v130
EXP v133,v133
FAD v247,v247,v131
CVT v121,v130,v131
EXP v134,v134
FAD v246,v246,v132
EXP v135,v135
FAD v247,v247,v133
CVT v122,v132,v133
EXP v136,v136
FAD v246,v246,v134
EXP v137,v137
FAD v247,v247,v135
CVT v123,v134,v135
EXP v138,v138
FAD v246,v246,v136
EXP v139,v139
FAD v247,v247,v137
CVT v124,v136,v137
EXP v140,v140
FAD v246,v246,v138
EXP v141,v141
FAD v247,v247,v139
CVT v125,v138,v139
EXP v142,v142
FAD v246,v246,v140
EXP v143,v143
FAD v247,v247,v141
CVT v126,v140,v141
FAD v246,v246,v142
FAD v247,v247,v143
CVT v127,v142,v143
FAD v244,v244,v245
FAD v246,v246,v247
v_max_f32 v251, v244, v246
v_cmp_nle_f32 vcc, v251, v255
s_nop 4
s_branch L_D_back
L_E_rare:
s_nop 12
s_mov_b32 s69, s59
buffer_load_dwordx4 a[128:131], v4, s[16:19], s69 offen offset:0
buffer_load_dwordx4 a[132:135], v4, s[16:19], s69 offen offset:1024
buffer_load_dwordx4 a[136:139], v4, s[16:19], s69 offen offset:2048
buffer_load_dwordx4 a[140:143], v4, s[16:19], s69 offen offset:3072
s_add_u32 s69, s69, 4096
buffer_load_dwordx4 a[144:147], v4, s[16:19], s69 offen offset:0
buffer_load_dwordx4 a[148:151], v4, s[16:19], s69 offen offset:1024
buffer_load_dwordx4 a[152:155], v4, s[16:19], s69 offen offset:2048
buffer_load_dwordx4 a[156:159], v4, s[16:19], s69 offen offset:3072
s_add_u32 s69, s69, 4096
buffer_load_dwordx4 a[160:163], v4, s[16:19], s69 offen offset:0
buffer_load_dwordx4 a[164:167], v4, s[16:19], s69 offen offset:1024
buffer_load_dwordx4 a[168:171], v4, s[16:19], s69 offen offset:2048
buffer_load_dwordx4 a[172:175], v4, s[16:19], s69 offen offset:3072
s_add_u32 s69, s69, 4096
buffer_load_dwordx4 a[176:179], v4, s[16:19], s69 offen offset:0
buffer_load_dwordx4 a[180:183], v4, s[16:19], s69 offen offset:1024
buffer_load_dwordx4 a[184:187], v4, s[16:19], s69 offen offset:2048
buffer_load_dwordx4 a[188:191], v4, s[16:19], s69 offen offset:3072
s_add_u32 s69, s69, 20480
s_waitcnt vmcnt(15)
M32 v[16:31],a[128:131],v[176:179],0
s_waitcnt vmcnt(14)
M32 v[16:31],a[132:135],v[180:183],v[16:31]
s_waitcnt vmcnt(13)
M32 v[16:31],a[136:139],v[184:187],v[16:31]
s_waitcnt vmcnt(12)
M32 v[16:31],a[140:143],v[188:191],v[16:31]
s_waitcnt vmcnt(11)
M32 v[16:31],a[144:147],v[192:195],v[16:31]
s_waitcnt vmcnt(10)
M32 v[16:31],a[148:151],v[196:199],v[16:31]
s_waitcnt vmcnt(9)
M32 v[16:31],a[152:155],v[200:203],v[16:31]
s_waitcnt vmcnt(8)
M32 v[16:31],a[156:159],v[204:207],v[16:31]
s_waitcnt vmcnt(7)
M32 v[32:47],a[160:163],v[176:179],0
s_waitcnt vmcnt(6)
M32 v[32:47],a[164:167],v[180:183],v[32:47]
s_waitcnt vmcnt(5)
M32 v[32:47],a[168:171],v[184:187],v[32:47]
s_waitcnt vmcnt(4)
M32 v[32:47],a[172:175],v[188:191],v[32:47]
s_waitcnt vmcnt(3)
M32 v[32:47],a[176:179],v[192:195],v[32:47]
s_waitcnt vmcnt(2)
M32 v[32:47],a[180:183],v[196:199],v[32:47]
s_waitcnt vmcnt(1)
M32 v[32:47],a[184:187],v[200:203],v[32:47]
s_waitcnt vmcnt(0)
M32 v[32:47],a[188:191],v[204:207],v[32:47]
buffer_load_dwordx4 a[128:131], v4, s[16:19], s69 offen offset:0
buffer_load_dwordx4 a[132:135], v4, s[16:19], s69 offen offset:1024
buffer_load_dwordx4 a[136:139], v4, s[16:19], s69 offen offset:2048
buffer_load_dwordx4 a[140:143], v4, s[16:19], s69 offen offset:3072
s_add_u32 s69, s69, 4096
buffer_load_dwordx4 a[144:147], v4, s[16:19], s69 offen offset:0
buffer_load_dwordx4 a[148:151], v4, s[16:19], s69 offen offset:1024
buffer_load_dwordx4 a[152:155], v4, s[16:19], s69 offen offset:2048
buffer_load_dwordx4 a[156:159], v4, s[16:19], s69 offen offset:3072
s_add_u32 s69, s69, 4096
buffer_load_dwordx4 a[160:163], v4, s[16:19], s69 offen offset:0
buffer_load_dwordx4 a[164:167], v4, s[16:19], s69 offen offset:1024
buffer_load_dwordx4 a[168:171], v4, s[16:19], s69 offen offset:2048
buffer_load_dwordx4 a[172:175], v4, s[16:19], s69 offen offset:3072
s_add_u32 s69, s69, 4096
buffer_load_dwordx4 a[176:179], v4, s[16:19], s69 offen offset:0
buffer_load_dwordx4 a[180:183], v4, s[16:19], s69 offen offset:1024
buffer_load_dwordx4 a[184:187], v4, s[16:19], s69 offen offset:2048
buffer_load_dwordx4 a[188:191], v4, s[16:19], s69 offen offset:3072
s_add_u32 s69, s69, 20480
s_waitcnt vmcnt(15)
M32 v[48:63],a[128:131],v[176:179],0
s_waitcnt vmcnt(14)
M32 v[48:63],a[132:135],v[180:183],v[48:63]
s_waitcnt vmcnt(13)
M32 v[48:63],a[136:139],v[184:187],v[48:63]
s_waitcnt vmcnt(12)
M32 v[48:63],a[140:143],v[188:191],v[48:63]
s_waitcnt vmcnt(11)
M32 v[48:63],a[144:147],v[192:195],v[48:63]
s_waitcnt vmcnt(10)
M32 v[48:63],a[148:151],v[196:199],v[48:63]
s_waitcnt vmcnt(9)
M32 v[48:63],a[152:155],v[200:203],v[48:63]
s_waitcnt vmcnt(8)
M32 v[48:63],a[156:159],v[204:207],v[48:63]
s_waitcnt vmcnt(7)
M32 v[64:79],a[160:163],v[176:179],0
s_waitcnt vmcnt(6)
M32 v[64:79],a[164:167],v[180:183],v[64:79]
s_waitcnt vmcnt(5)
M32 v[64:79],a[168:171],v[184:187],v[64:79]
s_waitcnt vmcnt(4)
M32 v[64:79],a[172:175],v[188:191],v[64:79]
s_waitcnt vmcnt(3)
M32 v[64:79],a[176:179],v[192:195],v[64:79]
s_waitcnt vmcnt(2)
M32 v[64:79],a[180:183],v[196:199],v[64:79]
s_waitcnt vmcnt(1)
M32 v[64:79],a[184:187],v[200:203],v[64:79]
s_waitcnt vmcnt(0)
M32 v[64:79],a[188:191],v[204:207],v[64:79]
v_max3_f32 v251, v16, v17, v18
v_max3_f32 v251, v251, v19, v20
v_max3_f32 v251, v251, v21, v22
v_max3_f32 v251, v251, v23, v24
v_max3_f32 v251, v251, v25, v26
v_max3_f32 v251, v251, v27, v28
v_max3_f32 v251, v251, v29, v30
v_max3_f32 v251, v251, v31, v32
v_max3_f32 v251, v251, v33, v34
v_max3_f32 v251, v251, v35, v36
v_max3_f32 v251, v251, v37, v38
v_max3_f32 v251, v251, v39, v40
v_max3_f32 v251, v251, v41, v42
v_max3_f32 v251, v251, v43, v44
v_max3_f32 v251, v251, v45, v46
v_max_f32 v251, v251, v47
v_max3_f32 v252, v48, v49, v50
v_max3_f32 v252, v252, v51, v52
v_max3_f32 v252, v252, v53, v54
v_max3_f32 v252, v252, v55, v56
v_max3_f32 v252, v252, v57, v58
v_max3_f32 v252, v252, v59, v60
v_max3_f32 v252, v252, v61, v62
v_max3_f32 v252, v252, v63, v64
v_max3_f32 v252, v252, v65, v66
v_max3_f32 v252, v252, v67, v68
v_max3_f32 v252, v252, v69, v70
v_max3_f32 v252, v252, v71, v72
v_max3_f32 v252, v252, v73, v74
v_max3_f32 v252, v252, v75, v76
v_max3_f32 v252, v252, v77, v78
v_max_f32 v252, v252, v79
v_max_f32 v251, v251, v252
v_mov_b32 v253, v251
s_nop 1
v_permlane32_swap_b32 v251, v253
v_max_f32 v251, v251, v253
v_max_f32 v251, v251, v240
FSB v253,v240,v251
EXP v254,v253
s_nop 0
FML v242,v242,v254
ARD v8,a0
ARD v9,a1
ARD v10,a2
ARD v11,a3
FML v8,v8,v254
FML v9,v9,v254
FML v10,v10,v254
FML v11,v11,v254
AWR a0,v8
AWR a1,v9
AWR a2,v10
AWR a3,v11
ARD v8,a4
ARD v9,a5
ARD v10,a6
ARD v11,a7
FML v8,v8,v254
FML v9,v9,v254
FML v10,v10,v254
FML v11,v11,v254
AWR a4,v8
AWR a5,v9
AWR a6,v10
AWR a7,v11
ARD v8,a8
ARD v9,a9
ARD v10,a10
ARD v11,a11
FML v8,v8,v254
FML v9,v9,v254
FML v10,v10,v254
FML v11,v11,v254
AWR a8,v8
AWR a9,v9
AWR a10,v10
AWR a11,v11
ARD v8,a12
ARD v9,a13
ARD v10,a14
ARD v11,a15
FML v8,v8,v254
FML v9,v9,v254
FML v10,v10,v254
FML v11,v11,v254
AWR a12,v8
AWR a13,v9
AWR a14,v10
AWR a15,v11
ARD v8,a16
ARD v9,a17
ARD v10,a18
ARD v11,a19
FML v8,v8,v254
FML v9,v9,v254
FML v10,v10,v254
FML v11,v11,v254
AWR a16,v8
AWR a17,v9
AWR a18,v10
AWR a19,v11
ARD v8,a20
ARD v9,a21
ARD v10,a22
ARD v11,a23
FML v8,v8,v254
FML v9,v9,v254
FML v10,v10,v254
FML v11,v11,v254
AWR a20,v8
AWR a21,v9
AWR a22,v10
AWR a23,v11
ARD v8,a24
ARD v9,a25
ARD v10,a26
ARD v11,a27
FML v8,v8,v254
FML v9,v9,v254
FML v10,v10,v254
FML v11,v11,v254
AWR a24,v8
AWR a25,v9
AWR a26,v10
AWR a27,v11
ARD v8,a28
ARD v9,a29
ARD v10,a30
ARD v11,a31
FML v8,v8,v254
FML v9,v9,v254
FML v10,v10,v254
FML v11,v11,v254
AWR a28,v8
AWR a29,v9
AWR a30,v10
AWR a31,v11
ARD v8,a32
ARD v9,a33
ARD v10,a34
ARD v11,a35
FML v8,v8,v254
FML v9,v9,v254
FML v10,v10,v254
FML v11,v11,v254
AWR a32,v8
AWR a33,v9
AWR a34,v10
AWR a35,v11
ARD v8,a36
ARD v9,a37
ARD v10,a38
ARD v11,a39
FML v8,v8,v254
FML v9,v9,v254
FML v10,v10,v254
FML v11,v11,v254
AWR a36,v8
AWR a37,v9
AWR a38,v10
AWR a39,v11
ARD v8,a40
ARD v9,a41
ARD v10,a42
ARD v11,a43
FML v8,v8,v254
FML v9,v9,v254
FML v10,v10,v254
FML v11,v11,v254
AWR a40,v8
AWR a41,v9
AWR a42,v10
AWR a43,v11
ARD v8,a44
ARD v9,a45
ARD v10,a46
ARD v11,a47
FML v8,v8,v254
FML v9,v9,v254
FML v10,v10,v254
FML v11,v11,v254
AWR a44,v8
AWR a45,v9
AWR a46,v10
AWR a47,v11
ARD v8,a48
ARD v9,a49
ARD v10,a50
ARD v11,a51
FML v8,v8,v254
FML v9,v9,v254
FML v10,v10,v254
FML v11,v11,v254
AWR a48,v8
AWR a49,v9
AWR a50,v10
AWR a51,v11
ARD v8,a52
ARD v9,a53
ARD v10,a54
ARD v11,a55
FML v8,v8,v254
FML v9,v9,v254
FML v10,v10,v254
FML v11,v11,v254
AWR a52,v8
AWR a53,v9
AWR a54,v10
AWR a55,v11
ARD v8,a56
ARD v9,a57
ARD v10,a58
ARD v11,a59
FML v8,v8,v254
FML v9,v9,v254
FML v10,v10,v254
FML v11,v11,v254
AWR a56,v8
AWR a57,v9
AWR a58,v10
AWR a59,v11
ARD v8,a60
ARD v9,a61
ARD v10,a62
ARD v11,a63
FML v8,v8,v254
FML v9,v9,v254
FML v10,v10,v254
FML v11,v11,v254
AWR a60,v8
AWR a61,v9
AWR a62,v10
AWR a63,v11
FAD v80,v80,v253
FAD v81,v81,v253
FAD v82,v82,v253
FAD v83,v83,v253
FAD v84,v84,v253
FAD v85,v85,v253
FAD v86,v86,v253
FAD v87,v87,v253
FAD v88,v88,v253
FAD v89,v89,v253
FAD v90,v90,v253
FAD v91,v91,v253
FAD v92,v92,v253
FAD v93,v93,v253
FAD v94,v94,v253
FAD v95,v95,v253
FAD v96,v96,v253
FAD v97,v97,v253
FAD v98,v98,v253
FAD v99,v99,v253
FAD v100,v100,v253
FAD v101,v101,v253
FAD v102,v102,v253
FAD v103,v103,v253
FAD v104,v104,v253
FAD v105,v105,v253
FAD v106,v106,v253
FAD v107,v107,v253
FAD v108,v108,v253
FAD v109,v109,v253
FAD v110,v110,v253
FAD v111,v111,v253
FAD v112,v112,v253
FAD v113,v113,v253
FAD v114,v114,v253
FAD v115,v115,v253
FAD v116,v116,v253
FAD v117,v117,v253
FAD v118,v118,v253
FAD v119,v119,v253
FAD v120,v120,v253
FAD v121,v121,v253
FAD v122,v122,v253
FAD v123,v123,v253
FAD v124,v124,v253
FAD v125,v125,v253
FAD v126,v126,v253
FAD v127,v127,v253
FAD v128,v128,v253
FAD v129,v129,v253
FAD v130,v130,v253
FAD v131,v131,v253
FAD v132,v132,v253
FAD v133,v133,v253
FAD v134,v134,v253
FAD v135,v135,v253
FAD v136,v136,v253
FAD v137,v137,v253
FAD v138,v138,v253
FAD v139,v139,v253
FAD v140,v140,v253
FAD v141,v141,v253
FAD v142,v142,v253
FAD v143,v143,v253
v_mov_b32 v240, v251
FSB v144,0,v251
FSB v145,0,v251
FSB v146,0,v251
FSB v147,0,v251
FSB v148,0,v251
FSB v149,0,v251
FSB v150,0,v251
FSB v151,0,v251
FSB v152,0,v251
FSB v153,0,v251
FSB v154,0,v251
FSB v155,0,v251
FSB v156,0,v251
FSB v157,0,v251
FSB v158,0,v251
FSB v159,0,v251
FSB v16,v16,v251
FSB v17,v17,v251
FSB v18,v18,v251
FSB v19,v19,v251
FSB v20,v20,v251
FSB v21,v21,v251
FSB v22,v22,v251
FSB v23,v23,v251
FSB v24,v24,v251
FSB v25,v25,v251
FSB v26,v26,v251
FSB v27,v27,v251
FSB v28,v28,v251
FSB v29,v29,v251
FSB v30,v30,v251
FSB v31,v31,v251
FSB v32,v32,v251
FSB v33,v33,v251
FSB v34,v34,v251
FSB v35,v35,v251
FSB v36,v36,v251
FSB v37,v37,v251
FSB v38,v38,v251
FSB v39,v39,v251
FSB v40,v40,v251
FSB v41,v41,v251
FSB v42,v42,v251
FSB v43,v43,v251
FSB v44,v44,v251
FSB v45,v45,v251
FSB v46,v46,v251
FSB v47,v47,v251
FSB v48,v48,v251
FSB v49,v49,v251
FSB v50,v50,v251
FSB v51,v51,v251
FSB v52,v52,v251
FSB v53,v53,v251
FSB v54,v54,v251
FSB v55,v55,v251
FSB v56,v56,v251
FSB v57,v57,v251
FSB v58,v58,v251
FSB v59,v59,v251
FSB v60,v60,v251
FSB v61,v61,v251
FSB v62,v62,v251
FSB v63,v63,v251
FSB v64,v64,v251
FSB v65,v65,v251
FSB v66,v66,v251
FSB v67,v67,v251
FSB v68,v68,v251
FSB v69,v69,v251
FSB v70,v70,v251
FSB v71,v71,v251
FSB v72,v72,v251
FSB v73,v73,v251
FSB v74,v74,v251
FSB v75,v75,v251
FSB v76,v76,v251
FSB v77,v77,v251
FSB v78,v78,v251
FSB v79,v79,v251
EXP v16,v16
EXP v17,v17
EXP v18,v18
FAD v244,v16,v17
EXP v19,v19
CVT v16,v16,v17
EXP v20,v20
FAD v245,v18,v19
EXP v21,v21
CVT v17,v18,v19
EXP v22,v22
FAD v244,v244,v20
EXP v23,v23
FAD v245,v245,v21
CVT v18,v20,v21
EXP v24,v24
FAD v244,v244,v22
EXP v25,v25
FAD v245,v245,v23
CVT v19,v22,v23
EXP v26,v26
FAD v244,v244,v24
EXP v27,v27
FAD v245,v245,v25
CVT v20,v24,v25
EXP v28,v28
FAD v244,v244,v26
EXP v29,v29
FAD v245,v245,v27
CVT v21,v26,v27
EXP v30,v30
FAD v244,v244,v28
EXP v31,v31
FAD v245,v245,v29
CVT v22,v28,v29
EXP v48,v48
FAD v244,v244,v30
EXP v49,v49
FAD v245,v245,v31
CVT v23,v30,v31
EXP v50,v50
FAD v246,v48,v49
EXP v51,v51
CVT v48,v48,v49
EXP v52,v52
FAD v247,v50,v51
EXP v53,v53
CVT v49,v50,v51
EXP v54,v54
FAD v246,v246,v52
EXP v55,v55
FAD v247,v247,v53
CVT v50,v52,v53
EXP v56,v56
FAD v246,v246,v54
EXP v57,v57
FAD v247,v247,v55
CVT v51,v54,v55
EXP v58,v58
FAD v246,v246,v56
EXP v59,v59
FAD v247,v247,v57
CVT v52,v56,v57
EXP v60,v60
FAD v246,v246,v58
EXP v61,v61
FAD v247,v247,v59
CVT v53,v58,v59
EXP v62,v62
FAD v246,v246,v60
EXP v63,v63
FAD v247,v247,v61
CVT v54,v60,v61
EXP v32,v32
FAD v246,v246,v62
EXP v33,v33
FAD v247,v247,v63
CVT v55,v62,v63
EXP v34,v34
FAD v244,v244,v32
EXP v35,v35
FAD v245,v245,v33
CVT v24,v32,v33
EXP v36,v36
FAD v244,v244,v34
EXP v37,v37
FAD v245,v245,v35
CVT v25,v34,v35
EXP v38,v38
FAD v244,v244,v36
EXP v39,v39
FAD v245,v245,v37
CVT v26,v36,v37
EXP v40,v40
FAD v244,v244,v38
EXP v41,v41
FAD v245,v245,v39
CVT v27,v38,v39
EXP v42,v42
FAD v244,v244,v40
EXP v43,v43
FAD v245,v245,v41
CVT v28,v40,v41
EXP v44,v44
FAD v244,v244,v42
EXP v45,v45
FAD v245,v245,v43
CVT v29,v42,v43
EXP v46,v46
FAD v244,v244,v44
EXP v47,v47
FAD v245,v245,v45
CVT v30,v44,v45
EXP v64,v64
FAD v244,v244,v46
EXP v65,v65
FAD v245,v245,v47
CVT v31,v46,v47
EXP v66,v66
FAD v246,v246,v64
EXP v67,v67
FAD v247,v247,v65
CVT v56,v64,v65
EXP v68,v68
FAD v246,v246,v66
EXP v69,v69
FAD v247,v247,v67
CVT v57,v66,v67
EXP v70,v70
FAD v246,v246,v68
EXP v71,v71
FAD v247,v247,v69
CVT v58,v68,v69
EXP v72,v72
FAD v246,v246,v70
EXP v73,v73
FAD v247,v247,v71
CVT v59,v70,v71
EXP v74,v74
FAD v246,v246,v72
EXP v75,v75
FAD v247,v247,v73
CVT v60,v72,v73
EXP v76,v76
FAD v246,v246,v74
EXP v77,v77
FAD v247,v247,v75
CVT v61,v74,v75
EXP v78,v78
FAD v246,v246,v76
EXP v79,v79
FAD v247,v247,v77
CVT v62,v76,v77
FAD v246,v246,v78
FAD v247,v247,v79
CVT v63,v78,v79
FAD v244,v244,v245
FAD v246,v246,v247
v_max_f32 v251, v244, v246
v_cmp_nle_f32 vcc, v251, v255
s_nop 4
s_branch L_E_back
L_F1_rare:
s_nop 12
s_mov_b32 s69, s59
buffer_load_dwordx4 a[128:131], v4, s[16:19], s69 offen offset:0
buffer_load_dwordx4 a[132:135], v4, s[16:19], s69 offen offset:1024
buffer_load_dwordx4 a[136:139], v4, s[16:19], s69 offen offset:2048
buffer_load_dwordx4 a[140:143], v4, s[16:19], s69 offen offset:3072
s_add_u32 s69, s69, 4096
buffer_load_dwordx4 a[144:147], v4, s[16:19], s69 offen offset:0
buffer_load_dwordx4 a[148:151], v4, s[16:19], s69 offen offset:1024
buffer_load_dwordx4 a[152:155], v4, s[16:19], s69 offen offset:2048
buffer_load_dwordx4 a[156:159], v4, s[16:19], s69 offen offset:3072
s_add_u32 s69, s69, 4096
buffer_load_dwordx4 a[160:163], v4, s[16:19], s69 offen offset:0
buffer_load_dwordx4 a[164:167], v4, s[16:19], s69 offen offset:1024
buffer_load_dwordx4 a[168:171], v4, s[16:19], s69 offen offset:2048
buffer_load_dwordx4 a[172:175], v4, s[16:19], s69 offen offset:3072
s_add_u32 s69, s69, 4096
buffer_load_dwordx4 a[176:179], v4, s[16:19], s69 offen offset:0
buffer_load_dwordx4 a[180:183], v4, s[16:19], s69 offen offset:1024
buffer_load_dwordx4 a[184:187], v4, s[16:19], s69 offen offset:2048
buffer_load_dwordx4 a[188:191], v4, s[16:19], s69 offen offset:3072
s_add_u32 s69, s69, 20480
s_waitcnt vmcnt(15)
M32 v[80:95],a[128:131],v[176:179],0
s_waitcnt vmcnt(14)
M32 v[80:95],a[132:135],v[180:183],v[80:95]
s_waitcnt vmcnt(13)
M32 v[80:95],a[136:139],v[184:187],v[80:95]
s_waitcnt vmcnt(12)
M32 v[80:95],a[140:143],v[188:191],v[80:95]
s_waitcnt vmcnt(11)
M32 v[80:95],a[144:147],v[192:195],v[80:95]
s_waitcnt vmcnt(10)
M32 v[80:95],a[148:151],v[196:199],v[80:95]
s_waitcnt vmcnt(9)
M32 v[80:95],a[152:155],v[200:203],v[80:95]
s_waitcnt vmcnt(8)
M32 v[80:95],a[156:159],v[204:207],v[80:95]
s_waitcnt vmcnt(7)
M32 v[96:111],a[160:163],v[176:179],0
s_waitcnt vmcnt(6)
M32 v[96:111],a[164:167],v[180:183],v[96:111]
s_waitcnt vmcnt(5)
M32 v[96:111],a[168:171],v[184:187],v[96:111]
s_waitcnt vmcnt(4)
M32 v[96:111],a[172:175],v[188:191],v[96:111]
s_waitcnt vmcnt(3)
M32 v[96:111],a[176:179],v[192:195],v[96:111]
s_waitcnt vmcnt(2)
M32 v[96:111],a[180:183],v[196:199],v[96:111]
s_waitcnt vmcnt(1)
M32 v[96:111],a[184:187],v[200:203],v[96:111]
s_waitcnt vmcnt(0)
M32 v[96:111],a[188:191],v[204:207],v[96:111]
buffer_load_dwordx4 a[128:131], v4, s[16:19], s69 offen offset:0
buffer_load_dwordx4 a[132:135], v4, s[16:19], s69 offen offset:1024
buffer_load_dwordx4 a[136:139], v4, s[16:19], s69 offen offset:2048
buffer_load_dwordx4 a[140:143], v4, s[16:19], s69 offen offset:3072
s_add_u32 s69, s69, 4096
buffer_load_dwordx4 a[144:147], v4, s[16:19], s69 offen offset:0
buffer_load_dwordx4 a[148:151], v4, s[16:19], s69 offen offset:1024
buffer_load_dwordx4 a[152:155], v4, s[16:19], s69 offen offset:2048
buffer_load_dwordx4 a[156:159], v4, s[16:19], s69 offen offset:3072
s_add_u32 s69, s69, 4096
buffer_load_dwordx4 a[160:163], v4, s[16:19], s69 offen offset:0
buffer_load_dwordx4 a[164:167], v4, s[16:19], s69 offen offset:1024
buffer_load_dwordx4 a[168:171], v4, s[16:19], s69 offen offset:2048
buffer_load_dwordx4 a[172:175], v4, s[16:19], s69 offen offset:3072
s_add_u32 s69, s69, 4096
buffer_load_dwordx4 a[176:179], v4, s[16:19], s69 offen offset:0
buffer_load_dwordx4 a[180:183], v4, s[16:19], s69 offen offset:1024
buffer_load_dwordx4 a[184:187], v4, s[16:19], s69 offen offset:2048
buffer_load_dwordx4 a[188:191], v4, s[16:19], s69 offen offset:3072
s_add_u32 s69, s69, 20480
s_waitcnt vmcnt(15)
M32 v[112:127],a[128:131],v[176:179],0
s_waitcnt vmcnt(14)
M32 v[112:127],a[132:135],v[180:183],v[112:127]
s_waitcnt vmcnt(13)
M32 v[112:127],a[136:139],v[184:187],v[112:127]
s_waitcnt vmcnt(12)
M32 v[112:127],a[140:143],v[188:191],v[112:127]
s_waitcnt vmcnt(11)
M32 v[112:127],a[144:147],v[192:195],v[112:127]
s_waitcnt vmcnt(10)
M32 v[112:127],a[148:151],v[196:199],v[112:127]
s_waitcnt vmcnt(9)
M32 v[112:127],a[152:155],v[200:203],v[112:127]
s_waitcnt vmcnt(8)
M32 v[112:127],a[156:159],v[204:207],v[112:127]
s_waitcnt vmcnt(7)
M32 v[128:143],a[160:163],v[176:179],0
s_waitcnt vmcnt(6)
M32 v[128:143],a[164:167],v[180:183],v[128:143]
s_waitcnt vmcnt(5)
M32 v[128:143],a[168:171],v[184:187],v[128:143]
s_waitcnt vmcnt(4)
M32 v[128:143],a[172:175],v[188:191],v[128:143]
s_waitcnt vmcnt(3)
M32 v[128:143],a[176:179],v[192:195],v[128:143]
s_waitcnt vmcnt(2)
M32 v[128:143],a[180:183],v[196:199],v[128:143]
s_waitcnt vmcnt(1)
M32 v[128:143],a[184:187],v[200:203],v[128:143]
s_waitcnt vmcnt(0)
M32 v[128:143],a[188:191],v[204:207],v[128:143]
v_max3_f32 v251, v80, v81, v82
v_max3_f32 v251, v251, v83, v84
v_max3_f32 v251, v251, v85, v86
v_max3_f32 v251, v251, v87, v88
v_max3_f32 v251, v251, v89, v90
v_max3_f32 v251, v251, v91, v92
v_max3_f32 v251, v251, v93, v94
v_max3_f32 v251, v251, v95, v96
v_max3_f32 v251, v251, v97, v98
v_max3_f32 v251, v251, v99, v100
v_max3_f32 v251, v251, v101, v102
v_max3_f32 v251, v251, v103, v104
v_max3_f32 v251, v251, v105, v106
v_max3_f32 v251, v251, v107, v108
v_max3_f32 v251, v251, v109, v110
v_max_f32 v251, v251, v111
v_max3_f32 v252, v112, v113, v114
v_max3_f32 v252, v252, v115, v116
v_max3_f32 v252, v252, v117, v118
v_max3_f32 v252, v252, v119, v120
v_max3_f32 v252, v252, v121, v122
v_max3_f32 v252, v252, v123, v124
v_max3_f32 v252, v252, v125, v126
v_max3_f32 v252, v252, v127, v128
v_max3_f32 v252, v252, v129, v130
v_max3_f32 v252, v252, v131, v132
v_max3_f32 v252, v252, v133, v134
v_max3_f32 v252, v252, v135, v136
v_max3_f32 v252, v252, v137, v138
v_max3_f32 v252, v252, v139, v140
v_max3_f32 v252, v252, v141, v142
v_max_f32 v252, v252, v143
v_max_f32 v251, v251, v252
v_mov_b32 v253, v251
s_nop 1
v_permlane32_swap_b32 v251, v253
v_max_f32 v251, v251, v253
v_max_f32 v251, v251, v240
FSB v253,v240,v251
EXP v254,v253
s_nop 0
FML v242,v242,v254
ARD v8,a0
ARD v9,a1
ARD v10,a2
ARD v11,a3
FML v8,v8,v254
FML v9,v9,v254
FML v10,v10,v254
FML v11,v11,v254
AWR a0,v8
AWR a1,v9
AWR a2,v10
AWR a3,v11
ARD v8,a4
ARD v9,a5
ARD v10,a6
ARD v11,a7
FML v8,v8,v254
FML v9,v9,v254
FML v10,v10,v254
FML v11,v11,v254
AWR a4,v8
AWR a5,v9
AWR a6,v10
AWR a7,v11
ARD v8,a8
ARD v9,a9
ARD v10,a10
ARD v11,a11
FML v8,v8,v254
FML v9,v9,v254
FML v10,v10,v254
FML v11,v11,v254
AWR a8,v8
AWR a9,v9
AWR a10,v10
AWR a11,v11
ARD v8,a12
ARD v9,a13
ARD v10,a14
ARD v11,a15
FML v8,v8,v254
FML v9,v9,v254
FML v10,v10,v254
FML v11,v11,v254
AWR a12,v8
AWR a13,v9
AWR a14,v10
AWR a15,v11
ARD v8,a16
ARD v9,a17
ARD v10,a18
ARD v11,a19
FML v8,v8,v254
FML v9,v9,v254
FML v10,v10,v254
FML v11,v11,v254
AWR a16,v8
AWR a17,v9
AWR a18,v10
AWR a19,v11
ARD v8,a20
ARD v9,a21
ARD v10,a22
ARD v11,a23
FML v8,v8,v254
FML v9,v9,v254
FML v10,v10,v254
FML v11,v11,v254
AWR a20,v8
AWR a21,v9
AWR a22,v10
AWR a23,v11
ARD v8,a24
ARD v9,a25
ARD v10,a26
ARD v11,a27
FML v8,v8,v254
FML v9,v9,v254
FML v10,v10,v254
FML v11,v11,v254
AWR a24,v8
AWR a25,v9
AWR a26,v10
AWR a27,v11
ARD v8,a28
ARD v9,a29
ARD v10,a30
ARD v11,a31
FML v8,v8,v254
FML v9,v9,v254
FML v10,v10,v254
FML v11,v11,v254
AWR a28,v8
AWR a29,v9
AWR a30,v10
AWR a31,v11
ARD v8,a32
ARD v9,a33
ARD v10,a34
ARD v11,a35
FML v8,v8,v254
FML v9,v9,v254
FML v10,v10,v254
FML v11,v11,v254
AWR a32,v8
AWR a33,v9
AWR a34,v10
AWR a35,v11
ARD v8,a36
ARD v9,a37
ARD v10,a38
ARD v11,a39
FML v8,v8,v254
FML v9,v9,v254
FML v10,v10,v254
FML v11,v11,v254
AWR a36,v8
AWR a37,v9
AWR a38,v10
AWR a39,v11
ARD v8,a40
ARD v9,a41
ARD v10,a42
ARD v11,a43
FML v8,v8,v254
FML v9,v9,v254
FML v10,v10,v254
FML v11,v11,v254
AWR a40,v8
AWR a41,v9
AWR a42,v10
AWR a43,v11
ARD v8,a44
ARD v9,a45
ARD v10,a46
ARD v11,a47
FML v8,v8,v254
FML v9,v9,v254
FML v10,v10,v254
FML v11,v11,v254
AWR a44,v8
AWR a45,v9
AWR a46,v10
AWR a47,v11
ARD v8,a48
ARD v9,a49
ARD v10,a50
ARD v11,a51
FML v8,v8,v254
FML v9,v9,v254
FML v10,v10,v254
FML v11,v11,v254
AWR a48,v8
AWR a49,v9
AWR a50,v10
AWR a51,v11
ARD v8,a52
ARD v9,a53
ARD v10,a54
ARD v11,a55
FML v8,v8,v254
FML v9,v9,v254
FML v10,v10,v254
FML v11,v11,v254
AWR a52,v8
AWR a53,v9
AWR a54,v10
AWR a55,v11
ARD v8,a56
ARD v9,a57
ARD v10,a58
ARD v11,a59
FML v8,v8,v254
FML v9,v9,v254
FML v10,v10,v254
FML v11,v11,v254
AWR a56,v8
AWR a57,v9
AWR a58,v10
AWR a59,v11
ARD v8,a60
ARD v9,a61
ARD v10,a62
ARD v11,a63
FML v8,v8,v254
FML v9,v9,v254
FML v10,v10,v254
FML v11,v11,v254
AWR a60,v8
AWR a61,v9
AWR a62,v10
AWR a63,v11
FAD v16,v16,v253
FAD v17,v17,v253
FAD v18,v18,v253
FAD v19,v19,v253
FAD v20,v20,v253
FAD v21,v21,v253
FAD v22,v22,v253
FAD v23,v23,v253
FAD v24,v24,v253
FAD v25,v25,v253
FAD v26,v26,v253
FAD v27,v27,v253
FAD v28,v28,v253
FAD v29,v29,v253
FAD v30,v30,v253
FAD v31,v31,v253
FAD v32,v32,v253
FAD v33,v33,v253
FAD v34,v34,v253
FAD v35,v35,v253
FAD v36,v36,v253
FAD v37,v37,v253
FAD v38,v38,v253
FAD v39,v39,v253
FAD v40,v40,v253
FAD v41,v41,v253
FAD v42,v42,v253
FAD v43,v43,v253
FAD v44,v44,v253
FAD v45,v45,v253
FAD v46,v46,v253
FAD v47,v47,v253
FAD v48,v48,v253
FAD v49,v49,v253
FAD v50,v50,v253
FAD v51,v51,v253
FAD v52,v52,v253
FAD v53,v53,v253
FAD v54,v54,v253
FAD v55,v55,v253
FAD v56,v56,v253
FAD v57,v57,v253
FAD v58,v58,v253
FAD v59,v59,v253
FAD v60,v60,v253
FAD v61,v61,v253
FAD v62,v62,v253
FAD v63,v63,v253
FAD v64,v64,v253
FAD v65,v65,v253
FAD v66,v66,v253
FAD v67,v67,v253
FAD v68,v68,v253
FAD v69,v69,v253
FAD v70,v70,v253
FAD v71,v71,v253
FAD v72,v72,v253
FAD v73,v73,v253
FAD v74,v74,v253
FAD v75,v75,v253
FAD v76,v76,v253
FAD v77,v77,v253
FAD v78,v78,v253
FAD v79,v79,v253
v_mov_b32 v240, v251
FSB v144,0,v251
FSB v145,0,v251
FSB v146,0,v251
FSB v147,0,v251
FSB v148,0,v251
FSB v149,0,v251
FSB v150,0,v251
FSB v151,0,v251
FSB v152,0,v251
FSB v153,0,v251
FSB v154,0,v251
FSB v155,0,v251
FSB v156,0,v251
FSB v157,0,v251
FSB v158,0,v251
FSB v159,0,v251
FSB v80,v80,v251
FSB v81,v81,v251
FSB v82,v82,v251
FSB v83,v83,v251
FSB v84,v84,v251
FSB v85,v85,v251
FSB v86,v86,v251
FSB v87,v87,v251
FSB v88,v88,v251
FSB v89,v89,v251
FSB v90,v90,v251
FSB v91,v91,v251
FSB v92,v92,v251
FSB v93,v93,v251
FSB v94,v94,v251
FSB v95,v95,v251
FSB v96,v96,v251
FSB v97,v97,v251
FSB v98,v98,v251
FSB v99,v99,v251
FSB v100,v100,v251
FSB v101,v101,v251
FSB v102,v102,v251
FSB v103,v103,v251
FSB v104,v104,v251
FSB v105,v105,v251
FSB v106,v106,v251
FSB v107,v107,v251
FSB v108,v108,v251
FSB v109,v109,v251
FSB v110,v110,v251
FSB v111,v111,v251
FSB v112,v112,v251
FSB v113,v113,v251
FSB v114,v114,v251
FSB v115,v115,v251
FSB v116,v116,v251
FSB v117,v117,v251
FSB v118,v118,v251
FSB v119,v119,v251
FSB v120,v120,v251
FSB v121,v121,v251
FSB v122,v122,v251
FSB v123,v123,v251
FSB v124,v124,v251
FSB v125,v125,v251
FSB v126,v126,v251
FSB v127,v127,v251
FSB v128,v128,v251
FSB v129,v129,v251
FSB v130,v130,v251
FSB v131,v131,v251
FSB v132,v132,v251
FSB v133,v133,v251
FSB v134,v134,v251
FSB v135,v135,v251
FSB v136,v136,v251
FSB v137,v137,v251
FSB v138,v138,v251
FSB v139,v139,v251
FSB v140,v140,v251
FSB v141,v141,v251
FSB v142,v142,v251
FSB v143,v143,v251
EXP v80,v80
EXP v81,v81
EXP v82,v82
FAD v244,v80,v81
EXP v83,v83
CVT v80,v80,v81
EXP v84,v84
FAD v245,v82,v83
EXP v85,v85
CVT v81,v82,v83
EXP v86,v86
FAD v244,v244,v84
EXP v87,v87
FAD v245,v245,v85
CVT v82,v84,v85
EXP v88,v88
FAD v244,v244,v86
EXP v89,v89
FAD v245,v245,v87
CVT v83,v86,v87
EXP v90,v90
FAD v244,v244,v88
EXP v91,v91
FAD v245,v245,v89
CVT v84,v88,v89
EXP v92,v92
FAD v244,v244,v90
EXP v93,v93
FAD v245,v245,v91
CVT v85,v90,v91
EXP v94,v94
FAD v244,v244,v92
EXP v95,v95
FAD v245,v245,v93
CVT v86,v92,v93
EXP v112,v112
FAD v244,v244,v94
EXP v113,v113
FAD v245,v245,v95
CVT v87,v94,v95
EXP v114,v114
FAD v246,v112,v113
EXP v115,v115
CVT v112,v112,v113
EXP v116,v116
FAD v247,v114,v115
EXP v117,v117
CVT v113,v114,v115
EXP v118,v118
FAD v246,v246,v116
EXP v119,v119
FAD v247,v247,v117
CVT v114,v116,v117
EXP v120,v120
FAD v246,v246,v118
EXP v121,v121
FAD v247,v247,v119
CVT v115,v118,v119
EXP v122,v122
FAD v246,v246,v120
EXP v123,v123
FAD v247,v247,v121
CVT v116,v120,v121
EXP v124,v124
FAD v246,v246,v122
EXP v125,v125
FAD v247,v247,v123
CVT v117,v122,v123
EXP v126,v126
FAD v246,v246,v124
EXP v127,v127
FAD v247,v247,v125
CVT v118,v124,v125
EXP v96,v96
FAD v246,v246,v126
EXP v97,v97
FAD v247,v247,v127
CVT v119,v126,v127
EXP v98,v98
FAD v244,v244,v96
EXP v99,v99
FAD v245,v245,v97
CVT v88,v96,v97
EXP v100,v100
FAD v244,v244,v98
EXP v101,v101
FAD v245,v245,v99
CVT v89,v98,v99
EXP v102,v102
FAD v244,v244,v100
EXP v103,v103
FAD v245,v245,v101
CVT v90,v100,v101
EXP v104,v104
FAD v244,v244,v102
EXP v105,v105
FAD v245,v245,v103
CVT v91,v102,v103
EXP v106,v106
FAD v244,v244,v104
EXP v107,v107
FAD v245,v245,v105
CVT v92,v104,v105
EXP v108,v108
FAD v244,v244,v106
EXP v109,v109
FAD v245,v245,v107
CVT v93,v106,v107
EXP v110,v110
FAD v244,v244,v108
EXP v111,v111
FAD v245,v245,v109
CVT v94,v108,v109
EXP v128,v128
FAD v244,v244,v110
EXP v129,v129
FAD v245,v245,v111
CVT v95,v110,v111
EXP v130,v130
FAD v246,v246,v128
EXP v131,v131
FAD v247,v247,v129
CVT v120,v128,v129
EXP v132,v132
FAD v246,v246,v130
EXP v133,v133
FAD v247,v247,v131
CVT v121,v130,v131
EXP v134,v134
FAD v246,v246,v132
EXP v135,v135
FAD v247,v247,v133
CVT v122,v132,v133
EXP v136,v136
FAD v246,v246,v134
EXP v137,v137
FAD v247,v247,v135
CVT v123,v134,v135
EXP v138,v138
FAD v246,v246,v136
EXP v139,v139
FAD v247,v247,v137
CVT v124,v136,v137
EXP v140,v140
FAD v246,v246,v138
EXP v141,v141
FAD v247,v247,v139
CVT v125,v138,v139
EXP v142,v142
FAD v246,v246,v140
EXP v143,v143
FAD v247,v247,v141
CVT v126,v140,v141
FAD v246,v246,v142
FAD v247,v247,v143
CVT v127,v142,v143
FAD v244,v244,v245
FAD v246,v246,v247
v_max_f32 v251, v244, v246
v_cmp_nle_f32 vcc, v251, v255
s_nop 4
s_branch L_F1_back
L_F0_rare:
s_nop 12
s_mov_b32 s69, s59
buffer_load_dwordx4 a[128:131], v4, s[16:19], s69 offen offset:0
buffer_load_dwordx4 a[132:135], v4, s[16:19], s69 offen offset:1024
buffer_load_dwordx4 a[136:139], v4, s[16:19], s69 offen offset:2048
buffer_load_dwordx4 a[140:143], v4, s[16:19], s69 offen offset:3072
s_add_u32 s69, s69, 4096
buffer_load_dwordx4 a[144:147], v4, s[16:19], s69 offen offset:0
buffer_load_dwordx4 a[148:151], v4, s[16:19], s69 offen offset:1024
buffer_load_dwordx4 a[152:155], v4, s[16:19], s69 offen offset:2048
buffer_load_dwordx4 a[156:159], v4, s[16:19], s69 offen offset:3072
s_add_u32 s69, s69, 4096
buffer_load_dwordx4 a[160:163], v4, s[16:19], s69 offen offset:0
buffer_load_dwordx4 a[164:167], v4, s[16:19], s69 offen offset:1024
buffer_load_dwordx4 a[168:171], v4, s[16:19], s69 offen offset:2048
buffer_load_dwordx4 a[172:175], v4, s[16:19], s69 offen offset:3072
s_add_u32 s69, s69, 4096
buffer_load_dwordx4 a[176:179], v4, s[16:19], s69 offen offset:0
buffer_load_dwordx4 a[180:183], v4, s[16:19], s69 offen offset:1024
buffer_load_dwordx4 a[184:187], v4, s[16:19], s69 offen offset:2048
buffer_load_dwordx4 a[188:191], v4, s[16:19], s69 offen offset:3072
s_add_u32 s69, s69, 20480
s_waitcnt vmcnt(15)
M32 v[16:31],a[128:131],v[176:179],0
s_waitcnt vmcnt(14)
M32 v[16:31],a[132:135],v[180:183],v[16:31]
s_waitcnt vmcnt(13)
M32 v[16:31],a[136:139],v[184:187],v[16:31]
s_waitcnt vmcnt(12)
M32 v[16:31],a[140:143],v[188:191],v[16:31]
s_waitcnt vmcnt(11)
M32 v[16:31],a[144:147],v[192:195],v[16:31]
s_waitcnt vmcnt(10)
M32 v[16:31],a[148:151],v[196:199],v[16:31]
s_waitcnt vmcnt(9)
M32 v[16:31],a[152:155],v[200:203],v[16:31]
s_waitcnt vmcnt(8)
M32 v[16:31],a[156:159],v[204:207],v[16:31]
s_waitcnt vmcnt(7)
M32 v[32:47],a[160:163],v[176:179],0
s_waitcnt vmcnt(6)
M32 v[32:47],a[164:167],v[180:183],v[32:47]
s_waitcnt vmcnt(5)
M32 v[32:47],a[168:171],v[184:187],v[32:47]
s_waitcnt vmcnt(4)
M32 v[32:47],a[172:175],v[188:191],v[32:47]
s_waitcnt vmcnt(3)
M32 v[32:47],a[176:179],v[192:195],v[32:47]
s_waitcnt vmcnt(2)
M32 v[32:47],a[180:183],v[196:199],v[32:47]
s_waitcnt vmcnt(1)
M32 v[32:47],a[184:187],v[200:203],v[32:47]
s_waitcnt vmcnt(0)
M32 v[32:47],a[188:191],v[204:207],v[32:47]
buffer_load_dwordx4 a[128:131], v4, s[16:19], s69 offen offset:0
buffer_load_dwordx4 a[132:135], v4, s[16:19], s69 offen offset:1024
buffer_load_dwordx4 a[136:139], v4, s[16:19], s69 offen offset:2048
buffer_load_dwordx4 a[140:143], v4, s[16:19], s69 offen offset:3072
s_add_u32 s69, s69, 4096
buffer_load_dwordx4 a[144:147], v4, s[16:19], s69 offen offset:0
buffer_load_dwordx4 a[148:151], v4, s[16:19], s69 offen offset:1024
buffer_load_dwordx4 a[152:155], v4, s[16:19], s69 offen offset:2048
buffer_load_dwordx4 a[156:159], v4, s[16:19], s69 offen offset:3072
s_add_u32 s69, s69, 4096
buffer_load_dwordx4 a[160:163], v4, s[16:19], s69 offen offset:0
buffer_load_dwordx4 a[164:167], v4, s[16:19], s69 offen offset:1024
buffer_load_dwordx4 a[168:171], v4, s[16:19], s69 offen offset:2048
buffer_load_dwordx4 a[172:175], v4, s[16:19], s69 offen offset:3072
s_add_u32 s69, s69, 4096
buffer_load_dwordx4 a[176:179], v4, s[16:19], s69 offen offset:0
buffer_load_dwordx4 a[180:183], v4, s[16:19], s69 offen offset:1024
buffer_load_dwordx4 a[184:187], v4, s[16:19], s69 offen offset:2048
buffer_load_dwordx4 a[188:191], v4, s[16:19], s69 offen offset:3072
s_add_u32 s69, s69, 20480
s_waitcnt vmcnt(15)
M32 v[48:63],a[128:131],v[176:179],0
s_waitcnt vmcnt(14)
M32 v[48:63],a[132:135],v[180:183],v[48:63]
s_waitcnt vmcnt(13)
M32 v[48:63],a[136:139],v[184:187],v[48:63]
s_waitcnt vmcnt(12)
M32 v[48:63],a[140:143],v[188:191],v[48:63]
s_waitcnt vmcnt(11)
M32 v[48:63],a[144:147],v[192:195],v[48:63]
s_waitcnt vmcnt(10)
M32 v[48:63],a[148:151],v[196:199],v[48:63]
s_waitcnt vmcnt(9)
M32 v[48:63],a[152:155],v[200:203],v[48:63]
s_waitcnt vmcnt(8)
M32 v[48:63],a[156:159],v[204:207],v[48:63]
s_waitcnt vmcnt(7)
M32 v[64:79],a[160:163],v[176:179],0
s_waitcnt vmcnt(6)
M32 v[64:79],a[164:167],v[180:183],v[64:79]
s_waitcnt vmcnt(5)
M32 v[64:79],a[168:171],v[184:187],v[64:79]
s_waitcnt vmcnt(4)
M32 v[64:79],a[172:175],v[188:191],v[64:79]
s_waitcnt vmcnt(3)
M32 v[64:79],a[176:179],v[192:195],v[64:79]
s_waitcnt vmcnt(2)
M32 v[64:79],a[180:183],v[196:199],v[64:79]
s_waitcnt vmcnt(1)
M32 v[64:79],a[184:187],v[200:203],v[64:79]
s_waitcnt vmcnt(0)
M32 v[64:79],a[188:191],v[204:207],v[64:79]
v_max3_f32 v251, v16, v17, v18
v_max3_f32 v251, v251, v19, v20
v_max3_f32 v251, v251, v21, v22
v_max3_f32 v251, v251, v23, v24
v_max3_f32 v251, v251, v25, v26
v_max3_f32 v251, v251, v27, v28
v_max3_f32 v251, v251, v29, v30
v_max3_f32 v251, v251, v31, v32
v_max3_f32 v251, v251, v33, v34
v_max3_f32 v251, v251, v35, v36
v_max3_f32 v251, v251, v37, v38
v_max3_f32 v251, v251, v39, v40
v_max3_f32 v251, v251, v41, v42
v_max3_f32 v251, v251, v43, v44
v_max3_f32 v251, v251, v45, v46
v_max_f32 v251, v251, v47
v_max3_f32 v252, v48, v49, v50
v_max3_f32 v252, v252, v51, v52
v_max3_f32 v252, v252, v53, v54
v_max3_f32 v252, v252, v55, v56
v_max3_f32 v252, v252, v57, v58
v_max3_f32 v252, v252, v59, v60
v_max3_f32 v252, v252, v61, v62
v_max3_f32 v252, v252, v63, v64
v_max3_f32 v252, v252, v65, v66
v_max3_f32 v252, v252, v67, v68
v_max3_f32 v252, v252, v69, v70
v_max3_f32 v252, v252, v71, v72
v_max3_f32 v252, v252, v73, v74
v_max3_f32 v252, v252, v75, v76
v_max3_f32 v252, v252, v77, v78
v_max_f32 v252, v252, v79
v_max_f32 v251, v251, v252
v_mov_b32 v253, v251
s_nop 1
v_permlane32_swap_b32 v251, v253
v_max_f32 v251, v251, v253
v_max_f32 v251, v251, v240
FSB v253,v240,v251
EXP v254,v253
s_nop 0
FML v242,v242,v254
ARD v8,a0
ARD v9,a1
ARD v10,a2
ARD v11,a3
FML v8,v8,v254
FML v9,v9,v254
FML v10,v10,v254
FML v11,v11,v254
AWR a0,v8
AWR a1,v9
AWR a2,v10
AWR a3,v11
ARD v8,a4
ARD v9,a5
ARD v10,a6
ARD v11,a7
FML v8,v8,v254
FML v9,v9,v254
FML v10,v10,v254
FML v11,v11,v254
AWR a4,v8
AWR a5,v9
AWR a6,v10
AWR a7,v11
ARD v8,a8
ARD v9,a9
ARD v10,a10
ARD v11,a11
FML v8,v8,v254
FML v9,v9,v254
FML v10,v10,v254
FML v11,v11,v254
AWR a8,v8
AWR a9,v9
AWR a10,v10
AWR a11,v11
ARD v8,a12
ARD v9,a13
ARD v10,a14
ARD v11,a15
FML v8,v8,v254
FML v9,v9,v254
FML v10,v10,v254
FML v11,v11,v254
AWR a12,v8
AWR a13,v9
AWR a14,v10
AWR a15,v11
ARD v8,a16
ARD v9,a17
ARD v10,a18
ARD v11,a19
FML v8,v8,v254
FML v9,v9,v254
FML v10,v10,v254
FML v11,v11,v254
AWR a16,v8
AWR a17,v9
AWR a18,v10
AWR a19,v11
ARD v8,a20
ARD v9,a21
ARD v10,a22
ARD v11,a23
FML v8,v8,v254
FML v9,v9,v254
FML v10,v10,v254
FML v11,v11,v254
AWR a20,v8
AWR a21,v9
AWR a22,v10
AWR a23,v11
ARD v8,a24
ARD v9,a25
ARD v10,a26
ARD v11,a27
FML v8,v8,v254
FML v9,v9,v254
FML v10,v10,v254
FML v11,v11,v254
AWR a24,v8
AWR a25,v9
AWR a26,v10
AWR a27,v11
ARD v8,a28
ARD v9,a29
ARD v10,a30
ARD v11,a31
FML v8,v8,v254
FML v9,v9,v254
FML v10,v10,v254
FML v11,v11,v254
AWR a28,v8
AWR a29,v9
AWR a30,v10
AWR a31,v11
ARD v8,a32
ARD v9,a33
ARD v10,a34
ARD v11,a35
FML v8,v8,v254
FML v9,v9,v254
FML v10,v10,v254
FML v11,v11,v254
AWR a32,v8
AWR a33,v9
AWR a34,v10
AWR a35,v11
ARD v8,a36
ARD v9,a37
ARD v10,a38
ARD v11,a39
FML v8,v8,v254
FML v9,v9,v254
FML v10,v10,v254
FML v11,v11,v254
AWR a36,v8
AWR a37,v9
AWR a38,v10
AWR a39,v11
ARD v8,a40
ARD v9,a41
ARD v10,a42
ARD v11,a43
FML v8,v8,v254
FML v9,v9,v254
FML v10,v10,v254
FML v11,v11,v254
AWR a40,v8
AWR a41,v9
AWR a42,v10
AWR a43,v11
ARD v8,a44
ARD v9,a45
ARD v10,a46
ARD v11,a47
FML v8,v8,v254
FML v9,v9,v254
FML v10,v10,v254
FML v11,v11,v254
AWR a44,v8
AWR a45,v9
AWR a46,v10
AWR a47,v11
ARD v8,a48
ARD v9,a49
ARD v10,a50
ARD v11,a51
FML v8,v8,v254
FML v9,v9,v254
FML v10,v10,v254
FML v11,v11,v254
AWR a48,v8
AWR a49,v9
AWR a50,v10
AWR a51,v11
ARD v8,a52
ARD v9,a53
ARD v10,a54
ARD v11,a55
FML v8,v8,v254
FML v9,v9,v254
FML v10,v10,v254
FML v11,v11,v254
AWR a52,v8
AWR a53,v9
AWR a54,v10
AWR a55,v11
ARD v8,a56
ARD v9,a57
ARD v10,a58
ARD v11,a59
FML v8,v8,v254
FML v9,v9,v254
FML v10,v10,v254
FML v11,v11,v254
AWR a56,v8
AWR a57,v9
AWR a58,v10
AWR a59,v11
ARD v8,a60
ARD v9,a61
ARD v10,a62
ARD v11,a63
FML v8,v8,v254
FML v9,v9,v254
FML v10,v10,v254
FML v11,v11,v254
AWR a60,v8
AWR a61,v9
AWR a62,v10
AWR a63,v11
FAD v80,v80,v253
FAD v81,v81,v253
FAD v82,v82,v253
FAD v83,v83,v253
FAD v84,v84,v253
FAD v85,v85,v253
FAD v86,v86,v253
FAD v87,v87,v253
FAD v88,v88,v253
FAD v89,v89,v253
FAD v90,v90,v253
FAD v91,v91,v253
FAD v92,v92,v253
FAD v93,v93,v253
FAD v94,v94,v253
FAD v95,v95,v253
FAD v96,v96,v253
FAD v97,v97,v253
FAD v98,v98,v253
FAD v99,v99,v253
FAD v100,v100,v253
FAD v101,v101,v253
FAD v102,v102,v253
FAD v103,v103,v253
FAD v104,v104,v253
FAD v105,v105,v253
FAD v106,v106,v253
FAD v107,v107,v253
FAD v108,v108,v253
FAD v109,v109,v253
FAD v110,v110,v253
FAD v111,v111,v253
FAD v112,v112,v253
FAD v113,v113,v253
FAD v114,v114,v253
FAD v115,v115,v253
FAD v116,v116,v253
FAD v117,v117,v253
FAD v118,v118,v253
FAD v119,v119,v253
FAD v120,v120,v253
FAD v121,v121,v253
FAD v122,v122,v253
FAD v123,v123,v253
FAD v124,v124,v253
FAD v125,v125,v253
FAD v126,v126,v253
FAD v127,v127,v253
FAD v128,v128,v253
FAD v129,v129,v253
FAD v130,v130,v253
FAD v131,v131,v253
FAD v132,v132,v253
FAD v133,v133,v253
FAD v134,v134,v253
FAD v135,v135,v253
FAD v136,v136,v253
FAD v137,v137,v253
FAD v138,v138,v253
FAD v139,v139,v253
FAD v140,v140,v253
FAD v141,v141,v253
FAD v142,v142,v253
FAD v143,v143,v253
v_mov_b32 v240, v251
FSB v144,0,v251
FSB v145,0,v251
FSB v146,0,v251
FSB v147,0,v251
FSB v148,0,v251
FSB v149,0,v251
FSB v150,0,v251
FSB v151,0,v251
FSB v152,0,v251
FSB v153,0,v251
FSB v154,0,v251
FSB v155,0,v251
FSB v156,0,v251
FSB v157,0,v251
FSB v158,0,v251
FSB v159,0,v251
FSB v16,v16,v251
FSB v17,v17,v251
FSB v18,v18,v251
FSB v19,v19,v251
FSB v20,v20,v251
FSB v21,v21,v251
FSB v22,v22,v251
FSB v23,v23,v251
FSB v24,v24,v251
FSB v25,v25,v251
FSB v26,v26,v251
FSB v27,v27,v251
FSB v28,v28,v251
FSB v29,v29,v251
FSB v30,v30,v251
FSB v31,v31,v251
FSB v32,v32,v251
FSB v33,v33,v251
FSB v34,v34,v251
FSB v35,v35,v251
FSB v36,v36,v251
FSB v37,v37,v251
FSB v38,v38,v251
FSB v39,v39,v251
FSB v40,v40,v251
FSB v41,v41,v251
FSB v42,v42,v251
FSB v43,v43,v251
FSB v44,v44,v251
FSB v45,v45,v251
FSB v46,v46,v251
FSB v47,v47,v251
FSB v48,v48,v251
FSB v49,v49,v251
FSB v50,v50,v251
FSB v51,v51,v251
FSB v52,v52,v251
FSB v53,v53,v251
FSB v54,v54,v251
FSB v55,v55,v251
FSB v56,v56,v251
FSB v57,v57,v251
FSB v58,v58,v251
FSB v59,v59,v251
FSB v60,v60,v251
FSB v61,v61,v251
FSB v62,v62,v251
FSB v63,v63,v251
FSB v64,v64,v251
FSB v65,v65,v251
FSB v66,v66,v251
FSB v67,v67,v251
FSB v68,v68,v251
FSB v69,v69,v251
FSB v70,v70,v251
FSB v71,v71,v251
FSB v72,v72,v251
FSB v73,v73,v251
FSB v74,v74,v251
FSB v75,v75,v251
FSB v76,v76,v251
FSB v77,v77,v251
FSB v78,v78,v251
FSB v79,v79,v251
EXP v16,v16
EXP v17,v17
EXP v18,v18
FAD v244,v16,v17
EXP v19,v19
CVT v16,v16,v17
EXP v20,v20
FAD v245,v18,v19
EXP v21,v21
CVT v17,v18,v19
EXP v22,v22
FAD v244,v244,v20
EXP v23,v23
FAD v245,v245,v21
CVT v18,v20,v21
EXP v24,v24
FAD v244,v244,v22
EXP v25,v25
FAD v245,v245,v23
CVT v19,v22,v23
EXP v26,v26
FAD v244,v244,v24
EXP v27,v27
FAD v245,v245,v25
CVT v20,v24,v25
EXP v28,v28
FAD v244,v244,v26
EXP v29,v29
FAD v245,v245,v27
CVT v21,v26,v27
EXP v30,v30
FAD v244,v244,v28
EXP v31,v31
FAD v245,v245,v29
CVT v22,v28,v29
EXP v48,v48
FAD v244,v244,v30
EXP v49,v49
FAD v245,v245,v31
CVT v23,v30,v31
EXP v50,v50
FAD v246,v48,v49
EXP v51,v51
CVT v48,v48,v49
EXP v52,v52
FAD v247,v50,v51
EXP v53,v53
CVT v49,v50,v51
EXP v54,v54
FAD v246,v246,v52
EXP v55,v55
FAD v247,v247,v53
CVT v50,v52,v53
EXP v56,v56
FAD v246,v246,v54
EXP v57,v57
FAD v247,v247,v55
CVT v51,v54,v55
EXP v58,v58
FAD v246,v246,v56
EXP v59,v59
FAD v247,v247,v57
CVT v52,v56,v57
EXP v60,v60
FAD v246,v246,v58
EXP v61,v61
FAD v247,v247,v59
CVT v53,v58,v59
EXP v62,v62
FAD v246,v246,v60
EXP v63,v63
FAD v247,v247,v61
CVT v54,v60,v61
EXP v32,v32
FAD v246,v246,v62
EXP v33,v33
FAD v247,v247,v63
CVT v55,v62,v63
EXP v34,v34
FAD v244,v244,v32
EXP v35,v35
FAD v245,v245,v33
CVT v24,v32,v33
EXP v36,v36
FAD v244,v244,v34
EXP v37,v37
FAD v245,v245,v35
CVT v25,v34,v35
EXP v38,v38
FAD v244,v244,v36
EXP v39,v39
FAD v245,v245,v37
CVT v26,v36,v37
EXP v40,v40
FAD v244,v244,v38
EXP v41,v41
FAD v245,v245,v39
CVT v27,v38,v39
EXP v42,v42
FAD v244,v244,v40
EXP v43,v43
FAD v245,v245,v41
CVT v28,v40,v41
EXP v44,v44
FAD v244,v244,v42
EXP v45,v45
FAD v245,v245,v43
CVT v29,v42,v43
EXP v46,v46
FAD v244,v244,v44
EXP v47,v47
FAD v245,v245,v45
CVT v30,v44,v45
EXP v64,v64
FAD v244,v244,v46
EXP v65,v65
FAD v245,v245,v47
CVT v31,v46,v47
EXP v66,v66
FAD v246,v246,v64
EXP v67,v67
FAD v247,v247,v65
CVT v56,v64,v65
EXP v68,v68
FAD v246,v246,v66
EXP v69,v69
FAD v247,v247,v67
CVT v57,v66,v67
EXP v70,v70
FAD v246,v246,v68
EXP v71,v71
FAD v247,v247,v69
CVT v58,v68,v69
EXP v72,v72
FAD v246,v246,v70
EXP v73,v73
FAD v247,v247,v71
CVT v59,v70,v71
EXP v74,v74
FAD v246,v246,v72
EXP v75,v75
FAD v247,v247,v73
CVT v60,v72,v73
EXP v76,v76
FAD v246,v246,v74
EXP v77,v77
FAD v247,v247,v75
CVT v61,v74,v75
EXP v78,v78
FAD v246,v246,v76
EXP v79,v79
FAD v247,v247,v77
CVT v62,v76,v77
FAD v246,v246,v78
FAD v247,v247,v79
CVT v63,v78,v79
FAD v244,v244,v245
FAD v246,v246,v247
v_max_f32 v251, v244, v246
v_cmp_nle_f32 vcc, v251, v255
s_nop 4
s_branch L_F0_back
L_Gp_rare:
s_nop 12
s_mov_b32 s69, s59
buffer_load_dwordx4 a[128:131], v4, s[16:19], s69 offen offset:0
buffer_load_dwordx4 a[132:135], v4, s[16:19], s69 offen offset:1024
buffer_load_dwordx4 a[136:139], v4, s[16:19], s69 offen offset:2048
buffer_load_dwordx4 a[140:143], v4, s[16:19], s69 offen offset:3072
s_add_u32 s69, s69, 4096
buffer_load_dwordx4 a[144:147], v4, s[16:19], s69 offen offset:0
buffer_load_dwordx4 a[148:151], v4, s[16:19], s69 offen offset:1024
buffer_load_dwordx4 a[152:155], v4, s[16:19], s69 offen offset:2048
buffer_load_dwordx4 a[156:159], v4, s[16:19], s69 offen offset:3072
s_add_u32 s69, s69, 4096
buffer_load_dwordx4 a[160:163], v4, s[16:19], s69 offen offset:0
buffer_load_dwordx4 a[164:167], v4, s[16:19], s69 offen offset:1024
buffer_load_dwordx4 a[168:171], v4, s[16:19], s69 offen offset:2048
buffer_load_dwordx4 a[172:175], v4, s[16:19], s69 offen offset:3072
s_add_u32 s69, s69, 4096
buffer_load_dwordx4 a[176:179], v4, s[16:19], s69 offen offset:0
buffer_load_dwordx4 a[180:183], v4, s[16:19], s69 offen offset:1024
buffer_load_dwordx4 a[184:187], v4, s[16:19], s69 offen offset:2048
buffer_load_dwordx4 a[188:191], v4, s[16:19], s69 offen offset:3072
s_add_u32 s69, s69, 20480
s_waitcnt vmcnt(15)
M32 v[16:31],a[128:131],v[176:179],0
s_waitcnt vmcnt(14)
M32 v[16:31],a[132:135],v[180:183],v[16:31]
s_waitcnt vmcnt(13)
M32 v[16:31],a[136:139],v[184:187],v[16:31]
s_waitcnt vmcnt(12)
M32 v[16:31],a[140:143],v[188:191],v[16:31]
s_waitcnt vmcnt(11)
M32 v[16:31],a[144:147],v[192:195],v[16:31]
s_waitcnt vmcnt(10)
M32 v[16:31],a[148:151],v[196:199],v[16:31]
s_waitcnt vmcnt(9)
M32 v[16:31],a[152:155],v[200:203],v[16:31]
s_waitcnt vmcnt(8)
M32 v[16:31],a[156:159],v[204:207],v[16:31]
s_waitcnt vmcnt(7)
M32 v[32:47],a[160:163],v[176:179],0
s_waitcnt vmcnt(6)
M32 v[32:47],a[164:167],v[180:183],v[32:47]
s_waitcnt vmcnt(5)
M32 v[32:47],a[168:171],v[184:187],v[32:47]
s_waitcnt vmcnt(4)
M32 v[32:47],a[172:175],v[188:191],v[32:47]
s_waitcnt vmcnt(3)
M32 v[32:47],a[176:179],v[192:195],v[32:47]
s_waitcnt vmcnt(2)
M32 v[32:47],a[180:183],v[196:199],v[32:47]
s_waitcnt vmcnt(1)
M32 v[32:47],a[184:187],v[200:203],v[32:47]
s_waitcnt vmcnt(0)
M32 v[32:47],a[188:191],v[204:207],v[32:47]
buffer_load_dwordx4 a[128:131], v4, s[16:19], s69 offen offset:0
buffer_load_dwordx4 a[132:135], v4, s[16:19], s69 offen offset:1024
buffer_load_dwordx4 a[136:139], v4, s[16:19], s69 offen offset:2048
buffer_load_dwordx4 a[140:143], v4, s[16:19], s69 offen offset:3072
s_add_u32 s69, s69, 4096
buffer_load_dwordx4 a[144:147], v4, s[16:19], s69 offen offset:0
buffer_load_dwordx4 a[148:151], v4, s[16:19], s69 offen offset:1024
buffer_load_dwordx4 a[152:155], v4, s[16:19], s69 offen offset:2048
buffer_load_dwordx4 a[156:159], v4, s[16:19], s69 offen offset:3072
s_add_u32 s69, s69, 4096
buffer_load_dwordx4 a[160:163], v4, s[16:19], s69 offen offset:0
buffer_load_dwordx4 a[164:167], v4, s[16:19], s69 offen offset:1024
buffer_load_dwordx4 a[168:171], v4, s[16:19], s69 offen offset:2048
buffer_load_dwordx4 a[172:175], v4, s[16:19], s69 offen offset:3072
s_add_u32 s69, s69, 4096
buffer_load_dwordx4 a[176:179], v4, s[16:19], s69 offen offset:0
buffer_load_dwordx4 a[180:183], v4, s[16:19], s69 offen offset:1024
buffer_load_dwordx4 a[184:187], v4, s[16:19], s69 offen offset:2048
buffer_load_dwordx4 a[188:191], v4, s[16:19], s69 offen offset:3072
s_add_u32 s69, s69, 20480
s_waitcnt vmcnt(15)
M32 v[48:63],a[128:131],v[176:179],0
s_waitcnt vmcnt(14)
M32 v[48:63],a[132:135],v[180:183],v[48:63]
s_waitcnt vmcnt(13)
M32 v[48:63],a[136:139],v[184:187],v[48:63]
s_waitcnt vmcnt(12)
M32 v[48:63],a[140:143],v[188:191],v[48:63]
s_waitcnt vmcnt(11)
M32 v[48:63],a[144:147],v[192:195],v[48:63]
s_waitcnt vmcnt(10)
M32 v[48:63],a[148:151],v[196:199],v[48:63]
s_waitcnt vmcnt(9)
M32 v[48:63],a[152:155],v[200:203],v[48:63]
s_waitcnt vmcnt(8)
M32 v[48:63],a[156:159],v[204:207],v[48:63]
s_waitcnt vmcnt(7)
M32 v[64:79],a[160:163],v[176:179],0
s_waitcnt vmcnt(6)
M32 v[64:79],a[164:167],v[180:183],v[64:79]
s_waitcnt vmcnt(5)
M32 v[64:79],a[168:171],v[184:187],v[64:79]
s_waitcnt vmcnt(4)
M32 v[64:79],a[172:175],v[188:191],v[64:79]
s_waitcnt vmcnt(3)
M32 v[64:79],a[176:179],v[192:195],v[64:79]
s_waitcnt vmcnt(2)
M32 v[64:79],a[180:183],v[196:199],v[64:79]
s_waitcnt vmcnt(1)
M32 v[64:79],a[184:187],v[200:203],v[64:79]
s_waitcnt vmcnt(0)
M32 v[64:79],a[188:191],v[204:207],v[64:79]
v_cmp_le_i32 s[36:37], 0, v248
v_cmp_le_i32 s[38:39], 1, v248
v_cmp_le_i32 s[40:41], 2, v248
v_cmp_le_i32 s[42:43], 3, v248
CND v16,v250,v16,s[36:37]
CND v17,v250,v17,s[38:39]
CND v18,v250,v18,s[40:41]
CND v19,v250,v19,s[42:43]
v_cmp_le_i32 s[36:37], 16, v248
v_cmp_le_i32 s[38:39], 17, v248
v_cmp_le_i32 s[40:41], 18, v248
v_cmp_le_i32 s[42:43], 19, v248
CND v20,v250,v20,s[36:37]
CND v21,v250,v21,s[38:39]
CND v22,v250,v22,s[40:41]
CND v23,v250,v23,s[42:43]
v_cmp_le_i32 s[36:37], 8, v248
v_cmp_le_i32 s[38:39], 9, v248
v_cmp_le_i32 s[40:41], 10, v248
v_cmp_le_i32 s[42:43], 11, v248
CND v24,v250,v24,s[36:37]
CND v25,v250,v25,s[38:39]
CND v26,v250,v26,s[40:41]
CND v27,v250,v27,s[42:43]
v_cmp_le_i32 s[36:37], 24, v248
v_cmp_le_i32 s[38:39], 25, v248
v_cmp_le_i32 s[40:41], 26, v248
v_cmp_le_i32 s[42:43], 27, v248
CND v28,v250,v28,s[36:37]
CND v29,v250,v29,s[38:39]
CND v30,v250,v30,s[40:41]
CND v31,v250,v31,s[42:43]
v_cmp_le_i32 s[36:37], 32, v248
v_cmp_le_i32 s[38:39], 33, v248
v_cmp_le_i32 s[40:41], 34, v248
v_cmp_le_i32 s[42:43], 35, v248
CND v32,v250,v32,s[36:37]
CND v33,v250,v33,s[38:39]
CND v34,v250,v34,s[40:41]
CND v35,v250,v35,s[42:43]
v_cmp_le_i32 s[36:37], 48, v248
v_cmp_le_i32 s[38:39], 49, v248
v_cmp_le_i32 s[40:41], 50, v248
v_cmp_le_i32 s[42:43], 51, v248
CND v36,v250,v36,s[36:37]
CND v37,v250,v37,s[38:39]
CND v38,v250,v38,s[40:41]
CND v39,v250,v39,s[42:43]
v_cmp_le_i32 s[36:37], 40, v248
v_cmp_le_i32 s[38:39], 41, v248
v_cmp_le_i32 s[40:41], 42, v248
v_cmp_le_i32 s[42:43], 43, v248
CND v40,v250,v40,s[36:37]
CND v41,v250,v41,s[38:39]
CND v42,v250,v42,s[40:41]
CND v43,v250,v43,s[42:43]
v_cmp_le_i32 s[36:37], 56, v248
v_cmp_le_i32 s[38:39], 57, v248
v_cmp_le_i32 s[40:41], 58, v248
v_cmp_le_i32 s[42:43], 59, v248
CND v44,v250,v44,s[36:37]
CND v45,v250,v45,s[38:39]
CND v46,v250,v46,s[40:41]
CND v47,v250,v47,s[42:43]
v_cmp_le_i32 s[36:37], 0, v249
v_cmp_le_i32 s[38:39], 1, v249
v_cmp_le_i32 s[40:41], 2, v249
v_cmp_le_i32 s[42:43], 3, v249
CND v48,v250,v48,s[36:37]
CND v49,v250,v49,s[38:39]
CND v50,v250,v50,s[40:41]
CND v51,v250,v51,s[42:43]
v_cmp_le_i32 s[36:37], 16, v249
v_cmp_le_i32 s[38:39], 17, v249
v_cmp_le_i32 s[40:41], 18, v249
v_cmp_le_i32 s[42:43], 19, v249
CND v52,v250,v52,s[36:37]
CND v53,v250,v53,s[38:39]
CND v54,v250,v54,s[40:41]
CND v55,v250,v55,s[42:43]
v_cmp_le_i32 s[36:37], 8, v249
v_cmp_le_i32 s[38:39], 9, v249
v_cmp_le_i32 s[40:41], 10, v249
v_cmp_le_i32 s[42:43], 11, v249
CND v56,v250,v56,s[36:37]
CND v57,v250,v57,s[38:39]
CND v58,v250,v58,s[40:41]
CND v59,v250,v59,s[42:43]
v_cmp_le_i32 s[36:37], 24, v249
v_cmp_le_i32 s[38:39], 25, v249
v_cmp_le_i32 s[40:41], 26, v249
v_cmp_le_i32 s[42:43], 27, v249
CND v60,v250,v60,s[36:37]
CND v61,v250,v61,s[38:39]
CND v62,v250,v62,s[40:41]
CND v63,v250,v63,s[42:43]
v_cmp_le_i32 s[36:37], 32, v249
v_cmp_le_i32 s[38:39], 33, v249
v_cmp_le_i32 s[40:41], 34, v249
v_cmp_le_i32 s[42:43], 35, v249
CND v64,v250,v64,s[36:37]
CND v65,v250,v65,s[38:39]
CND v66,v250,v66,s[40:41]
CND v67,v250,v67,s[42:43]
v_cmp_le_i32 s[36:37], 48, v249
v_cmp_le_i32 s[38:39], 49, v249
v_cmp_le_i32 s[40:41], 50, v249
v_cmp_le_i32 s[42:43], 51, v249
CND v68,v250,v68,s[36:37]
CND v69,v250,v69,s[38:39]
CND v70,v250,v70,s[40:41]
CND v71,v250,v71,s[42:43]
v_cmp_le_i32 s[36:37], 40, v249
v_cmp_le_i32 s[38:39], 41, v249
v_cmp_le_i32 s[40:41], 42, v249
v_cmp_le_i32 s[42:43], 43, v249
CND v72,v250,v72,s[36:37]
CND v73,v250,v73,s[38:39]
CND v74,v250,v74,s[40:41]
CND v75,v250,v75,s[42:43]
v_cmp_le_i32 s[36:37], 56, v249
v_cmp_le_i32 s[38:39], 57, v249
v_cmp_le_i32 s[40:41], 58, v249
v_cmp_le_i32 s[42:43], 59, v249
CND v76,v250,v76,s[36:37]
CND v77,v250,v77,s[38:39]
CND v78,v250,v78,s[40:41]
CND v79,v250,v79,s[42:43]
v_max3_f32 v251, v16, v17, v18
v_max3_f32 v251, v251, v19, v20
v_max3_f32 v251, v251, v21, v22
v_max3_f32 v251, v251, v23, v24
v_max3_f32 v251, v251, v25, v26
v_max3_f32 v251, v251, v27, v28
v_max3_f32 v251, v251, v29, v30
v_max3_f32 v251, v251, v31, v32
v_max3_f32 v251, v251, v33, v34
v_max3_f32 v251, v251, v35, v36
v_max3_f32 v251, v251, v37, v38
v_max3_f32 v251, v251, v39, v40
v_max3_f32 v251, v251, v41, v42
v_max3_f32 v251, v251, v43, v44
v_max3_f32 v251, v251, v45, v46
v_max_f32 v251, v251, v47
v_max3_f32 v252, v48, v49, v50
v_max3_f32 v252, v252, v51, v52
v_max3_f32 v252, v252, v53, v54
v_max3_f32 v252, v252, v55, v56
v_max3_f32 v252, v252, v57, v58
v_max3_f32 v252, v252, v59, v60
v_max3_f32 v252, v252, v61, v62
v_max3_f32 v252, v252, v63, v64
v_max3_f32 v252, v252, v65, v66
v_max3_f32 v252, v252, v67, v68
v_max3_f32 v252, v252, v69, v70
v_max3_f32 v252, v252, v71, v72
v_max3_f32 v252, v252, v73, v74
v_max3_f32 v252, v252, v75, v76
v_max3_f32 v252, v252, v77, v78
v_max_f32 v252, v252, v79
v_max_f32 v251, v251, v252
v_mov_b32 v253, v251
s_nop 1
v_permlane32_swap_b32 v251, v253
v_max_f32 v251, v251, v253
v_max_f32 v251, v251, v240
FSB v253,v240,v251
EXP v254,v253
s_nop 0
FML v242,v242,v254
ARD v8,a0
ARD v9,a1
ARD v10,a2
ARD v11,a3
FML v8,v8,v254
FML v9,v9,v254
FML v10,v10,v254
FML v11,v11,v254
AWR a0,v8
AWR a1,v9
AWR a2,v10
AWR a3,v11
ARD v8,a4
ARD v9,a5
ARD v10,a6
ARD v11,a7
FML v8,v8,v254
FML v9,v9,v254
FML v10,v10,v254
FML v11,v11,v254
AWR a4,v8
AWR a5,v9
AWR a6,v10
AWR a7,v11
ARD v8,a8
ARD v9,a9
ARD v10,a10
ARD v11,a11
FML v8,v8,v254
FML v9,v9,v254
FML v10,v10,v254
FML v11,v11,v254
AWR a8,v8
AWR a9,v9
AWR a10,v10
AWR a11,v11
ARD v8,a12
ARD v9,a13
ARD v10,a14
ARD v11,a15
FML v8,v8,v254
FML v9,v9,v254
FML v10,v10,v254
FML v11,v11,v254
AWR a12,v8
AWR a13,v9
AWR a14,v10
AWR a15,v11
ARD v8,a16
ARD v9,a17
ARD v10,a18
ARD v11,a19
FML v8,v8,v254
FML v9,v9,v254
FML v10,v10,v254
FML v11,v11,v254
AWR a16,v8
AWR a17,v9
AWR a18,v10
AWR a19,v11
ARD v8,a20
ARD v9,a21
ARD v10,a22
ARD v11,a23
FML v8,v8,v254
FML v9,v9,v254
FML v10,v10,v254
FML v11,v11,v254
AWR a20,v8
AWR a21,v9
AWR a22,v10
AWR a23,v11
ARD v8,a24
ARD v9,a25
ARD v10,a26
ARD v11,a27
FML v8,v8,v254
FML v9,v9,v254
FML v10,v10,v254
FML v11,v11,v254
AWR a24,v8
AWR a25,v9
AWR a26,v10
AWR a27,v11
ARD v8,a28
ARD v9,a29
ARD v10,a30
ARD v11,a31
FML v8,v8,v254
FML v9,v9,v254
FML v10,v10,v254
FML v11,v11,v254
AWR a28,v8
AWR a29,v9
AWR a30,v10
AWR a31,v11
ARD v8,a32
ARD v9,a33
ARD v10,a34
ARD v11,a35
FML v8,v8,v254
FML v9,v9,v254
FML v10,v10,v254
FML v11,v11,v254
AWR a32,v8
AWR a33,v9
AWR a34,v10
AWR a35,v11
ARD v8,a36
ARD v9,a37
ARD v10,a38
ARD v11,a39
FML v8,v8,v254
FML v9,v9,v254
FML v10,v10,v254
FML v11,v11,v254
AWR a36,v8
AWR a37,v9
AWR a38,v10
AWR a39,v11
ARD v8,a40
ARD v9,a41
ARD v10,a42
ARD v11,a43
FML v8,v8,v254
FML v9,v9,v254
FML v10,v10,v254
FML v11,v11,v254
AWR a40,v8
AWR a41,v9
AWR a42,v10
AWR a43,v11
ARD v8,a44
ARD v9,a45
ARD v10,a46
ARD v11,a47
FML v8,v8,v254
FML v9,v9,v254
FML v10,v10,v254
FML v11,v11,v254
AWR a44,v8
AWR a45,v9
AWR a46,v10
AWR a47,v11
ARD v8,a48
ARD v9,a49
ARD v10,a50
ARD v11,a51
FML v8,v8,v254
FML v9,v9,v254
FML v10,v10,v254
FML v11,v11,v254
AWR a48,v8
AWR a49,v9
AWR a50,v10
AWR a51,v11
ARD v8,a52
ARD v9,a53
ARD v10,a54
ARD v11,a55
FML v8,v8,v254
FML v9,v9,v254
FML v10,v10,v254
FML v11,v11,v254
AWR a52,v8
AWR a53,v9
AWR a54,v10
AWR a55,v11
ARD v8,a56
ARD v9,a57
ARD v10,a58
ARD v11,a59
FML v8,v8,v254
FML v9,v9,v254
FML v10,v10,v254
FML v11,v11,v254
AWR a56,v8
AWR a57,v9
AWR a58,v10
AWR a59,v11
ARD v8,a60
ARD v9,a61
ARD v10,a62
ARD v11,a63
FML v8,v8,v254
FML v9,v9,v254
FML v10,v10,v254
FML v11,v11,v254
AWR a60,v8
AWR a61,v9
AWR a62,v10
AWR a63,v11
v_mov_b32 v240, v251
FSB v144,0,v251
FSB v145,0,v251
FSB v146,0,v251
FSB v147,0,v251
FSB v148,0,v251
FSB v149,0,v251
FSB v150,0,v251
FSB v151,0,v251
FSB v152,0,v251
FSB v153,0,v251
FSB v154,0,v251
FSB v155,0,v251
FSB v156,0,v251
FSB v157,0,v251
FSB v158,0,v251
FSB v159,0,v251
FSB v16,v16,v251
FSB v17,v17,v251
FSB v18,v18,v251
FSB v19,v19,v251
FSB v20,v20,v251
FSB v21,v21,v251
FSB v22,v22,v251
FSB v23,v23,v251
FSB v24,v24,v251
FSB v25,v25,v251
FSB v26,v26,v251
FSB v27,v27,v251
FSB v28,v28,v251
FSB v29,v29,v251
FSB v30,v30,v251
FSB v31,v31,v251
FSB v32,v32,v251
FSB v33,v33,v251
FSB v34,v34,v251
FSB v35,v35,v251
FSB v36,v36,v251
FSB v37,v37,v251
FSB v38,v38,v251
FSB v39,v39,v251
FSB v40,v40,v251
FSB v41,v41,v251
FSB v42,v42,v251
FSB v43,v43,v251
FSB v44,v44,v251
FSB v45,v45,v251
FSB v46,v46,v251
FSB v47,v47,v251
FSB v48,v48,v251
FSB v49,v49,v251
FSB v50,v50,v251
FSB v51,v51,v251
FSB v52,v52,v251
FSB v53,v53,v251
FSB v54,v54,v251
FSB v55,v55,v251
FSB v56,v56,v251
FSB v57,v57,v251
FSB v58,v58,v251
FSB v59,v59,v251
FSB v60,v60,v251
FSB v61,v61,v251
FSB v62,v62,v251
FSB v63,v63,v251
FSB v64,v64,v251
FSB v65,v65,v251
FSB v66,v66,v251
FSB v67,v67,v251
FSB v68,v68,v251
FSB v69,v69,v251
FSB v70,v70,v251
FSB v71,v71,v251
FSB v72,v72,v251
FSB v73,v73,v251
FSB v74,v74,v251
FSB v75,v75,v251
FSB v76,v76,v251
FSB v77,v77,v251
FSB v78,v78,v251
FSB v79,v79,v251
EXP v16,v16
EXP v17,v17
EXP v18,v18
FAD v244,v16,v17
EXP v19,v19
CVT v16,v16,v17
EXP v20,v20
FAD v245,v18,v19
EXP v21,v21
CVT v17,v18,v19
EXP v22,v22
FAD v244,v244,v20
EXP v23,v23
FAD v245,v245,v21
CVT v18,v20,v21
EXP v24,v24
FAD v244,v244,v22
EXP v25,v25
FAD v245,v245,v23
CVT v19,v22,v23
EXP v26,v26
FAD v244,v244,v24
EXP v27,v27
FAD v245,v245,v25
CVT v20,v24,v25
EXP v28,v28
FAD v244,v244,v26
EXP v29,v29
FAD v245,v245,v27
CVT v21,v26,v27
EXP v30,v30
FAD v244,v244,v28
EXP v31,v31
FAD v245,v245,v29
CVT v22,v28,v29
EXP v48,v48
FAD v244,v244,v30
EXP v49,v49
FAD v245,v245,v31
CVT v23,v30,v31
EXP v50,v50
FAD v246,v48,v49
EXP v51,v51
CVT v48,v48,v49
EXP v52,v52
FAD v247,v50,v51
EXP v53,v53
CVT v49,v50,v51
EXP v54,v54
FAD v246,v246,v52
EXP v55,v55
FAD v247,v247,v53
CVT v50,v52,v53
EXP v56,v56
FAD v246,v246,v54
EXP v57,v57
FAD v247,v247,v55
CVT v51,v54,v55
EXP v58,v58
FAD v246,v246,v56
EXP v59,v59
FAD v247,v247,v57
CVT v52,v56,v57
EXP v60,v60
FAD v246,v246,v58
EXP v61,v61
FAD v247,v247,v59
CVT v53,v58,v59
EXP v62,v62
FAD v246,v246,v60
EXP v63,v63
FAD v247,v247,v61
CVT v54,v60,v61
EXP v32,v32
FAD v246,v246,v62
EXP v33,v33
FAD v247,v247,v63
CVT v55,v62,v63
EXP v34,v34
FAD v244,v244,v32
EXP v35,v35
FAD v245,v245,v33
CVT v24,v32,v33
EXP v36,v36
FAD v244,v244,v34
EXP v37,v37
FAD v245,v245,v35
CVT v25,v34,v35
EXP v38,v38
FAD v244,v244,v36
EXP v39,v39
FAD v245,v245,v37
CVT v26,v36,v37
EXP v40,v40
FAD v244,v244,v38
EXP v41,v41
FAD v245,v245,v39
CVT v27,v38,v39
EXP v42,v42
FAD v244,v244,v40
EXP v43,v43
FAD v245,v245,v41
CVT v28,v40,v41
EXP v44,v44
FAD v244,v244,v42
EXP v45,v45
FAD v245,v245,v43
CVT v29,v42,v43
EXP v46,v46
FAD v244,v244,v44
EXP v47,v47
FAD v245,v245,v45
CVT v30,v44,v45
EXP v64,v64
FAD v244,v244,v46
EXP v65,v65
FAD v245,v245,v47
CVT v31,v46,v47
EXP v66,v66
FAD v246,v246,v64
EXP v67,v67
FAD v247,v247,v65
CVT v56,v64,v65
EXP v68,v68
FAD v246,v246,v66
EXP v69,v69
FAD v247,v247,v67
CVT v57,v66,v67
EXP v70,v70
FAD v246,v246,v68
EXP v71,v71
FAD v247,v247,v69
CVT v58,v68,v69
EXP v72,v72
FAD v246,v246,v70
EXP v73,v73
FAD v247,v247,v71
CVT v59,v70,v71
EXP v74,v74
FAD v246,v246,v72
EXP v75,v75
FAD v247,v247,v73
CVT v60,v72,v73
EXP v76,v76
FAD v246,v246,v74
EXP v77,v77
FAD v247,v247,v75
CVT v61,v74,v75
EXP v78,v78
FAD v246,v246,v76
EXP v79,v79
FAD v247,v247,v77
CVT v62,v76,v77
FAD v246,v246,v78
FAD v247,v247,v79
CVT v63,v78,v79
FAD v244,v244,v245
FAD v246,v246,v247
v_max_f32 v251, v244, v246
v_cmp_nle_f32 vcc, v251, v255
s_nop 4
s_branch L_Gp_back
L_G_rare:
s_nop 12
s_mov_b32 s69, s59
buffer_load_dwordx4 a[128:131], v4, s[16:19], s69 offen offset:0
buffer_load_dwordx4 a[132:135], v4, s[16:19], s69 offen offset:1024
buffer_load_dwordx4 a[136:139], v4, s[16:19], s69 offen offset:2048
buffer_load_dwordx4 a[140:143], v4, s[16:19], s69 offen offset:3072
s_add_u32 s69, s69, 4096
buffer_load_dwordx4 a[144:147], v4, s[16:19], s69 offen offset:0
buffer_load_dwordx4 a[148:151], v4, s[16:19], s69 offen offset:1024
buffer_load_dwordx4 a[152:155], v4, s[16:19], s69 offen offset:2048
buffer_load_dwordx4 a[156:159], v4, s[16:19], s69 offen offset:3072
s_add_u32 s69, s69, 4096
buffer_load_dwordx4 a[160:163], v4, s[16:19], s69 offen offset:0
buffer_load_dwordx4 a[164:167], v4, s[16:19], s69 offen offset:1024
buffer_load_dwordx4 a[168:171], v4, s[16:19], s69 offen offset:2048
buffer_load_dwordx4 a[172:175], v4, s[16:19], s69 offen offset:3072
s_add_u32 s69, s69, 4096
buffer_load_dwordx4 a[176:179], v4, s[16:19], s69 offen offset:0
buffer_load_dwordx4 a[180:183], v4, s[16:19], s69 offen offset:1024
buffer_load_dwordx4 a[184:187], v4, s[16:19], s69 offen offset:2048
buffer_load_dwordx4 a[188:191], v4, s[16:19], s69 offen offset:3072
s_add_u32 s69, s69, 20480
s_waitcnt vmcnt(15)
M32 v[16:31],a[128:131],v[176:179],0
s_waitcnt vmcnt(14)
M32 v[16:31],a[132:135],v[180:183],v[16:31]
s_waitcnt vmcnt(13)
M32 v[16:31],a[136:139],v[184:187],v[16:31]
s_waitcnt vmcnt(12)
M32 v[16:31],a[140:143],v[188:191],v[16:31]
s_waitcnt vmcnt(11)
M32 v[16:31],a[144:147],v[192:195],v[16:31]
s_waitcnt vmcnt(10)
M32 v[16:31],a[148:151],v[196:199],v[16:31]
s_waitcnt vmcnt(9)
M32 v[16:31],a[152:155],v[200:203],v[16:31]
s_waitcnt vmcnt(8)
M32 v[16:31],a[156:159],v[204:207],v[16:31]
s_waitcnt vmcnt(7)
M32 v[32:47],a[160:163],v[176:179],0
s_waitcnt vmcnt(6)
M32 v[32:47],a[164:167],v[180:183],v[32:47]
s_waitcnt vmcnt(5)
M32 v[32:47],a[168:171],v[184:187],v[32:47]
s_waitcnt vmcnt(4)
M32 v[32:47],a[172:175],v[188:191],v[32:47]
s_waitcnt vmcnt(3)
M32 v[32:47],a[176:179],v[192:195],v[32:47]
s_waitcnt vmcnt(2)
M32 v[32:47],a[180:183],v[196:199],v[32:47]
s_waitcnt vmcnt(1)
M32 v[32:47],a[184:187],v[200:203],v[32:47]
s_waitcnt vmcnt(0)
M32 v[32:47],a[188:191],v[204:207],v[32:47]
buffer_load_dwordx4 a[128:131], v4, s[16:19], s69 offen offset:0
buffer_load_dwordx4 a[132:135], v4, s[16:19], s69 offen offset:1024
buffer_load_dwordx4 a[136:139], v4, s[16:19], s69 offen offset:2048
buffer_load_dwordx4 a[140:143], v4, s[16:19], s69 offen offset:3072
s_add_u32 s69, s69, 4096
buffer_load_dwordx4 a[144:147], v4, s[16:19], s69 offen offset:0
buffer_load_dwordx4 a[148:151], v4, s[16:19], s69 offen offset:1024
buffer_load_dwordx4 a[152:155], v4, s[16:19], s69 offen offset:2048
buffer_load_dwordx4 a[156:159], v4, s[16:19], s69 offen offset:3072
s_add_u32 s69, s69, 4096
buffer_load_dwordx4 a[160:163], v4, s[16:19], s69 offen offset:0
buffer_load_dwordx4 a[164:167], v4, s[16:19], s69 offen offset:1024
buffer_load_dwordx4 a[168:171], v4, s[16:19], s69 offen offset:2048
buffer_load_dwordx4 a[172:175], v4, s[16:19], s69 offen offset:3072
s_add_u32 s69, s69, 4096
buffer_load_dwordx4 a[176:179], v4, s[16:19], s69 offen offset:0
buffer_load_dwordx4 a[180:183], v4, s[16:19], s69 offen offset:1024
buffer_load_dwordx4 a[184:187], v4, s[16:19], s69 offen offset:2048
buffer_load_dwordx4 a[188:191], v4, s[16:19], s69 offen offset:3072
s_add_u32 s69, s69, 20480
s_waitcnt vmcnt(15)
M32 v[48:63],a[128:131],v[176:179],0
s_waitcnt vmcnt(14)
M32 v[48:63],a[132:135],v[180:183],v[48:63]
s_waitcnt vmcnt(13)
M32 v[48:63],a[136:139],v[184:187],v[48:63]
s_waitcnt vmcnt(12)
M32 v[48:63],a[140:143],v[188:191],v[48:63]
s_waitcnt vmcnt(11)
M32 v[48:63],a[144:147],v[192:195],v[48:63]
s_waitcnt vmcnt(10)
M32 v[48:63],a[148:151],v[196:199],v[48:63]
s_waitcnt vmcnt(9)
M32 v[48:63],a[152:155],v[200:203],v[48:63]
s_waitcnt vmcnt(8)
M32 v[48:63],a[156:159],v[204:207],v[48:63]
s_waitcnt vmcnt(7)
M32 v[64:79],a[160:163],v[176:179],0
s_waitcnt vmcnt(6)
M32 v[64:79],a[164:167],v[180:183],v[64:79]
s_waitcnt vmcnt(5)
M32 v[64:79],a[168:171],v[184:187],v[64:79]
s_waitcnt vmcnt(4)
M32 v[64:79],a[172:175],v[188:191],v[64:79]
s_waitcnt vmcnt(3)
M32 v[64:79],a[176:179],v[192:195],v[64:79]
s_waitcnt vmcnt(2)
M32 v[64:79],a[180:183],v[196:199],v[64:79]
s_waitcnt vmcnt(1)
M32 v[64:79],a[184:187],v[200:203],v[64:79]
s_waitcnt vmcnt(0)
M32 v[64:79],a[188:191],v[204:207],v[64:79]
v_cmp_le_i32 s[36:37], 0, v248
v_cmp_le_i32 s[38:39], 1, v248
v_cmp_le_i32 s[40:41], 2, v248
v_cmp_le_i32 s[42:43], 3, v248
CND v16,v250,v16,s[36:37]
CND v17,v250,v17,s[38:39]
CND v18,v250,v18,s[40:41]
CND v19,v250,v19,s[42:43]
v_cmp_le_i32 s[36:37], 16, v248
v_cmp_le_i32 s[38:39], 17, v248
v_cmp_le_i32 s[40:41], 18, v248
v_cmp_le_i32 s[42:43], 19, v248
CND v20,v250,v20,s[36:37]
CND v21,v250,v21,s[38:39]
CND v22,v250,v22,s[40:41]
CND v23,v250,v23,s[42:43]
v_cmp_le_i32 s[36:37], 8, v248
v_cmp_le_i32 s[38:39], 9, v248
v_cmp_le_i32 s[40:41], 10, v248
v_cmp_le_i32 s[42:43], 11, v248
CND v24,v250,v24,s[36:37]
CND v25,v250,v25,s[38:39]
CND v26,v250,v26,s[40:41]
CND v27,v250,v27,s[42:43]
v_cmp_le_i32 s[36:37], 24, v248
v_cmp_le_i32 s[38:39], 25, v248
v_cmp_le_i32 s[40:41], 26, v248
v_cmp_le_i32 s[42:43], 27, v248
CND v28,v250,v28,s[36:37]
CND v29,v250,v29,s[38:39]
CND v30,v250,v30,s[40:41]
CND v31,v250,v31,s[42:43]
v_cmp_le_i32 s[36:37], 32, v248
v_cmp_le_i32 s[38:39], 33, v248
v_cmp_le_i32 s[40:41], 34, v248
v_cmp_le_i32 s[42:43], 35, v248
CND v32,v250,v32,s[36:37]
CND v33,v250,v33,s[38:39]
CND v34,v250,v34,s[40:41]
CND v35,v250,v35,s[42:43]
v_cmp_le_i32 s[36:37], 48, v248
v_cmp_le_i32 s[38:39], 49, v248
v_cmp_le_i32 s[40:41], 50, v248
v_cmp_le_i32 s[42:43], 51, v248
CND v36,v250,v36,s[36:37]
CND v37,v250,v37,s[38:39]
CND v38,v250,v38,s[40:41]
CND v39,v250,v39,s[42:43]
v_cmp_le_i32 s[36:37], 40, v248
v_cmp_le_i32 s[38:39], 41, v248
v_cmp_le_i32 s[40:41], 42, v248
v_cmp_le_i32 s[42:43], 43, v248
CND v40,v250,v40,s[36:37]
CND v41,v250,v41,s[38:39]
CND v42,v250,v42,s[40:41]
CND v43,v250,v43,s[42:43]
v_cmp_le_i32 s[36:37], 56, v248
v_cmp_le_i32 s[38:39], 57, v248
v_cmp_le_i32 s[40:41], 58, v248
v_cmp_le_i32 s[42:43], 59, v248
CND v44,v250,v44,s[36:37]
CND v45,v250,v45,s[38:39]
CND v46,v250,v46,s[40:41]
CND v47,v250,v47,s[42:43]
v_cmp_le_i32 s[36:37], 0, v249
v_cmp_le_i32 s[38:39], 1, v249
v_cmp_le_i32 s[40:41], 2, v249
v_cmp_le_i32 s[42:43], 3, v249
CND v48,v250,v48,s[36:37]
CND v49,v250,v49,s[38:39]
CND v50,v250,v50,s[40:41]
CND v51,v250,v51,s[42:43]
v_cmp_le_i32 s[36:37], 16, v249
v_cmp_le_i32 s[38:39], 17, v249
v_cmp_le_i32 s[40:41], 18, v249
v_cmp_le_i32 s[42:43], 19, v249
CND v52,v250,v52,s[36:37]
CND v53,v250,v53,s[38:39]
CND v54,v250,v54,s[40:41]
CND v55,v250,v55,s[42:43]
v_cmp_le_i32 s[36:37], 8, v249
v_cmp_le_i32 s[38:39], 9, v249
v_cmp_le_i32 s[40:41], 10, v249
v_cmp_le_i32 s[42:43], 11, v249
CND v56,v250,v56,s[36:37]
CND v57,v250,v57,s[38:39]
CND v58,v250,v58,s[40:41]
CND v59,v250,v59,s[42:43]
v_cmp_le_i32 s[36:37], 24, v249
v_cmp_le_i32 s[38:39], 25, v249
v_cmp_le_i32 s[40:41], 26, v249
v_cmp_le_i32 s[42:43], 27, v249
CND v60,v250,v60,s[36:37]
CND v61,v250,v61,s[38:39]
CND v62,v250,v62,s[40:41]
CND v63,v250,v63,s[42:43]
v_cmp_le_i32 s[36:37], 32, v249
v_cmp_le_i32 s[38:39], 33, v249
v_cmp_le_i32 s[40:41], 34, v249
v_cmp_le_i32 s[42:43], 35, v249
CND v64,v250,v64,s[36:37]
CND v65,v250,v65,s[38:39]
CND v66,v250,v66,s[40:41]
CND v67,v250,v67,s[42:43]
v_cmp_le_i32 s[36:37], 48, v249
v_cmp_le_i32 s[38:39], 49, v249
v_cmp_le_i32 s[40:41], 50, v249
v_cmp_le_i32 s[42:43], 51, v249
CND v68,v250,v68,s[36:37]
CND v69,v250,v69,s[38:39]
CND v70,v250,v70,s[40:41]
CND v71,v250,v71,s[42:43]
v_cmp_le_i32 s[36:37], 40, v249
v_cmp_le_i32 s[38:39], 41, v249
v_cmp_le_i32 s[40:41], 42, v249
v_cmp_le_i32 s[42:43], 43, v249
CND v72,v250,v72,s[36:37]
CND v73,v250,v73,s[38:39]
CND v74,v250,v74,s[40:41]
CND v75,v250,v75,s[42:43]
v_cmp_le_i32 s[36:37], 56, v249
v_cmp_le_i32 s[38:39], 57, v249
v_cmp_le_i32 s[40:41], 58, v249
v_cmp_le_i32 s[42:43], 59, v249
CND v76,v250,v76,s[36:37]
CND v77,v250,v77,s[38:39]
CND v78,v250,v78,s[40:41]
CND v79,v250,v79,s[42:43]
v_max3_f32 v251, v16, v17, v18
v_max3_f32 v251, v251, v19, v20
v_max3_f32 v251, v251, v21, v22
v_max3_f32 v251, v251, v23, v24
v_max3_f32 v251, v251, v25, v26
v_max3_f32 v251, v251, v27, v28
v_max3_f32 v251, v251, v29, v30
v_max3_f32 v251, v251, v31, v32
v_max3_f32 v251, v251, v33, v34
v_max3_f32 v251, v251, v35, v36
v_max3_f32 v251, v251, v37, v38
v_max3_f32 v251, v251, v39, v40
v_max3_f32 v251, v251, v41, v42
v_max3_f32 v251, v251, v43, v44
v_max3_f32 v251, v251, v45, v46
v_max_f32 v251, v251, v47
v_max3_f32 v252, v48, v49, v50
v_max3_f32 v252, v252, v51, v52
v_max3_f32 v252, v252, v53, v54
v_max3_f32 v252, v252, v55, v56
v_max3_f32 v252, v252, v57, v58
v_max3_f32 v252, v252, v59, v60
v_max3_f32 v252, v252, v61, v62
v_max3_f32 v252, v252, v63, v64
v_max3_f32 v252, v252, v65, v66
v_max3_f32 v252, v252, v67, v68
v_max3_f32 v252, v252, v69, v70
v_max3_f32 v252, v252, v71, v72
v_max3_f32 v252, v252, v73, v74
v_max3_f32 v252, v252, v75, v76
v_max3_f32 v252, v252, v77, v78
v_max_f32 v252, v252, v79
v_max_f32 v251, v251, v252
v_mov_b32 v253, v251
s_nop 1
v_permlane32_swap_b32 v251, v253
v_max_f32 v251, v251, v253
v_max_f32 v251, v251, v240
FSB v253,v240,v251
EXP v254,v253
s_nop 0
FML v242,v242,v254
ARD v8,a0
ARD v9,a1
ARD v10,a2
ARD v11,a3
FML v8,v8,v254
FML v9,v9,v254
FML v10,v10,v254
FML v11,v11,v254
AWR a0,v8
AWR a1,v9
AWR a2,v10
AWR a3,v11
ARD v8,a4
ARD v9,a5
ARD v10,a6
ARD v11,a7
FML v8,v8,v254
FML v9,v9,v254
FML v10,v10,v254
FML v11,v11,v254
AWR a4,v8
AWR a5,v9
AWR a6,v10
AWR a7,v11
ARD v8,a8
ARD v9,a9
ARD v10,a10
ARD v11,a11
FML v8,v8,v254
FML v9,v9,v254
FML v10,v10,v254
FML v11,v11,v254
AWR a8,v8
AWR a9,v9
AWR a10,v10
AWR a11,v11
ARD v8,a12
ARD v9,a13
ARD v10,a14
ARD v11,a15
FML v8,v8,v254
FML v9,v9,v254
FML v10,v10,v254
FML v11,v11,v254
AWR a12,v8
AWR a13,v9
AWR a14,v10
AWR a15,v11
ARD v8,a16
ARD v9,a17
ARD v10,a18
ARD v11,a19
FML v8,v8,v254
FML v9,v9,v254
FML v10,v10,v254
FML v11,v11,v254
AWR a16,v8
AWR a17,v9
AWR a18,v10
AWR a19,v11
ARD v8,a20
ARD v9,a21
ARD v10,a22
ARD v11,a23
FML v8,v8,v254
FML v9,v9,v254
FML v10,v10,v254
FML v11,v11,v254
AWR a20,v8
AWR a21,v9
AWR a22,v10
AWR a23,v11
ARD v8,a24
ARD v9,a25
ARD v10,a26
ARD v11,a27
FML v8,v8,v254
FML v9,v9,v254
FML v10,v10,v254
FML v11,v11,v254
AWR a24,v8
AWR a25,v9
AWR a26,v10
AWR a27,v11
ARD v8,a28
ARD v9,a29
ARD v10,a30
ARD v11,a31
FML v8,v8,v254
FML v9,v9,v254
FML v10,v10,v254
FML v11,v11,v254
AWR a28,v8
AWR a29,v9
AWR a30,v10
AWR a31,v11
ARD v8,a32
ARD v9,a33
ARD v10,a34
ARD v11,a35
FML v8,v8,v254
FML v9,v9,v254
FML v10,v10,v254
FML v11,v11,v254
AWR a32,v8
AWR a33,v9
AWR a34,v10
AWR a35,v11
ARD v8,a36
ARD v9,a37
ARD v10,a38
ARD v11,a39
FML v8,v8,v254
FML v9,v9,v254
FML v10,v10,v254
FML v11,v11,v254
AWR a36,v8
AWR a37,v9
AWR a38,v10
AWR a39,v11
ARD v8,a40
ARD v9,a41
ARD v10,a42
ARD v11,a43
FML v8,v8,v254
FML v9,v9,v254
FML v10,v10,v254
FML v11,v11,v254
AWR a40,v8
AWR a41,v9
AWR a42,v10
AWR a43,v11
ARD v8,a44
ARD v9,a45
ARD v10,a46
ARD v11,a47
FML v8,v8,v254
FML v9,v9,v254
FML v10,v10,v254
FML v11,v11,v254
AWR a44,v8
AWR a45,v9
AWR a46,v10
AWR a47,v11
ARD v8,a48
ARD v9,a49
ARD v10,a50
ARD v11,a51
FML v8,v8,v254
FML v9,v9,v254
FML v10,v10,v254
FML v11,v11,v254
AWR a48,v8
AWR a49,v9
AWR a50,v10
AWR a51,v11
ARD v8,a52
ARD v9,a53
ARD v10,a54
ARD v11,a55
FML v8,v8,v254
FML v9,v9,v254
FML v10,v10,v254
FML v11,v11,v254
AWR a52,v8
AWR a53,v9
AWR a54,v10
AWR a55,v11
ARD v8,a56
ARD v9,a57
ARD v10,a58
ARD v11,a59
FML v8,v8,v254
FML v9,v9,v254
FML v10,v10,v254
FML v11,v11,v254
AWR a56,v8
AWR a57,v9
AWR a58,v10
AWR a59,v11
ARD v8,a60
ARD v9,a61
ARD v10,a62
ARD v11,a63
FML v8,v8,v254
FML v9,v9,v254
FML v10,v10,v254
FML v11,v11,v254
AWR a60,v8
AWR a61,v9
AWR a62,v10
AWR a63,v11
v_mov_b32 v240, v251
FSB v144,0,v251
FSB v145,0,v251
FSB v146,0,v251
FSB v147,0,v251
FSB v148,0,v251
FSB v149,0,v251
FSB v150,0,v251
FSB v151,0,v251
FSB v152,0,v251
FSB v153,0,v251
FSB v154,0,v251
FSB v155,0,v251
FSB v156,0,v251
FSB v157,0,v251
FSB v158,0,v251
FSB v159,0,v251
FSB v16,v16,v251
FSB v17,v17,v251
FSB v18,v18,v251
FSB v19,v19,v251
FSB v20,v20,v251
FSB v21,v21,v251
FSB v22,v22,v251
FSB v23,v23,v251
FSB v24,v24,v251
FSB v25,v25,v251
FSB v26,v26,v251
FSB v27,v27,v251
FSB v28,v28,v251
FSB v29,v29,v251
FSB v30,v30,v251
FSB v31,v31,v251
FSB v32,v32,v251
FSB v33,v33,v251
FSB v34,v34,v251
FSB v35,v35,v251
FSB v36,v36,v251
FSB v37,v37,v251
FSB v38,v38,v251
FSB v39,v39,v251
FSB v40,v40,v251
FSB v41,v41,v251
FSB v42,v42,v251
FSB v43,v43,v251
FSB v44,v44,v251
FSB v45,v45,v251
FSB v46,v46,v251
FSB v47,v47,v251
FSB v48,v48,v251
FSB v49,v49,v251
FSB v50,v50,v251
FSB v51,v51,v251
FSB v52,v52,v251
FSB v53,v53,v251
FSB v54,v54,v251
FSB v55,v55,v251
FSB v56,v56,v251
FSB v57,v57,v251
FSB v58,v58,v251
FSB v59,v59,v251
FSB v60,v60,v251
FSB v61,v61,v251
FSB v62,v62,v251
FSB v63,v63,v251
FSB v64,v64,v251
FSB v65,v65,v251
FSB v66,v66,v251
FSB v67,v67,v251
FSB v68,v68,v251
FSB v69,v69,v251
FSB v70,v70,v251
FSB v71,v71,v251
FSB v72,v72,v251
FSB v73,v73,v251
FSB v74,v74,v251
FSB v75,v75,v251
FSB v76,v76,v251
FSB v77,v77,v251
FSB v78,v78,v251
FSB v79,v79,v251
EXP v16,v16
EXP v17,v17
EXP v18,v18
FAD v244,v16,v17
EXP v19,v19
CVT v16,v16,v17
EXP v20,v20
FAD v245,v18,v19
EXP v21,v21
CVT v17,v18,v19
EXP v22,v22
FAD v244,v244,v20
EXP v23,v23
FAD v245,v245,v21
CVT v18,v20,v21
EXP v24,v24
FAD v244,v244,v22
EXP v25,v25
FAD v245,v245,v23
CVT v19,v22,v23
EXP v26,v26
FAD v244,v244,v24
EXP v27,v27
FAD v245,v245,v25
CVT v20,v24,v25
EXP v28,v28
FAD v244,v244,v26
EXP v29,v29
FAD v245,v245,v27
CVT v21,v26,v27
EXP v30,v30
FAD v244,v244,v28
EXP v31,v31
FAD v245,v245,v29
CVT v22,v28,v29
EXP v48,v48
FAD v244,v244,v30
EXP v49,v49
FAD v245,v245,v31
CVT v23,v30,v31
EXP v50,v50
FAD v246,v48,v49
EXP v51,v51
CVT v48,v48,v49
EXP v52,v52
FAD v247,v50,v51
EXP v53,v53
CVT v49,v50,v51
EXP v54,v54
FAD v246,v246,v52
EXP v55,v55
FAD v247,v247,v53
CVT v50,v52,v53
EXP v56,v56
FAD v246,v246,v54
EXP v57,v57
FAD v247,v247,v55
CVT v51,v54,v55
EXP v58,v58
FAD v246,v246,v56
EXP v59,v59
FAD v247,v247,v57
CVT v52,v56,v57
EXP v60,v60
FAD v246,v246,v58
EXP v61,v61
FAD v247,v247,v59
CVT v53,v58,v59
EXP v62,v62
FAD v246,v246,v60
EXP v63,v63
FAD v247,v247,v61
CVT v54,v60,v61
EXP v32,v32
FAD v246,v246,v62
EXP v33,v33
FAD v247,v247,v63
CVT v55,v62,v63
EXP v34,v34
FAD v244,v244,v32
EXP v35,v35
FAD v245,v245,v33
CVT v24,v32,v33
EXP v36,v36
FAD v244,v244,v34
EXP v37,v37
FAD v245,v245,v35
CVT v25,v34,v35
EXP v38,v38
FAD v244,v244,v36
EXP v39,v39
FAD v245,v245,v37
CVT v26,v36,v37
EXP v40,v40
FAD v244,v244,v38
EXP v41,v41
FAD v245,v245,v39
CVT v27,v38,v39
EXP v42,v42
FAD v244,v244,v40
EXP v43,v43
FAD v245,v245,v41
CVT v28,v40,v41
EXP v44,v44
FAD v244,v244,v42
EXP v45,v45
FAD v245,v245,v43
CVT v29,v42,v43
EXP v46,v46
FAD v244,v244,v44
EXP v47,v47
FAD v245,v245,v45
CVT v30,v44,v45
EXP v64,v64
FAD v244,v244,v46
EXP v65,v65
FAD v245,v245,v47
CVT v31,v46,v47
EXP v66,v66
FAD v246,v246,v64
EXP v67,v67
FAD v247,v247,v65
CVT v56,v64,v65
EXP v68,v68
FAD v246,v246,v66
EXP v69,v69
FAD v247,v247,v67
CVT v57,v66,v67
EXP v70,v70
FAD v246,v246,v68
EXP v71,v71
FAD v247,v247,v69
CVT v58,v68,v69
EXP v72,v72
FAD v246,v246,v70
EXP v73,v73
FAD v247,v247,v71
CVT v59,v70,v71
EXP v74,v74
FAD v246,v246,v72
EXP v75,v75
FAD v247,v247,v73
CVT v60,v72,v73
EXP v76,v76
FAD v246,v246,v74
EXP v77,v77
FAD v247,v247,v75
CVT v61,v74,v75
EXP v78,v78
FAD v246,v246,v76
EXP v79,v79
FAD v247,v247,v77
CVT v62,v76,v77
FAD v246,v246,v78
FAD v247,v247,v79
CVT v63,v78,v79
FAD v244,v244,v245
FAD v246,v246,v247
v_max_f32 v251, v244, v246
v_cmp_nle_f32 vcc, v251, v255
s_nop 4
s_branch L_G_back
L_attn_kernel_end:
s_endpgm
.p2align 8
oproj_kernel:
s_cmp_ge_u32 s2, 256
s_cbranch_scc1 L_oproj_kernel_end
v_lshrrev_b32 v2, 6, v0
v_and_b32 v1, 63, v0
v_readfirstlane_b32 s3, v2
s_load_dwordx2 s[12:13], s[0:1], 40
s_load_dwordx2 s[48:49], s[0:1], 104
s_load_dwordx2 s[20:21], s[0:1], 0
s_load_dwordx2 s[16:17], s[0:1], 56
s_and_b32 s50, s2, 7
s_lshr_b32 s51, s2, 3
s_lshr_b32 s52, s50, 1
s_lshl_b32 s52, s52, 2
s_and_b32 s53, s51, 3
s_add_u32 s52, s52, s53
s_and_b32 s53, s50, 1
s_lshl_b32 s53, s53, 3
s_lshr_b32 s51, s51, 2
s_add_u32 s53, s53, s51
s_lshr_b32 s53, s2, 5
s_lshl_b32 s53, s53, 1
s_and_b32 s56, s50, 1
s_add_u32 s53, s53, s56
s_mul_i32 s60, s52, 1048576
s_mul_i32 s56, s3, 32768
s_add_u32 s60, s60, s56
s_mul_i32 s61, s3, 2097152
s_lshl_b32 s56, s53, 7
s_add_u32 s61, s61, s56
s_add_u32 s54, s52, s53
s_lshl_b32 s58, s3, 14
s_lshl_b32 s56, s3, 1
v_lshlrev_b32 v14, 4, v1
v_bfe_u32 v15, v1, 2, 2
v_lshrrev_b32 v16, 5, v1
v_lshl_add_u32 v16, v16, 2, v15
v_lshlrev_b32 v10, 11, v16
v_bfe_u32 v16, v1, 4, 1
v_lshl_add_u32 v10, v16, 6, v10
v_and_b32 v17, 3, v1
v_lshl_add_u32 v10, v17, 4, v10
v_add_u32 v11, 15360, v10
v_add_u32 v12, 15360, v11
v_add_u32 v13, 15360, v12
s_add_u32 s57, s56, 0
s_and_b32 s57, s57, 7
s_mul_i32 s57, s57, 131072
v_add_u32 v2, s57, v14
s_add_u32 s57, s56, 1
s_and_b32 s57, s57, 7
s_mul_i32 s57, s57, 131072
v_add_u32 v3, s57, v14
s_add_u32 s57, s56, 2
s_and_b32 s57, s57, 7
s_mul_i32 s57, s57, 131072
v_add_u32 v4, s57, v14
s_add_u32 s57, s56, 3
s_and_b32 s57, s57, 7
s_mul_i32 s57, s57, 131072
v_add_u32 v5, s57, v14
s_add_u32 s57, s56, 4
s_and_b32 s57, s57, 7
s_mul_i32 s57, s57, 131072
v_add_u32 v6, s57, v14
s_add_u32 s57, s56, 5
s_and_b32 s57, s57, 7
s_mul_i32 s57, s57, 131072
v_add_u32 v7, s57, v14
s_add_u32 s57, s56, 6
s_and_b32 s57, s57, 7
s_mul_i32 s57, s57, 131072
v_add_u32 v8, s57, v14
s_add_u32 s57, s56, 7
s_and_b32 s57, s57, 7
s_mul_i32 s57, s57, 131072
v_add_u32 v9, s57, v14
v_lshrrev_b32 v18, 5, v1
v_lshlrev_b32 v18, 11, v18
v_lshl_add_u32 v18, v16, 9, v18
v_lshl_add_u32 v18, v15, 6, v18
v_lshl_add_u32 v18, v17, 4, v18
v_add_u32 v15, s58, v18
s_add_u32 s56, s54, 0
s_and_b32 s56, s56, 3
s_lshl_b32 s57, s56, 10
s_add_u32 s40, s60, s57
s_lshl_b32 s57, s56, 16
s_add_u32 s44, s61, s57
s_add_u32 s56, s54, 1
s_and_b32 s56, s56, 3
s_lshl_b32 s57, s56, 10
s_add_u32 s41, s60, s57
s_lshl_b32 s57, s56, 16
s_add_u32 s45, s61, s57
s_add_u32 s56, s54, 2
s_and_b32 s56, s56, 3
s_lshl_b32 s57, s56, 10
s_add_u32 s42, s60, s57
s_lshl_b32 s57, s56, 16
s_add_u32 s46, s61, s57
s_add_u32 s56, s54, 3
s_and_b32 s56, s56, 3
s_lshl_b32 s57, s56, 10
s_add_u32 s43, s60, s57
s_lshl_b32 s57, s56, 16
s_add_u32 s47, s61, s57
s_waitcnt lgkmcnt(0)
s_mov_b32 s14, 8388608
s_mov_b32 s15, 0x20000
s_add_u32 s8, s48, 50331648
s_addc_u32 s9, s49, 0
s_mov_b32 s10, 16777216
s_mov_b32 s11, 0x20000
s_add_u32 m0, s58, 0
s_nop 0
buffer_load_dwordx4 v10, s[12:15], s44 offen offset:0 lds
buffer_load_dwordx4 v11, s[12:15], s44 offen offset:1024 lds
buffer_load_dwordx4 v12, s[12:15], s44 offen offset:2048 lds
buffer_load_dwordx4 v13, s[12:15], s44 offen offset:3072 lds
s_add_u32 s44, s44, 262144
buffer_load_dwordx4 a[128:131], v2, s[8:11], s40 offen
buffer_load_dwordx4 a[132:135], v3, s[8:11], s40 offen
buffer_load_dwordx4 a[136:139], v4, s[8:11], s40 offen
buffer_load_dwordx4 a[140:143], v5, s[8:11], s40 offen
buffer_load_dwordx4 a[144:147], v6, s[8:11], s40 offen
buffer_load_dwordx4 a[148:151], v7, s[8:11], s40 offen
buffer_load_dwordx4 a[152:155], v8, s[8:11], s40 offen
buffer_load_dwordx4 a[156:159], v9, s[8:11], s40 offen
s_add_u32 s40, s40, 4096
s_add_u32 s24, s48, 262144
s_addc_u32 s25, s49, 0
s_mov_b32 s26, 24576
s_mov_b32 s27, 0x20000
s_mov_b32 s18, 7340032
s_mov_b32 s19, 0x20000
s_min_u32 s32, s2, 223
s_mul_i32 s33, s32, 1171
s_lshr_b32 s33, s33, 16
s_mul_i32 s34, s33, 56
s_sub_u32 s32, s32, s34
v_lshrrev_b32 v204, 3, v1
v_and_b32 v205, 7, v1
s_lshl_b32 s34, s33, 8
s_lshl_b32 s35, s3, 6
s_add_u32 s34, s34, s35
v_lshl_add_u32 v206, v204, 3, s34
v_mul_u32_u24 v207, 7168, v206
v_lshl_add_u32 v207, v205, 4, v207
s_lshl_b32 s35, s32, 7
v_add_u32 v207, s35, v207
v_lshlrev_b32 v206, 2, v206
s_movk_i32 s36, 12288
s_movk_i32 s37, 16384
s_mov_b32 s38, 0
buffer_load_dwordx4 v[96:99], v206, s[24:27], s36 offen offset:0
buffer_load_dwordx4 v[64:67], v207, s[16:19], s38 offen
s_add_u32 s38, s38, 7168
buffer_load_dwordx4 v[100:103], v206, s[24:27], s36 offen offset:16
buffer_load_dwordx4 v[68:71], v207, s[16:19], s38 offen
s_add_u32 s38, s38, 7168
buffer_load_dwordx4 v[104:107], v206, s[24:27], s37 offen offset:0
buffer_load_dwordx4 v[72:75], v207, s[16:19], s38 offen
s_add_u32 s38, s38, 7168
buffer_load_dwordx4 v[108:111], v206, s[24:27], s37 offen offset:16
buffer_load_dwordx4 v[76:79], v207, s[16:19], s38 offen
s_add_u32 s38, s38, 7168
buffer_load_dwordx4 v[80:83], v207, s[16:19], s38 offen
s_add_u32 s38, s38, 7168
buffer_load_dwordx4 v[84:87], v207, s[16:19], s38 offen
s_add_u32 s38, s38, 7168
buffer_load_dwordx4 v[88:91], v207, s[16:19], s38 offen
s_add_u32 s38, s38, 7168
buffer_load_dwordx4 v[92:95], v207, s[16:19], s38 offen
s_add_u32 s38, s38, 7168
s_add_u32 m0, s58, 4096
s_nop 0
buffer_load_dwordx4 v10, s[12:15], s45 offen offset:0 lds
buffer_load_dwordx4 v11, s[12:15], s45 offen offset:1024 lds
buffer_load_dwordx4 v12, s[12:15], s45 offen offset:2048 lds
buffer_load_dwordx4 v13, s[12:15], s45 offen offset:3072 lds
s_add_u32 s45, s45, 262144
buffer_load_dwordx4 a[160:163], v2, s[8:11], s41 offen
buffer_load_dwordx4 a[164:167], v3, s[8:11], s41 offen
buffer_load_dwordx4 a[168:171], v4, s[8:11], s41 offen
buffer_load_dwordx4 a[172:175], v5, s[8:11], s41 offen
buffer_load_dwordx4 a[176:179], v6, s[8:11], s41 offen
buffer_load_dwordx4 a[180:183], v7, s[8:11], s41 offen
buffer_load_dwordx4 a[184:187], v8, s[8:11], s41 offen
buffer_load_dwordx4 a[188:191], v9, s[8:11], s41 offen
s_add_u32 s41, s41, 4096
s_add_u32 m0, s58, 8192
s_nop 0
buffer_load_dwordx4 v10, s[12:15], s46 offen offset:0 lds
buffer_load_dwordx4 v11, s[12:15], s46 offen offset:1024 lds
buffer_load_dwordx4 v12, s[12:15], s46 offen offset:2048 lds
buffer_load_dwordx4 v13, s[12:15], s46 offen offset:3072 lds
s_add_u32 s46, s46, 262144
buffer_load_dwordx4 a[192:195], v2, s[8:11], s42 offen
buffer_load_dwordx4 a[196:199], v3, s[8:11], s42 offen
buffer_load_dwordx4 a[200:203], v4, s[8:11], s42 offen
buffer_load_dwordx4 a[204:207], v5, s[8:11], s42 offen
buffer_load_dwordx4 a[208:211], v6, s[8:11], s42 offen
buffer_load_dwordx4 a[212:215], v7, s[8:11], s42 offen
buffer_load_dwordx4 a[216:219], v8, s[8:11], s42 offen
buffer_load_dwordx4 a[220:223], v9, s[8:11], s42 offen
s_add_u32 s42, s42, 4096
s_add_u32 m0, s58, 12288
s_nop 0
buffer_load_dwordx4 v10, s[12:15], s47 offen offset:0 lds
buffer_load_dwordx4 v11, s[12:15], s47 offen offset:1024 lds
buffer_load_dwordx4 v12, s[12:15], s47 offen offset:2048 lds
buffer_load_dwordx4 v13, s[12:15], s47 offen offset:3072 lds
s_add_u32 s47, s47, 262144
buffer_load_dwordx4 a[224:227], v2, s[8:11], s43 offen
buffer_load_dwordx4 a[228:231], v3, s[8:11], s43 offen
buffer_load_dwordx4 a[232:235], v4, s[8:11], s43 offen
buffer_load_dwordx4 a[236:239], v5, s[8:11], s43 offen
buffer_load_dwordx4 a[240:243], v6, s[8:11], s43 offen
buffer_load_dwordx4 a[244:247], v7, s[8:11], s43 offen
buffer_load_dwordx4 a[248:251], v8, s[8:11], s43 offen
buffer_load_dwordx4 a[252:255], v9, s[8:11], s43 offen
s_add_u32 s43, s43, 4096
s_mov_b32 s22, 4194304
s_mov_b32 s23, 0x20000
s_mov_b32 s28, s48
s_mov_b32 s29, s49
s_mov_b32 s30, 16777216
s_mov_b32 s31, 0x20000
s_lshl_b32 s62, s52, 3
s_lshl_b32 s56, s3, 1
s_add_u32 s62, s62, s56
s_lshl_b32 s63, s62, 15
s_lshl_b32 s56, s53, 7
s_add_u32 s63, s63, s56
s_lshl_b32 s64, s62, 15
s_lshl_b32 s56, s53, 11
s_add_u32 s64, s64, s56
s_add_u32 s65, s64, 9437184
s_add_u32 s64, s64, 5242880
s_lshl_b32 s66, s62, 11
s_lshl_b32 s56, s53, 3
s_add_u32 s66, s66, s56
s_add_u32 s66, s66, 524288
s_lshl_b32 s67, s53, 8
v_and_b32 v192, 15, v1
v_lshrrev_b32 v193, 4, v1
v_lshlrev_b32 v194, 11, v192
v_lshl_add_u32 v194, v193, 4, v194
v_add_u32 v195, 32768, v194
v_lshlrev_b32 v196, 5, v193
v_lshlrev_b32 v197, 7, v192
v_add_u32 v198, 32768, v14
s_mul_i32 s56, s3, 24576
s_add_u32 s56, s56, 65536
v_add_u32 v199, s56, v14
s_add_u32 s56, s3, 1
s_and_b32 s56, s56, 3
s_mul_i32 s56, s56, 24576
s_add_u32 s56, s56, 65536
v_add_u32 v200, s56, v14
s_add_u32 s56, s3, 2
s_and_b32 s56, s56, 3
s_mul_i32 s56, s56, 24576
s_add_u32 s56, s56, 73728
v_add_u32 v201, s56, v14
s_add_u32 s56, s3, 3
s_and_b32 s56, s56, 3
s_mul_i32 s56, s56, 24576
s_add_u32 s56, s56, 81920
v_add_u32 v202, s56, v14
v_mov_b32 v48, 0
v_mov_b32 v49, 0
v_mov_b32 v50, 0
v_mov_b32 v51, 0
s_nop 1
M32 a[0:15],v[48:51],v[48:51],0
M32 a[16:31],v[48:51],v[48:51],0
M32 a[32:47],v[48:51],v[48:51],0
M32 a[48:63],v[48:51],v[48:51],0
M32 a[64:79],v[48:51],v[48:51],0
M32 a[80:95],v[48:51],v[48:51],0
M32 a[96:111],v[48:51],v[48:51],0
M32 a[112:127],v[48:51],v[48:51],0
s_waitcnt vmcnt(56)
DTR v[16:17],v15 offset:0
DTR v[18:19],v15 offset:1024
DTR v[20:21],v15 offset:8
DTR v[22:23],v15 offset:1032
DTR v[24:25],v15 offset:256
DTR v[26:27],v15 offset:1280
DTR v[28:29],v15 offset:264
DTR v[30:31],v15 offset:1288
s_waitcnt vmcnt(55) lgkmcnt(6)
M16 a[0:3],v[16:19],a[128:131],a[0:3]
s_waitcnt vmcnt(43)
FAD v104,1.0,v104
v_lshlrev_b32 v144, 16, v64
v_and_b32 v145, 0xffff0000, v64
s_waitcnt lgkmcnt(4)
M16 a[4:7],v[20:23],a[128:131],a[4:7]
FML v112,v144,v104
FML v113,v145,v104
s_waitcnt lgkmcnt(2)
M16 a[8:11],v[24:27],a[128:131],a[8:11]
s_add_u32 m0, s58, 0
FML v120,v144,v96
FML v121,v145,v96
v_lshlrev_b32 v144, 16, v65
s_waitcnt lgkmcnt(0)
M16 a[12:15],v[28:31],a[128:131],a[12:15]
buffer_load_dwordx4 v10, s[12:15], s44 offen offset:0 lds
v_and_b32 v145, 0xffff0000, v65
FML v114,v144,v104
M16 a[16:19],v[16:19],a[132:135],a[16:19]
buffer_load_dwordx4 a[128:131], v2, s[8:11], s40 offen
FML v115,v145,v104
FML v122,v144,v96
FML v123,v145,v96
M16 a[20:23],v[20:23],a[132:135],a[20:23]
buffer_load_dwordx4 v11, s[12:15], s44 offen offset:1024 lds
v_lshlrev_b32 v144, 16, v66
v_and_b32 v145, 0xffff0000, v66
M16 a[24:27],v[24:27],a[132:135],a[24:27]
buffer_load_dwordx4 v12, s[12:15], s44 offen offset:2048 lds
FML v116,v144,v104
FML v117,v145,v104
FML v124,v144,v96
M16 a[28:31],v[28:31],a[132:135],a[28:31]
buffer_load_dwordx4 v13, s[12:15], s44 offen offset:3072 lds
s_add_u32 s44, s44, 262144
FML v125,v145,v96
v_lshlrev_b32 v144, 16, v67
M16 a[32:35],v[16:19],a[136:139],a[32:35]
buffer_load_dwordx4 a[132:135], v3, s[8:11], s40 offen
v_and_b32 v145, 0xffff0000, v67
FML v118,v144,v104
M16 a[36:39],v[20:23],a[136:139],a[36:39]
s_waitcnt vmcnt(38)
FML v119,v145,v104
FML v126,v144,v96
FML v127,v145,v96
M16 a[40:43],v[24:27],a[136:139],a[40:43]
FAD v105,1.0,v105
v_lshlrev_b32 v144, 16, v68
M16 a[44:47],v[28:31],a[136:139],a[44:47]
DTR v[32:33],v15 offset:4096
v_and_b32 v145, 0xffff0000, v68
v_fmac_f32 v112, v144, v105
v_fmac_f32 v113, v145, v105
M16 a[48:51],v[16:19],a[140:143],a[48:51]
buffer_load_dwordx4 a[136:139], v4, s[8:11], s40 offen
v_fmac_f32 v120, v144, v97
v_fmac_f32 v121, v145, v97
M16 a[52:55],v[20:23],a[140:143],a[52:55]
DTR v[34:35],v15 offset:5120
v_lshlrev_b32 v144, 16, v69
v_and_b32 v145, 0xffff0000, v69
v_fmac_f32 v114, v144, v105
M16 a[56:59],v[24:27],a[140:143],a[56:59]
v_fmac_f32 v115, v145, v105
v_fmac_f32 v122, v144, v97
M16 a[60:63],v[28:31],a[140:143],a[60:63]
DTR v[36:37],v15 offset:4104
v_fmac_f32 v123, v145, v97
v_lshlrev_b32 v144, 16, v70
M16 a[64:67],v[16:19],a[144:147],a[64:67]
buffer_load_dwordx4 a[140:143], v5, s[8:11], s40 offen
v_and_b32 v145, 0xffff0000, v70
v_fmac_f32 v116, v144, v105
v_fmac_f32 v117, v145, v105
M16 a[68:71],v[20:23],a[144:147],a[68:71]
DTR v[38:39],v15 offset:5128
v_fmac_f32 v124, v144, v97
v_fmac_f32 v125, v145, v97
M16 a[72:75],v[24:27],a[144:147],a[72:75]
v_lshlrev_b32 v144, 16, v71
v_and_b32 v145, 0xffff0000, v71
v_fmac_f32 v118, v144, v105
M16 a[76:79],v[28:31],a[144:147],a[76:79]
DTR v[40:41],v15 offset:4352
v_fmac_f32 v119, v145, v105
v_fmac_f32 v126, v144, v97
M16 a[80:83],v[16:19],a[148:151],a[80:83]
buffer_load_dwordx4 a[144:147], v6, s[8:11], s40 offen
v_fmac_f32 v127, v145, v97
FAD v106,1.0,v106
v_lshlrev_b32 v144, 16, v72
M16 a[84:87],v[20:23],a[148:151],a[84:87]
DTR v[42:43],v15 offset:5376
v_and_b32 v145, 0xffff0000, v72
v_fmac_f32 v112, v144, v106
M16 a[88:91],v[24:27],a[148:151],a[88:91]
v_fmac_f32 v113, v145, v106
v_fmac_f32 v120, v144, v98
v_fmac_f32 v121, v145, v98
M16 a[92:95],v[28:31],a[148:151],a[92:95]
DTR v[44:45],v15 offset:4360
v_lshlrev_b32 v144, 16, v73
v_and_b32 v145, 0xffff0000, v73
M16 a[96:99],v[16:19],a[152:155],a[96:99]
buffer_load_dwordx4 a[148:151], v7, s[8:11], s40 offen
v_fmac_f32 v114, v144, v106
v_fmac_f32 v115, v145, v106
M16 a[100:103],v[20:23],a[152:155],a[100:103]
DTR v[46:47],v15 offset:5384
v_fmac_f32 v122, v144, v98
v_fmac_f32 v123, v145, v98
v_lshlrev_b32 v144, 16, v74
M16 a[104:107],v[24:27],a[152:155],a[104:107]
v_and_b32 v145, 0xffff0000, v74
v_fmac_f32 v116, v144, v106
M16 a[108:111],v[28:31],a[152:155],a[108:111]
v_fmac_f32 v117, v145, v106
v_fmac_f32 v124, v144, v98
v_fmac_f32 v125, v145, v98
M16 a[112:115],v[16:19],a[156:159],a[112:115]
buffer_load_dwordx4 a[152:155], v8, s[8:11], s40 offen
v_lshlrev_b32 v144, 16, v75
v_and_b32 v145, 0xffff0000, v75
M16 a[116:119],v[20:23],a[156:159],a[116:119]
v_fmac_f32 v118, v144, v106
v_fmac_f32 v119, v145, v106
v_fmac_f32 v126, v144, v98
M16 a[120:123],v[24:27],a[156:159],a[120:123]
v_fmac_f32 v127, v145, v98
FAD v107,1.0,v107
M16 a[124:127],v[28:31],a[156:159],a[124:127]
buffer_load_dwordx4 a[156:159], v9, s[8:11], s40 offen
s_add_u32 s40, s40, 4096
v_lshlrev_b32 v144, 16, v76
v_and_b32 v145, 0xffff0000, v76
s_waitcnt vmcnt(43) lgkmcnt(6)
M16 a[0:3],v[32:35],a[160:163],a[0:3]
v_fmac_f32 v112, v144, v107
v_fmac_f32 v113, v145, v107
v_fmac_f32 v120, v144, v99
s_waitcnt lgkmcnt(4)
M16 a[4:7],v[36:39],a[160:163],a[4:7]
v_fmac_f32 v121, v145, v99
v_lshlrev_b32 v144, 16, v77
s_waitcnt lgkmcnt(2)
M16 a[8:11],v[40:43],a[160:163],a[8:11]
s_add_u32 m0, s58, 4096
v_and_b32 v145, 0xffff0000, v77
v_fmac_f32 v114, v144, v107
v_fmac_f32 v115, v145, v107
s_waitcnt lgkmcnt(0)
M16 a[12:15],v[44:47],a[160:163],a[12:15]
buffer_load_dwordx4 v10, s[12:15], s45 offen offset:0 lds
v_fmac_f32 v122, v144, v99
v_fmac_f32 v123, v145, v99
s_waitcnt vmcnt(43)
M16 a[16:19],v[32:35],a[164:167],a[16:19]
buffer_load_dwordx4 a[160:163], v2, s[8:11], s41 offen
v_lshlrev_b32 v144, 16, v78
v_and_b32 v145, 0xffff0000, v78
v_fmac_f32 v116, v144, v107
M16 a[20:23],v[36:39],a[164:167],a[20:23]
buffer_load_dwordx4 v11, s[12:15], s45 offen offset:1024 lds
v_fmac_f32 v117, v145, v107
v_fmac_f32 v124, v144, v99
M16 a[24:27],v[40:43],a[164:167],a[24:27]
buffer_load_dwordx4 v12, s[12:15], s45 offen offset:2048 lds
v_fmac_f32 v125, v145, v99
v_lshlrev_b32 v144, 16, v79
v_and_b32 v145, 0xffff0000, v79
M16 a[28:31],v[44:47],a[164:167],a[28:31]
buffer_load_dwordx4 v13, s[12:15], s45 offen offset:3072 lds
s_add_u32 s45, s45, 262144
v_fmac_f32 v118, v144, v107
v_fmac_f32 v119, v145, v107
s_waitcnt vmcnt(46)
M16 a[32:35],v[32:35],a[168:171],a[32:35]
buffer_load_dwordx4 a[164:167], v3, s[8:11], s41 offen
v_fmac_f32 v126, v144, v99
v_fmac_f32 v127, v145, v99
FAD v108,1.0,v108
M16 a[36:39],v[36:39],a[168:171],a[36:39]
s_waitcnt vmcnt(38)
v_lshlrev_b32 v144, 16, v80
v_and_b32 v145, 0xffff0000, v80
M16 a[40:43],v[40:43],a[168:171],a[40:43]
v_fmac_f32 v112, v144, v108
v_fmac_f32 v113, v145, v108
v_fmac_f32 v120, v144, v100
M16 a[44:47],v[44:47],a[168:171],a[44:47]
DTR v[16:17],v15 offset:8192
v_fmac_f32 v121, v145, v100
v_lshlrev_b32 v144, 16, v81
M16 a[48:51],v[32:35],a[172:175],a[48:51]
buffer_load_dwordx4 a[168:171], v4, s[8:11], s41 offen
v_and_b32 v145, 0xffff0000, v81
v_fmac_f32 v114, v144, v108
v_fmac_f32 v115, v145, v108
M16 a[52:55],v[36:39],a[172:175],a[52:55]
DTR v[18:19],v15 offset:9216
v_fmac_f32 v122, v144, v100
v_fmac_f32 v123, v145, v100
M16 a[56:59],v[40:43],a[172:175],a[56:59]
v_lshlrev_b32 v144, 16, v82
v_and_b32 v145, 0xffff0000, v82
v_fmac_f32 v116, v144, v108
M16 a[60:63],v[44:47],a[172:175],a[60:63]
DTR v[20:21],v15 offset:8200
v_fmac_f32 v117, v145, v108
v_fmac_f32 v124, v144, v100
M16 a[64:67],v[32:35],a[176:179],a[64:67]
buffer_load_dwordx4 a[172:175], v5, s[8:11], s41 offen
v_fmac_f32 v125, v145, v100
v_lshlrev_b32 v144, 16, v83
M16 a[68:71],v[36:39],a[176:179],a[68:71]
DTR v[22:23],v15 offset:9224
v_and_b32 v145, 0xffff0000, v83
v_fmac_f32 v118, v144, v108
v_fmac_f32 v119, v145, v108
M16 a[72:75],v[40:43],a[176:179],a[72:75]
v_fmac_f32 v126, v144, v100
v_fmac_f32 v127, v145, v100
M16 a[76:79],v[44:47],a[176:179],a[76:79]
DTR v[24:25],v15 offset:8448
FAD v109,1.0,v109
v_lshlrev_b32 v144, 16, v84
v_and_b32 v145, 0xffff0000, v84
M16 a[80:83],v[32:35],a[180:183],a[80:83]
buffer_load_dwordx4 a[176:179], v6, s[8:11], s41 offen
v_fmac_f32 v112, v144, v109
v_fmac_f32 v113, v145, v109
M16 a[84:87],v[36:39],a[180:183],a[84:87]
DTR v[26:27],v15 offset:9472
v_fmac_f32 v120, v144, v101
v_fmac_f32 v121, v145, v101
v_lshlrev_b32 v144, 16, v85
M16 a[88:91],v[40:43],a[180:183],a[88:91]
v_and_b32 v145, 0xffff0000, v85
v_fmac_f32 v114, v144, v109
M16 a[92:95],v[44:47],a[180:183],a[92:95]
DTR v[28:29],v15 offset:8456
v_fmac_f32 v115, v145, v109
v_fmac_f32 v122, v144, v101
v_fmac_f32 v123, v145, v101
M16 a[96:99],v[32:35],a[184:187],a[96:99]
buffer_load_dwordx4 a[180:183], v7, s[8:11], s41 offen
v_lshlrev_b32 v144, 16, v86
v_and_b32 v145, 0xffff0000, v86
M16 a[100:103],v[36:39],a[184:187],a[100:103]
DTR v[30:31],v15 offset:9480
v_fmac_f32 v116, v144, v109
v_fmac_f32 v117, v145, v109
v_fmac_f32 v124, v144, v101
M16 a[104:107],v[40:43],a[184:187],a[104:107]
v_fmac_f32 v125, v145, v101
v_lshlrev_b32 v144, 16, v87
M16 a[108:111],v[44:47],a[184:187],a[108:111]
v_and_b32 v145, 0xffff0000, v87
v_fmac_f32 v118, v144, v109
v_fmac_f32 v119, v145, v109
M16 a[112:115],v[32:35],a[188:191],a[112:115]
buffer_load_dwordx4 a[184:187], v8, s[8:11], s41 offen
v_fmac_f32 v126, v144, v101
v_fmac_f32 v127, v145, v101
M16 a[116:119],v[36:39],a[188:191],a[116:119]
FAD v110,1.0,v110
v_lshlrev_b32 v144, 16, v88
v_and_b32 v145, 0xffff0000, v88
M16 a[120:123],v[40:43],a[188:191],a[120:123]
v_fmac_f32 v112, v144, v110
v_fmac_f32 v113, v145, v110
M16 a[124:127],v[44:47],a[188:191],a[124:127]
buffer_load_dwordx4 a[188:191], v9, s[8:11], s41 offen
s_add_u32 s41, s41, 4096
v_fmac_f32 v120, v144, v102
v_fmac_f32 v121, v145, v102
s_waitcnt vmcnt(43) lgkmcnt(6)
M16 a[0:3],v[16:19],a[192:195],a[0:3]
v_lshlrev_b32 v144, 16, v89
v_and_b32 v145, 0xffff0000, v89
v_fmac_f32 v114, v144, v110
s_waitcnt lgkmcnt(4)
M16 a[4:7],v[20:23],a[192:195],a[4:7]
v_fmac_f32 v115, v145, v110
v_fmac_f32 v122, v144, v102
s_waitcnt lgkmcnt(2)
M16 a[8:11],v[24:27],a[192:195],a[8:11]
s_add_u32 m0, s58, 8192
v_fmac_f32 v123, v145, v102
v_lshlrev_b32 v144, 16, v90
v_and_b32 v145, 0xffff0000, v90
s_waitcnt lgkmcnt(0)
M16 a[12:15],v[28:31],a[192:195],a[12:15]
buffer_load_dwordx4 v10, s[12:15], s46 offen offset:0 lds
v_fmac_f32 v116, v144, v110
v_fmac_f32 v117, v145, v110
s_waitcnt vmcnt(43)
M16 a[16:19],v[16:19],a[196:199],a[16:19]
buffer_load_dwordx4 a[192:195], v2, s[8:11], s42 offen
v_fmac_f32 v124, v144, v102
v_fmac_f32 v125, v145, v102
v_lshlrev_b32 v144, 16, v91
M16 a[20:23],v[20:23],a[196:199],a[20:23]
buffer_load_dwordx4 v11, s[12:15], s46 offen offset:1024 lds
v_and_b32 v145, 0xffff0000, v91
v_fmac_f32 v118, v144, v110
M16 a[24:27],v[24:27],a[196:199],a[24:27]
buffer_load_dwordx4 v12, s[12:15], s46 offen offset:2048 lds
v_fmac_f32 v119, v145, v110
v_fmac_f32 v126, v144, v102
v_fmac_f32 v127, v145, v102
M16 a[28:31],v[28:31],a[196:199],a[28:31]
buffer_load_dwordx4 v13, s[12:15], s46 offen offset:3072 lds
s_add_u32 s46, s46, 262144
FAD v111,1.0,v111
v_lshlrev_b32 v144, 16, v92
s_waitcnt vmcnt(46)
M16 a[32:35],v[16:19],a[200:203],a[32:35]
buffer_load_dwordx4 a[196:199], v3, s[8:11], s42 offen
v_and_b32 v145, 0xffff0000, v92
v_fmac_f32 v112, v144, v111
M16 a[36:39],v[20:23],a[200:203],a[36:39]
s_waitcnt vmcnt(38)
v_fmac_f32 v113, v145, v111
v_fmac_f32 v120, v144, v103
v_fmac_f32 v121, v145, v103
M16 a[40:43],v[24:27],a[200:203],a[40:43]
v_lshlrev_b32 v144, 16, v93
v_and_b32 v145, 0xffff0000, v93
M16 a[44:47],v[28:31],a[200:203],a[44:47]
DTR v[32:33],v15 offset:12288
v_fmac_f32 v114, v144, v111
v_fmac_f32 v115, v145, v111
v_fmac_f32 v122, v144, v103
M16 a[48:51],v[16:19],a[204:207],a[48:51]
buffer_load_dwordx4 a[200:203], v4, s[8:11], s42 offen
v_fmac_f32 v123, v145, v103
v_lshlrev_b32 v144, 16, v94
M16 a[52:55],v[20:23],a[204:207],a[52:55]
DTR v[34:35],v15 offset:13312
v_and_b32 v145, 0xffff0000, v94
v_fmac_f32 v116, v144, v111
v_fmac_f32 v117, v145, v111
M16 a[56:59],v[24:27],a[204:207],a[56:59]
v_fmac_f32 v124, v144, v103
v_fmac_f32 v125, v145, v103
M16 a[60:63],v[28:31],a[204:207],a[60:63]
DTR v[36:37],v15 offset:12296
v_lshlrev_b32 v144, 16, v95
v_and_b32 v145, 0xffff0000, v95
M16 a[64:67],v[16:19],a[208:211],a[64:67]
buffer_load_dwordx4 a[204:207], v5, s[8:11], s42 offen
v_fmac_f32 v118, v144, v111
v_fmac_f32 v119, v145, v111
v_fmac_f32 v126, v144, v103
M16 a[68:71],v[20:23],a[208:211],a[68:71]
DTR v[38:39],v15 offset:13320
v_fmac_f32 v127, v145, v103
v_add_f32_dpp v112, v112, v112 row_ror:8 row_mask:0xf bank_mask:0xf
M16 a[72:75],v[24:27],a[208:211],a[72:75]
v_add_f32_dpp v113, v113, v113 row_ror:8 row_mask:0xf bank_mask:0xf
v_add_f32_dpp v114, v114, v114 row_ror:8 row_mask:0xf bank_mask:0xf
v_add_f32_dpp v115, v115, v115 row_ror:8 row_mask:0xf bank_mask:0xf
M16 a[76:79],v[28:31],a[208:211],a[76:79]
DTR v[40:41],v15 offset:12544
v_add_f32_dpp v116, v116, v116 row_ror:8 row_mask:0xf bank_mask:0xf
v_add_f32_dpp v117, v117, v117 row_ror:8 row_mask:0xf bank_mask:0xf
M16 a[80:83],v[16:19],a[212:215],a[80:83]
buffer_load_dwordx4 a[208:211], v6, s[8:11], s42 offen
v_add_f32_dpp v118, v118, v118 row_ror:8 row_mask:0xf bank_mask:0xf
v_add_f32_dpp v119, v119, v119 row_ror:8 row_mask:0xf bank_mask:0xf
v_add_f32_dpp v120, v120, v120 row_ror:8 row_mask:0xf bank_mask:0xf
M16 a[84:87],v[20:23],a[212:215],a[84:87]
DTR v[42:43],v15 offset:13568
v_add_f32_dpp v121, v121, v121 row_ror:8 row_mask:0xf bank_mask:0xf
v_add_f32_dpp v122, v122, v122 row_ror:8 row_mask:0xf bank_mask:0xf
M16 a[88:91],v[24:27],a[212:215],a[88:91]
v_add_f32_dpp v123, v123, v123 row_ror:8 row_mask:0xf bank_mask:0xf
v_add_f32_dpp v124, v124, v124 row_ror:8 row_mask:0xf bank_mask:0xf
v_add_f32_dpp v125, v125, v125 row_ror:8 row_mask:0xf bank_mask:0xf
M16 a[92:95],v[28:31],a[212:215],a[92:95]
DTR v[44:45],v15 offset:12552
v_add_f32_dpp v126, v126, v126 row_ror:8 row_mask:0xf bank_mask:0xf
v_add_f32_dpp v127, v127, v127 row_ror:8 row_mask:0xf bank_mask:0xf
M16 a[96:99],v[16:19],a[216:219],a[96:99]
buffer_load_dwordx4 a[212:215], v7, s[8:11], s42 offen
v_mov_b32 v128, v112
v_mov_b32 v129, v113
M16 a[100:103],v[20:23],a[216:219],a[100:103]
DTR v[46:47],v15 offset:13576
v_mov_b32 v130, v114
v_mov_b32 v131, v115
v_mov_b32 v132, v116
M16 a[104:107],v[24:27],a[216:219],a[104:107]
v_mov_b32 v133, v117
v_mov_b32 v134, v118
M16 a[108:111],v[28:31],a[216:219],a[108:111]
v_mov_b32 v135, v119
v_mov_b32 v136, v120
v_mov_b32 v137, v121
M16 a[112:115],v[16:19],a[220:223],a[112:115]
buffer_load_dwordx4 a[216:219], v8, s[8:11], s42 offen
v_mov_b32 v138, v122
v_mov_b32 v139, v123
M16 a[116:119],v[20:23],a[220:223],a[116:119]
v_mov_b32 v140, v124
v_mov_b32 v141, v125
v_mov_b32 v142, v126
M16 a[120:123],v[24:27],a[220:223],a[120:123]
v_mov_b32 v143, v127
v_permlane16_swap_b32 v112, v128
M16 a[124:127],v[28:31],a[220:223],a[124:127]
buffer_load_dwordx4 a[220:223], v9, s[8:11], s42 offen
s_add_u32 s42, s42, 4096
v_permlane16_swap_b32 v113, v129
v_permlane16_swap_b32 v114, v130
s_waitcnt vmcnt(43) lgkmcnt(6)
M16 a[0:3],v[32:35],a[224:227],a[0:3]
v_permlane16_swap_b32 v115, v131
v_permlane16_swap_b32 v116, v132
v_permlane16_swap_b32 v117, v133
s_waitcnt lgkmcnt(4)
M16 a[4:7],v[36:39],a[224:227],a[4:7]
v_permlane16_swap_b32 v118, v134
v_permlane16_swap_b32 v119, v135
s_waitcnt lgkmcnt(2)
M16 a[8:11],v[40:43],a[224:227],a[8:11]
s_add_u32 m0, s58, 12288
v_permlane16_swap_b32 v120, v136
v_permlane16_swap_b32 v121, v137
v_permlane16_swap_b32 v122, v138
s_waitcnt lgkmcnt(0)
M16 a[12:15],v[44:47],a[224:227],a[12:15]
buffer_load_dwordx4 v10, s[12:15], s47 offen offset:0 lds
v_permlane16_swap_b32 v123, v139
v_permlane16_swap_b32 v124, v140
s_waitcnt vmcnt(43)
M16 a[16:19],v[32:35],a[228:231],a[16:19]
buffer_load_dwordx4 a[224:227], v2, s[8:11], s43 offen
v_permlane16_swap_b32 v125, v141
v_permlane16_swap_b32 v126, v142
v_permlane16_swap_b32 v127, v143
M16 a[20:23],v[36:39],a[228:231],a[20:23]
buffer_load_dwordx4 v11, s[12:15], s47 offen offset:1024 lds
FAD v112,v112,v128
FAD v113,v113,v129
M16 a[24:27],v[40:43],a[228:231],a[24:27]
buffer_load_dwordx4 v12, s[12:15], s47 offen offset:2048 lds
FAD v114,v114,v130
FAD v115,v115,v131
FAD v116,v116,v132
M16 a[28:31],v[44:47],a[228:231],a[28:31]
buffer_load_dwordx4 v13, s[12:15], s47 offen offset:3072 lds
s_add_u32 s47, s47, 262144
FAD v117,v117,v133
FAD v118,v118,v134
s_waitcnt vmcnt(46)
M16 a[32:35],v[32:35],a[232:235],a[32:35]
buffer_load_dwordx4 a[228:231], v3, s[8:11], s43 offen
FAD v119,v119,v135
FAD v120,v120,v136
FAD v121,v121,v137
M16 a[36:39],v[36:39],a[232:235],a[36:39]
s_waitcnt vmcnt(37)
FAD v122,v122,v138
FAD v123,v123,v139
M16 a[40:43],v[40:43],a[232:235],a[40:43]
FAD v124,v124,v140
FAD v125,v125,v141
FAD v126,v126,v142
M16 a[44:47],v[44:47],a[232:235],a[44:47]
DTR v[16:17],v15 offset:0
FAD v127,v127,v143
v_mov_b32 v128, v112
M16 a[48:51],v[32:35],a[236:239],a[48:51]
buffer_load_dwordx4 a[232:235], v4, s[8:11], s43 offen
v_mov_b32 v129, v113
v_mov_b32 v130, v114
v_mov_b32 v131, v115
M16 a[52:55],v[36:39],a[236:239],a[52:55]
DTR v[18:19],v15 offset:1024
v_mov_b32 v132, v116
v_mov_b32 v133, v117
M16 a[56:59],v[40:43],a[236:239],a[56:59]
v_mov_b32 v134, v118
v_mov_b32 v135, v119
v_mov_b32 v136, v120
M16 a[60:63],v[44:47],a[236:239],a[60:63]
DTR v[20:21],v15 offset:8
v_mov_b32 v137, v121
v_mov_b32 v138, v122
M16 a[64:67],v[32:35],a[240:243],a[64:67]
buffer_load_dwordx4 a[236:239], v5, s[8:11], s43 offen
v_mov_b32 v139, v123
v_mov_b32 v140, v124
M16 a[68:71],v[36:39],a[240:243],a[68:71]
DTR v[22:23],v15 offset:1032
v_mov_b32 v141, v125
v_mov_b32 v142, v126
v_mov_b32 v143, v127
M16 a[72:75],v[40:43],a[240:243],a[72:75]
v_permlane32_swap_b32 v112, v128
v_permlane32_swap_b32 v113, v129
M16 a[76:79],v[44:47],a[240:243],a[76:79]
DTR v[24:25],v15 offset:256
v_permlane32_swap_b32 v114, v130
v_permlane32_swap_b32 v115, v131
v_permlane32_swap_b32 v116, v132
M16 a[80:83],v[32:35],a[244:247],a[80:83]
buffer_load_dwordx4 a[240:243], v6, s[8:11], s43 offen
v_permlane32_swap_b32 v117, v133
v_permlane32_swap_b32 v118, v134
M16 a[84:87],v[36:39],a[244:247],a[84:87]
DTR v[26:27],v15 offset:1280
v_permlane32_swap_b32 v119, v135
v_permlane32_swap_b32 v120, v136
v_permlane32_swap_b32 v121, v137
M16 a[88:91],v[40:43],a[244:247],a[88:91]
v_permlane32_swap_b32 v122, v138
v_permlane32_swap_b32 v123, v139
M16 a[92:95],v[44:47],a[244:247],a[92:95]
DTR v[28:29],v15 offset:264
v_permlane32_swap_b32 v124, v140
v_permlane32_swap_b32 v125, v141
v_permlane32_swap_b32 v126, v142
M16 a[96:99],v[32:35],a[248:251],a[96:99]
buffer_load_dwordx4 a[244:247], v7, s[8:11], s43 offen
v_permlane32_swap_b32 v127, v143
FAD v112,v112,v128
M16 a[100:103],v[36:39],a[248:251],a[100:103]
DTR v[30:31],v15 offset:1288
FAD v113,v113,v129
FAD v114,v114,v130
FAD v115,v115,v131
M16 a[104:107],v[40:43],a[248:251],a[104:107]
FAD v116,v116,v132
FAD v117,v117,v133
M16 a[108:111],v[44:47],a[248:251],a[108:111]
FAD v118,v118,v134
FAD v119,v119,v135
FAD v120,v120,v136
M16 a[112:115],v[32:35],a[252:255],a[112:115]
buffer_load_dwordx4 a[248:251], v8, s[8:11], s43 offen
FAD v121,v121,v137
FAD v122,v122,v138
M16 a[116:119],v[36:39],a[252:255],a[116:119]
FAD v123,v123,v139
FAD v124,v124,v140
FAD v125,v125,v141
M16 a[120:123],v[40:43],a[252:255],a[120:123]
FAD v126,v126,v142
FAD v127,v127,v143
M16 a[124:127],v[44:47],a[252:255],a[124:127]
buffer_load_dwordx4 a[252:255], v9, s[8:11], s43 offen
s_add_u32 s43, s43, 4096
v_lshlrev_b32 v209, 6, v205
v_add_u32 v209, s58, v209
s_mov_b32 s59, 6
L_oproj_kernel_lp:
s_waitcnt lgkmcnt(6)
M16 a[0:3],v[16:19],a[128:131],a[0:3]
s_waitcnt lgkmcnt(4)
M16 a[4:7],v[20:23],a[128:131],a[4:7]
s_waitcnt lgkmcnt(2)
M16 a[8:11],v[24:27],a[128:131],a[8:11]
s_add_u32 m0, s58, 0
s_waitcnt lgkmcnt(0)
M16 a[12:15],v[28:31],a[128:131],a[12:15]
buffer_load_dwordx4 v10, s[12:15], s44 offen offset:0 lds
s_waitcnt vmcnt(43)
M16 a[16:19],v[16:19],a[132:135],a[16:19]
buffer_load_dwordx4 a[128:131], v2, s[8:11], s40 offen
M16 a[20:23],v[20:23],a[132:135],a[20:23]
buffer_load_dwordx4 v11, s[12:15], s44 offen offset:1024 lds
M16 a[24:27],v[24:27],a[132:135],a[24:27]
buffer_load_dwordx4 v12, s[12:15], s44 offen offset:2048 lds
M16 a[28:31],v[28:31],a[132:135],a[28:31]
buffer_load_dwordx4 v13, s[12:15], s44 offen offset:3072 lds
s_add_u32 s44, s44, 262144
s_waitcnt vmcnt(46)
M16 a[32:35],v[16:19],a[136:139],a[32:35]
buffer_load_dwordx4 a[132:135], v3, s[8:11], s40 offen
M16 a[36:39],v[20:23],a[136:139],a[36:39]
s_waitcnt vmcnt(37)
M16 a[40:43],v[24:27],a[136:139],a[40:43]
M16 a[44:47],v[28:31],a[136:139],a[44:47]
DTR v[32:33],v15 offset:4096
M16 a[48:51],v[16:19],a[140:143],a[48:51]
buffer_load_dwordx4 a[136:139], v4, s[8:11], s40 offen
M16 a[52:55],v[20:23],a[140:143],a[52:55]
DTR v[34:35],v15 offset:5120
M16 a[56:59],v[24:27],a[140:143],a[56:59]
M16 a[60:63],v[28:31],a[140:143],a[60:63]
DTR v[36:37],v15 offset:4104
M16 a[64:67],v[16:19],a[144:147],a[64:67]
buffer_load_dwordx4 a[140:143], v5, s[8:11], s40 offen
M16 a[68:71],v[20:23],a[144:147],a[68:71]
DTR v[38:39],v15 offset:5128
M16 a[72:75],v[24:27],a[144:147],a[72:75]
M16 a[76:79],v[28:31],a[144:147],a[76:79]
DTR v[40:41],v15 offset:4352
M16 a[80:83],v[16:19],a[148:151],a[80:83]
buffer_load_dwordx4 a[144:147], v6, s[8:11], s40 offen
M16 a[84:87],v[20:23],a[148:151],a[84:87]
DTR v[42:43],v15 offset:5376
M16 a[88:91],v[24:27],a[148:151],a[88:91]
M16 a[92:95],v[28:31],a[148:151],a[92:95]
DTR v[44:45],v15 offset:4360
M16 a[96:99],v[16:19],a[152:155],a[96:99]
buffer_load_dwordx4 a[148:151], v7, s[8:11], s40 offen
M16 a[100:103],v[20:23],a[152:155],a[100:103]
DTR v[46:47],v15 offset:5384
M16 a[104:107],v[24:27],a[152:155],a[104:107]
M16 a[108:111],v[28:31],a[152:155],a[108:111]
M16 a[112:115],v[16:19],a[156:159],a[112:115]
buffer_load_dwordx4 a[152:155], v8, s[8:11], s40 offen
M16 a[116:119],v[20:23],a[156:159],a[116:119]
M16 a[120:123],v[24:27],a[156:159],a[120:123]
M16 a[124:127],v[28:31],a[156:159],a[124:127]
buffer_load_dwordx4 a[156:159], v9, s[8:11], s40 offen
s_add_u32 s40, s40, 4096
s_waitcnt lgkmcnt(6)
M16 a[0:3],v[32:35],a[160:163],a[0:3]
s_waitcnt lgkmcnt(4)
M16 a[4:7],v[36:39],a[160:163],a[4:7]
s_waitcnt lgkmcnt(2)
M16 a[8:11],v[40:43],a[160:163],a[8:11]
s_add_u32 m0, s58, 4096
s_waitcnt lgkmcnt(0)
M16 a[12:15],v[44:47],a[160:163],a[12:15]
buffer_load_dwordx4 v10, s[12:15], s45 offen offset:0 lds
s_waitcnt vmcnt(43)
M16 a[16:19],v[32:35],a[164:167],a[16:19]
buffer_load_dwordx4 a[160:163], v2, s[8:11], s41 offen
M16 a[20:23],v[36:39],a[164:167],a[20:23]
buffer_load_dwordx4 v11, s[12:15], s45 offen offset:1024 lds
M16 a[24:27],v[40:43],a[164:167],a[24:27]
buffer_load_dwordx4 v12, s[12:15], s45 offen offset:2048 lds
M16 a[28:31],v[44:47],a[164:167],a[28:31]
buffer_load_dwordx4 v13, s[12:15], s45 offen offset:3072 lds
s_add_u32 s45, s45, 262144
s_waitcnt vmcnt(46)
M16 a[32:35],v[32:35],a[168:171],a[32:35]
buffer_load_dwordx4 a[164:167], v3, s[8:11], s41 offen
M16 a[36:39],v[36:39],a[168:171],a[36:39]
s_waitcnt vmcnt(37)
M16 a[40:43],v[40:43],a[168:171],a[40:43]
M16 a[44:47],v[44:47],a[168:171],a[44:47]
DTR v[16:17],v15 offset:8192
M16 a[48:51],v[32:35],a[172:175],a[48:51]
buffer_load_dwordx4 a[168:171], v4, s[8:11], s41 offen
M16 a[52:55],v[36:39],a[172:175],a[52:55]
DTR v[18:19],v15 offset:9216
M16 a[56:59],v[40:43],a[172:175],a[56:59]
M16 a[60:63],v[44:47],a[172:175],a[60:63]
DTR v[20:21],v15 offset:8200
M16 a[64:67],v[32:35],a[176:179],a[64:67]
buffer_load_dwordx4 a[172:175], v5, s[8:11], s41 offen
M16 a[68:71],v[36:39],a[176:179],a[68:71]
DTR v[22:23],v15 offset:9224
M16 a[72:75],v[40:43],a[176:179],a[72:75]
M16 a[76:79],v[44:47],a[176:179],a[76:79]
DTR v[24:25],v15 offset:8448
M16 a[80:83],v[32:35],a[180:183],a[80:83]
buffer_load_dwordx4 a[176:179], v6, s[8:11], s41 offen
M16 a[84:87],v[36:39],a[180:183],a[84:87]
DTR v[26:27],v15 offset:9472
M16 a[88:91],v[40:43],a[180:183],a[88:91]
M16 a[92:95],v[44:47],a[180:183],a[92:95]
DTR v[28:29],v15 offset:8456
M16 a[96:99],v[32:35],a[184:187],a[96:99]
buffer_load_dwordx4 a[180:183], v7, s[8:11], s41 offen
M16 a[100:103],v[36:39],a[184:187],a[100:103]
DTR v[30:31],v15 offset:9480
M16 a[104:107],v[40:43],a[184:187],a[104:107]
M16 a[108:111],v[44:47],a[184:187],a[108:111]
M16 a[112:115],v[32:35],a[188:191],a[112:115]
buffer_load_dwordx4 a[184:187], v8, s[8:11], s41 offen
M16 a[116:119],v[36:39],a[188:191],a[116:119]
M16 a[120:123],v[40:43],a[188:191],a[120:123]
M16 a[124:127],v[44:47],a[188:191],a[124:127]
buffer_load_dwordx4 a[188:191], v9, s[8:11], s41 offen
s_add_u32 s41, s41, 4096
s_waitcnt lgkmcnt(6)
M16 a[0:3],v[16:19],a[192:195],a[0:3]
s_waitcnt lgkmcnt(4)
M16 a[4:7],v[20:23],a[192:195],a[4:7]
s_waitcnt lgkmcnt(2)
M16 a[8:11],v[24:27],a[192:195],a[8:11]
s_add_u32 m0, s58, 8192
s_waitcnt lgkmcnt(0)
M16 a[12:15],v[28:31],a[192:195],a[12:15]
buffer_load_dwordx4 v10, s[12:15], s46 offen offset:0 lds
s_waitcnt vmcnt(43)
M16 a[16:19],v[16:19],a[196:199],a[16:19]
buffer_load_dwordx4 a[192:195], v2, s[8:11], s42 offen
M16 a[20:23],v[20:23],a[196:199],a[20:23]
buffer_load_dwordx4 v11, s[12:15], s46 offen offset:1024 lds
M16 a[24:27],v[24:27],a[196:199],a[24:27]
buffer_load_dwordx4 v12, s[12:15], s46 offen offset:2048 lds
M16 a[28:31],v[28:31],a[196:199],a[28:31]
buffer_load_dwordx4 v13, s[12:15], s46 offen offset:3072 lds
s_add_u32 s46, s46, 262144
s_waitcnt vmcnt(46)
M16 a[32:35],v[16:19],a[200:203],a[32:35]
buffer_load_dwordx4 a[196:199], v3, s[8:11], s42 offen
M16 a[36:39],v[20:23],a[200:203],a[36:39]
s_waitcnt vmcnt(37)
M16 a[40:43],v[24:27],a[200:203],a[40:43]
M16 a[44:47],v[28:31],a[200:203],a[44:47]
DTR v[32:33],v15 offset:12288
M16 a[48:51],v[16:19],a[204:207],a[48:51]
buffer_load_dwordx4 a[200:203], v4, s[8:11], s42 offen
M16 a[52:55],v[20:23],a[204:207],a[52:55]
DTR v[34:35],v15 offset:13312
M16 a[56:59],v[24:27],a[204:207],a[56:59]
M16 a[60:63],v[28:31],a[204:207],a[60:63]
DTR v[36:37],v15 offset:12296
M16 a[64:67],v[16:19],a[208:211],a[64:67]
buffer_load_dwordx4 a[204:207], v5, s[8:11], s42 offen
M16 a[68:71],v[20:23],a[208:211],a[68:71]
DTR v[38:39],v15 offset:13320
M16 a[72:75],v[24:27],a[208:211],a[72:75]
M16 a[76:79],v[28:31],a[208:211],a[76:79]
DTR v[40:41],v15 offset:12544
M16 a[80:83],v[16:19],a[212:215],a[80:83]
buffer_load_dwordx4 a[208:211], v6, s[8:11], s42 offen
M16 a[84:87],v[20:23],a[212:215],a[84:87]
DTR v[42:43],v15 offset:13568
M16 a[88:91],v[24:27],a[212:215],a[88:91]
M16 a[92:95],v[28:31],a[212:215],a[92:95]
DTR v[44:45],v15 offset:12552
M16 a[96:99],v[16:19],a[216:219],a[96:99]
buffer_load_dwordx4 a[212:215], v7, s[8:11], s42 offen
M16 a[100:103],v[20:23],a[216:219],a[100:103]
DTR v[46:47],v15 offset:13576
M16 a[104:107],v[24:27],a[216:219],a[104:107]
M16 a[108:111],v[28:31],a[216:219],a[108:111]
M16 a[112:115],v[16:19],a[220:223],a[112:115]
buffer_load_dwordx4 a[216:219], v8, s[8:11], s42 offen
M16 a[116:119],v[20:23],a[220:223],a[116:119]
M16 a[120:123],v[24:27],a[220:223],a[120:123]
M16 a[124:127],v[28:31],a[220:223],a[124:127]
buffer_load_dwordx4 a[220:223], v9, s[8:11], s42 offen
s_add_u32 s42, s42, 4096
s_waitcnt lgkmcnt(6)
M16 a[0:3],v[32:35],a[224:227],a[0:3]
s_waitcnt lgkmcnt(4)
M16 a[4:7],v[36:39],a[224:227],a[4:7]
s_waitcnt lgkmcnt(2)
M16 a[8:11],v[40:43],a[224:227],a[8:11]
s_add_u32 m0, s58, 12288
s_waitcnt lgkmcnt(0)
M16 a[12:15],v[44:47],a[224:227],a[12:15]
buffer_load_dwordx4 v10, s[12:15], s47 offen offset:0 lds
s_waitcnt vmcnt(43)
M16 a[16:19],v[32:35],a[228:231],a[16:19]
buffer_load_dwordx4 a[224:227], v2, s[8:11], s43 offen
M16 a[20:23],v[36:39],a[228:231],a[20:23]
buffer_load_dwordx4 v11, s[12:15], s47 offen offset:1024 lds
M16 a[24:27],v[40:43],a[228:231],a[24:27]
buffer_load_dwordx4 v12, s[12:15], s47 offen offset:2048 lds
M16 a[28:31],v[44:47],a[228:231],a[28:31]
buffer_load_dwordx4 v13, s[12:15], s47 offen offset:3072 lds
s_add_u32 s47, s47, 262144
s_waitcnt vmcnt(46)
M16 a[32:35],v[32:35],a[232:235],a[32:35]
buffer_load_dwordx4 a[228:231], v3, s[8:11], s43 offen
M16 a[36:39],v[36:39],a[232:235],a[36:39]
s_waitcnt vmcnt(37)
M16 a[40:43],v[40:43],a[232:235],a[40:43]
M16 a[44:47],v[44:47],a[232:235],a[44:47]
DTR v[16:17],v15 offset:0
M16 a[48:51],v[32:35],a[236:239],a[48:51]
buffer_load_dwordx4 a[232:235], v4, s[8:11], s43 offen
M16 a[52:55],v[36:39],a[236:239],a[52:55]
DTR v[18:19],v15 offset:1024
M16 a[56:59],v[40:43],a[236:239],a[56:59]
M16 a[60:63],v[44:47],a[236:239],a[60:63]
DTR v[20:21],v15 offset:8
M16 a[64:67],v[32:35],a[240:243],a[64:67]
buffer_load_dwordx4 a[236:239], v5, s[8:11], s43 offen
M16 a[68:71],v[36:39],a[240:243],a[68:71]
DTR v[22:23],v15 offset:1032
M16 a[72:75],v[40:43],a[240:243],a[72:75]
M16 a[76:79],v[44:47],a[240:243],a[76:79]
DTR v[24:25],v15 offset:256
M16 a[80:83],v[32:35],a[244:247],a[80:83]
buffer_load_dwordx4 a[240:243], v6, s[8:11], s43 offen
M16 a[84:87],v[36:39],a[244:247],a[84:87]
DTR v[26:27],v15 offset:1280
M16 a[88:91],v[40:43],a[244:247],a[88:91]
M16 a[92:95],v[44:47],a[244:247],a[92:95]
DTR v[28:29],v15 offset:264
M16 a[96:99],v[32:35],a[248:251],a[96:99]
buffer_load_dwordx4 a[244:247], v7, s[8:11], s43 offen
M16 a[100:103],v[36:39],a[248:251],a[100:103]
DTR v[30:31],v15 offset:1288
M16 a[104:107],v[40:43],a[248:251],a[104:107]
M16 a[108:111],v[44:47],a[248:251],a[108:111]
M16 a[112:115],v[32:35],a[252:255],a[112:115]
buffer_load_dwordx4 a[248:251], v8, s[8:11], s43 offen
M16 a[116:119],v[36:39],a[252:255],a[116:119]
M16 a[120:123],v[40:43],a[252:255],a[120:123]
M16 a[124:127],v[44:47],a[252:255],a[124:127]
buffer_load_dwordx4 a[252:255], v9, s[8:11], s43 offen
s_add_u32 s43, s43, 4096
s_sub_u32 s59, s59, 1
s_cmp_lg_u32 s59, 0
s_cbranch_scc1 L_oproj_kernel_lp
s_add_u32 s68, s67, 8192
s_add_u32 s69, s67, 16384
s_waitcnt lgkmcnt(6)
M16 a[0:3],v[16:19],a[128:131],a[0:3]
s_waitcnt lgkmcnt(4)
M16 a[4:7],v[20:23],a[128:131],a[4:7]
s_waitcnt lgkmcnt(2)
M16 a[8:11],v[24:27],a[128:131],a[8:11]
buffer_load_dwordx4 v[144:147], v194, s[20:23], s63 offen offset:0
s_waitcnt lgkmcnt(0)
M16 a[12:15],v[28:31],a[128:131],a[12:15]
s_waitcnt vmcnt(43)
M16 a[16:19],v[16:19],a[132:135],a[16:19]
buffer_load_dwordx4 v[148:151], v194, s[20:23], s63 offen offset:64
M16 a[20:23],v[20:23],a[132:135],a[20:23]
M16 a[24:27],v[24:27],a[132:135],a[24:27]
buffer_load_dwordx4 v[152:155], v195, s[20:23], s63 offen offset:0
M16 a[28:31],v[28:31],a[132:135],a[28:31]
s_waitcnt vmcnt(44)
M16 a[32:35],v[16:19],a[136:139],a[32:35]
buffer_load_dwordx4 v[156:159], v195, s[20:23], s63 offen offset:64
M16 a[36:39],v[20:23],a[136:139],a[36:39]
s_waitcnt vmcnt(35)
M16 a[40:43],v[24:27],a[136:139],a[40:43]
buffer_load_dwordx4 v[160:163], v196, s[24:27], s68 offen offset:0
M16 a[44:47],v[28:31],a[136:139],a[44:47]
DTR v[32:33],v15 offset:4096
M16 a[48:51],v[16:19],a[140:143],a[48:51]
buffer_load_dwordx4 v[176:179], v196, s[24:27], s69 offen offset:0
M16 a[52:55],v[20:23],a[140:143],a[52:55]
DTR v[34:35],v15 offset:5120
M16 a[56:59],v[24:27],a[140:143],a[56:59]
buffer_load_dwordx4 v[164:167], v196, s[24:27], s68 offen offset:16
M16 a[60:63],v[28:31],a[140:143],a[60:63]
DTR v[36:37],v15 offset:4104
M16 a[64:67],v[16:19],a[144:147],a[64:67]
buffer_load_dwordx4 v[180:183], v196, s[24:27], s69 offen offset:16
M16 a[68:71],v[20:23],a[144:147],a[68:71]
DTR v[38:39],v15 offset:5128
M16 a[72:75],v[24:27],a[144:147],a[72:75]
buffer_load_dwordx4 v[168:171], v196, s[24:27], s68 offen offset:128
M16 a[76:79],v[28:31],a[144:147],a[76:79]
DTR v[40:41],v15 offset:4352
M16 a[80:83],v[16:19],a[148:151],a[80:83]
buffer_load_dwordx4 v[184:187], v196, s[24:27], s69 offen offset:128
M16 a[84:87],v[20:23],a[148:151],a[84:87]
DTR v[42:43],v15 offset:5376
M16 a[88:91],v[24:27],a[148:151],a[88:91]
buffer_load_dwordx4 v[172:175], v196, s[24:27], s68 offen offset:144
M16 a[92:95],v[28:31],a[148:151],a[92:95]
DTR v[44:45],v15 offset:4360
M16 a[96:99],v[16:19],a[152:155],a[96:99]
buffer_load_dwordx4 v[188:191], v196, s[24:27], s69 offen offset:144
M16 a[100:103],v[20:23],a[152:155],a[100:103]
DTR v[46:47],v15 offset:5384
M16 a[104:107],v[24:27],a[152:155],a[104:107]
M16 a[108:111],v[28:31],a[152:155],a[108:111]
M16 a[112:115],v[16:19],a[156:159],a[112:115]
M16 a[116:119],v[20:23],a[156:159],a[116:119]
M16 a[120:123],v[24:27],a[156:159],a[120:123]
M16 a[124:127],v[28:31],a[156:159],a[124:127]
s_waitcnt lgkmcnt(6)
M16 a[0:3],v[32:35],a[160:163],a[0:3]
s_waitcnt lgkmcnt(4)
M16 a[4:7],v[36:39],a[160:163],a[4:7]
s_waitcnt lgkmcnt(2)
M16 a[8:11],v[40:43],a[160:163],a[8:11]
s_waitcnt lgkmcnt(0)
M16 a[12:15],v[44:47],a[160:163],a[12:15]
s_waitcnt vmcnt(42)
M16 a[16:19],v[32:35],a[164:167],a[16:19]
M16 a[20:23],v[36:39],a[164:167],a[20:23]
M16 a[24:27],v[40:43],a[164:167],a[24:27]
M16 a[28:31],v[44:47],a[164:167],a[28:31]
s_waitcnt vmcnt(41)
M16 a[32:35],v[32:35],a[168:171],a[32:35]
M16 a[36:39],v[36:39],a[168:171],a[36:39]
s_waitcnt vmcnt(31)
M16 a[40:43],v[40:43],a[168:171],a[40:43]
M16 a[44:47],v[44:47],a[168:171],a[44:47]
DTR v[16:17],v15 offset:8192
M16 a[48:51],v[32:35],a[172:175],a[48:51]
M16 a[52:55],v[36:39],a[172:175],a[52:55]
DTR v[18:19],v15 offset:9216
M16 a[56:59],v[40:43],a[172:175],a[56:59]
M16 a[60:63],v[44:47],a[172:175],a[60:63]
DTR v[20:21],v15 offset:8200
M16 a[64:67],v[32:35],a[176:179],a[64:67]
M16 a[68:71],v[36:39],a[176:179],a[68:71]
DTR v[22:23],v15 offset:9224
M16 a[72:75],v[40:43],a[176:179],a[72:75]
M16 a[76:79],v[44:47],a[176:179],a[76:79]
DTR v[24:25],v15 offset:8448
M16 a[80:83],v[32:35],a[180:183],a[80:83]
M16 a[84:87],v[36:39],a[180:183],a[84:87]
DTR v[26:27],v15 offset:9472
M16 a[88:91],v[40:43],a[180:183],a[88:91]
M16 a[92:95],v[44:47],a[180:183],a[92:95]
DTR v[28:29],v15 offset:8456
M16 a[96:99],v[32:35],a[184:187],a[96:99]
M16 a[100:103],v[36:39],a[184:187],a[100:103]
DTR v[30:31],v15 offset:9480
M16 a[104:107],v[40:43],a[184:187],a[104:107]
M16 a[108:111],v[44:47],a[184:187],a[108:111]
M16 a[112:115],v[32:35],a[188:191],a[112:115]
M16 a[116:119],v[36:39],a[188:191],a[116:119]
M16 a[120:123],v[40:43],a[188:191],a[120:123]
M16 a[124:127],v[44:47],a[188:191],a[124:127]
s_waitcnt lgkmcnt(6)
M16 a[0:3],v[16:19],a[192:195],a[0:3]
s_waitcnt lgkmcnt(4)
M16 a[4:7],v[20:23],a[192:195],a[4:7]
s_waitcnt lgkmcnt(2)
M16 a[8:11],v[24:27],a[192:195],a[8:11]
s_waitcnt lgkmcnt(0)
M16 a[12:15],v[28:31],a[192:195],a[12:15]
s_waitcnt vmcnt(30)
M16 a[16:19],v[16:19],a[196:199],a[16:19]
M16 a[20:23],v[20:23],a[196:199],a[20:23]
M16 a[24:27],v[24:27],a[196:199],a[24:27]
M16 a[28:31],v[28:31],a[196:199],a[28:31]
s_waitcnt vmcnt(29)
M16 a[32:35],v[16:19],a[200:203],a[32:35]
M16 a[36:39],v[20:23],a[200:203],a[36:39]
s_waitcnt vmcnt(19)
M16 a[40:43],v[24:27],a[200:203],a[40:43]
M16 a[44:47],v[28:31],a[200:203],a[44:47]
DTR v[32:33],v15 offset:12288
M16 a[48:51],v[16:19],a[204:207],a[48:51]
M16 a[52:55],v[20:23],a[204:207],a[52:55]
DTR v[34:35],v15 offset:13312
M16 a[56:59],v[24:27],a[204:207],a[56:59]
M16 a[60:63],v[28:31],a[204:207],a[60:63]
DTR v[36:37],v15 offset:12296
M16 a[64:67],v[16:19],a[208:211],a[64:67]
M16 a[68:71],v[20:23],a[208:211],a[68:71]
DTR v[38:39],v15 offset:13320
M16 a[72:75],v[24:27],a[208:211],a[72:75]
M16 a[76:79],v[28:31],a[208:211],a[76:79]
DTR v[40:41],v15 offset:12544
M16 a[80:83],v[16:19],a[212:215],a[80:83]
M16 a[84:87],v[20:23],a[212:215],a[84:87]
DTR v[42:43],v15 offset:13568
M16 a[88:91],v[24:27],a[212:215],a[88:91]
M16 a[92:95],v[28:31],a[212:215],a[92:95]
DTR v[44:45],v15 offset:12552
M16 a[96:99],v[16:19],a[216:219],a[96:99]
M16 a[100:103],v[20:23],a[216:219],a[100:103]
DTR v[46:47],v15 offset:13576
M16 a[104:107],v[24:27],a[216:219],a[104:107]
M16 a[108:111],v[28:31],a[216:219],a[108:111]
M16 a[112:115],v[16:19],a[220:223],a[112:115]
M16 a[116:119],v[20:23],a[220:223],a[116:119]
M16 a[120:123],v[24:27],a[220:223],a[120:123]
M16 a[124:127],v[28:31],a[220:223],a[124:127]
ds_write_b128 v209, v[112:115] offset:0
ds_write_b128 v209, v[116:119] offset:16
ds_write_b128 v209, v[120:123] offset:32
ds_write_b128 v209, v[124:127] offset:48
s_waitcnt vmcnt(17) lgkmcnt(10)
M16 a[32:35],v[32:35],a[232:235],a[32:35]
s_waitcnt lgkmcnt(8)
M16 a[36:39],v[36:39],a[232:235],a[36:39]
s_waitcnt lgkmcnt(6)
M16 a[40:43],v[40:43],a[232:235],a[40:43]
s_waitcnt lgkmcnt(4)
M16 a[44:47],v[44:47],a[232:235],a[44:47]
s_waitcnt vmcnt(16)
M16 a[48:51],v[32:35],a[236:239],a[48:51]
M16 a[52:55],v[36:39],a[236:239],a[52:55]
M16 a[56:59],v[40:43],a[236:239],a[56:59]
ds_write_b128 v200, a[32:35] offset:0
M16 a[60:63],v[44:47],a[236:239],a[60:63]
ds_write_b128 v200, a[36:39] offset:1024
s_waitcnt vmcnt(15)
M16 a[64:67],v[32:35],a[240:243],a[64:67]
ds_write_b128 v200, a[40:43] offset:2048
M16 a[68:71],v[36:39],a[240:243],a[68:71]
ds_write_b128 v200, a[44:47] offset:3072
M16 a[72:75],v[40:43],a[240:243],a[72:75]
ds_write_b128 v200, a[48:51] offset:4096
M16 a[76:79],v[44:47],a[240:243],a[76:79]
ds_write_b128 v200, a[52:55] offset:5120
s_waitcnt vmcnt(14)
M16 a[80:83],v[32:35],a[244:247],a[80:83]
ds_write_b128 v200, a[56:59] offset:6144
M16 a[84:87],v[36:39],a[244:247],a[84:87]
ds_write_b128 v200, a[60:63] offset:7168
M16 a[88:91],v[40:43],a[244:247],a[88:91]
ds_write_b128 v201, a[64:67] offset:0
M16 a[92:95],v[44:47],a[244:247],a[92:95]
ds_write_b128 v201, a[68:71] offset:1024
s_waitcnt vmcnt(13)
M16 a[96:99],v[32:35],a[248:251],a[96:99]
ds_write_b128 v201, a[72:75] offset:2048
M16 a[100:103],v[36:39],a[248:251],a[100:103]
ds_write_b128 v201, a[76:79] offset:3072
M16 a[104:107],v[40:43],a[248:251],a[104:107]
ds_write_b128 v201, a[80:83] offset:4096
M16 a[108:111],v[44:47],a[248:251],a[108:111]
ds_write_b128 v201, a[84:87] offset:5120
s_waitcnt vmcnt(12)
M16 a[112:115],v[32:35],a[252:255],a[112:115]
ds_write_b128 v201, a[88:91] offset:6144
M16 a[116:119],v[36:39],a[252:255],a[116:119]
ds_write_b128 v201, a[92:95] offset:7168
M16 a[120:123],v[40:43],a[252:255],a[120:123]
ds_write_b128 v202, a[96:99] offset:0
M16 a[124:127],v[44:47],a[252:255],a[124:127]
ds_write_b128 v202, a[100:103] offset:1024
M16 a[0:3],v[32:35],a[224:227],a[0:3]
ds_write_b128 v202, a[104:107] offset:2048
M16 a[4:7],v[36:39],a[224:227],a[4:7]
ds_write_b128 v202, a[108:111] offset:3072
M16 a[8:11],v[40:43],a[224:227],a[8:11]
ds_write_b128 v202, a[112:115] offset:4096
M16 a[12:15],v[44:47],a[224:227],a[12:15]
ds_write_b128 v202, a[116:119] offset:5120
M16 a[16:19],v[32:35],a[228:231],a[16:19]
ds_write_b128 v202, a[120:123] offset:6144
M16 a[20:23],v[36:39],a[228:231],a[20:23]
ds_write_b128 v202, a[124:127] offset:7168
M16 a[24:27],v[40:43],a[228:231],a[24:27]
M16 a[28:31],v[44:47],a[228:231],a[28:31]
s_waitcnt lgkmcnt(0)
s_barrier
DR4 v[48:51],v199 offset:0
DR4 v[52:55],v199 offset:1024
DR4 v[56:59],v199 offset:2048
DR4 v[60:63],v199 offset:3072
DR4 v[64:67],v199 offset:4096
DR4 v[68:71],v199 offset:5120
DR4 v[72:75],v199 offset:6144
DR4 v[76:79],v199 offset:7168
DR4 v[80:83],v199 offset:8192
DR4 v[84:87],v199 offset:9216
DR4 v[88:91],v199 offset:10240
DR4 v[92:95],v199 offset:11264
DR4 v[96:99],v199 offset:12288
DR4 v[100:103],v199 offset:13312
DR4 v[104:107],v199 offset:14336
DR4 v[108:111],v199 offset:15360
DR4 v[112:115],v199 offset:16384
DR4 v[116:119],v199 offset:17408
DR4 v[120:123],v199 offset:18432
DR4 v[124:127],v199 offset:19456
DR4 v[128:131],v199 offset:20480
DR4 v[132:135],v199 offset:21504
DR4 v[136:139],v199 offset:22528
DR4 v[140:143],v199 offset:23552
v_lshlrev_b32 v203, 6, v204
v_lshl_add_u32 v203, v205, 2, v203
s_and_b32 s35, s3, 1
s_lshl_b32 s34, s35, 5
v_add_u32 v203, s34, v203
ds_read_b32 v204, v203 offset:0
ds_read_b32 v205, v203 offset:16384
ds_read_b32 v206, v203 offset:32768
ds_read_b32 v207, v203 offset:49152
s_lshl_b32 s34, s33, 1
s_add_u32 s34, s34, s35
s_mul_i32 s34, s34, 14336
s_lshl_b32 s32, s32, 8
s_add_u32 s34, s34, s32
s_add_u32 s34, s34, 327680
s_lshr_b32 s35, s3, 1
s_cmp_ge_u32 s2, 224
s_cselect_b32 s35, 1, s35
s_lshl_b32 s35, s35, 24
v_lshl_add_u32 v203, v1, 2, s35
ARD v208,a0
ARD v209,a1
ARD v210,a2
ARD v211,a3
ARD v212,a4
ARD v213,a5
ARD v214,a6
ARD v215,a7
ARD v216,a8
ARD v217,a9
ARD v218,a10
ARD v219,a11
ARD v220,a12
ARD v221,a13
ARD v222,a14
ARD v223,a15
ARD v224,a16
ARD v225,a17
ARD v226,a18
ARD v227,a19
ARD v228,a20
ARD v229,a21
ARD v230,a22
ARD v231,a23
ARD v232,a24
ARD v233,a25
ARD v234,a26
ARD v235,a27
ARD v236,a28
ARD v237,a29
ARD v238,a30
ARD v239,a31
s_waitcnt vmcnt(6)
FAD v176,1.0,v176
FAD v177,1.0,v177
FAD v178,1.0,v178
FAD v179,1.0,v179
s_waitcnt vmcnt(4)
FAD v180,1.0,v180
FAD v181,1.0,v181
FAD v182,1.0,v182
FAD v183,1.0,v183
s_waitcnt vmcnt(2)
FAD v184,1.0,v184
FAD v185,1.0,v185
FAD v186,1.0,v186
FAD v187,1.0,v187
s_waitcnt vmcnt(0)
FAD v188,1.0,v188
FAD v189,1.0,v189
FAD v190,1.0,v190
FAD v191,1.0,v191
s_waitcnt lgkmcnt(15)
v_pk_add_f32 v[208:209], v[208:209], v[48:49]
v_pk_add_f32 v[210:211], v[210:211], v[50:51]
s_waitcnt lgkmcnt(15)
v_pk_add_f32 v[212:213], v[212:213], v[52:53]
v_pk_add_f32 v[214:215], v[214:215], v[54:55]
s_waitcnt lgkmcnt(15)
v_pk_add_f32 v[216:217], v[216:217], v[56:57]
v_pk_add_f32 v[218:219], v[218:219], v[58:59]
s_waitcnt lgkmcnt(15)
v_pk_add_f32 v[220:221], v[220:221], v[60:61]
v_pk_add_f32 v[222:223], v[222:223], v[62:63]
s_waitcnt lgkmcnt(15)
v_pk_add_f32 v[224:225], v[224:225], v[64:65]
v_pk_add_f32 v[226:227], v[226:227], v[66:67]
s_waitcnt lgkmcnt(15)
v_pk_add_f32 v[228:229], v[228:229], v[68:69]
v_pk_add_f32 v[230:231], v[230:231], v[70:71]
s_waitcnt lgkmcnt(15)
v_pk_add_f32 v[232:233], v[232:233], v[72:73]
v_pk_add_f32 v[234:235], v[234:235], v[74:75]
s_waitcnt lgkmcnt(15)
v_pk_add_f32 v[236:237], v[236:237], v[76:77]
v_pk_add_f32 v[238:239], v[238:239], v[78:79]
s_waitcnt lgkmcnt(15)
v_pk_add_f32 v[208:209], v[208:209], v[80:81]
v_pk_add_f32 v[210:211], v[210:211], v[82:83]
s_waitcnt lgkmcnt(15)
v_pk_add_f32 v[212:213], v[212:213], v[84:85]
v_pk_add_f32 v[214:215], v[214:215], v[86:87]
s_waitcnt lgkmcnt(15)
v_pk_add_f32 v[216:217], v[216:217], v[88:89]
v_pk_add_f32 v[218:219], v[218:219], v[90:91]
s_waitcnt lgkmcnt(15)
v_pk_add_f32 v[220:221], v[220:221], v[92:93]
v_pk_add_f32 v[222:223], v[222:223], v[94:95]
s_waitcnt lgkmcnt(15)
v_pk_add_f32 v[224:225], v[224:225], v[96:97]
v_pk_add_f32 v[226:227], v[226:227], v[98:99]
s_waitcnt lgkmcnt(14)
v_pk_add_f32 v[228:229], v[228:229], v[100:101]
v_pk_add_f32 v[230:231], v[230:231], v[102:103]
s_waitcnt lgkmcnt(13)
v_pk_add_f32 v[232:233], v[232:233], v[104:105]
v_pk_add_f32 v[234:235], v[234:235], v[106:107]
s_waitcnt lgkmcnt(12)
v_pk_add_f32 v[236:237], v[236:237], v[108:109]
v_pk_add_f32 v[238:239], v[238:239], v[110:111]
s_waitcnt lgkmcnt(11)
v_pk_add_f32 v[208:209], v[208:209], v[112:113]
v_pk_add_f32 v[210:211], v[210:211], v[114:115]
s_waitcnt lgkmcnt(10)
v_pk_add_f32 v[212:213], v[212:213], v[116:117]
v_pk_add_f32 v[214:215], v[214:215], v[118:119]
s_waitcnt lgkmcnt(9)
v_pk_add_f32 v[216:217], v[216:217], v[120:121]
v_pk_add_f32 v[218:219], v[218:219], v[122:123]
s_waitcnt lgkmcnt(8)
v_pk_add_f32 v[220:221], v[220:221], v[124:125]
v_pk_add_f32 v[222:223], v[222:223], v[126:127]
s_waitcnt lgkmcnt(7)
v_pk_add_f32 v[224:225], v[224:225], v[128:129]
v_pk_add_f32 v[226:227], v[226:227], v[130:131]
s_waitcnt lgkmcnt(6)
v_pk_add_f32 v[228:229], v[228:229], v[132:133]
v_pk_add_f32 v[230:231], v[230:231], v[134:135]
s_waitcnt lgkmcnt(5)
v_pk_add_f32 v[232:233], v[232:233], v[136:137]
v_pk_add_f32 v[234:235], v[234:235], v[138:139]
s_waitcnt lgkmcnt(4)
v_pk_add_f32 v[236:237], v[236:237], v[140:141]
v_pk_add_f32 v[238:239], v[238:239], v[142:143]
v_lshlrev_b32 v48, 16, v144
v_and_b32 v49, 0xffff0000, v144
v_lshlrev_b32 v50, 16, v145
v_and_b32 v51, 0xffff0000, v145
v_lshlrev_b32 v52, 16, v146
v_and_b32 v53, 0xffff0000, v146
v_lshlrev_b32 v54, 16, v147
v_and_b32 v55, 0xffff0000, v147
v_fma_f32 v208, v208, v160, v48
v_fma_f32 v209, v209, v161, v49
v_fma_f32 v210, v210, v162, v50
v_fma_f32 v211, v211, v163, v51
v_fma_f32 v212, v212, v164, v52
v_fma_f32 v213, v213, v165, v53
v_fma_f32 v214, v214, v166, v54
v_fma_f32 v215, v215, v167, v55
CVT v56,v208,v209
CVT v57,v210,v211
CVT v58,v212,v213
CVT v59,v214,v215
buffer_store_dwordx4 v[56:59], v14, s[28:31], s64 offen offset:0 sc1
v_pk_mul_f32 v[48:49], v[208:209], v[176:177]
v_pk_mul_f32 v[50:51], v[210:211], v[178:179]
v_pk_mul_f32 v[52:53], v[212:213], v[180:181]
v_pk_mul_f32 v[54:55], v[214:215], v[182:183]
CVT v60,v48,v49
CVT v61,v50,v51
CVT v62,v52,v53
CVT v63,v54,v55
buffer_store_dwordx4 v[60:63], v14, s[28:31], s65 offen offset:0 sc1
v_lshlrev_b32 v64, 16, v148
v_and_b32 v65, 0xffff0000, v148
v_lshlrev_b32 v66, 16, v149
v_and_b32 v67, 0xffff0000, v149
v_lshlrev_b32 v68, 16, v150
v_and_b32 v69, 0xffff0000, v150
v_lshlrev_b32 v70, 16, v151
v_and_b32 v71, 0xffff0000, v151
v_fma_f32 v216, v216, v168, v64
v_fma_f32 v217, v217, v169, v65
v_fma_f32 v218, v218, v170, v66
v_fma_f32 v219, v219, v171, v67
v_fma_f32 v220, v220, v172, v68
v_fma_f32 v221, v221, v173, v69
v_fma_f32 v222, v222, v174, v70
v_fma_f32 v223, v223, v175, v71
CVT v72,v216,v217
CVT v73,v218,v219
CVT v74,v220,v221
CVT v75,v222,v223
buffer_store_dwordx4 v[72:75], v14, s[28:31], s64 offen offset:1024 sc1
v_pk_mul_f32 v[64:65], v[216:217], v[184:185]
v_pk_mul_f32 v[66:67], v[218:219], v[186:187]
v_pk_mul_f32 v[68:69], v[220:221], v[188:189]
v_pk_mul_f32 v[70:71], v[222:223], v[190:191]
CVT v76,v64,v65
CVT v77,v66,v67
CVT v78,v68,v69
CVT v79,v70,v71
buffer_store_dwordx4 v[76:79], v14, s[28:31], s65 offen offset:1024 sc1
FAD v120,v208,v209
FML v121,v208,v208
v_fmac_f32 v121, v209, v209
FAD v120,v120,v210
v_fmac_f32 v121, v210, v210
FAD v120,v120,v211
v_fmac_f32 v121, v211, v211
FAD v120,v120,v212
v_fmac_f32 v121, v212, v212
FAD v120,v120,v213
v_fmac_f32 v121, v213, v213
FAD v120,v120,v214
v_fmac_f32 v121, v214, v214
FAD v120,v120,v215
v_fmac_f32 v121, v215, v215
FAD v120,v120,v216
v_fmac_f32 v121, v216, v216
FAD v120,v120,v217
v_fmac_f32 v121, v217, v217
FAD v120,v120,v218
v_fmac_f32 v121, v218, v218
FAD v120,v120,v219
v_fmac_f32 v121, v219, v219
FAD v120,v120,v220
v_fmac_f32 v121, v220, v220
FAD v120,v120,v221
v_fmac_f32 v121, v221, v221
FAD v120,v120,v222
v_fmac_f32 v121, v222, v222
FAD v120,v120,v223
v_fmac_f32 v121, v223, v223
v_mov_b32 v122, v120
v_mov_b32 v123, v121
s_nop 0
v_permlane32_swap_b32 v120, v122
v_permlane32_swap_b32 v121, v123
FAD v120,v120,v122
FAD v121,v121,v123
v_mov_b32 v122, v120
v_mov_b32 v123, v121
s_nop 0
v_permlane16_swap_b32 v120, v122
v_permlane16_swap_b32 v121, v123
FAD v120,v120,v122
FAD v121,v121,v123
v_lshlrev_b32 v80, 16, v152
v_and_b32 v81, 0xffff0000, v152
v_lshlrev_b32 v82, 16, v153
v_and_b32 v83, 0xffff0000, v153
v_lshlrev_b32 v84, 16, v154
v_and_b32 v85, 0xffff0000, v154
v_lshlrev_b32 v86, 16, v155
v_and_b32 v87, 0xffff0000, v155
v_fma_f32 v224, v224, v160, v80
v_fma_f32 v225, v225, v161, v81
v_fma_f32 v226, v226, v162, v82
v_fma_f32 v227, v227, v163, v83
v_fma_f32 v228, v228, v164, v84
v_fma_f32 v229, v229, v165, v85
v_fma_f32 v230, v230, v166, v86
v_fma_f32 v231, v231, v167, v87
CVT v88,v224,v225
CVT v89,v226,v227
CVT v90,v228,v229
CVT v91,v230,v231
buffer_store_dwordx4 v[88:91], v198, s[28:31], s64 offen offset:0 sc1
v_pk_mul_f32 v[80:81], v[224:225], v[176:177]
v_pk_mul_f32 v[82:83], v[226:227], v[178:179]
v_pk_mul_f32 v[84:85], v[228:229], v[180:181]
v_pk_mul_f32 v[86:87], v[230:231], v[182:183]
CVT v92,v80,v81
CVT v93,v82,v83
CVT v94,v84,v85
CVT v95,v86,v87
buffer_store_dwordx4 v[92:95], v198, s[28:31], s65 offen offset:0 sc1
v_lshlrev_b32 v96, 16, v156
v_and_b32 v97, 0xffff0000, v156
v_lshlrev_b32 v98, 16, v157
v_and_b32 v99, 0xffff0000, v157
v_lshlrev_b32 v100, 16, v158
v_and_b32 v101, 0xffff0000, v158
v_lshlrev_b32 v102, 16, v159
v_and_b32 v103, 0xffff0000, v159
v_fma_f32 v232, v232, v168, v96
v_fma_f32 v233, v233, v169, v97
v_fma_f32 v234, v234, v170, v98
v_fma_f32 v235, v235, v171, v99
v_fma_f32 v236, v236, v172, v100
v_fma_f32 v237, v237, v173, v101
v_fma_f32 v238, v238, v174, v102
v_fma_f32 v239, v239, v175, v103
CVT v104,v232,v233
CVT v105,v234,v235
CVT v106,v236,v237
CVT v107,v238,v239
buffer_store_dwordx4 v[104:107], v198, s[28:31], s64 offen offset:1024 sc1
v_pk_mul_f32 v[96:97], v[232:233], v[184:185]
v_pk_mul_f32 v[98:99], v[234:235], v[186:187]
v_pk_mul_f32 v[100:101], v[236:237], v[188:189]
v_pk_mul_f32 v[102:103], v[238:239], v[190:191]
CVT v108,v96,v97
CVT v109,v98,v99
CVT v110,v100,v101
CVT v111,v102,v103
buffer_store_dwordx4 v[108:111], v198, s[28:31], s65 offen offset:1024 sc1
FAD v124,v224,v225
FML v125,v224,v224
v_fmac_f32 v125, v225, v225
FAD v124,v124,v226
v_fmac_f32 v125, v226, v226
FAD v124,v124,v227
v_fmac_f32 v125, v227, v227
FAD v124,v124,v228
v_fmac_f32 v125, v228, v228
FAD v124,v124,v229
v_fmac_f32 v125, v229, v229
FAD v124,v124,v230
v_fmac_f32 v125, v230, v230
FAD v124,v124,v231
v_fmac_f32 v125, v231, v231
FAD v124,v124,v232
v_fmac_f32 v125, v232, v232
FAD v124,v124,v233
v_fmac_f32 v125, v233, v233
FAD v124,v124,v234
v_fmac_f32 v125, v234, v234
FAD v124,v124,v235
v_fmac_f32 v125, v235, v235
FAD v124,v124,v236
v_fmac_f32 v125, v236, v236
FAD v124,v124,v237
v_fmac_f32 v125, v237, v237
FAD v124,v124,v238
v_fmac_f32 v125, v238, v238
FAD v124,v124,v239
v_fmac_f32 v125, v239, v239
v_mov_b32 v126, v124
v_mov_b32 v127, v125
s_nop 0
v_permlane32_swap_b32 v124, v126
v_permlane32_swap_b32 v125, v127
FAD v124,v124,v126
FAD v125,v125,v127
v_mov_b32 v126, v124
v_mov_b32 v127, v125
s_nop 0
v_permlane16_swap_b32 v124, v126
v_permlane16_swap_b32 v125, v127
FAD v124,v124,v126
FAD v125,v125,v127
s_waitcnt lgkmcnt(2)
FAD v204,v204,v205
s_waitcnt lgkmcnt(0)
FAD v206,v206,v207
FAD v204,v204,v206
buffer_store_dword v204, v203, s[28:31], s34 offen sc1
s_mov_b64 exec, 0xffff
buffer_store_dwordx2 v[120:121], v197, s[28:31], s66 offen sc1
buffer_store_dwordx2 v[124:125], v197, s[28:31], s66 offen offset:2048 sc1
L_oproj_kernel_end:
s_endpgm
.p2align 8
ffn1_kernel:
s_cmp_ge_u32 s2, 256
s_cbranch_scc1 L_ffn1_kernel_end
v_lshrrev_b32 v2, 6, v0
v_and_b32 v1, 63, v0
v_readfirstlane_b32 s3, v2
s_load_dwordx2 s[12:13], s[0:1], 56
s_load_dwordx2 s[48:49], s[0:1], 104
s_and_b32 s50, s2, 7
s_lshr_b32 s51, s2, 3
s_and_b32 s54, s51, 7
s_lshr_b32 s55, s51, 3
s_and_b32 s52, s50, 1
s_lshl_b32 s52, s52, 3
s_add_u32 s52, s52, s54
s_lshr_b32 s53, s50, 1
s_lshl_b32 s53, s53, 2
s_add_u32 s53, s53, s55
s_mul_i32 s55, s55, 5
s_lshl_b32 s54, s54, 1
s_add_u32 s59, s54, s55
s_mov_b32 s59, 0
s_lshl_b32 s62, s52, 3
s_lshl_b32 s56, s3, 1
s_add_u32 s62, s62, s56
s_lshl_b32 s63, s62, 15
s_add_u32 s63, s63, 9437184
s_mul_i32 s64, s53, 448
s_andn2_b32 s64, s64, 127
s_mul_i32 s56, s3, 114688
s_add_u32 s64, s64, s56
s_lshl_b32 s58, s3, 13
v_lshlrev_b32 v14, 4, v1
v_add_u32 v13, 32768, v14
v_bfe_u32 v2, v1, 2, 3
v_mul_u32_u24 v2, 7168, v2
v_and_b32 v15, 3, v1
v_lshrrev_b32 v16, 5, v1
v_lshl_add_u32 v2, v16, 6, v2
v_lshl_add_u32 v2, v15, 4, v2
v_xor_b32 v3, 32, v2
v_add_u32 v3, 57344, v3
s_waitcnt lgkmcnt(0)
s_mov_b32 s14, 7340032
s_mov_b32 s15, 0x20000
s_mov_b32 s8, s48
s_mov_b32 s9, s49
s_mov_b32 s10, 16777216
s_mov_b32 s11, 0x20000
s_mul_i32 s61, s59, 458752
s_add_u32 s61, s61, s64
s_lshl_b32 s60, s59, 11
s_add_u32 s60, s60, s63
s_add_u32 s59, s59, 1
s_and_b32 s59, s59, 15
s_add_u32 m0, s58, 0
s_nop 0
buffer_load_dwordx4 v2, s[12:15], s61 offen offset:0 lds
s_add_u32 m0, s58, 1024
s_nop 0
buffer_load_dwordx4 v3, s[12:15], s61 offen offset:0 lds
s_add_u32 m0, s58, 1920
s_nop 0
buffer_load_dwordx4 v2, s[12:15], s61 offen offset:128 lds
s_add_u32 m0, s58, 2944
s_nop 0
buffer_load_dwordx4 v3, s[12:15], s61 offen offset:128 lds
s_add_u32 m0, s58, 3840
s_nop 0
buffer_load_dwordx4 v2, s[12:15], s61 offen offset:256 lds
s_add_u32 m0, s58, 4864
s_nop 0
buffer_load_dwordx4 v3, s[12:15], s61 offen offset:256 lds
s_add_u32 m0, s58, 5760
s_nop 0
buffer_load_dwordx4 v2, s[12:15], s61 offen offset:384 lds
s_add_u32 m0, s58, 6784
s_nop 0
buffer_load_dwordx4 v3, s[12:15], s61 offen offset:384 lds
buffer_load_dwordx4 a[0:3], v14, s[8:11], s60 offen offset:0
buffer_load_dwordx4 a[4:7], v13, s[8:11], s60 offen offset:0
buffer_load_dwordx4 a[8:11], v14, s[8:11], s60 offen offset:1024
buffer_load_dwordx4 a[12:15], v13, s[8:11], s60 offen offset:1024
s_mul_i32 s61, s59, 458752
s_add_u32 s61, s61, s64
s_lshl_b32 s60, s59, 11
s_add_u32 s60, s60, s63
s_add_u32 s59, s59, 1
s_and_b32 s59, s59, 15
s_add_u32 m0, s58, 32768
s_nop 0
buffer_load_dwordx4 v2, s[12:15], s61 offen offset:0 lds
s_add_u32 m0, s58, 33792
s_nop 0
buffer_load_dwordx4 v3, s[12:15], s61 offen offset:0 lds
s_add_u32 m0, s58, 34688
s_nop 0
buffer_load_dwordx4 v2, s[12:15], s61 offen offset:128 lds
s_add_u32 m0, s58, 35712
s_nop 0
buffer_load_dwordx4 v3, s[12:15], s61 offen offset:128 lds
s_add_u32 m0, s58, 36608
s_nop 0
buffer_load_dwordx4 v2, s[12:15], s61 offen offset:256 lds
s_add_u32 m0, s58, 37632
s_nop 0
buffer_load_dwordx4 v3, s[12:15], s61 offen offset:256 lds
s_add_u32 m0, s58, 38528
s_nop 0
buffer_load_dwordx4 v2, s[12:15], s61 offen offset:384 lds
s_add_u32 m0, s58, 39552
s_nop 0
buffer_load_dwordx4 v3, s[12:15], s61 offen offset:384 lds
buffer_load_dwordx4 a[16:19], v14, s[8:11], s60 offen offset:0
buffer_load_dwordx4 a[20:23], v13, s[8:11], s60 offen offset:0
buffer_load_dwordx4 a[24:27], v14, s[8:11], s60 offen offset:1024
buffer_load_dwordx4 a[28:31], v13, s[8:11], s60 offen offset:1024
s_mul_i32 s61, s59, 458752
s_add_u32 s61, s61, s64
s_lshl_b32 s60, s59, 11
s_add_u32 s60, s60, s63
s_add_u32 s59, s59, 1
s_and_b32 s59, s59, 15
s_add_u32 m0, s58, 65536
s_nop 0
buffer_load_dwordx4 v2, s[12:15], s61 offen offset:0 lds
s_add_u32 m0, s58, 66560
s_nop 0
buffer_load_dwordx4 v3, s[12:15], s61 offen offset:0 lds
s_add_u32 m0, s58, 67456
s_nop 0
buffer_load_dwordx4 v2, s[12:15], s61 offen offset:128 lds
s_add_u32 m0, s58, 68480
s_nop 0
buffer_load_dwordx4 v3, s[12:15], s61 offen offset:128 lds
s_add_u32 m0, s58, 69376
s_nop 0
buffer_load_dwordx4 v2, s[12:15], s61 offen offset:256 lds
s_add_u32 m0, s58, 70400
s_nop 0
buffer_load_dwordx4 v3, s[12:15], s61 offen offset:256 lds
s_add_u32 m0, s58, 71296
s_nop 0
buffer_load_dwordx4 v2, s[12:15], s61 offen offset:384 lds
s_add_u32 m0, s58, 72320
s_nop 0
buffer_load_dwordx4 v3, s[12:15], s61 offen offset:384 lds
buffer_load_dwordx4 a[32:35], v14, s[8:11], s60 offen offset:0
buffer_load_dwordx4 a[36:39], v13, s[8:11], s60 offen offset:0
buffer_load_dwordx4 a[40:43], v14, s[8:11], s60 offen offset:1024
buffer_load_dwordx4 a[44:47], v13, s[8:11], s60 offen offset:1024
s_mul_i32 s56, s53, 896
s_add_u32 s56, s56, 327680
v_min_u32 v44, 223, v0
v_lshlrev_b32 v44, 2, v44
buffer_load_dword v48, v44, s[8:11], s56 offen
s_add_u32 s56, s56, 14336
buffer_load_dword v49, v44, s[8:11], s56 offen
s_add_u32 s56, s56, 14336
buffer_load_dword v50, v44, s[8:11], s56 offen
s_add_u32 s56, s56, 14336
buffer_load_dword v51, v44, s[8:11], s56 offen
s_add_u32 s56, s56, 14336
buffer_load_dword v52, v44, s[8:11], s56 offen
s_add_u32 s56, s56, 14336
buffer_load_dword v53, v44, s[8:11], s56 offen
s_add_u32 s56, s56, 14336
buffer_load_dword v54, v44, s[8:11], s56 offen
s_add_u32 s56, s56, 14336
buffer_load_dword v55, v44, s[8:11], s56 offen
s_lshl_b32 s57, s62, 11
s_add_u32 s57, s57, 524288
v_and_b32 v45, 15, v1
v_lshrrev_b32 v46, 4, v1
v_lshlrev_b32 v47, 7, v45
v_lshl_add_u32 v47, v46, 5, v47
buffer_load_dwordx4 v[56:59], v47, s[8:11], s57 offen offset:0
buffer_load_dwordx4 v[60:63], v47, s[8:11], s57 offen offset:16
buffer_load_dwordx4 v[64:67], v47, s[8:11], s57 offen offset:2048
buffer_load_dwordx4 v[68:71], v47, s[8:11], s57 offen offset:2064
s_add_u32 s20, s48, 67108864
s_addc_u32 s21, s49, 0
s_mov_b32 s22, 14680064
s_mov_b32 s23, 0x20000
v_lshlrev_b32 v9, 13, v16
v_bfe_u32 v17, v1, 4, 1
v_lshl_add_u32 v9, v17, 10, v9
v_bfe_u32 v18, v1, 2, 2
v_lshl_add_u32 v9, v18, 6, v9
v_lshl_add_u32 v9, v15, 3, v9
v_lshlrev_b32 v17, 5, v17
v_add_u32 v10, v9, v17
v_xor_b32 v17, 32, v17
v_add_u32 v11, v9, v17
s_bitcmp1_b32 s53, 0
s_cselect_b32 s57, 512, 0
s_mul_i32 s56, s57, 3
s_add_u32 s56, s56, 512
v_add_u32 v7, s56, v10
v_add_u32 v8, s56, v11
v_add_u32 v10, s57, v10
v_add_u32 v11, s57, v11
v_add_u32 v72, 65536, v10
v_add_u32 v73, 65536, v11
v_add_u32 v74, 65536, v7
v_add_u32 v75, 65536, v8
s_mul_i32 s65, s62, 114688
s_mul_i32 s56, s53, 7168
s_add_u32 s65, s65, s56
v_add_u32 v12, 114688, v14
v_lshlrev_b32 v46, 4, v46
v_add_u32 v46, 131072, v46
v_add_u32 v44, 131072, v44
v_mov_b32 v76, 0
v_mov_b32 v77, 0
v_mov_b32 v78, 0
v_mov_b32 v79, 0
s_nop 1
M32 v[128:143],v[76:79],v[76:79],0
M32 v[144:159],v[76:79],v[76:79],0
M32 v[160:175],v[76:79],v[76:79],0
M32 v[176:191],v[76:79],v[76:79],0
M32 v[192:207],v[76:79],v[76:79],0
M32 v[208:223],v[76:79],v[76:79],0
M32 v[224:239],v[76:79],v[76:79],0
s_waitcnt vmcnt(40)
s_barrier
DTR v[16:17],v10 offset:0
DTR v[18:19],v10 offset:256
DTR v[20:21],v11 offset:0
DTR v[22:23],v11 offset:256
DTR v[24:25],v7 offset:0
DTR v[26:27],v7 offset:256
DTR v[28:29],v8 offset:0
DTR v[30:31],v8 offset:256
DTR v[32:33],v10 offset:2048
DTR v[34:35],v10 offset:2304
s_mov_b32 s66, 3
L_f1_lp:
s_waitcnt vmcnt(27) lgkmcnt(8)
M16 v[128:131],v[16:19],a[0:3],v[128:131]
DTR v[36:37],v11 offset:2048
s_mul_i32 s61, s59, 458752
s_add_u32 s61, s61, s64
s_lshl_b32 s60, s59, 11
s_add_u32 s60, s60, s63
s_add_u32 s59, s59, 1
s_and_b32 s59, s59, 15
s_add_u32 m0, s58, 98304
s_waitcnt vmcnt(26)
M16 v[132:135],v[16:19],a[4:7],v[132:135]
DTR v[38:39],v11 offset:2304
buffer_load_dwordx4 v2, s[12:15], s61 offen offset:0 lds
s_add_u32 m0, s58, 99328
s_waitcnt lgkmcnt(8)
M16 v[136:139],v[20:23],a[0:3],v[136:139]
DTR v[40:41],v7 offset:2048
M16 v[140:143],v[20:23],a[4:7],v[140:143]
DTR v[42:43],v7 offset:2304
s_waitcnt lgkmcnt(8)
M16 v[144:147],v[24:27],a[0:3],v[144:147]
DTR v[16:17],v8 offset:2048
M16 v[148:151],v[24:27],a[4:7],v[148:151]
DTR v[18:19],v8 offset:2304
buffer_load_dwordx4 v3, s[12:15], s61 offen offset:0 lds
s_add_u32 m0, s58, 100224
s_waitcnt lgkmcnt(8)
M16 v[152:155],v[28:31],a[0:3],v[152:155]
DTR v[20:21],v10 offset:4096
M16 v[156:159],v[28:31],a[4:7],v[156:159]
DTR v[22:23],v10 offset:4352
s_waitcnt lgkmcnt(8)
M16 v[160:163],v[32:35],a[0:3],v[160:163]
DTR v[24:25],v11 offset:4096
M16 v[164:167],v[32:35],a[4:7],v[164:167]
DTR v[26:27],v11 offset:4352
s_waitcnt lgkmcnt(8)
M16 v[168:171],v[36:39],a[0:3],v[168:171]
DTR v[28:29],v7 offset:4096
buffer_load_dwordx4 v2, s[12:15], s61 offen offset:128 lds
s_add_u32 m0, s58, 101248
M16 v[172:175],v[36:39],a[4:7],v[172:175]
DTR v[30:31],v7 offset:4352
s_waitcnt lgkmcnt(8)
M16 v[176:179],v[40:43],a[0:3],v[176:179]
DTR v[32:33],v8 offset:4096
M16 v[180:183],v[40:43],a[4:7],v[180:183]
DTR v[34:35],v8 offset:4352
s_waitcnt lgkmcnt(8)
M16 v[184:187],v[16:19],a[0:3],v[184:187]
DTR v[36:37],v10 offset:6144
buffer_load_dwordx4 v3, s[12:15], s61 offen offset:128 lds
s_add_u32 m0, s58, 102144
M16 v[188:191],v[16:19],a[4:7],v[188:191]
DTR v[38:39],v10 offset:6400
s_waitcnt lgkmcnt(8)
M16 v[192:195],v[20:23],a[0:3],v[192:195]
DTR v[40:41],v11 offset:6144
M16 v[196:199],v[20:23],a[4:7],v[196:199]
DTR v[42:43],v11 offset:6400
s_waitcnt lgkmcnt(8)
M16 v[200:203],v[24:27],a[0:3],v[200:203]
DTR v[16:17],v10 offset:16384
M16 v[204:207],v[24:27],a[4:7],v[204:207]
DTR v[18:19],v10 offset:16640
buffer_load_dwordx4 v2, s[12:15], s61 offen offset:256 lds
s_add_u32 m0, s58, 103168
s_waitcnt lgkmcnt(8)
M16 v[208:211],v[28:31],a[0:3],v[208:211]
DTR v[20:21],v11 offset:16384
M16 v[212:215],v[28:31],a[4:7],v[212:215]
DTR v[22:23],v11 offset:16640
s_waitcnt lgkmcnt(8)
M16 v[216:219],v[32:35],a[0:3],v[216:219]
DTR v[24:25],v7 offset:16384
M16 v[220:223],v[32:35],a[4:7],v[220:223]
DTR v[26:27],v7 offset:16640
buffer_load_dwordx4 v3, s[12:15], s61 offen offset:256 lds
s_add_u32 m0, s58, 104064
s_waitcnt lgkmcnt(8)
M16 v[224:227],v[36:39],a[0:3],v[224:227]
DTR v[28:29],v8 offset:16384
M16 v[228:231],v[36:39],a[4:7],v[228:231]
DTR v[30:31],v8 offset:16640
s_waitcnt lgkmcnt(8)
M16 v[232:235],v[40:43],a[0:3],v[232:235]
DTR v[32:33],v10 offset:18432
M16 v[236:239],v[40:43],a[4:7],v[236:239]
DTR v[34:35],v10 offset:18688
s_waitcnt vmcnt(31) lgkmcnt(8)
M16 v[128:131],v[16:19],a[8:11],v[128:131]
DTR v[36:37],v11 offset:18432
buffer_load_dwordx4 v2, s[12:15], s61 offen offset:384 lds
s_add_u32 m0, s58, 105088
s_waitcnt vmcnt(31)
M16 v[132:135],v[16:19],a[12:15],v[132:135]
DTR v[38:39],v11 offset:18688
s_waitcnt lgkmcnt(8)
M16 v[136:139],v[20:23],a[8:11],v[136:139]
DTR v[40:41],v7 offset:18432
M16 v[140:143],v[20:23],a[12:15],v[140:143]
DTR v[42:43],v7 offset:18688
s_waitcnt lgkmcnt(8)
M16 v[144:147],v[24:27],a[8:11],v[144:147]
DTR v[16:17],v8 offset:18432
M16 v[148:151],v[24:27],a[12:15],v[148:151]
DTR v[18:19],v8 offset:18688
buffer_load_dwordx4 v3, s[12:15], s61 offen offset:384 lds
s_waitcnt lgkmcnt(8)
M16 v[152:155],v[28:31],a[8:11],v[152:155]
DTR v[20:21],v10 offset:20480
M16 v[156:159],v[28:31],a[12:15],v[156:159]
DTR v[22:23],v10 offset:20736
s_waitcnt lgkmcnt(8)
M16 v[160:163],v[32:35],a[8:11],v[160:163]
DTR v[24:25],v11 offset:20480
M16 v[164:167],v[32:35],a[12:15],v[164:167]
DTR v[26:27],v11 offset:20736
buffer_load_dwordx4 a[48:51], v14, s[8:11], s60 offen offset:0
s_waitcnt lgkmcnt(8)
M16 v[168:171],v[36:39],a[8:11],v[168:171]
DTR v[28:29],v7 offset:20480
M16 v[172:175],v[36:39],a[12:15],v[172:175]
DTR v[30:31],v7 offset:20736
s_waitcnt lgkmcnt(8)
M16 v[176:179],v[40:43],a[8:11],v[176:179]
DTR v[32:33],v8 offset:20480
M16 v[180:183],v[40:43],a[12:15],v[180:183]
DTR v[34:35],v8 offset:20736
s_waitcnt lgkmcnt(8)
M16 v[184:187],v[16:19],a[8:11],v[184:187]
DTR v[36:37],v10 offset:22528
buffer_load_dwordx4 a[52:55], v13, s[8:11], s60 offen offset:0
M16 v[188:191],v[16:19],a[12:15],v[188:191]
DTR v[38:39],v10 offset:22784
s_waitcnt lgkmcnt(8)
M16 v[192:195],v[20:23],a[8:11],v[192:195]
DTR v[40:41],v11 offset:22528
M16 v[196:199],v[20:23],a[12:15],v[196:199]
DTR v[42:43],v11 offset:22784
s_waitcnt lgkmcnt(8)
M16 v[200:203],v[24:27],a[8:11],v[200:203]
buffer_load_dwordx4 a[56:59], v14, s[8:11], s60 offen offset:1024
M16 v[204:207],v[24:27],a[12:15],v[204:207]
s_waitcnt lgkmcnt(6)
M16 v[208:211],v[28:31],a[8:11],v[208:211]
M16 v[212:215],v[28:31],a[12:15],v[212:215]
s_waitcnt lgkmcnt(0)
s_waitcnt vmcnt(27)
s_barrier
DTR v[16:17],v10 offset:32768
DTR v[18:19],v10 offset:33024
M16 v[216:219],v[32:35],a[8:11],v[216:219]
DTR v[20:21],v11 offset:32768
DTR v[22:23],v11 offset:33024
M16 v[220:223],v[32:35],a[12:15],v[220:223]
DTR v[24:25],v7 offset:32768
DTR v[26:27],v7 offset:33024
buffer_load_dwordx4 a[60:63], v13, s[8:11], s60 offen offset:1024
M16 v[224:227],v[36:39],a[8:11],v[224:227]
DTR v[28:29],v8 offset:32768
DTR v[30:31],v8 offset:33024
M16 v[228:231],v[36:39],a[12:15],v[228:231]
DTR v[32:33],v10 offset:34816
DTR v[34:35],v10 offset:35072
M16 v[232:235],v[40:43],a[8:11],v[232:235]
M16 v[236:239],v[40:43],a[12:15],v[236:239]
s_waitcnt vmcnt(27) lgkmcnt(8)
M16 v[128:131],v[16:19],a[16:19],v[128:131]
DTR v[36:37],v11 offset:34816
s_mul_i32 s61, s59, 458752
s_add_u32 s61, s61, s64
s_lshl_b32 s60, s59, 11
s_add_u32 s60, s60, s63
s_add_u32 s59, s59, 1
s_and_b32 s59, s59, 15
s_add_u32 m0, s58, 0
s_waitcnt vmcnt(26)
M16 v[132:135],v[16:19],a[20:23],v[132:135]
DTR v[38:39],v11 offset:35072
buffer_load_dwordx4 v2, s[12:15], s61 offen offset:0 lds
s_add_u32 m0, s58, 1024
s_waitcnt lgkmcnt(8)
M16 v[136:139],v[20:23],a[16:19],v[136:139]
DTR v[40:41],v7 offset:34816
M16 v[140:143],v[20:23],a[20:23],v[140:143]
DTR v[42:43],v7 offset:35072
s_waitcnt lgkmcnt(8)
M16 v[144:147],v[24:27],a[16:19],v[144:147]
DTR v[16:17],v8 offset:34816
M16 v[148:151],v[24:27],a[20:23],v[148:151]
DTR v[18:19],v8 offset:35072
buffer_load_dwordx4 v3, s[12:15], s61 offen offset:0 lds
s_add_u32 m0, s58, 1920
s_waitcnt lgkmcnt(8)
M16 v[152:155],v[28:31],a[16:19],v[152:155]
DTR v[20:21],v10 offset:36864
M16 v[156:159],v[28:31],a[20:23],v[156:159]
DTR v[22:23],v10 offset:37120
s_waitcnt lgkmcnt(8)
M16 v[160:163],v[32:35],a[16:19],v[160:163]
DTR v[24:25],v11 offset:36864
M16 v[164:167],v[32:35],a[20:23],v[164:167]
DTR v[26:27],v11 offset:37120
s_waitcnt lgkmcnt(8)
M16 v[168:171],v[36:39],a[16:19],v[168:171]
DTR v[28:29],v7 offset:36864
buffer_load_dwordx4 v2, s[12:15], s61 offen offset:128 lds
s_add_u32 m0, s58, 2944
M16 v[172:175],v[36:39],a[20:23],v[172:175]
DTR v[30:31],v7 offset:37120
s_waitcnt lgkmcnt(8)
M16 v[176:179],v[40:43],a[16:19],v[176:179]
DTR v[32:33],v8 offset:36864
M16 v[180:183],v[40:43],a[20:23],v[180:183]
DTR v[34:35],v8 offset:37120
s_waitcnt lgkmcnt(8)
M16 v[184:187],v[16:19],a[16:19],v[184:187]
DTR v[36:37],v10 offset:38912
buffer_load_dwordx4 v3, s[12:15], s61 offen offset:128 lds
s_add_u32 m0, s58, 3840
M16 v[188:191],v[16:19],a[20:23],v[188:191]
DTR v[38:39],v10 offset:39168
s_waitcnt lgkmcnt(8)
M16 v[192:195],v[20:23],a[16:19],v[192:195]
DTR v[40:41],v11 offset:38912
M16 v[196:199],v[20:23],a[20:23],v[196:199]
DTR v[42:43],v11 offset:39168
s_waitcnt lgkmcnt(8)
M16 v[200:203],v[24:27],a[16:19],v[200:203]
DTR v[16:17],v10 offset:49152
M16 v[204:207],v[24:27],a[20:23],v[204:207]
DTR v[18:19],v10 offset:49408
buffer_load_dwordx4 v2, s[12:15], s61 offen offset:256 lds
s_add_u32 m0, s58, 4864
s_waitcnt lgkmcnt(8)
M16 v[208:211],v[28:31],a[16:19],v[208:211]
DTR v[20:21],v11 offset:49152
M16 v[212:215],v[28:31],a[20:23],v[212:215]
DTR v[22:23],v11 offset:49408
s_waitcnt lgkmcnt(8)
M16 v[216:219],v[32:35],a[16:19],v[216:219]
DTR v[24:25],v7 offset:49152
M16 v[220:223],v[32:35],a[20:23],v[220:223]
DTR v[26:27],v7 offset:49408
buffer_load_dwordx4 v3, s[12:15], s61 offen offset:256 lds
s_add_u32 m0, s58, 5760
s_waitcnt lgkmcnt(8)
M16 v[224:227],v[36:39],a[16:19],v[224:227]
DTR v[28:29],v8 offset:49152
M16 v[228:231],v[36:39],a[20:23],v[228:231]
DTR v[30:31],v8 offset:49408
s_waitcnt lgkmcnt(8)
M16 v[232:235],v[40:43],a[16:19],v[232:235]
DTR v[32:33],v10 offset:51200
M16 v[236:239],v[40:43],a[20:23],v[236:239]
DTR v[34:35],v10 offset:51456
s_waitcnt vmcnt(31) lgkmcnt(8)
M16 v[128:131],v[16:19],a[24:27],v[128:131]
DTR v[36:37],v11 offset:51200
buffer_load_dwordx4 v2, s[12:15], s61 offen offset:384 lds
s_add_u32 m0, s58, 6784
s_waitcnt vmcnt(31)
M16 v[132:135],v[16:19],a[28:31],v[132:135]
DTR v[38:39],v11 offset:51456
s_waitcnt lgkmcnt(8)
M16 v[136:139],v[20:23],a[24:27],v[136:139]
DTR v[40:41],v7 offset:51200
M16 v[140:143],v[20:23],a[28:31],v[140:143]
DTR v[42:43],v7 offset:51456
s_waitcnt lgkmcnt(8)
M16 v[144:147],v[24:27],a[24:27],v[144:147]
DTR v[16:17],v8 offset:51200
M16 v[148:151],v[24:27],a[28:31],v[148:151]
DTR v[18:19],v8 offset:51456
buffer_load_dwordx4 v3, s[12:15], s61 offen offset:384 lds
s_waitcnt lgkmcnt(8)
M16 v[152:155],v[28:31],a[24:27],v[152:155]
DTR v[20:21],v10 offset:53248
M16 v[156:159],v[28:31],a[28:31],v[156:159]
DTR v[22:23],v10 offset:53504
s_waitcnt lgkmcnt(8)
M16 v[160:163],v[32:35],a[24:27],v[160:163]
DTR v[24:25],v11 offset:53248
M16 v[164:167],v[32:35],a[28:31],v[164:167]
DTR v[26:27],v11 offset:53504
buffer_load_dwordx4 a[0:3], v14, s[8:11], s60 offen offset:0
s_waitcnt lgkmcnt(8)
M16 v[168:171],v[36:39],a[24:27],v[168:171]
DTR v[28:29],v7 offset:53248
M16 v[172:175],v[36:39],a[28:31],v[172:175]
DTR v[30:31],v7 offset:53504
s_waitcnt lgkmcnt(8)
M16 v[176:179],v[40:43],a[24:27],v[176:179]
DTR v[32:33],v8 offset:53248
M16 v[180:183],v[40:43],a[28:31],v[180:183]
DTR v[34:35],v8 offset:53504
s_waitcnt lgkmcnt(8)
M16 v[184:187],v[16:19],a[24:27],v[184:187]
DTR v[36:37],v10 offset:55296
buffer_load_dwordx4 a[4:7], v13, s[8:11], s60 offen offset:0
M16 v[188:191],v[16:19],a[28:31],v[188:191]
DTR v[38:39],v10 offset:55552
s_waitcnt lgkmcnt(8)
M16 v[192:195],v[20:23],a[24:27],v[192:195]
DTR v[40:41],v11 offset:55296
M16 v[196:199],v[20:23],a[28:31],v[196:199]
DTR v[42:43],v11 offset:55552
s_waitcnt lgkmcnt(8)
M16 v[200:203],v[24:27],a[24:27],v[200:203]
buffer_load_dwordx4 a[8:11], v14, s[8:11], s60 offen offset:1024
M16 v[204:207],v[24:27],a[28:31],v[204:207]
s_waitcnt lgkmcnt(6)
M16 v[208:211],v[28:31],a[24:27],v[208:211]
M16 v[212:215],v[28:31],a[28:31],v[212:215]
s_waitcnt lgkmcnt(0)
s_waitcnt vmcnt(27)
s_barrier
DTR v[16:17],v72 offset:0
DTR v[18:19],v72 offset:256
M16 v[216:219],v[32:35],a[24:27],v[216:219]
DTR v[20:21],v73 offset:0
DTR v[22:23],v73 offset:256
M16 v[220:223],v[32:35],a[28:31],v[220:223]
DTR v[24:25],v74 offset:0
DTR v[26:27],v74 offset:256
buffer_load_dwordx4 a[12:15], v13, s[8:11], s60 offen offset:1024
M16 v[224:227],v[36:39],a[24:27],v[224:227]
DTR v[28:29],v75 offset:0
DTR v[30:31],v75 offset:256
M16 v[228:231],v[36:39],a[28:31],v[228:231]
DTR v[32:33],v72 offset:2048
DTR v[34:35],v72 offset:2304
M16 v[232:235],v[40:43],a[24:27],v[232:235]
M16 v[236:239],v[40:43],a[28:31],v[236:239]
s_waitcnt vmcnt(27) lgkmcnt(8)
M16 v[128:131],v[16:19],a[32:35],v[128:131]
DTR v[36:37],v73 offset:2048
s_mul_i32 s61, s59, 458752
s_add_u32 s61, s61, s64
s_lshl_b32 s60, s59, 11
s_add_u32 s60, s60, s63
s_add_u32 s59, s59, 1
s_and_b32 s59, s59, 15
s_add_u32 m0, s58, 32768
s_waitcnt vmcnt(26)
M16 v[132:135],v[16:19],a[36:39],v[132:135]
DTR v[38:39],v73 offset:2304
buffer_load_dwordx4 v2, s[12:15], s61 offen offset:0 lds
s_add_u32 m0, s58, 33792
s_waitcnt lgkmcnt(8)
M16 v[136:139],v[20:23],a[32:35],v[136:139]
DTR v[40:41],v74 offset:2048
M16 v[140:143],v[20:23],a[36:39],v[140:143]
DTR v[42:43],v74 offset:2304
s_waitcnt lgkmcnt(8)
M16 v[144:147],v[24:27],a[32:35],v[144:147]
DTR v[16:17],v75 offset:2048
M16 v[148:151],v[24:27],a[36:39],v[148:151]
DTR v[18:19],v75 offset:2304
buffer_load_dwordx4 v3, s[12:15], s61 offen offset:0 lds
s_add_u32 m0, s58, 34688
s_waitcnt lgkmcnt(8)
M16 v[152:155],v[28:31],a[32:35],v[152:155]
DTR v[20:21],v72 offset:4096
M16 v[156:159],v[28:31],a[36:39],v[156:159]
DTR v[22:23],v72 offset:4352
s_waitcnt lgkmcnt(8)
M16 v[160:163],v[32:35],a[32:35],v[160:163]
DTR v[24:25],v73 offset:4096
M16 v[164:167],v[32:35],a[36:39],v[164:167]
DTR v[26:27],v73 offset:4352
s_waitcnt lgkmcnt(8)
M16 v[168:171],v[36:39],a[32:35],v[168:171]
DTR v[28:29],v74 offset:4096
buffer_load_dwordx4 v2, s[12:15], s61 offen offset:128 lds
s_add_u32 m0, s58, 35712
M16 v[172:175],v[36:39],a[36:39],v[172:175]
DTR v[30:31],v74 offset:4352
s_waitcnt lgkmcnt(8)
M16 v[176:179],v[40:43],a[32:35],v[176:179]
DTR v[32:33],v75 offset:4096
M16 v[180:183],v[40:43],a[36:39],v[180:183]
DTR v[34:35],v75 offset:4352
s_waitcnt lgkmcnt(8)
M16 v[184:187],v[16:19],a[32:35],v[184:187]
DTR v[36:37],v72 offset:6144
buffer_load_dwordx4 v3, s[12:15], s61 offen offset:128 lds
s_add_u32 m0, s58, 36608
M16 v[188:191],v[16:19],a[36:39],v[188:191]
DTR v[38:39],v72 offset:6400
s_waitcnt lgkmcnt(8)
M16 v[192:195],v[20:23],a[32:35],v[192:195]
DTR v[40:41],v73 offset:6144
M16 v[196:199],v[20:23],a[36:39],v[196:199]
DTR v[42:43],v73 offset:6400
s_waitcnt lgkmcnt(8)
M16 v[200:203],v[24:27],a[32:35],v[200:203]
DTR v[16:17],v72 offset:16384
M16 v[204:207],v[24:27],a[36:39],v[204:207]
DTR v[18:19],v72 offset:16640
buffer_load_dwordx4 v2, s[12:15], s61 offen offset:256 lds
s_add_u32 m0, s58, 37632
s_waitcnt lgkmcnt(8)
M16 v[208:211],v[28:31],a[32:35],v[208:211]
DTR v[20:21],v73 offset:16384
M16 v[212:215],v[28:31],a[36:39],v[212:215]
DTR v[22:23],v73 offset:16640
s_waitcnt lgkmcnt(8)
M16 v[216:219],v[32:35],a[32:35],v[216:219]
DTR v[24:25],v74 offset:16384
M16 v[220:223],v[32:35],a[36:39],v[220:223]
DTR v[26:27],v74 offset:16640
buffer_load_dwordx4 v3, s[12:15], s61 offen offset:256 lds
s_add_u32 m0, s58, 38528
s_waitcnt lgkmcnt(8)
M16 v[224:227],v[36:39],a[32:35],v[224:227]
DTR v[28:29],v75 offset:16384
M16 v[228:231],v[36:39],a[36:39],v[228:231]
DTR v[30:31],v75 offset:16640
s_waitcnt lgkmcnt(8)
M16 v[232:235],v[40:43],a[32:35],v[232:235]
DTR v[32:33],v72 offset:18432
M16 v[236:239],v[40:43],a[36:39],v[236:239]
DTR v[34:35],v72 offset:18688
s_waitcnt vmcnt(31) lgkmcnt(8)
M16 v[128:131],v[16:19],a[40:43],v[128:131]
DTR v[36:37],v73 offset:18432
buffer_load_dwordx4 v2, s[12:15], s61 offen offset:384 lds
s_add_u32 m0, s58, 39552
s_waitcnt vmcnt(31)
M16 v[132:135],v[16:19],a[44:47],v[132:135]
DTR v[38:39],v73 offset:18688
s_waitcnt lgkmcnt(8)
M16 v[136:139],v[20:23],a[40:43],v[136:139]
DTR v[40:41],v74 offset:18432
M16 v[140:143],v[20:23],a[44:47],v[140:143]
DTR v[42:43],v74 offset:18688
s_waitcnt lgkmcnt(8)
M16 v[144:147],v[24:27],a[40:43],v[144:147]
DTR v[16:17],v75 offset:18432
M16 v[148:151],v[24:27],a[44:47],v[148:151]
DTR v[18:19],v75 offset:18688
buffer_load_dwordx4 v3, s[12:15], s61 offen offset:384 lds
s_waitcnt lgkmcnt(8)
M16 v[152:155],v[28:31],a[40:43],v[152:155]
DTR v[20:21],v72 offset:20480
M16 v[156:159],v[28:31],a[44:47],v[156:159]
DTR v[22:23],v72 offset:20736
s_waitcnt lgkmcnt(8)
M16 v[160:163],v[32:35],a[40:43],v[160:163]
DTR v[24:25],v73 offset:20480
M16 v[164:167],v[32:35],a[44:47],v[164:167]
DTR v[26:27],v73 offset:20736
buffer_load_dwordx4 a[16:19], v14, s[8:11], s60 offen offset:0
s_waitcnt lgkmcnt(8)
M16 v[168:171],v[36:39],a[40:43],v[168:171]
DTR v[28:29],v74 offset:20480
M16 v[172:175],v[36:39],a[44:47],v[172:175]
DTR v[30:31],v74 offset:20736
s_waitcnt lgkmcnt(8)
M16 v[176:179],v[40:43],a[40:43],v[176:179]
DTR v[32:33],v75 offset:20480
M16 v[180:183],v[40:43],a[44:47],v[180:183]
DTR v[34:35],v75 offset:20736
s_waitcnt lgkmcnt(8)
M16 v[184:187],v[16:19],a[40:43],v[184:187]
DTR v[36:37],v72 offset:22528
buffer_load_dwordx4 a[20:23], v13, s[8:11], s60 offen offset:0
M16 v[188:191],v[16:19],a[44:47],v[188:191]
DTR v[38:39],v72 offset:22784
s_waitcnt lgkmcnt(8)
M16 v[192:195],v[20:23],a[40:43],v[192:195]
DTR v[40:41],v73 offset:22528
M16 v[196:199],v[20:23],a[44:47],v[196:199]
DTR v[42:43],v73 offset:22784
s_waitcnt lgkmcnt(8)
M16 v[200:203],v[24:27],a[40:43],v[200:203]
buffer_load_dwordx4 a[24:27], v14, s[8:11], s60 offen offset:1024
M16 v[204:207],v[24:27],a[44:47],v[204:207]
s_waitcnt lgkmcnt(6)
M16 v[208:211],v[28:31],a[40:43],v[208:211]
M16 v[212:215],v[28:31],a[44:47],v[212:215]
s_waitcnt lgkmcnt(0)
s_waitcnt vmcnt(27)
s_barrier
DTR v[16:17],v72 offset:32768
DTR v[18:19],v72 offset:33024
M16 v[216:219],v[32:35],a[40:43],v[216:219]
DTR v[20:21],v73 offset:32768
DTR v[22:23],v73 offset:33024
M16 v[220:223],v[32:35],a[44:47],v[220:223]
DTR v[24:25],v74 offset:32768
DTR v[26:27],v74 offset:33024
buffer_load_dwordx4 a[28:31], v13, s[8:11], s60 offen offset:1024
M16 v[224:227],v[36:39],a[40:43],v[224:227]
DTR v[28:29],v75 offset:32768
DTR v[30:31],v75 offset:33024
M16 v[228:231],v[36:39],a[44:47],v[228:231]
DTR v[32:33],v72 offset:34816
DTR v[34:35],v72 offset:35072
M16 v[232:235],v[40:43],a[40:43],v[232:235]
M16 v[236:239],v[40:43],a[44:47],v[236:239]
s_waitcnt vmcnt(27) lgkmcnt(8)
M16 v[128:131],v[16:19],a[48:51],v[128:131]
DTR v[36:37],v73 offset:34816
s_mul_i32 s61, s59, 458752
s_add_u32 s61, s61, s64
s_lshl_b32 s60, s59, 11
s_add_u32 s60, s60, s63
s_add_u32 s59, s59, 1
s_and_b32 s59, s59, 15
s_add_u32 m0, s58, 65536
s_waitcnt vmcnt(26)
M16 v[132:135],v[16:19],a[52:55],v[132:135]
DTR v[38:39],v73 offset:35072
buffer_load_dwordx4 v2, s[12:15], s61 offen offset:0 lds
s_add_u32 m0, s58, 66560
s_waitcnt lgkmcnt(8)
M16 v[136:139],v[20:23],a[48:51],v[136:139]
DTR v[40:41],v74 offset:34816
M16 v[140:143],v[20:23],a[52:55],v[140:143]
DTR v[42:43],v74 offset:35072
s_waitcnt lgkmcnt(8)
M16 v[144:147],v[24:27],a[48:51],v[144:147]
DTR v[16:17],v75 offset:34816
M16 v[148:151],v[24:27],a[52:55],v[148:151]
DTR v[18:19],v75 offset:35072
buffer_load_dwordx4 v3, s[12:15], s61 offen offset:0 lds
s_add_u32 m0, s58, 67456
s_waitcnt lgkmcnt(8)
M16 v[152:155],v[28:31],a[48:51],v[152:155]
DTR v[20:21],v72 offset:36864
M16 v[156:159],v[28:31],a[52:55],v[156:159]
DTR v[22:23],v72 offset:37120
s_waitcnt lgkmcnt(8)
M16 v[160:163],v[32:35],a[48:51],v[160:163]
DTR v[24:25],v73 offset:36864
M16 v[164:167],v[32:35],a[52:55],v[164:167]
DTR v[26:27],v73 offset:37120
s_waitcnt lgkmcnt(8)
M16 v[168:171],v[36:39],a[48:51],v[168:171]
DTR v[28:29],v74 offset:36864
buffer_load_dwordx4 v2, s[12:15], s61 offen offset:128 lds
s_add_u32 m0, s58, 68480
M16 v[172:175],v[36:39],a[52:55],v[172:175]
DTR v[30:31],v74 offset:37120
s_waitcnt lgkmcnt(8)
M16 v[176:179],v[40:43],a[48:51],v[176:179]
DTR v[32:33],v75 offset:36864
M16 v[180:183],v[40:43],a[52:55],v[180:183]
DTR v[34:35],v75 offset:37120
s_waitcnt lgkmcnt(8)
M16 v[184:187],v[16:19],a[48:51],v[184:187]
DTR v[36:37],v72 offset:38912
buffer_load_dwordx4 v3, s[12:15], s61 offen offset:128 lds
s_add_u32 m0, s58, 69376
M16 v[188:191],v[16:19],a[52:55],v[188:191]
DTR v[38:39],v72 offset:39168
s_waitcnt lgkmcnt(8)
M16 v[192:195],v[20:23],a[48:51],v[192:195]
DTR v[40:41],v73 offset:38912
M16 v[196:199],v[20:23],a[52:55],v[196:199]
DTR v[42:43],v73 offset:39168
s_waitcnt lgkmcnt(8)
M16 v[200:203],v[24:27],a[48:51],v[200:203]
DTR v[16:17],v72 offset:49152
M16 v[204:207],v[24:27],a[52:55],v[204:207]
DTR v[18:19],v72 offset:49408
buffer_load_dwordx4 v2, s[12:15], s61 offen offset:256 lds
s_add_u32 m0, s58, 70400
s_waitcnt lgkmcnt(8)
M16 v[208:211],v[28:31],a[48:51],v[208:211]
DTR v[20:21],v73 offset:49152
M16 v[212:215],v[28:31],a[52:55],v[212:215]
DTR v[22:23],v73 offset:49408
s_waitcnt lgkmcnt(8)
M16 v[216:219],v[32:35],a[48:51],v[216:219]
DTR v[24:25],v74 offset:49152
M16 v[220:223],v[32:35],a[52:55],v[220:223]
DTR v[26:27],v74 offset:49408
buffer_load_dwordx4 v3, s[12:15], s61 offen offset:256 lds
s_add_u32 m0, s58, 71296
s_waitcnt lgkmcnt(8)
M16 v[224:227],v[36:39],a[48:51],v[224:227]
DTR v[28:29],v75 offset:49152
M16 v[228:231],v[36:39],a[52:55],v[228:231]
DTR v[30:31],v75 offset:49408
s_waitcnt lgkmcnt(8)
M16 v[232:235],v[40:43],a[48:51],v[232:235]
DTR v[32:33],v72 offset:51200
M16 v[236:239],v[40:43],a[52:55],v[236:239]
DTR v[34:35],v72 offset:51456
s_waitcnt vmcnt(31) lgkmcnt(8)
M16 v[128:131],v[16:19],a[56:59],v[128:131]
DTR v[36:37],v73 offset:51200
buffer_load_dwordx4 v2, s[12:15], s61 offen offset:384 lds
s_add_u32 m0, s58, 72320
s_waitcnt vmcnt(31)
M16 v[132:135],v[16:19],a[60:63],v[132:135]
DTR v[38:39],v73 offset:51456
s_waitcnt lgkmcnt(8)
M16 v[136:139],v[20:23],a[56:59],v[136:139]
DTR v[40:41],v74 offset:51200
M16 v[140:143],v[20:23],a[60:63],v[140:143]
DTR v[42:43],v74 offset:51456
s_waitcnt lgkmcnt(8)
M16 v[144:147],v[24:27],a[56:59],v[144:147]
DTR v[16:17],v75 offset:51200
M16 v[148:151],v[24:27],a[60:63],v[148:151]
DTR v[18:19],v75 offset:51456
buffer_load_dwordx4 v3, s[12:15], s61 offen offset:384 lds
s_waitcnt lgkmcnt(8)
M16 v[152:155],v[28:31],a[56:59],v[152:155]
DTR v[20:21],v72 offset:53248
M16 v[156:159],v[28:31],a[60:63],v[156:159]
DTR v[22:23],v72 offset:53504
s_waitcnt lgkmcnt(8)
M16 v[160:163],v[32:35],a[56:59],v[160:163]
DTR v[24:25],v73 offset:53248
M16 v[164:167],v[32:35],a[60:63],v[164:167]
DTR v[26:27],v73 offset:53504
buffer_load_dwordx4 a[32:35], v14, s[8:11], s60 offen offset:0
s_waitcnt lgkmcnt(8)
M16 v[168:171],v[36:39],a[56:59],v[168:171]
DTR v[28:29],v74 offset:53248
M16 v[172:175],v[36:39],a[60:63],v[172:175]
DTR v[30:31],v74 offset:53504
s_waitcnt lgkmcnt(8)
M16 v[176:179],v[40:43],a[56:59],v[176:179]
DTR v[32:33],v75 offset:53248
M16 v[180:183],v[40:43],a[60:63],v[180:183]
DTR v[34:35],v75 offset:53504
s_waitcnt lgkmcnt(8)
M16 v[184:187],v[16:19],a[56:59],v[184:187]
DTR v[36:37],v72 offset:55296
buffer_load_dwordx4 a[36:39], v13, s[8:11], s60 offen offset:0
M16 v[188:191],v[16:19],a[60:63],v[188:191]
DTR v[38:39],v72 offset:55552
s_waitcnt lgkmcnt(8)
M16 v[192:195],v[20:23],a[56:59],v[192:195]
DTR v[40:41],v73 offset:55296
M16 v[196:199],v[20:23],a[60:63],v[196:199]
DTR v[42:43],v73 offset:55552
s_waitcnt lgkmcnt(8)
M16 v[200:203],v[24:27],a[56:59],v[200:203]
buffer_load_dwordx4 a[40:43], v14, s[8:11], s60 offen offset:1024
M16 v[204:207],v[24:27],a[60:63],v[204:207]
s_waitcnt lgkmcnt(6)
M16 v[208:211],v[28:31],a[56:59],v[208:211]
M16 v[212:215],v[28:31],a[60:63],v[212:215]
s_waitcnt lgkmcnt(0)
s_waitcnt vmcnt(27)
s_barrier
DTR v[16:17],v10 offset:0
DTR v[18:19],v10 offset:256
M16 v[216:219],v[32:35],a[56:59],v[216:219]
DTR v[20:21],v11 offset:0
DTR v[22:23],v11 offset:256
M16 v[220:223],v[32:35],a[60:63],v[220:223]
DTR v[24:25],v7 offset:0
DTR v[26:27],v7 offset:256
buffer_load_dwordx4 a[44:47], v13, s[8:11], s60 offen offset:1024
M16 v[224:227],v[36:39],a[56:59],v[224:227]
DTR v[28:29],v8 offset:0
DTR v[30:31],v8 offset:256
M16 v[228:231],v[36:39],a[60:63],v[228:231]
DTR v[32:33],v10 offset:2048
DTR v[34:35],v10 offset:2304
M16 v[232:235],v[40:43],a[56:59],v[232:235]
M16 v[236:239],v[40:43],a[60:63],v[236:239]
s_sub_u32 s66, s66, 1
s_cmp_lg_u32 s66, 0
s_cbranch_scc1 L_f1_lp
s_waitcnt vmcnt(27) lgkmcnt(8)
M16 v[128:131],v[16:19],a[0:3],v[128:131]
DTR v[36:37],v11 offset:2048
s_mul_i32 s61, s59, 458752
s_add_u32 s61, s61, s64
s_lshl_b32 s60, s59, 11
s_add_u32 s60, s60, s63
s_add_u32 s59, s59, 1
s_and_b32 s59, s59, 15
s_add_u32 m0, s58, 98304
s_waitcnt vmcnt(26)
M16 v[132:135],v[16:19],a[4:7],v[132:135]
DTR v[38:39],v11 offset:2304
buffer_load_dwordx4 v2, s[12:15], s61 offen offset:0 lds
s_add_u32 m0, s58, 99328
s_waitcnt lgkmcnt(8)
M16 v[136:139],v[20:23],a[0:3],v[136:139]
DTR v[40:41],v7 offset:2048
M16 v[140:143],v[20:23],a[4:7],v[140:143]
DTR v[42:43],v7 offset:2304
s_waitcnt lgkmcnt(8)
M16 v[144:147],v[24:27],a[0:3],v[144:147]
DTR v[16:17],v8 offset:2048
M16 v[148:151],v[24:27],a[4:7],v[148:151]
DTR v[18:19],v8 offset:2304
buffer_load_dwordx4 v3, s[12:15], s61 offen offset:0 lds
s_add_u32 m0, s58, 100224
s_waitcnt lgkmcnt(8)
M16 v[152:155],v[28:31],a[0:3],v[152:155]
DTR v[20:21],v10 offset:4096
M16 v[156:159],v[28:31],a[4:7],v[156:159]
DTR v[22:23],v10 offset:4352
s_waitcnt lgkmcnt(8)
M16 v[160:163],v[32:35],a[0:3],v[160:163]
DTR v[24:25],v11 offset:4096
M16 v[164:167],v[32:35],a[4:7],v[164:167]
DTR v[26:27],v11 offset:4352
s_waitcnt lgkmcnt(8)
M16 v[168:171],v[36:39],a[0:3],v[168:171]
DTR v[28:29],v7 offset:4096
buffer_load_dwordx4 v2, s[12:15], s61 offen offset:128 lds
s_add_u32 m0, s58, 101248
M16 v[172:175],v[36:39],a[4:7],v[172:175]
DTR v[30:31],v7 offset:4352
s_waitcnt lgkmcnt(8)
M16 v[176:179],v[40:43],a[0:3],v[176:179]
DTR v[32:33],v8 offset:4096
M16 v[180:183],v[40:43],a[4:7],v[180:183]
DTR v[34:35],v8 offset:4352
s_waitcnt lgkmcnt(8)
M16 v[184:187],v[16:19],a[0:3],v[184:187]
DTR v[36:37],v10 offset:6144
buffer_load_dwordx4 v3, s[12:15], s61 offen offset:128 lds
s_add_u32 m0, s58, 102144
M16 v[188:191],v[16:19],a[4:7],v[188:191]
DTR v[38:39],v10 offset:6400
s_waitcnt lgkmcnt(8)
M16 v[192:195],v[20:23],a[0:3],v[192:195]
DTR v[40:41],v11 offset:6144
M16 v[196:199],v[20:23],a[4:7],v[196:199]
DTR v[42:43],v11 offset:6400
s_waitcnt lgkmcnt(8)
M16 v[200:203],v[24:27],a[0:3],v[200:203]
DTR v[16:17],v10 offset:16384
M16 v[204:207],v[24:27],a[4:7],v[204:207]
DTR v[18:19],v10 offset:16640
buffer_load_dwordx4 v2, s[12:15], s61 offen offset:256 lds
s_add_u32 m0, s58, 103168
s_waitcnt lgkmcnt(8)
M16 v[208:211],v[28:31],a[0:3],v[208:211]
DTR v[20:21],v11 offset:16384
M16 v[212:215],v[28:31],a[4:7],v[212:215]
DTR v[22:23],v11 offset:16640
s_waitcnt lgkmcnt(8)
M16 v[216:219],v[32:35],a[0:3],v[216:219]
DTR v[24:25],v7 offset:16384
M16 v[220:223],v[32:35],a[4:7],v[220:223]
DTR v[26:27],v7 offset:16640
buffer_load_dwordx4 v3, s[12:15], s61 offen offset:256 lds
s_add_u32 m0, s58, 104064
s_waitcnt lgkmcnt(8)
M16 v[224:227],v[36:39],a[0:3],v[224:227]
DTR v[28:29],v8 offset:16384
M16 v[228:231],v[36:39],a[4:7],v[228:231]
DTR v[30:31],v8 offset:16640
s_waitcnt lgkmcnt(8)
M16 v[232:235],v[40:43],a[0:3],v[232:235]
DTR v[32:33],v10 offset:18432
M16 v[236:239],v[40:43],a[4:7],v[236:239]
DTR v[34:35],v10 offset:18688
s_waitcnt vmcnt(31) lgkmcnt(8)
M16 v[128:131],v[16:19],a[8:11],v[128:131]
DTR v[36:37],v11 offset:18432
buffer_load_dwordx4 v2, s[12:15], s61 offen offset:384 lds
s_add_u32 m0, s58, 105088
s_waitcnt vmcnt(31)
M16 v[132:135],v[16:19],a[12:15],v[132:135]
DTR v[38:39],v11 offset:18688
s_waitcnt lgkmcnt(8)
M16 v[136:139],v[20:23],a[8:11],v[136:139]
DTR v[40:41],v7 offset:18432
M16 v[140:143],v[20:23],a[12:15],v[140:143]
DTR v[42:43],v7 offset:18688
s_waitcnt lgkmcnt(8)
M16 v[144:147],v[24:27],a[8:11],v[144:147]
DTR v[16:17],v8 offset:18432
M16 v[148:151],v[24:27],a[12:15],v[148:151]
DTR v[18:19],v8 offset:18688
buffer_load_dwordx4 v3, s[12:15], s61 offen offset:384 lds
s_waitcnt lgkmcnt(8)
M16 v[152:155],v[28:31],a[8:11],v[152:155]
DTR v[20:21],v10 offset:20480
M16 v[156:159],v[28:31],a[12:15],v[156:159]
DTR v[22:23],v10 offset:20736
s_waitcnt lgkmcnt(8)
M16 v[160:163],v[32:35],a[8:11],v[160:163]
DTR v[24:25],v11 offset:20480
M16 v[164:167],v[32:35],a[12:15],v[164:167]
DTR v[26:27],v11 offset:20736
buffer_load_dwordx4 a[48:51], v14, s[8:11], s60 offen offset:0
s_waitcnt lgkmcnt(8)
M16 v[168:171],v[36:39],a[8:11],v[168:171]
DTR v[28:29],v7 offset:20480
M16 v[172:175],v[36:39],a[12:15],v[172:175]
DTR v[30:31],v7 offset:20736
s_waitcnt lgkmcnt(8)
M16 v[176:179],v[40:43],a[8:11],v[176:179]
DTR v[32:33],v8 offset:20480
M16 v[180:183],v[40:43],a[12:15],v[180:183]
DTR v[34:35],v8 offset:20736
s_waitcnt lgkmcnt(8)
M16 v[184:187],v[16:19],a[8:11],v[184:187]
DTR v[36:37],v10 offset:22528
buffer_load_dwordx4 a[52:55], v13, s[8:11], s60 offen offset:0
M16 v[188:191],v[16:19],a[12:15],v[188:191]
DTR v[38:39],v10 offset:22784
s_waitcnt lgkmcnt(8)
M16 v[192:195],v[20:23],a[8:11],v[192:195]
DTR v[40:41],v11 offset:22528
M16 v[196:199],v[20:23],a[12:15],v[196:199]
DTR v[42:43],v11 offset:22784
s_waitcnt lgkmcnt(8)
M16 v[200:203],v[24:27],a[8:11],v[200:203]
buffer_load_dwordx4 a[56:59], v14, s[8:11], s60 offen offset:1024
M16 v[204:207],v[24:27],a[12:15],v[204:207]
s_waitcnt lgkmcnt(6)
M16 v[208:211],v[28:31],a[8:11],v[208:211]
M16 v[212:215],v[28:31],a[12:15],v[212:215]
s_waitcnt lgkmcnt(0)
s_waitcnt vmcnt(27)
s_barrier
DTR v[16:17],v10 offset:32768
DTR v[18:19],v10 offset:33024
M16 v[216:219],v[32:35],a[8:11],v[216:219]
DTR v[20:21],v11 offset:32768
DTR v[22:23],v11 offset:33024
M16 v[220:223],v[32:35],a[12:15],v[220:223]
DTR v[24:25],v7 offset:32768
DTR v[26:27],v7 offset:33024
buffer_load_dwordx4 a[60:63], v13, s[8:11], s60 offen offset:1024
M16 v[224:227],v[36:39],a[8:11],v[224:227]
DTR v[28:29],v8 offset:32768
DTR v[30:31],v8 offset:33024
M16 v[228:231],v[36:39],a[12:15],v[228:231]
DTR v[32:33],v10 offset:34816
DTR v[34:35],v10 offset:35072
M16 v[232:235],v[40:43],a[8:11],v[232:235]
M16 v[236:239],v[40:43],a[12:15],v[236:239]
s_waitcnt vmcnt(27) lgkmcnt(8)
M16 v[128:131],v[16:19],a[16:19],v[128:131]
DTR v[36:37],v11 offset:34816
s_waitcnt vmcnt(26)
M16 v[132:135],v[16:19],a[20:23],v[132:135]
DTR v[38:39],v11 offset:35072
FAD v48,v48,v50
FAD v49,v49,v51
FAD v52,v52,v54
s_waitcnt lgkmcnt(8)
M16 v[136:139],v[20:23],a[16:19],v[136:139]
DTR v[40:41],v7 offset:34816
M16 v[140:143],v[20:23],a[20:23],v[140:143]
DTR v[42:43],v7 offset:35072
s_waitcnt lgkmcnt(8)
M16 v[144:147],v[24:27],a[16:19],v[144:147]
DTR v[16:17],v8 offset:34816
FAD v53,v53,v55
FAD v48,v48,v52
FAD v49,v49,v53
ds_write_b32 v44, v48
M16 v[148:151],v[24:27],a[20:23],v[148:151]
DTR v[18:19],v8 offset:35072
s_waitcnt lgkmcnt(9)
M16 v[152:155],v[28:31],a[16:19],v[152:155]
DTR v[20:21],v10 offset:36864
M16 v[156:159],v[28:31],a[20:23],v[156:159]
DTR v[22:23],v10 offset:37120
ds_write_b32 v44, v49 offset:896
FAD v56,v56,v58
FAD v57,v57,v59
s_waitcnt lgkmcnt(10)
M16 v[160:163],v[32:35],a[16:19],v[160:163]
DTR v[24:25],v11 offset:36864
M16 v[164:167],v[32:35],a[20:23],v[164:167]
DTR v[26:27],v11 offset:37120
s_waitcnt lgkmcnt(10)
M16 v[168:171],v[36:39],a[16:19],v[168:171]
DTR v[28:29],v7 offset:36864
FAD v60,v60,v62
FAD v61,v61,v63
FAD v56,v56,v60
FAD v57,v57,v61
M16 v[172:175],v[36:39],a[20:23],v[172:175]
DTR v[30:31],v7 offset:37120
s_waitcnt lgkmcnt(10)
M16 v[176:179],v[40:43],a[16:19],v[176:179]
DTR v[32:33],v8 offset:36864
M16 v[180:183],v[40:43],a[20:23],v[180:183]
DTR v[34:35],v8 offset:37120
FAD v64,v64,v66
FAD v65,v65,v67
FAD v68,v68,v70
s_waitcnt lgkmcnt(9)
M16 v[184:187],v[16:19],a[16:19],v[184:187]
DTR v[36:37],v10 offset:38912
M16 v[188:191],v[16:19],a[20:23],v[188:191]
DTR v[38:39],v10 offset:39168
s_waitcnt lgkmcnt(9)
M16 v[192:195],v[20:23],a[16:19],v[192:195]
DTR v[40:41],v11 offset:38912
FAD v69,v69,v71
FAD v64,v64,v68
FAD v65,v65,v69
v_mov_b32 v58, v56
M16 v[196:199],v[20:23],a[20:23],v[196:199]
DTR v[42:43],v11 offset:39168
s_waitcnt lgkmcnt(8)
M16 v[200:203],v[24:27],a[16:19],v[200:203]
DTR v[16:17],v10 offset:49152
M16 v[204:207],v[24:27],a[20:23],v[204:207]
DTR v[18:19],v10 offset:49408
v_mov_b32 v59, v57
v_mov_b32 v66, v64
v_mov_b32 v67, v65
s_waitcnt lgkmcnt(8)
M16 v[208:211],v[28:31],a[16:19],v[208:211]
DTR v[20:21],v11 offset:49152
M16 v[212:215],v[28:31],a[20:23],v[212:215]
DTR v[22:23],v11 offset:49408
s_waitcnt lgkmcnt(8)
M16 v[216:219],v[32:35],a[16:19],v[216:219]
DTR v[24:25],v7 offset:49152
v_permlane32_swap_b32 v56, v58
v_permlane32_swap_b32 v57, v59
v_permlane32_swap_b32 v64, v66
v_permlane32_swap_b32 v65, v67
M16 v[220:223],v[32:35],a[20:23],v[220:223]
DTR v[26:27],v7 offset:49408
s_waitcnt lgkmcnt(8)
M16 v[224:227],v[36:39],a[16:19],v[224:227]
DTR v[28:29],v8 offset:49152
M16 v[228:231],v[36:39],a[20:23],v[228:231]
DTR v[30:31],v8 offset:49408
FAD v56,v56,v58
FAD v57,v57,v59
FAD v64,v64,v66
s_waitcnt lgkmcnt(8)
M16 v[232:235],v[40:43],a[16:19],v[232:235]
DTR v[32:33],v10 offset:51200
M16 v[236:239],v[40:43],a[20:23],v[236:239]
DTR v[34:35],v10 offset:51456
s_waitcnt vmcnt(25) lgkmcnt(8)
M16 v[128:131],v[16:19],a[24:27],v[128:131]
DTR v[36:37],v11 offset:51200
FAD v65,v65,v67
v_mov_b32 v58, v56
v_mov_b32 v59, v57
v_mov_b32 v66, v64
s_waitcnt vmcnt(24)
M16 v[132:135],v[16:19],a[28:31],v[132:135]
DTR v[38:39],v11 offset:51456
s_waitcnt lgkmcnt(8)
M16 v[136:139],v[20:23],a[24:27],v[136:139]
DTR v[40:41],v7 offset:51200
M16 v[140:143],v[20:23],a[28:31],v[140:143]
DTR v[42:43],v7 offset:51456
v_mov_b32 v67, v65
v_permlane16_swap_b32 v56, v58
v_permlane16_swap_b32 v57, v59
s_waitcnt lgkmcnt(8)
M16 v[144:147],v[24:27],a[24:27],v[144:147]
DTR v[16:17],v8 offset:51200
M16 v[148:151],v[24:27],a[28:31],v[148:151]
DTR v[18:19],v8 offset:51456
s_waitcnt lgkmcnt(8)
M16 v[152:155],v[28:31],a[24:27],v[152:155]
DTR v[20:21],v10 offset:53248
v_permlane16_swap_b32 v64, v66
v_permlane16_swap_b32 v65, v67
FAD v56,v56,v58
FAD v57,v57,v59
M16 v[156:159],v[28:31],a[28:31],v[156:159]
DTR v[22:23],v10 offset:53504
s_waitcnt lgkmcnt(8)
M16 v[160:163],v[32:35],a[24:27],v[160:163]
DTR v[24:25],v11 offset:53248
M16 v[164:167],v[32:35],a[28:31],v[164:167]
DTR v[26:27],v11 offset:53504
FAD v64,v64,v66
FAD v65,v65,v67
FML v80,0xba800000,v56
s_waitcnt lgkmcnt(8)
M16 v[168:171],v[36:39],a[24:27],v[168:171]
DTR v[28:29],v7 offset:53248
M16 v[172:175],v[36:39],a[28:31],v[172:175]
DTR v[30:31],v7 offset:53504
s_waitcnt lgkmcnt(8)
M16 v[176:179],v[40:43],a[24:27],v[176:179]
DTR v[32:33],v8 offset:53248
FML v57,0x3a800000,v57
v_fma_f32 v57, -v80, v80, v57
v_max_f32 v57, 0, v57
FAD v57,0x3727c5ac,v57
M16 v[180:183],v[40:43],a[28:31],v[180:183]
DTR v[34:35],v8 offset:53504
s_waitcnt lgkmcnt(8)
M16 v[184:187],v[16:19],a[24:27],v[184:187]
DTR v[36:37],v10 offset:55296
M16 v[188:191],v[16:19],a[28:31],v[188:191]
DTR v[38:39],v10 offset:55552
v_rsq_f32 v82, v57
FML v84,0xba800000,v64
FML v65,0x3a800000,v65
s_waitcnt lgkmcnt(8)
M16 v[192:195],v[20:23],a[24:27],v[192:195]
DTR v[40:41],v11 offset:55296
M16 v[196:199],v[20:23],a[28:31],v[196:199]
DTR v[42:43],v11 offset:55552
s_waitcnt lgkmcnt(8)
M16 v[200:203],v[24:27],a[24:27],v[200:203]
v_fma_f32 v65, -v84, v84, v65
v_max_f32 v65, 0, v65
FAD v65,0x3727c5ac,v65
v_rsq_f32 v86, v65
M16 v[204:207],v[24:27],a[28:31],v[204:207]
s_waitcnt lgkmcnt(6)
M16 v[208:211],v[28:31],a[24:27],v[208:211]
M16 v[212:215],v[28:31],a[28:31],v[212:215]
s_waitcnt lgkmcnt(0)
s_waitcnt vmcnt(4)
s_barrier
DTR v[16:17],v72 offset:0
DTR v[18:19],v72 offset:256
M16 v[216:219],v[32:35],a[24:27],v[216:219]
DTR v[20:21],v72 offset:16384
DTR v[22:23],v72 offset:16640
M16 v[220:223],v[32:35],a[28:31],v[220:223]
DTR v[24:25],v72 offset:32768
DTR v[26:27],v72 offset:33024
M16 v[224:227],v[36:39],a[24:27],v[224:227]
DTR v[28:29],v72 offset:49152
DTR v[30:31],v72 offset:49408
M16 v[228:231],v[36:39],a[28:31],v[228:231]
DTR v[32:33],v73 offset:0
DTR v[34:35],v73 offset:256
M16 v[232:235],v[40:43],a[24:27],v[232:235]
M16 v[236:239],v[40:43],a[28:31],v[236:239]
s_waitcnt lgkmcnt(8)
M16 v[128:131],v[16:19],a[32:35],v[128:131]
DTR v[36:37],v73 offset:16384
M16 v[132:135],v[16:19],a[36:39],v[132:135]
DTR v[38:39],v73 offset:16640
s_waitcnt lgkmcnt(8)
M16 v[128:131],v[20:23],a[40:43],v[128:131]
DTR v[40:41],v73 offset:32768
M16 v[132:135],v[20:23],a[44:47],v[132:135]
DTR v[42:43],v73 offset:33024
s_waitcnt vmcnt(3) lgkmcnt(8)
M16 v[128:131],v[24:27],a[48:51],v[128:131]
DTR v[16:17],v73 offset:49152
s_waitcnt vmcnt(2)
M16 v[132:135],v[24:27],a[52:55],v[132:135]
DTR v[18:19],v73 offset:49408
s_waitcnt vmcnt(1) lgkmcnt(8)
M16 v[128:131],v[28:31],a[56:59],v[128:131]
DTR v[20:21],v74 offset:0
s_waitcnt vmcnt(0)
M16 v[132:135],v[28:31],a[60:63],v[132:135]
DTR v[22:23],v74 offset:256
s_waitcnt lgkmcnt(8)
M16 v[136:139],v[32:35],a[32:35],v[136:139]
DTR v[24:25],v74 offset:16384
DR4 v[88:91],v46 offset:0
M16 v[140:143],v[32:35],a[36:39],v[140:143]
DTR v[26:27],v74 offset:16640
s_waitcnt lgkmcnt(9)
M16 v[136:139],v[36:39],a[40:43],v[136:139]
DTR v[28:29],v74 offset:32768
DR4 v[92:95],v46 offset:896
M16 v[140:143],v[36:39],a[44:47],v[140:143]
DTR v[30:31],v74 offset:33024
s_waitcnt lgkmcnt(10)
M16 v[136:139],v[40:43],a[48:51],v[136:139]
DTR v[32:33],v74 offset:49152
DR4 v[96:99],v46 offset:64
M16 v[140:143],v[40:43],a[52:55],v[140:143]
DTR v[34:35],v74 offset:49408
s_waitcnt lgkmcnt(11)
M16 v[136:139],v[16:19],a[56:59],v[136:139]
DTR v[36:37],v75 offset:0
DR4 v[100:103],v46 offset:960
M16 v[140:143],v[16:19],a[60:63],v[140:143]
DTR v[38:39],v75 offset:256
s_waitcnt lgkmcnt(12)
M16 v[144:147],v[20:23],a[32:35],v[144:147]
DTR v[40:41],v75 offset:16384
M16 v[148:151],v[20:23],a[36:39],v[148:151]
DTR v[42:43],v75 offset:16640
s_waitcnt lgkmcnt(12)
v_fmac_f32 v128, v88, v80
v_fmac_f32 v129, v89, v80
v_fmac_f32 v130, v90, v80
v_fmac_f32 v131, v91, v80
s_waitcnt lgkmcnt(11)
M16 v[144:147],v[24:27],a[40:43],v[144:147]
DTR v[16:17],v75 offset:32768
s_waitcnt lgkmcnt(10)
v_fma_f32 v128, v128, v82, v92
v_fma_f32 v129, v129, v82, v93
v_fma_f32 v130, v130, v82, v94
v_fma_f32 v131, v131, v82, v95
M16 v[148:151],v[24:27],a[44:47],v[148:151]
DTR v[18:19],v75 offset:33024
v_max_f32 v128, 0, v128
v_max_f32 v129, 0, v129
v_max_f32 v130, 0, v130
v_max_f32 v131, 0, v131
s_waitcnt lgkmcnt(10)
M16 v[144:147],v[28:31],a[48:51],v[144:147]
DTR v[20:21],v75 offset:49152
CVT v48,v128,v129
CVT v49,v130,v131
s_waitcnt lgkmcnt(9)
v_fmac_f32 v136, v96, v80
v_fmac_f32 v137, v97, v80
M16 v[148:151],v[28:31],a[52:55],v[148:151]
DTR v[22:23],v75 offset:49408
v_fmac_f32 v138, v98, v80
v_fmac_f32 v139, v99, v80
s_waitcnt lgkmcnt(7)
v_fma_f32 v136, v136, v82, v100
v_fma_f32 v137, v137, v82, v101
M16 v[144:147],v[32:35],a[56:59],v[144:147]
DTR v[24:25],v72 offset:2048
v_fma_f32 v138, v138, v82, v102
v_fma_f32 v139, v139, v82, v103
v_max_f32 v136, 0, v136
v_max_f32 v137, 0, v137
M16 v[148:151],v[32:35],a[60:63],v[148:151]
DTR v[26:27],v72 offset:2304
v_max_f32 v138, 0, v138
v_max_f32 v139, 0, v139
CVT v50,v136,v137
CVT v51,v138,v139
s_waitcnt lgkmcnt(8)
M16 v[152:155],v[36:39],a[32:35],v[152:155]
DTR v[28:29],v72 offset:18432
buffer_store_dwordx4 v[48:51], v14, s[20:23], s65 offen offset:0 sc1
v_fmac_f32 v132, v88, v84
v_fmac_f32 v133, v89, v84
DR4 v[104:107],v46 offset:128
M16 v[156:159],v[36:39],a[36:39],v[156:159]
DTR v[30:31],v72 offset:18688
v_fmac_f32 v134, v90, v84
v_fmac_f32 v135, v91, v84
v_fma_f32 v132, v132, v86, v92
v_fma_f32 v133, v133, v86, v93
s_waitcnt lgkmcnt(9)
M16 v[152:155],v[40:43],a[40:43],v[152:155]
DTR v[32:33],v72 offset:34816
v_fma_f32 v134, v134, v86, v94
v_fma_f32 v135, v135, v86, v95
v_max_f32 v132, 0, v132
v_max_f32 v133, 0, v133
DR4 v[108:111],v46 offset:1024
M16 v[156:159],v[40:43],a[44:47],v[156:159]
DTR v[34:35],v72 offset:35072
v_max_f32 v134, 0, v134
v_max_f32 v135, 0, v135
CVT v52,v132,v133
CVT v53,v134,v135
s_waitcnt lgkmcnt(10)
M16 v[152:155],v[16:19],a[48:51],v[152:155]
DTR v[36:37],v72 offset:51200
v_fmac_f32 v140, v96, v84
v_fmac_f32 v141, v97, v84
v_fmac_f32 v142, v98, v84
v_fmac_f32 v143, v99, v84
DR4 v[112:115],v46 offset:192
M16 v[156:159],v[16:19],a[52:55],v[156:159]
DTR v[38:39],v72 offset:51456
v_fma_f32 v140, v140, v86, v100
v_fma_f32 v141, v141, v86, v101
v_fma_f32 v142, v142, v86, v102
v_fma_f32 v143, v143, v86, v103
s_waitcnt lgkmcnt(11)
M16 v[152:155],v[20:23],a[56:59],v[152:155]
DTR v[40:41],v73 offset:2048
v_max_f32 v140, 0, v140
v_max_f32 v141, 0, v141
v_max_f32 v142, 0, v142
v_max_f32 v143, 0, v143
DR4 v[116:119],v46 offset:1088
M16 v[156:159],v[20:23],a[60:63],v[156:159]
DTR v[42:43],v73 offset:2304
CVT v54,v140,v141
CVT v55,v142,v143
buffer_store_dwordx4 v[52:55], v12, s[20:23], s65 offen offset:0 sc1
s_waitcnt lgkmcnt(12)
M16 v[160:163],v[24:27],a[32:35],v[160:163]
DTR v[16:17],v73 offset:18432
M16 v[164:167],v[24:27],a[36:39],v[164:167]
DTR v[18:19],v73 offset:18688
s_waitcnt lgkmcnt(12)
v_fmac_f32 v144, v104, v80
v_fmac_f32 v145, v105, v80
v_fmac_f32 v146, v106, v80
v_fmac_f32 v147, v107, v80
s_waitcnt lgkmcnt(11)
M16 v[160:163],v[28:31],a[40:43],v[160:163]
DTR v[20:21],v73 offset:34816
s_waitcnt lgkmcnt(10)
v_fma_f32 v144, v144, v82, v108
v_fma_f32 v145, v145, v82, v109
v_fma_f32 v146, v146, v82, v110
v_fma_f32 v147, v147, v82, v111
M16 v[164:167],v[28:31],a[44:47],v[164:167]
DTR v[22:23],v73 offset:35072
v_max_f32 v144, 0, v144
v_max_f32 v145, 0, v145
v_max_f32 v146, 0, v146
v_max_f32 v147, 0, v147
s_waitcnt lgkmcnt(10)
M16 v[160:163],v[32:35],a[48:51],v[160:163]
DTR v[24:25],v73 offset:51200
CVT v56,v144,v145
CVT v57,v146,v147
s_waitcnt lgkmcnt(9)
v_fmac_f32 v152, v112, v80
v_fmac_f32 v153, v113, v80
M16 v[164:167],v[32:35],a[52:55],v[164:167]
DTR v[26:27],v73 offset:51456
v_fmac_f32 v154, v114, v80
v_fmac_f32 v155, v115, v80
s_waitcnt lgkmcnt(7)
v_fma_f32 v152, v152, v82, v116
v_fma_f32 v153, v153, v82, v117
M16 v[160:163],v[36:39],a[56:59],v[160:163]
DTR v[28:29],v74 offset:2048
v_fma_f32 v154, v154, v82, v118
v_fma_f32 v155, v155, v82, v119
v_max_f32 v152, 0, v152
v_max_f32 v153, 0, v153
M16 v[164:167],v[36:39],a[60:63],v[164:167]
DTR v[30:31],v74 offset:2304
v_max_f32 v154, 0, v154
v_max_f32 v155, 0, v155
CVT v58,v152,v153
CVT v59,v154,v155
s_waitcnt lgkmcnt(8)
M16 v[168:171],v[40:43],a[32:35],v[168:171]
DTR v[32:33],v74 offset:18432
buffer_store_dwordx4 v[56:59], v14, s[20:23], s65 offen offset:1024 sc1
v_fmac_f32 v148, v104, v84
v_fmac_f32 v149, v105, v84
DR4 v[88:91],v46 offset:256
M16 v[172:175],v[40:43],a[36:39],v[172:175]
DTR v[34:35],v74 offset:18688
v_fmac_f32 v150, v106, v84
v_fmac_f32 v151, v107, v84
v_fma_f32 v148, v148, v86, v108
v_fma_f32 v149, v149, v86, v109
s_waitcnt lgkmcnt(9)
M16 v[168:171],v[16:19],a[40:43],v[168:171]
DTR v[36:37],v74 offset:34816
v_fma_f32 v150, v150, v86, v110
v_fma_f32 v151, v151, v86, v111
v_max_f32 v148, 0, v148
v_max_f32 v149, 0, v149
DR4 v[92:95],v46 offset:1152
M16 v[172:175],v[16:19],a[44:47],v[172:175]
DTR v[38:39],v74 offset:35072
v_max_f32 v150, 0, v150
v_max_f32 v151, 0, v151
CVT v60,v148,v149
CVT v61,v150,v151
s_waitcnt lgkmcnt(10)
M16 v[168:171],v[20:23],a[48:51],v[168:171]
DTR v[40:41],v74 offset:51200
v_fmac_f32 v156, v112, v84
v_fmac_f32 v157, v113, v84
v_fmac_f32 v158, v114, v84
v_fmac_f32 v159, v115, v84
DR4 v[96:99],v46 offset:320
M16 v[172:175],v[20:23],a[52:55],v[172:175]
DTR v[42:43],v74 offset:51456
v_fma_f32 v156, v156, v86, v116
v_fma_f32 v157, v157, v86, v117
v_fma_f32 v158, v158, v86, v118
v_fma_f32 v159, v159, v86, v119
s_waitcnt lgkmcnt(11)
M16 v[168:171],v[24:27],a[56:59],v[168:171]
DTR v[16:17],v75 offset:2048
v_max_f32 v156, 0, v156
v_max_f32 v157, 0, v157
v_max_f32 v158, 0, v158
v_max_f32 v159, 0, v159
DR4 v[100:103],v46 offset:1216
M16 v[172:175],v[24:27],a[60:63],v[172:175]
DTR v[18:19],v75 offset:2304
CVT v62,v156,v157
CVT v63,v158,v159
buffer_store_dwordx4 v[60:63], v12, s[20:23], s65 offen offset:1024 sc1
s_waitcnt lgkmcnt(12)
M16 v[176:179],v[28:31],a[32:35],v[176:179]
DTR v[20:21],v75 offset:18432
M16 v[180:183],v[28:31],a[36:39],v[180:183]
DTR v[22:23],v75 offset:18688
s_waitcnt lgkmcnt(12)
v_fmac_f32 v160, v88, v80
v_fmac_f32 v161, v89, v80
v_fmac_f32 v162, v90, v80
v_fmac_f32 v163, v91, v80
s_waitcnt lgkmcnt(11)
M16 v[176:179],v[32:35],a[40:43],v[176:179]
DTR v[24:25],v75 offset:34816
s_waitcnt lgkmcnt(10)
v_fma_f32 v160, v160, v82, v92
v_fma_f32 v161, v161, v82, v93
v_fma_f32 v162, v162, v82, v94
v_fma_f32 v163, v163, v82, v95
M16 v[180:183],v[32:35],a[44:47],v[180:183]
DTR v[26:27],v75 offset:35072
v_max_f32 v160, 0, v160
v_max_f32 v161, 0, v161
v_max_f32 v162, 0, v162
v_max_f32 v163, 0, v163
s_waitcnt lgkmcnt(10)
M16 v[176:179],v[36:39],a[48:51],v[176:179]
DTR v[28:29],v75 offset:51200
CVT v48,v160,v161
CVT v49,v162,v163
s_waitcnt lgkmcnt(9)
v_fmac_f32 v168, v96, v80
v_fmac_f32 v169, v97, v80
M16 v[180:183],v[36:39],a[52:55],v[180:183]
DTR v[30:31],v75 offset:51456
v_fmac_f32 v170, v98, v80
v_fmac_f32 v171, v99, v80
s_waitcnt lgkmcnt(7)
v_fma_f32 v168, v168, v82, v100
v_fma_f32 v169, v169, v82, v101
M16 v[176:179],v[40:43],a[56:59],v[176:179]
DTR v[32:33],v72 offset:4096
v_fma_f32 v170, v170, v82, v102
v_fma_f32 v171, v171, v82, v103
v_max_f32 v168, 0, v168
v_max_f32 v169, 0, v169
M16 v[180:183],v[40:43],a[60:63],v[180:183]
DTR v[34:35],v72 offset:4352
v_max_f32 v170, 0, v170
v_max_f32 v171, 0, v171
CVT v50,v168,v169
CVT v51,v170,v171
s_waitcnt lgkmcnt(8)
M16 v[184:187],v[16:19],a[32:35],v[184:187]
DTR v[36:37],v72 offset:20480
buffer_store_dwordx4 v[48:51], v14, s[20:23], s65 offen offset:2048 sc1
v_fmac_f32 v164, v88, v84
v_fmac_f32 v165, v89, v84
DR4 v[104:107],v46 offset:384
M16 v[188:191],v[16:19],a[36:39],v[188:191]
DTR v[38:39],v72 offset:20736
v_fmac_f32 v166, v90, v84
v_fmac_f32 v167, v91, v84
v_fma_f32 v164, v164, v86, v92
v_fma_f32 v165, v165, v86, v93
s_waitcnt lgkmcnt(9)
M16 v[184:187],v[20:23],a[40:43],v[184:187]
DTR v[40:41],v72 offset:36864
v_fma_f32 v166, v166, v86, v94
v_fma_f32 v167, v167, v86, v95
v_max_f32 v164, 0, v164
v_max_f32 v165, 0, v165
DR4 v[108:111],v46 offset:1280
M16 v[188:191],v[20:23],a[44:47],v[188:191]
DTR v[42:43],v72 offset:37120
v_max_f32 v166, 0, v166
v_max_f32 v167, 0, v167
CVT v52,v164,v165
CVT v53,v166,v167
s_waitcnt lgkmcnt(10)
M16 v[184:187],v[24:27],a[48:51],v[184:187]
DTR v[16:17],v72 offset:53248
v_fmac_f32 v172, v96, v84
v_fmac_f32 v173, v97, v84
v_fmac_f32 v174, v98, v84
v_fmac_f32 v175, v99, v84
DR4 v[112:115],v46 offset:448
M16 v[188:191],v[24:27],a[52:55],v[188:191]
DTR v[18:19],v72 offset:53504
v_fma_f32 v172, v172, v86, v100
v_fma_f32 v173, v173, v86, v101
v_fma_f32 v174, v174, v86, v102
v_fma_f32 v175, v175, v86, v103
s_waitcnt lgkmcnt(11)
M16 v[184:187],v[28:31],a[56:59],v[184:187]
DTR v[20:21],v73 offset:4096
v_max_f32 v172, 0, v172
v_max_f32 v173, 0, v173
v_max_f32 v174, 0, v174
v_max_f32 v175, 0, v175
DR4 v[116:119],v46 offset:1344
M16 v[188:191],v[28:31],a[60:63],v[188:191]
DTR v[22:23],v73 offset:4352
CVT v54,v172,v173
CVT v55,v174,v175
buffer_store_dwordx4 v[52:55], v12, s[20:23], s65 offen offset:2048 sc1
s_waitcnt lgkmcnt(12)
M16 v[192:195],v[32:35],a[32:35],v[192:195]
DTR v[24:25],v73 offset:20480
M16 v[196:199],v[32:35],a[36:39],v[196:199]
DTR v[26:27],v73 offset:20736
s_waitcnt lgkmcnt(12)
v_fmac_f32 v176, v104, v80
v_fmac_f32 v177, v105, v80
v_fmac_f32 v178, v106, v80
v_fmac_f32 v179, v107, v80
s_waitcnt lgkmcnt(11)
M16 v[192:195],v[36:39],a[40:43],v[192:195]
DTR v[28:29],v73 offset:36864
s_waitcnt lgkmcnt(10)
v_fma_f32 v176, v176, v82, v108
v_fma_f32 v177, v177, v82, v109
v_fma_f32 v178, v178, v82, v110
v_fma_f32 v179, v179, v82, v111
M16 v[196:199],v[36:39],a[44:47],v[196:199]
DTR v[30:31],v73 offset:37120
v_max_f32 v176, 0, v176
v_max_f32 v177, 0, v177
v_max_f32 v178, 0, v178
v_max_f32 v179, 0, v179
s_waitcnt lgkmcnt(10)
M16 v[192:195],v[40:43],a[48:51],v[192:195]
DTR v[32:33],v73 offset:53248
CVT v56,v176,v177
CVT v57,v178,v179
s_waitcnt lgkmcnt(9)
v_fmac_f32 v184, v112, v80
v_fmac_f32 v185, v113, v80
M16 v[196:199],v[40:43],a[52:55],v[196:199]
DTR v[34:35],v73 offset:53504
v_fmac_f32 v186, v114, v80
v_fmac_f32 v187, v115, v80
s_waitcnt lgkmcnt(7)
v_fma_f32 v184, v184, v82, v116
v_fma_f32 v185, v185, v82, v117
M16 v[192:195],v[16:19],a[56:59],v[192:195]
DTR v[36:37],v74 offset:4096
v_fma_f32 v186, v186, v82, v118
v_fma_f32 v187, v187, v82, v119
v_max_f32 v184, 0, v184
v_max_f32 v185, 0, v185
M16 v[196:199],v[16:19],a[60:63],v[196:199]
DTR v[38:39],v74 offset:4352
v_max_f32 v186, 0, v186
v_max_f32 v187, 0, v187
CVT v58,v184,v185
CVT v59,v186,v187
s_waitcnt lgkmcnt(8)
M16 v[200:203],v[20:23],a[32:35],v[200:203]
DTR v[40:41],v74 offset:20480
buffer_store_dwordx4 v[56:59], v14, s[20:23], s65 offen offset:3072 sc1
v_fmac_f32 v180, v104, v84
v_fmac_f32 v181, v105, v84
v_fmac_f32 v182, v106, v84
DR4 v[88:91],v46 offset:512
M16 v[204:207],v[20:23],a[36:39],v[204:207]
DTR v[42:43],v74 offset:20736
v_fmac_f32 v183, v107, v84
v_fma_f32 v180, v180, v86, v108
v_fma_f32 v181, v181, v86, v109
v_fma_f32 v182, v182, v86, v110
s_waitcnt lgkmcnt(9)
M16 v[200:203],v[24:27],a[40:43],v[200:203]
DTR v[16:17],v74 offset:36864
v_fma_f32 v183, v183, v86, v111
v_max_f32 v180, 0, v180
v_max_f32 v181, 0, v181
v_max_f32 v182, 0, v182
DR4 v[92:95],v46 offset:1408
M16 v[204:207],v[24:27],a[44:47],v[204:207]
DTR v[18:19],v74 offset:37120
v_max_f32 v183, 0, v183
CVT v60,v180,v181
CVT v61,v182,v183
v_fmac_f32 v188, v112, v84
s_waitcnt lgkmcnt(10)
M16 v[200:203],v[28:31],a[48:51],v[200:203]
DTR v[20:21],v74 offset:53248
v_fmac_f32 v189, v113, v84
v_fmac_f32 v190, v114, v84
v_fmac_f32 v191, v115, v84
v_fma_f32 v188, v188, v86, v116
DR4 v[96:99],v46 offset:576
M16 v[204:207],v[28:31],a[52:55],v[204:207]
DTR v[22:23],v74 offset:53504
v_fma_f32 v189, v189, v86, v117
v_fma_f32 v190, v190, v86, v118
v_fma_f32 v191, v191, v86, v119
v_max_f32 v188, 0, v188
s_waitcnt lgkmcnt(11)
M16 v[200:203],v[32:35],a[56:59],v[200:203]
DTR v[24:25],v75 offset:4096
v_max_f32 v189, 0, v189
v_max_f32 v190, 0, v190
v_max_f32 v191, 0, v191
CVT v62,v188,v189
DR4 v[100:103],v46 offset:1472
M16 v[204:207],v[32:35],a[60:63],v[204:207]
DTR v[26:27],v75 offset:4352
CVT v63,v190,v191
buffer_store_dwordx4 v[60:63], v12, s[20:23], s65 offen offset:3072 sc1
s_add_u32 s65, s65, 4096
s_waitcnt lgkmcnt(12)
M16 v[208:211],v[36:39],a[32:35],v[208:211]
DTR v[28:29],v75 offset:20480
M16 v[212:215],v[36:39],a[36:39],v[212:215]
DTR v[30:31],v75 offset:20736
s_waitcnt lgkmcnt(12)
v_fmac_f32 v192, v88, v80
v_fmac_f32 v193, v89, v80
v_fmac_f32 v194, v90, v80
v_fmac_f32 v195, v91, v80
s_waitcnt lgkmcnt(11)
M16 v[208:211],v[40:43],a[40:43],v[208:211]
DTR v[32:33],v75 offset:36864
s_waitcnt lgkmcnt(10)
v_fma_f32 v192, v192, v82, v92
v_fma_f32 v193, v193, v82, v93
v_fma_f32 v194, v194, v82, v94
v_fma_f32 v195, v195, v82, v95
M16 v[212:215],v[40:43],a[44:47],v[212:215]
DTR v[34:35],v75 offset:37120
v_max_f32 v192, 0, v192
v_max_f32 v193, 0, v193
v_max_f32 v194, 0, v194
v_max_f32 v195, 0, v195
s_waitcnt lgkmcnt(10)
M16 v[208:211],v[16:19],a[48:51],v[208:211]
DTR v[36:37],v75 offset:53248
CVT v48,v192,v193
CVT v49,v194,v195
s_waitcnt lgkmcnt(9)
v_fmac_f32 v200, v96, v80
v_fmac_f32 v201, v97, v80
M16 v[212:215],v[16:19],a[52:55],v[212:215]
DTR v[38:39],v75 offset:53504
v_fmac_f32 v202, v98, v80
v_fmac_f32 v203, v99, v80
s_waitcnt lgkmcnt(7)
v_fma_f32 v200, v200, v82, v100
v_fma_f32 v201, v201, v82, v101
M16 v[208:211],v[20:23],a[56:59],v[208:211]
DTR v[40:41],v72 offset:6144
v_fma_f32 v202, v202, v82, v102
v_fma_f32 v203, v203, v82, v103
v_max_f32 v200, 0, v200
v_max_f32 v201, 0, v201
M16 v[212:215],v[20:23],a[60:63],v[212:215]
DTR v[42:43],v72 offset:6400
v_max_f32 v202, 0, v202
v_max_f32 v203, 0, v203
CVT v50,v200,v201
CVT v51,v202,v203
s_waitcnt lgkmcnt(8)
M16 v[216:219],v[24:27],a[32:35],v[216:219]
DTR v[16:17],v72 offset:22528
buffer_store_dwordx4 v[48:51], v14, s[20:23], s65 offen offset:0 sc1
v_fmac_f32 v196, v88, v84
v_fmac_f32 v197, v89, v84
DR4 v[104:107],v46 offset:640
M16 v[220:223],v[24:27],a[36:39],v[220:223]
DTR v[18:19],v72 offset:22784
v_fmac_f32 v198, v90, v84
v_fmac_f32 v199, v91, v84
v_fma_f32 v196, v196, v86, v92
v_fma_f32 v197, v197, v86, v93
s_waitcnt lgkmcnt(9)
M16 v[216:219],v[28:31],a[40:43],v[216:219]
DTR v[20:21],v72 offset:38912
v_fma_f32 v198, v198, v86, v94
v_fma_f32 v199, v199, v86, v95
v_max_f32 v196, 0, v196
v_max_f32 v197, 0, v197
DR4 v[108:111],v46 offset:1536
M16 v[220:223],v[28:31],a[44:47],v[220:223]
DTR v[22:23],v72 offset:39168
v_max_f32 v198, 0, v198
v_max_f32 v199, 0, v199
CVT v52,v196,v197
CVT v53,v198,v199
s_waitcnt lgkmcnt(10)
M16 v[216:219],v[32:35],a[48:51],v[216:219]
DTR v[24:25],v72 offset:55296
v_fmac_f32 v204, v96, v84
v_fmac_f32 v205, v97, v84
v_fmac_f32 v206, v98, v84
v_fmac_f32 v207, v99, v84
DR4 v[112:115],v46 offset:704
M16 v[220:223],v[32:35],a[52:55],v[220:223]
DTR v[26:27],v72 offset:55552
v_fma_f32 v204, v204, v86, v100
v_fma_f32 v205, v205, v86, v101
v_fma_f32 v206, v206, v86, v102
v_fma_f32 v207, v207, v86, v103
s_waitcnt lgkmcnt(11)
M16 v[216:219],v[36:39],a[56:59],v[216:219]
DTR v[28:29],v73 offset:6144
v_max_f32 v204, 0, v204
v_max_f32 v205, 0, v205
v_max_f32 v206, 0, v206
v_max_f32 v207, 0, v207
DR4 v[116:119],v46 offset:1600
M16 v[220:223],v[36:39],a[60:63],v[220:223]
DTR v[30:31],v73 offset:6400
CVT v54,v204,v205
CVT v55,v206,v207
buffer_store_dwordx4 v[52:55], v12, s[20:23], s65 offen offset:0 sc1
s_waitcnt lgkmcnt(12)
M16 v[224:227],v[40:43],a[32:35],v[224:227]
DTR v[32:33],v73 offset:22528
M16 v[228:231],v[40:43],a[36:39],v[228:231]
DTR v[34:35],v73 offset:22784
s_waitcnt lgkmcnt(12)
v_fmac_f32 v208, v104, v80
v_fmac_f32 v209, v105, v80
v_fmac_f32 v210, v106, v80
v_fmac_f32 v211, v107, v80
s_waitcnt lgkmcnt(11)
M16 v[224:227],v[16:19],a[40:43],v[224:227]
DTR v[36:37],v73 offset:38912
s_waitcnt lgkmcnt(10)
v_fma_f32 v208, v208, v82, v108
v_fma_f32 v209, v209, v82, v109
v_fma_f32 v210, v210, v82, v110
v_fma_f32 v211, v211, v82, v111
M16 v[228:231],v[16:19],a[44:47],v[228:231]
DTR v[38:39],v73 offset:39168
v_max_f32 v208, 0, v208
v_max_f32 v209, 0, v209
v_max_f32 v210, 0, v210
v_max_f32 v211, 0, v211
s_waitcnt lgkmcnt(10)
M16 v[224:227],v[20:23],a[48:51],v[224:227]
DTR v[40:41],v73 offset:55296
CVT v56,v208,v209
CVT v57,v210,v211
s_waitcnt lgkmcnt(9)
v_fmac_f32 v216, v112, v80
v_fmac_f32 v217, v113, v80
M16 v[228:231],v[20:23],a[52:55],v[228:231]
DTR v[42:43],v73 offset:55552
v_fmac_f32 v218, v114, v80
v_fmac_f32 v219, v115, v80
s_waitcnt lgkmcnt(7)
v_fma_f32 v216, v216, v82, v116
v_fma_f32 v217, v217, v82, v117
M16 v[224:227],v[24:27],a[56:59],v[224:227]
v_fma_f32 v218, v218, v82, v118
v_fma_f32 v219, v219, v82, v119
v_max_f32 v216, 0, v216
v_max_f32 v217, 0, v217
M16 v[228:231],v[24:27],a[60:63],v[228:231]
v_max_f32 v218, 0, v218
v_max_f32 v219, 0, v219
CVT v58,v216,v217
CVT v59,v218,v219
s_waitcnt lgkmcnt(6)
M16 v[232:235],v[28:31],a[32:35],v[232:235]
buffer_store_dwordx4 v[56:59], v14, s[20:23], s65 offen offset:1024 sc1
v_fmac_f32 v212, v104, v84
v_fmac_f32 v213, v105, v84
DR4 v[88:91],v46 offset:768
M16 v[236:239],v[28:31],a[36:39],v[236:239]
v_fmac_f32 v214, v106, v84
v_fmac_f32 v215, v107, v84
v_fma_f32 v212, v212, v86, v108
v_fma_f32 v213, v213, v86, v109
s_waitcnt lgkmcnt(5)
M16 v[232:235],v[32:35],a[40:43],v[232:235]
v_fma_f32 v214, v214, v86, v110
v_fma_f32 v215, v215, v86, v111
v_max_f32 v212, 0, v212
v_max_f32 v213, 0, v213
DR4 v[92:95],v46 offset:1664
M16 v[236:239],v[32:35],a[44:47],v[236:239]
v_max_f32 v214, 0, v214
v_max_f32 v215, 0, v215
CVT v60,v212,v213
CVT v61,v214,v215
s_waitcnt lgkmcnt(4)
M16 v[232:235],v[36:39],a[48:51],v[232:235]
v_fmac_f32 v220, v112, v84
v_fmac_f32 v221, v113, v84
v_fmac_f32 v222, v114, v84
v_fmac_f32 v223, v115, v84
DR4 v[96:99],v46 offset:832
M16 v[236:239],v[36:39],a[52:55],v[236:239]
v_fma_f32 v220, v220, v86, v116
v_fma_f32 v221, v221, v86, v117
v_fma_f32 v222, v222, v86, v118
v_fma_f32 v223, v223, v86, v119
s_waitcnt lgkmcnt(3)
M16 v[232:235],v[40:43],a[56:59],v[232:235]
v_max_f32 v220, 0, v220
v_max_f32 v221, 0, v221
v_max_f32 v222, 0, v222
v_max_f32 v223, 0, v223
DR4 v[100:103],v46 offset:1728
M16 v[236:239],v[40:43],a[60:63],v[236:239]
CVT v62,v220,v221
CVT v63,v222,v223
buffer_store_dwordx4 v[60:63], v12, s[20:23], s65 offen offset:1024 sc1
s_waitcnt lgkmcnt(3)
v_fmac_f32 v224, v88, v80
v_fmac_f32 v225, v89, v80
v_fmac_f32 v226, v90, v80
v_fmac_f32 v227, v91, v80
s_waitcnt lgkmcnt(2)
v_fma_f32 v224, v224, v82, v92
v_fma_f32 v225, v225, v82, v93
v_fma_f32 v226, v226, v82, v94
v_fma_f32 v227, v227, v82, v95
v_max_f32 v224, 0, v224
v_max_f32 v225, 0, v225
v_max_f32 v226, 0, v226
v_max_f32 v227, 0, v227
CVT v48,v224,v225
CVT v49,v226,v227
s_waitcnt lgkmcnt(1)
v_fmac_f32 v232, v96, v80
v_fmac_f32 v233, v97, v80
v_fmac_f32 v234, v98, v80
v_fmac_f32 v235, v99, v80
s_waitcnt lgkmcnt(0)
v_fma_f32 v232, v232, v82, v100
v_fma_f32 v233, v233, v82, v101
v_fma_f32 v234, v234, v82, v102
v_fma_f32 v235, v235, v82, v103
v_max_f32 v232, 0, v232
v_max_f32 v233, 0, v233
v_max_f32 v234, 0, v234
v_max_f32 v235, 0, v235
CVT v50,v232,v233
CVT v51,v234,v235
buffer_store_dwordx4 v[48:51], v14, s[20:23], s65 offen offset:2048 sc1
v_fmac_f32 v228, v88, v84
v_fmac_f32 v229, v89, v84
v_fmac_f32 v230, v90, v84
v_fmac_f32 v231, v91, v84
v_fma_f32 v228, v228, v86, v92
v_fma_f32 v229, v229, v86, v93
v_fma_f32 v230, v230, v86, v94
v_fma_f32 v231, v231, v86, v95
v_max_f32 v228, 0, v228
v_max_f32 v229, 0, v229
v_max_f32 v230, 0, v230
v_max_f32 v231, 0, v231
CVT v52,v228,v229
CVT v53,v230,v231
v_fmac_f32 v236, v96, v84
v_fmac_f32 v237, v97, v84
v_fmac_f32 v238, v98, v84
v_fmac_f32 v239, v99, v84
v_fma_f32 v236, v236, v86, v100
v_fma_f32 v237, v237, v86, v101
v_fma_f32 v238, v238, v86, v102
v_fma_f32 v239, v239, v86, v103
v_max_f32 v236, 0, v236
v_max_f32 v237, 0, v237
v_max_f32 v238, 0, v238
v_max_f32 v239, 0, v239
CVT v54,v236,v237
CVT v55,v238,v239
buffer_store_dwordx4 v[52:55], v12, s[20:23], s65 offen offset:2048 sc1
L_ffn1_kernel_end:
s_endpgm
.p2align 8
ffn2_kernel:
s_cmp_ge_u32 s2, 256
s_cbranch_scc1 L_ffn2_kernel_end
v_lshrrev_b32 v2, 6, v0
v_and_b32 v1, 63, v0
v_readfirstlane_b32 s3, v2
s_load_dwordx2 s[12:13], s[0:1], 64
s_load_dwordx2 s[48:49], s[0:1], 104
s_load_dwordx2 s[20:21], s[0:1], 88
s_and_b32 s50, s2, 7
s_lshr_b32 s51, s2, 3
s_lshr_b32 s52, s50, 1
s_lshl_b32 s52, s52, 2
s_and_b32 s53, s51, 3
s_add_u32 s52, s52, s53
s_and_b32 s53, s50, 1
s_lshl_b32 s53, s53, 3
s_lshr_b32 s51, s51, 2
s_add_u32 s53, s53, s51
s_lshr_b32 s53, s2, 5
s_lshl_b32 s53, s53, 1
s_and_b32 s56, s50, 1
s_add_u32 s53, s53, s56
s_mul_i32 s60, s52, 917504
s_mul_i32 s56, s3, 28672
s_add_u32 s60, s60, s56
s_mul_i32 s61, s3, 1835008
s_lshl_b32 s56, s53, 7
s_add_u32 s61, s61, s56
s_add_u32 s54, s52, s53
s_lshl_b32 s58, s3, 14
s_lshl_b32 s56, s3, 1
v_lshlrev_b32 v14, 4, v1
v_bfe_u32 v15, v1, 2, 2
v_lshrrev_b32 v16, 5, v1
v_lshl_add_u32 v16, v16, 2, v15
v_lshlrev_b32 v10, 11, v16
v_bfe_u32 v16, v1, 4, 1
v_lshl_add_u32 v10, v16, 6, v10
v_and_b32 v17, 3, v1
v_lshl_add_u32 v10, v17, 4, v10
v_add_u32 v11, 15360, v10
v_add_u32 v12, 15360, v11
v_add_u32 v13, 15360, v12
s_add_u32 s57, s56, 0
s_and_b32 s57, s57, 7
s_mul_i32 s57, s57, 114688
v_add_u32 v2, s57, v14
s_add_u32 s57, s56, 1
s_and_b32 s57, s57, 7
s_mul_i32 s57, s57, 114688
v_add_u32 v3, s57, v14
s_add_u32 s57, s56, 2
s_and_b32 s57, s57, 7
s_mul_i32 s57, s57, 114688
v_add_u32 v4, s57, v14
s_add_u32 s57, s56, 3
s_and_b32 s57, s57, 7
s_mul_i32 s57, s57, 114688
v_add_u32 v5, s57, v14
s_add_u32 s57, s56, 4
s_and_b32 s57, s57, 7
s_mul_i32 s57, s57, 114688
v_add_u32 v6, s57, v14
s_add_u32 s57, s56, 5
s_and_b32 s57, s57, 7
s_mul_i32 s57, s57, 114688
v_add_u32 v7, s57, v14
s_add_u32 s57, s56, 6
s_and_b32 s57, s57, 7
s_mul_i32 s57, s57, 114688
v_add_u32 v8, s57, v14
s_add_u32 s57, s56, 7
s_and_b32 s57, s57, 7
s_mul_i32 s57, s57, 114688
v_add_u32 v9, s57, v14
v_lshrrev_b32 v18, 5, v1
v_lshlrev_b32 v18, 10, v18
v_lshl_add_u32 v18, v16, 9, v18
v_lshl_add_u32 v18, v15, 6, v18
v_lshl_add_u32 v18, v17, 4, v18
v_add_u32 v15, s58, v18
s_add_u32 s56, s54, 0
s_and_b32 s56, s56, 3
s_lshl_b32 s57, s56, 10
s_add_u32 s40, s60, s57
s_lshl_b32 s57, s56, 16
s_add_u32 s44, s61, s57
s_add_u32 s56, s54, 1
s_and_b32 s56, s56, 3
s_lshl_b32 s57, s56, 10
s_add_u32 s41, s60, s57
s_lshl_b32 s57, s56, 16
s_add_u32 s45, s61, s57
s_add_u32 s56, s54, 2
s_and_b32 s56, s56, 3
s_lshl_b32 s57, s56, 10
s_add_u32 s42, s60, s57
s_lshl_b32 s57, s56, 16
s_add_u32 s46, s61, s57
s_add_u32 s56, s54, 3
s_and_b32 s56, s56, 3
s_lshl_b32 s57, s56, 10
s_add_u32 s43, s60, s57
s_lshl_b32 s57, s56, 16
s_add_u32 s47, s61, s57
s_waitcnt lgkmcnt(0)
s_mov_b32 s14, 7340032
s_mov_b32 s15, 0x20000
s_add_u32 s8, s48, 67108864
s_addc_u32 s9, s49, 0
s_mov_b32 s10, 14680064
s_mov_b32 s11, 0x20000
s_add_u32 m0, s58, 0
s_nop 0
buffer_load_dwordx4 v10, s[12:15], s44 offen offset:0 lds
buffer_load_dwordx4 v11, s[12:15], s44 offen offset:1024 lds
buffer_load_dwordx4 v12, s[12:15], s44 offen offset:2048 lds
buffer_load_dwordx4 v13, s[12:15], s44 offen offset:3072 lds
s_add_u32 s44, s44, 262144
buffer_load_dwordx4 a[128:131], v2, s[8:11], s40 offen
buffer_load_dwordx4 a[132:135], v3, s[8:11], s40 offen
buffer_load_dwordx4 a[136:139], v4, s[8:11], s40 offen
buffer_load_dwordx4 a[140:143], v5, s[8:11], s40 offen
buffer_load_dwordx4 a[144:147], v6, s[8:11], s40 offen
buffer_load_dwordx4 a[148:151], v7, s[8:11], s40 offen
buffer_load_dwordx4 a[152:155], v8, s[8:11], s40 offen
buffer_load_dwordx4 a[156:159], v9, s[8:11], s40 offen
s_add_u32 s40, s40, 4096
s_add_u32 s24, s48, 262144
s_addc_u32 s25, s49, 0
s_mov_b32 s26, 24576
s_mov_b32 s27, 0x20000
s_add_u32 m0, s58, 4096
s_nop 0
buffer_load_dwordx4 v10, s[12:15], s45 offen offset:0 lds
buffer_load_dwordx4 v11, s[12:15], s45 offen offset:1024 lds
buffer_load_dwordx4 v12, s[12:15], s45 offen offset:2048 lds
buffer_load_dwordx4 v13, s[12:15], s45 offen offset:3072 lds
s_add_u32 s45, s45, 262144
buffer_load_dwordx4 a[160:163], v2, s[8:11], s41 offen
buffer_load_dwordx4 a[164:167], v3, s[8:11], s41 offen
buffer_load_dwordx4 a[168:171], v4, s[8:11], s41 offen
buffer_load_dwordx4 a[172:175], v5, s[8:11], s41 offen
buffer_load_dwordx4 a[176:179], v6, s[8:11], s41 offen
buffer_load_dwordx4 a[180:183], v7, s[8:11], s41 offen
buffer_load_dwordx4 a[184:187], v8, s[8:11], s41 offen
buffer_load_dwordx4 a[188:191], v9, s[8:11], s41 offen
s_add_u32 s41, s41, 4096
s_add_u32 m0, s58, 8192
s_nop 0
buffer_load_dwordx4 v10, s[12:15], s46 offen offset:0 lds
buffer_load_dwordx4 v11, s[12:15], s46 offen offset:1024 lds
buffer_load_dwordx4 v12, s[12:15], s46 offen offset:2048 lds
buffer_load_dwordx4 v13, s[12:15], s46 offen offset:3072 lds
s_add_u32 s46, s46, 262144
buffer_load_dwordx4 a[192:195], v2, s[8:11], s42 offen
buffer_load_dwordx4 a[196:199], v3, s[8:11], s42 offen
buffer_load_dwordx4 a[200:203], v4, s[8:11], s42 offen
buffer_load_dwordx4 a[204:207], v5, s[8:11], s42 offen
buffer_load_dwordx4 a[208:211], v6, s[8:11], s42 offen
buffer_load_dwordx4 a[212:215], v7, s[8:11], s42 offen
buffer_load_dwordx4 a[216:219], v8, s[8:11], s42 offen
buffer_load_dwordx4 a[220:223], v9, s[8:11], s42 offen
s_add_u32 s42, s42, 4096
s_add_u32 m0, s58, 12288
s_nop 0
buffer_load_dwordx4 v10, s[12:15], s47 offen offset:0 lds
buffer_load_dwordx4 v11, s[12:15], s47 offen offset:1024 lds
buffer_load_dwordx4 v12, s[12:15], s47 offen offset:2048 lds
buffer_load_dwordx4 v13, s[12:15], s47 offen offset:3072 lds
s_add_u32 s47, s47, 262144
buffer_load_dwordx4 a[224:227], v2, s[8:11], s43 offen
buffer_load_dwordx4 a[228:231], v3, s[8:11], s43 offen
buffer_load_dwordx4 a[232:235], v4, s[8:11], s43 offen
buffer_load_dwordx4 a[236:239], v5, s[8:11], s43 offen
buffer_load_dwordx4 a[240:243], v6, s[8:11], s43 offen
buffer_load_dwordx4 a[244:247], v7, s[8:11], s43 offen
buffer_load_dwordx4 a[248:251], v8, s[8:11], s43 offen
buffer_load_dwordx4 a[252:255], v9, s[8:11], s43 offen
s_add_u32 s43, s43, 4096
s_mov_b32 s22, 4194304
s_mov_b32 s23, 0x20000
s_mov_b32 s28, s48
s_mov_b32 s29, s49
s_mov_b32 s30, 16777216
s_mov_b32 s31, 0x20000
s_lshl_b32 s62, s52, 3
s_lshl_b32 s56, s3, 1
s_add_u32 s62, s62, s56
s_lshl_b32 s63, s62, 15
s_lshl_b32 s56, s53, 7
s_add_u32 s63, s63, s56
s_lshl_b32 s64, s62, 15
s_lshl_b32 s56, s53, 11
s_add_u32 s64, s64, s56
s_add_u32 s65, s64, 9437184
s_add_u32 s64, s64, 5242880
s_lshl_b32 s66, s62, 11
s_lshl_b32 s56, s53, 3
s_add_u32 s66, s66, s56
s_add_u32 s66, s66, 524288
s_lshl_b32 s67, s53, 8
v_and_b32 v192, 15, v1
v_lshrrev_b32 v193, 4, v1
v_lshlrev_b32 v194, 11, v192
v_lshl_add_u32 v194, v193, 4, v194
v_add_u32 v195, 32768, v194
v_lshlrev_b32 v196, 5, v193
v_lshlrev_b32 v197, 7, v192
v_add_u32 v198, 32768, v14
s_mul_i32 s56, s3, 24576
s_add_u32 s56, s56, 65536
v_add_u32 v199, s56, v14
s_add_u32 s56, s3, 1
s_and_b32 s56, s56, 3
s_mul_i32 s56, s56, 24576
s_add_u32 s56, s56, 65536
v_add_u32 v200, s56, v14
s_add_u32 s56, s3, 2
s_and_b32 s56, s56, 3
s_mul_i32 s56, s56, 24576
s_add_u32 s56, s56, 73728
v_add_u32 v201, s56, v14
s_add_u32 s56, s3, 3
s_and_b32 s56, s56, 3
s_mul_i32 s56, s56, 24576
s_add_u32 s56, s56, 81920
v_add_u32 v202, s56, v14
v_mov_b32 v48, 0
v_mov_b32 v49, 0
v_mov_b32 v50, 0
v_mov_b32 v51, 0
s_nop 1
M32 a[0:15],v[48:51],v[48:51],0
M32 a[16:31],v[48:51],v[48:51],0
M32 a[32:47],v[48:51],v[48:51],0
M32 a[48:63],v[48:51],v[48:51],0
M32 a[64:79],v[48:51],v[48:51],0
M32 a[80:95],v[48:51],v[48:51],0
M32 a[96:111],v[48:51],v[48:51],0
M32 a[112:127],v[48:51],v[48:51],0
s_waitcnt vmcnt(44)
DTR v[16:17],v15 offset:0
DTR v[18:19],v15 offset:2048
DTR v[20:21],v15 offset:8
DTR v[22:23],v15 offset:2056
DTR v[24:25],v15 offset:256
DTR v[26:27],v15 offset:2304
DTR v[28:29],v15 offset:264
DTR v[30:31],v15 offset:2312
s_mov_b32 s59, 6
L_ffn2_kernel_lp:
s_waitcnt vmcnt(43) lgkmcnt(6)
M16 a[0:3],v[16:19],a[128:131],a[0:3]
s_waitcnt lgkmcnt(4)
M16 a[4:7],v[20:23],a[128:131],a[4:7]
s_waitcnt lgkmcnt(2)
M16 a[8:11],v[24:27],a[128:131],a[8:11]
s_add_u32 m0, s58, 0
s_waitcnt lgkmcnt(0)
M16 a[12:15],v[28:31],a[128:131],a[12:15]
buffer_load_dwordx4 v10, s[12:15], s44 offen offset:0 lds
s_waitcnt vmcnt(43)
M16 a[16:19],v[16:19],a[132:135],a[16:19]
buffer_load_dwordx4 a[128:131], v2, s[8:11], s40 offen
M16 a[20:23],v[20:23],a[132:135],a[20:23]
buffer_load_dwordx4 v11, s[12:15], s44 offen offset:1024 lds
M16 a[24:27],v[24:27],a[132:135],a[24:27]
buffer_load_dwordx4 v12, s[12:15], s44 offen offset:2048 lds
M16 a[28:31],v[28:31],a[132:135],a[28:31]
buffer_load_dwordx4 v13, s[12:15], s44 offen offset:3072 lds
s_add_u32 s44, s44, 262144
s_waitcnt vmcnt(46)
M16 a[32:35],v[16:19],a[136:139],a[32:35]
buffer_load_dwordx4 a[132:135], v3, s[8:11], s40 offen
M16 a[36:39],v[20:23],a[136:139],a[36:39]
s_waitcnt vmcnt(37)
M16 a[40:43],v[24:27],a[136:139],a[40:43]
M16 a[44:47],v[28:31],a[136:139],a[44:47]
DTR v[32:33],v15 offset:4096
M16 a[48:51],v[16:19],a[140:143],a[48:51]
buffer_load_dwordx4 a[136:139], v4, s[8:11], s40 offen
M16 a[52:55],v[20:23],a[140:143],a[52:55]
DTR v[34:35],v15 offset:6144
M16 a[56:59],v[24:27],a[140:143],a[56:59]
M16 a[60:63],v[28:31],a[140:143],a[60:63]
DTR v[36:37],v15 offset:4104
M16 a[64:67],v[16:19],a[144:147],a[64:67]
buffer_load_dwordx4 a[140:143], v5, s[8:11], s40 offen
M16 a[68:71],v[20:23],a[144:147],a[68:71]
DTR v[38:39],v15 offset:6152
M16 a[72:75],v[24:27],a[144:147],a[72:75]
M16 a[76:79],v[28:31],a[144:147],a[76:79]
DTR v[40:41],v15 offset:4352
M16 a[80:83],v[16:19],a[148:151],a[80:83]
buffer_load_dwordx4 a[144:147], v6, s[8:11], s40 offen
M16 a[84:87],v[20:23],a[148:151],a[84:87]
DTR v[42:43],v15 offset:6400
M16 a[88:91],v[24:27],a[148:151],a[88:91]
M16 a[92:95],v[28:31],a[148:151],a[92:95]
DTR v[44:45],v15 offset:4360
M16 a[96:99],v[16:19],a[152:155],a[96:99]
buffer_load_dwordx4 a[148:151], v7, s[8:11], s40 offen
M16 a[100:103],v[20:23],a[152:155],a[100:103]
DTR v[46:47],v15 offset:6408
M16 a[104:107],v[24:27],a[152:155],a[104:107]
M16 a[108:111],v[28:31],a[152:155],a[108:111]
M16 a[112:115],v[16:19],a[156:159],a[112:115]
buffer_load_dwordx4 a[152:155], v8, s[8:11], s40 offen
M16 a[116:119],v[20:23],a[156:159],a[116:119]
M16 a[120:123],v[24:27],a[156:159],a[120:123]
M16 a[124:127],v[28:31],a[156:159],a[124:127]
buffer_load_dwordx4 a[156:159], v9, s[8:11], s40 offen
s_add_u32 s40, s40, 4096
s_waitcnt vmcnt(43) lgkmcnt(6)
M16 a[0:3],v[32:35],a[160:163],a[0:3]
s_waitcnt lgkmcnt(4)
M16 a[4:7],v[36:39],a[160:163],a[4:7]
s_waitcnt lgkmcnt(2)
M16 a[8:11],v[40:43],a[160:163],a[8:11]
s_add_u32 m0, s58, 4096
s_waitcnt lgkmcnt(0)
M16 a[12:15],v[44:47],a[160:163],a[12:15]
buffer_load_dwordx4 v10, s[12:15], s45 offen offset:0 lds
s_waitcnt vmcnt(43)
M16 a[16:19],v[32:35],a[164:167],a[16:19]
buffer_load_dwordx4 a[160:163], v2, s[8:11], s41 offen
M16 a[20:23],v[36:39],a[164:167],a[20:23]
buffer_load_dwordx4 v11, s[12:15], s45 offen offset:1024 lds
M16 a[24:27],v[40:43],a[164:167],a[24:27]
buffer_load_dwordx4 v12, s[12:15], s45 offen offset:2048 lds
M16 a[28:31],v[44:47],a[164:167],a[28:31]
buffer_load_dwordx4 v13, s[12:15], s45 offen offset:3072 lds
s_add_u32 s45, s45, 262144
s_waitcnt vmcnt(46)
M16 a[32:35],v[32:35],a[168:171],a[32:35]
buffer_load_dwordx4 a[164:167], v3, s[8:11], s41 offen
M16 a[36:39],v[36:39],a[168:171],a[36:39]
s_waitcnt vmcnt(37)
M16 a[40:43],v[40:43],a[168:171],a[40:43]
M16 a[44:47],v[44:47],a[168:171],a[44:47]
DTR v[16:17],v15 offset:8192
M16 a[48:51],v[32:35],a[172:175],a[48:51]
buffer_load_dwordx4 a[168:171], v4, s[8:11], s41 offen
M16 a[52:55],v[36:39],a[172:175],a[52:55]
DTR v[18:19],v15 offset:10240
M16 a[56:59],v[40:43],a[172:175],a[56:59]
M16 a[60:63],v[44:47],a[172:175],a[60:63]
DTR v[20:21],v15 offset:8200
M16 a[64:67],v[32:35],a[176:179],a[64:67]
buffer_load_dwordx4 a[172:175], v5, s[8:11], s41 offen
M16 a[68:71],v[36:39],a[176:179],a[68:71]
DTR v[22:23],v15 offset:10248
M16 a[72:75],v[40:43],a[176:179],a[72:75]
M16 a[76:79],v[44:47],a[176:179],a[76:79]
DTR v[24:25],v15 offset:8448
M16 a[80:83],v[32:35],a[180:183],a[80:83]
buffer_load_dwordx4 a[176:179], v6, s[8:11], s41 offen
M16 a[84:87],v[36:39],a[180:183],a[84:87]
DTR v[26:27],v15 offset:10496
M16 a[88:91],v[40:43],a[180:183],a[88:91]
M16 a[92:95],v[44:47],a[180:183],a[92:95]
DTR v[28:29],v15 offset:8456
M16 a[96:99],v[32:35],a[184:187],a[96:99]
buffer_load_dwordx4 a[180:183], v7, s[8:11], s41 offen
M16 a[100:103],v[36:39],a[184:187],a[100:103]
DTR v[30:31],v15 offset:10504
M16 a[104:107],v[40:43],a[184:187],a[104:107]
M16 a[108:111],v[44:47],a[184:187],a[108:111]
M16 a[112:115],v[32:35],a[188:191],a[112:115]
buffer_load_dwordx4 a[184:187], v8, s[8:11], s41 offen
M16 a[116:119],v[36:39],a[188:191],a[116:119]
M16 a[120:123],v[40:43],a[188:191],a[120:123]
M16 a[124:127],v[44:47],a[188:191],a[124:127]
buffer_load_dwordx4 a[188:191], v9, s[8:11], s41 offen
s_add_u32 s41, s41, 4096
s_waitcnt vmcnt(43) lgkmcnt(6)
M16 a[0:3],v[16:19],a[192:195],a[0:3]
s_waitcnt lgkmcnt(4)
M16 a[4:7],v[20:23],a[192:195],a[4:7]
s_waitcnt lgkmcnt(2)
M16 a[8:11],v[24:27],a[192:195],a[8:11]
s_add_u32 m0, s58, 8192
s_waitcnt lgkmcnt(0)
M16 a[12:15],v[28:31],a[192:195],a[12:15]
buffer_load_dwordx4 v10, s[12:15], s46 offen offset:0 lds
s_waitcnt vmcnt(43)
M16 a[16:19],v[16:19],a[196:199],a[16:19]
buffer_load_dwordx4 a[192:195], v2, s[8:11], s42 offen
M16 a[20:23],v[20:23],a[196:199],a[20:23]
buffer_load_dwordx4 v11, s[12:15], s46 offen offset:1024 lds
M16 a[24:27],v[24:27],a[196:199],a[24:27]
buffer_load_dwordx4 v12, s[12:15], s46 offen offset:2048 lds
M16 a[28:31],v[28:31],a[196:199],a[28:31]
buffer_load_dwordx4 v13, s[12:15], s46 offen offset:3072 lds
s_add_u32 s46, s46, 262144
s_waitcnt vmcnt(46)
M16 a[32:35],v[16:19],a[200:203],a[32:35]
buffer_load_dwordx4 a[196:199], v3, s[8:11], s42 offen
M16 a[36:39],v[20:23],a[200:203],a[36:39]
s_waitcnt vmcnt(37)
M16 a[40:43],v[24:27],a[200:203],a[40:43]
M16 a[44:47],v[28:31],a[200:203],a[44:47]
DTR v[32:33],v15 offset:12288
M16 a[48:51],v[16:19],a[204:207],a[48:51]
buffer_load_dwordx4 a[200:203], v4, s[8:11], s42 offen
M16 a[52:55],v[20:23],a[204:207],a[52:55]
DTR v[34:35],v15 offset:14336
M16 a[56:59],v[24:27],a[204:207],a[56:59]
M16 a[60:63],v[28:31],a[204:207],a[60:63]
DTR v[36:37],v15 offset:12296
M16 a[64:67],v[16:19],a[208:211],a[64:67]
buffer_load_dwordx4 a[204:207], v5, s[8:11], s42 offen
M16 a[68:71],v[20:23],a[208:211],a[68:71]
DTR v[38:39],v15 offset:14344
M16 a[72:75],v[24:27],a[208:211],a[72:75]
M16 a[76:79],v[28:31],a[208:211],a[76:79]
DTR v[40:41],v15 offset:12544
M16 a[80:83],v[16:19],a[212:215],a[80:83]
buffer_load_dwordx4 a[208:211], v6, s[8:11], s42 offen
M16 a[84:87],v[20:23],a[212:215],a[84:87]
DTR v[42:43],v15 offset:14592
M16 a[88:91],v[24:27],a[212:215],a[88:91]
M16 a[92:95],v[28:31],a[212:215],a[92:95]
DTR v[44:45],v15 offset:12552
M16 a[96:99],v[16:19],a[216:219],a[96:99]
buffer_load_dwordx4 a[212:215], v7, s[8:11], s42 offen
M16 a[100:103],v[20:23],a[216:219],a[100:103]
DTR v[46:47],v15 offset:14600
M16 a[104:107],v[24:27],a[216:219],a[104:107]
M16 a[108:111],v[28:31],a[216:219],a[108:111]
M16 a[112:115],v[16:19],a[220:223],a[112:115]
buffer_load_dwordx4 a[216:219], v8, s[8:11], s42 offen
M16 a[116:119],v[20:23],a[220:223],a[116:119]
M16 a[120:123],v[24:27],a[220:223],a[120:123]
M16 a[124:127],v[28:31],a[220:223],a[124:127]
buffer_load_dwordx4 a[220:223], v9, s[8:11], s42 offen
s_add_u32 s42, s42, 4096
s_waitcnt vmcnt(43) lgkmcnt(6)
M16 a[0:3],v[32:35],a[224:227],a[0:3]
s_waitcnt lgkmcnt(4)
M16 a[4:7],v[36:39],a[224:227],a[4:7]
s_waitcnt lgkmcnt(2)
M16 a[8:11],v[40:43],a[224:227],a[8:11]
s_add_u32 m0, s58, 12288
s_waitcnt lgkmcnt(0)
M16 a[12:15],v[44:47],a[224:227],a[12:15]
buffer_load_dwordx4 v10, s[12:15], s47 offen offset:0 lds
s_waitcnt vmcnt(43)
M16 a[16:19],v[32:35],a[228:231],a[16:19]
buffer_load_dwordx4 a[224:227], v2, s[8:11], s43 offen
M16 a[20:23],v[36:39],a[228:231],a[20:23]
buffer_load_dwordx4 v11, s[12:15], s47 offen offset:1024 lds
M16 a[24:27],v[40:43],a[228:231],a[24:27]
buffer_load_dwordx4 v12, s[12:15], s47 offen offset:2048 lds
M16 a[28:31],v[44:47],a[228:231],a[28:31]
buffer_load_dwordx4 v13, s[12:15], s47 offen offset:3072 lds
s_add_u32 s47, s47, 262144
s_waitcnt vmcnt(46)
M16 a[32:35],v[32:35],a[232:235],a[32:35]
buffer_load_dwordx4 a[228:231], v3, s[8:11], s43 offen
M16 a[36:39],v[36:39],a[232:235],a[36:39]
s_waitcnt vmcnt(37)
M16 a[40:43],v[40:43],a[232:235],a[40:43]
M16 a[44:47],v[44:47],a[232:235],a[44:47]
DTR v[16:17],v15 offset:0
M16 a[48:51],v[32:35],a[236:239],a[48:51]
buffer_load_dwordx4 a[232:235], v4, s[8:11], s43 offen
M16 a[52:55],v[36:39],a[236:239],a[52:55]
DTR v[18:19],v15 offset:2048
M16 a[56:59],v[40:43],a[236:239],a[56:59]
M16 a[60:63],v[44:47],a[236:239],a[60:63]
DTR v[20:21],v15 offset:8
M16 a[64:67],v[32:35],a[240:243],a[64:67]
buffer_load_dwordx4 a[236:239], v5, s[8:11], s43 offen
M16 a[68:71],v[36:39],a[240:243],a[68:71]
DTR v[22:23],v15 offset:2056
M16 a[72:75],v[40:43],a[240:243],a[72:75]
M16 a[76:79],v[44:47],a[240:243],a[76:79]
DTR v[24:25],v15 offset:256
M16 a[80:83],v[32:35],a[244:247],a[80:83]
buffer_load_dwordx4 a[240:243], v6, s[8:11], s43 offen
M16 a[84:87],v[36:39],a[244:247],a[84:87]
DTR v[26:27],v15 offset:2304
M16 a[88:91],v[40:43],a[244:247],a[88:91]
M16 a[92:95],v[44:47],a[244:247],a[92:95]
DTR v[28:29],v15 offset:264
M16 a[96:99],v[32:35],a[248:251],a[96:99]
buffer_load_dwordx4 a[244:247], v7, s[8:11], s43 offen
M16 a[100:103],v[36:39],a[248:251],a[100:103]
DTR v[30:31],v15 offset:2312
M16 a[104:107],v[40:43],a[248:251],a[104:107]
M16 a[108:111],v[44:47],a[248:251],a[108:111]
M16 a[112:115],v[32:35],a[252:255],a[112:115]
buffer_load_dwordx4 a[248:251], v8, s[8:11], s43 offen
M16 a[116:119],v[36:39],a[252:255],a[116:119]
M16 a[120:123],v[40:43],a[252:255],a[120:123]
M16 a[124:127],v[44:47],a[252:255],a[124:127]
buffer_load_dwordx4 a[252:255], v9, s[8:11], s43 offen
s_add_u32 s43, s43, 4096
s_sub_u32 s59, s59, 1
s_cmp_lg_u32 s59, 0
s_cbranch_scc1 L_ffn2_kernel_lp
s_add_u32 s68, s67, 20480
s_add_u32 s69, s67, 16384
s_waitcnt lgkmcnt(6)
M16 a[0:3],v[16:19],a[128:131],a[0:3]
s_waitcnt lgkmcnt(4)
M16 a[4:7],v[20:23],a[128:131],a[4:7]
s_waitcnt lgkmcnt(2)
M16 a[8:11],v[24:27],a[128:131],a[8:11]
buffer_load_dwordx4 v[144:147], v14, s[28:31], s64 offen offset:0
s_waitcnt lgkmcnt(0)
M16 a[12:15],v[28:31],a[128:131],a[12:15]
s_waitcnt vmcnt(43)
M16 a[16:19],v[16:19],a[132:135],a[16:19]
buffer_load_dwordx4 v[148:151], v14, s[28:31], s64 offen offset:1024
M16 a[20:23],v[20:23],a[132:135],a[20:23]
M16 a[24:27],v[24:27],a[132:135],a[24:27]
buffer_load_dwordx4 v[152:155], v198, s[28:31], s64 offen offset:0
M16 a[28:31],v[28:31],a[132:135],a[28:31]
s_waitcnt vmcnt(44)
M16 a[32:35],v[16:19],a[136:139],a[32:35]
buffer_load_dwordx4 v[156:159], v198, s[28:31], s64 offen offset:1024
M16 a[36:39],v[20:23],a[136:139],a[36:39]
s_waitcnt vmcnt(35)
M16 a[40:43],v[24:27],a[136:139],a[40:43]
buffer_load_dwordx4 v[160:163], v196, s[24:27], s68 offen offset:0
M16 a[44:47],v[28:31],a[136:139],a[44:47]
DTR v[32:33],v15 offset:4096
M16 a[48:51],v[16:19],a[140:143],a[48:51]
buffer_load_dwordx4 v[164:167], v196, s[24:27], s68 offen offset:16
M16 a[52:55],v[20:23],a[140:143],a[52:55]
DTR v[34:35],v15 offset:6144
M16 a[56:59],v[24:27],a[140:143],a[56:59]
buffer_load_dwordx4 v[168:171], v196, s[24:27], s68 offen offset:128
M16 a[60:63],v[28:31],a[140:143],a[60:63]
DTR v[36:37],v15 offset:4104
M16 a[64:67],v[16:19],a[144:147],a[64:67]
buffer_load_dwordx4 v[172:175], v196, s[24:27], s68 offen offset:144
M16 a[68:71],v[20:23],a[144:147],a[68:71]
DTR v[38:39],v15 offset:6152
M16 a[72:75],v[24:27],a[144:147],a[72:75]
M16 a[76:79],v[28:31],a[144:147],a[76:79]
DTR v[40:41],v15 offset:4352
M16 a[80:83],v[16:19],a[148:151],a[80:83]
M16 a[84:87],v[20:23],a[148:151],a[84:87]
DTR v[42:43],v15 offset:6400
M16 a[88:91],v[24:27],a[148:151],a[88:91]
M16 a[92:95],v[28:31],a[148:151],a[92:95]
DTR v[44:45],v15 offset:4360
M16 a[96:99],v[16:19],a[152:155],a[96:99]
M16 a[100:103],v[20:23],a[152:155],a[100:103]
DTR v[46:47],v15 offset:6408
M16 a[104:107],v[24:27],a[152:155],a[104:107]
M16 a[108:111],v[28:31],a[152:155],a[108:111]
M16 a[112:115],v[16:19],a[156:159],a[112:115]
M16 a[116:119],v[20:23],a[156:159],a[116:119]
M16 a[120:123],v[24:27],a[156:159],a[120:123]
M16 a[124:127],v[28:31],a[156:159],a[124:127]
s_waitcnt lgkmcnt(6)
M16 a[0:3],v[32:35],a[160:163],a[0:3]
s_waitcnt lgkmcnt(4)
M16 a[4:7],v[36:39],a[160:163],a[4:7]
s_waitcnt lgkmcnt(2)
M16 a[8:11],v[40:43],a[160:163],a[8:11]
s_waitcnt lgkmcnt(0)
M16 a[12:15],v[44:47],a[160:163],a[12:15]
s_waitcnt vmcnt(38)
M16 a[16:19],v[32:35],a[164:167],a[16:19]
M16 a[20:23],v[36:39],a[164:167],a[20:23]
M16 a[24:27],v[40:43],a[164:167],a[24:27]
M16 a[28:31],v[44:47],a[164:167],a[28:31]
s_waitcnt vmcnt(37)
M16 a[32:35],v[32:35],a[168:171],a[32:35]
M16 a[36:39],v[36:39],a[168:171],a[36:39]
s_waitcnt vmcnt(27)
M16 a[40:43],v[40:43],a[168:171],a[40:43]
M16 a[44:47],v[44:47],a[168:171],a[44:47]
DTR v[16:17],v15 offset:8192
M16 a[48:51],v[32:35],a[172:175],a[48:51]
M16 a[52:55],v[36:39],a[172:175],a[52:55]
DTR v[18:19],v15 offset:10240
M16 a[56:59],v[40:43],a[172:175],a[56:59]
M16 a[60:63],v[44:47],a[172:175],a[60:63]
DTR v[20:21],v15 offset:8200
M16 a[64:67],v[32:35],a[176:179],a[64:67]
M16 a[68:71],v[36:39],a[176:179],a[68:71]
DTR v[22:23],v15 offset:10248
M16 a[72:75],v[40:43],a[176:179],a[72:75]
M16 a[76:79],v[44:47],a[176:179],a[76:79]
DTR v[24:25],v15 offset:8448
M16 a[80:83],v[32:35],a[180:183],a[80:83]
M16 a[84:87],v[36:39],a[180:183],a[84:87]
DTR v[26:27],v15 offset:10496
M16 a[88:91],v[40:43],a[180:183],a[88:91]
M16 a[92:95],v[44:47],a[180:183],a[92:95]
DTR v[28:29],v15 offset:8456
M16 a[96:99],v[32:35],a[184:187],a[96:99]
M16 a[100:103],v[36:39],a[184:187],a[100:103]
DTR v[30:31],v15 offset:10504
M16 a[104:107],v[40:43],a[184:187],a[104:107]
M16 a[108:111],v[44:47],a[184:187],a[108:111]
M16 a[112:115],v[32:35],a[188:191],a[112:115]
M16 a[116:119],v[36:39],a[188:191],a[116:119]
M16 a[120:123],v[40:43],a[188:191],a[120:123]
M16 a[124:127],v[44:47],a[188:191],a[124:127]
s_waitcnt lgkmcnt(6)
M16 a[0:3],v[16:19],a[192:195],a[0:3]
s_waitcnt lgkmcnt(4)
M16 a[4:7],v[20:23],a[192:195],a[4:7]
s_waitcnt lgkmcnt(2)
M16 a[8:11],v[24:27],a[192:195],a[8:11]
s_waitcnt lgkmcnt(0)
M16 a[12:15],v[28:31],a[192:195],a[12:15]
s_waitcnt vmcnt(26)
M16 a[16:19],v[16:19],a[196:199],a[16:19]
M16 a[20:23],v[20:23],a[196:199],a[20:23]
M16 a[24:27],v[24:27],a[196:199],a[24:27]
M16 a[28:31],v[28:31],a[196:199],a[28:31]
s_waitcnt vmcnt(25)
M16 a[32:35],v[16:19],a[200:203],a[32:35]
M16 a[36:39],v[20:23],a[200:203],a[36:39]
s_waitcnt vmcnt(15)
M16 a[40:43],v[24:27],a[200:203],a[40:43]
M16 a[44:47],v[28:31],a[200:203],a[44:47]
DTR v[32:33],v15 offset:12288
M16 a[48:51],v[16:19],a[204:207],a[48:51]
M16 a[52:55],v[20:23],a[204:207],a[52:55]
DTR v[34:35],v15 offset:14336
M16 a[56:59],v[24:27],a[204:207],a[56:59]
M16 a[60:63],v[28:31],a[204:207],a[60:63]
DTR v[36:37],v15 offset:12296
M16 a[64:67],v[16:19],a[208:211],a[64:67]
M16 a[68:71],v[20:23],a[208:211],a[68:71]
DTR v[38:39],v15 offset:14344
M16 a[72:75],v[24:27],a[208:211],a[72:75]
M16 a[76:79],v[28:31],a[208:211],a[76:79]
DTR v[40:41],v15 offset:12544
M16 a[80:83],v[16:19],a[212:215],a[80:83]
M16 a[84:87],v[20:23],a[212:215],a[84:87]
DTR v[42:43],v15 offset:14592
M16 a[88:91],v[24:27],a[212:215],a[88:91]
M16 a[92:95],v[28:31],a[212:215],a[92:95]
DTR v[44:45],v15 offset:12552
M16 a[96:99],v[16:19],a[216:219],a[96:99]
M16 a[100:103],v[20:23],a[216:219],a[100:103]
DTR v[46:47],v15 offset:14600
M16 a[104:107],v[24:27],a[216:219],a[104:107]
M16 a[108:111],v[28:31],a[216:219],a[108:111]
M16 a[112:115],v[16:19],a[220:223],a[112:115]
M16 a[116:119],v[20:23],a[220:223],a[116:119]
M16 a[120:123],v[24:27],a[220:223],a[120:123]
M16 a[124:127],v[28:31],a[220:223],a[124:127]
s_waitcnt vmcnt(13) lgkmcnt(6)
M16 a[32:35],v[32:35],a[232:235],a[32:35]
s_waitcnt lgkmcnt(4)
M16 a[36:39],v[36:39],a[232:235],a[36:39]
s_waitcnt lgkmcnt(2)
M16 a[40:43],v[40:43],a[232:235],a[40:43]
s_waitcnt lgkmcnt(0)
M16 a[44:47],v[44:47],a[232:235],a[44:47]
s_waitcnt vmcnt(12)
M16 a[48:51],v[32:35],a[236:239],a[48:51]
M16 a[52:55],v[36:39],a[236:239],a[52:55]
M16 a[56:59],v[40:43],a[236:239],a[56:59]
ds_write_b128 v200, a[32:35] offset:0
M16 a[60:63],v[44:47],a[236:239],a[60:63]
ds_write_b128 v200, a[36:39] offset:1024
s_waitcnt vmcnt(11)
M16 a[64:67],v[32:35],a[240:243],a[64:67]
ds_write_b128 v200, a[40:43] offset:2048
M16 a[68:71],v[36:39],a[240:243],a[68:71]
ds_write_b128 v200, a[44:47] offset:3072
M16 a[72:75],v[40:43],a[240:243],a[72:75]
ds_write_b128 v200, a[48:51] offset:4096
M16 a[76:79],v[44:47],a[240:243],a[76:79]
ds_write_b128 v200, a[52:55] offset:5120
s_waitcnt vmcnt(10)
M16 a[80:83],v[32:35],a[244:247],a[80:83]
ds_write_b128 v200, a[56:59] offset:6144
M16 a[84:87],v[36:39],a[244:247],a[84:87]
ds_write_b128 v200, a[60:63] offset:7168
M16 a[88:91],v[40:43],a[244:247],a[88:91]
ds_write_b128 v201, a[64:67] offset:0
M16 a[92:95],v[44:47],a[244:247],a[92:95]
ds_write_b128 v201, a[68:71] offset:1024
s_waitcnt vmcnt(9)
M16 a[96:99],v[32:35],a[248:251],a[96:99]
ds_write_b128 v201, a[72:75] offset:2048
M16 a[100:103],v[36:39],a[248:251],a[100:103]
ds_write_b128 v201, a[76:79] offset:3072
M16 a[104:107],v[40:43],a[248:251],a[104:107]
ds_write_b128 v201, a[80:83] offset:4096
M16 a[108:111],v[44:47],a[248:251],a[108:111]
ds_write_b128 v201, a[84:87] offset:5120
s_waitcnt vmcnt(8)
M16 a[112:115],v[32:35],a[252:255],a[112:115]
ds_write_b128 v201, a[88:91] offset:6144
M16 a[116:119],v[36:39],a[252:255],a[116:119]
ds_write_b128 v201, a[92:95] offset:7168
M16 a[120:123],v[40:43],a[252:255],a[120:123]
ds_write_b128 v202, a[96:99] offset:0
M16 a[124:127],v[44:47],a[252:255],a[124:127]
ds_write_b128 v202, a[100:103] offset:1024
M16 a[0:3],v[32:35],a[224:227],a[0:3]
ds_write_b128 v202, a[104:107] offset:2048
M16 a[4:7],v[36:39],a[224:227],a[4:7]
ds_write_b128 v202, a[108:111] offset:3072
M16 a[8:11],v[40:43],a[224:227],a[8:11]
ds_write_b128 v202, a[112:115] offset:4096
M16 a[12:15],v[44:47],a[224:227],a[12:15]
ds_write_b128 v202, a[116:119] offset:5120
M16 a[16:19],v[32:35],a[228:231],a[16:19]
ds_write_b128 v202, a[120:123] offset:6144
M16 a[20:23],v[36:39],a[228:231],a[20:23]
ds_write_b128 v202, a[124:127] offset:7168
M16 a[24:27],v[40:43],a[228:231],a[24:27]
M16 a[28:31],v[44:47],a[228:231],a[28:31]
s_waitcnt lgkmcnt(0)
s_barrier
DR4 v[48:51],v199 offset:0
DR4 v[52:55],v199 offset:1024
DR4 v[56:59],v199 offset:2048
DR4 v[60:63],v199 offset:3072
DR4 v[64:67],v199 offset:4096
DR4 v[68:71],v199 offset:5120
DR4 v[72:75],v199 offset:6144
DR4 v[76:79],v199 offset:7168
DR4 v[80:83],v199 offset:8192
DR4 v[84:87],v199 offset:9216
DR4 v[88:91],v199 offset:10240
DR4 v[92:95],v199 offset:11264
DR4 v[96:99],v199 offset:12288
DR4 v[100:103],v199 offset:13312
DR4 v[104:107],v199 offset:14336
DR4 v[108:111],v199 offset:15360
DR4 v[112:115],v199 offset:16384
DR4 v[116:119],v199 offset:17408
DR4 v[120:123],v199 offset:18432
DR4 v[124:127],v199 offset:19456
DR4 v[128:131],v199 offset:20480
DR4 v[132:135],v199 offset:21504
DR4 v[136:139],v199 offset:22528
DR4 v[140:143],v199 offset:23552
ARD v208,a0
ARD v209,a1
ARD v210,a2
ARD v211,a3
ARD v212,a4
ARD v213,a5
ARD v214,a6
ARD v215,a7
ARD v216,a8
ARD v217,a9
ARD v218,a10
ARD v219,a11
ARD v220,a12
ARD v221,a13
ARD v222,a14
ARD v223,a15
ARD v224,a16
ARD v225,a17
ARD v226,a18
ARD v227,a19
ARD v228,a20
ARD v229,a21
ARD v230,a22
ARD v231,a23
ARD v232,a24
ARD v233,a25
ARD v234,a26
ARD v235,a27
ARD v236,a28
ARD v237,a29
ARD v238,a30
ARD v239,a31
s_waitcnt lgkmcnt(15)
v_pk_add_f32 v[208:209], v[208:209], v[48:49]
v_pk_add_f32 v[210:211], v[210:211], v[50:51]
s_waitcnt lgkmcnt(15)
v_pk_add_f32 v[212:213], v[212:213], v[52:53]
v_pk_add_f32 v[214:215], v[214:215], v[54:55]
s_waitcnt lgkmcnt(15)
v_pk_add_f32 v[216:217], v[216:217], v[56:57]
v_pk_add_f32 v[218:219], v[218:219], v[58:59]
s_waitcnt lgkmcnt(15)
v_pk_add_f32 v[220:221], v[220:221], v[60:61]
v_pk_add_f32 v[222:223], v[222:223], v[62:63]
s_waitcnt lgkmcnt(15)
v_pk_add_f32 v[224:225], v[224:225], v[64:65]
v_pk_add_f32 v[226:227], v[226:227], v[66:67]
s_waitcnt lgkmcnt(15)
v_pk_add_f32 v[228:229], v[228:229], v[68:69]
v_pk_add_f32 v[230:231], v[230:231], v[70:71]
s_waitcnt lgkmcnt(15)
v_pk_add_f32 v[232:233], v[232:233], v[72:73]
v_pk_add_f32 v[234:235], v[234:235], v[74:75]
s_waitcnt lgkmcnt(15)
v_pk_add_f32 v[236:237], v[236:237], v[76:77]
v_pk_add_f32 v[238:239], v[238:239], v[78:79]
s_waitcnt lgkmcnt(15)
v_pk_add_f32 v[208:209], v[208:209], v[80:81]
v_pk_add_f32 v[210:211], v[210:211], v[82:83]
s_waitcnt lgkmcnt(14)
v_pk_add_f32 v[212:213], v[212:213], v[84:85]
v_pk_add_f32 v[214:215], v[214:215], v[86:87]
s_waitcnt lgkmcnt(13)
v_pk_add_f32 v[216:217], v[216:217], v[88:89]
v_pk_add_f32 v[218:219], v[218:219], v[90:91]
s_waitcnt lgkmcnt(12)
v_pk_add_f32 v[220:221], v[220:221], v[92:93]
v_pk_add_f32 v[222:223], v[222:223], v[94:95]
s_waitcnt lgkmcnt(11)
v_pk_add_f32 v[224:225], v[224:225], v[96:97]
v_pk_add_f32 v[226:227], v[226:227], v[98:99]
s_waitcnt lgkmcnt(10)
v_pk_add_f32 v[228:229], v[228:229], v[100:101]
v_pk_add_f32 v[230:231], v[230:231], v[102:103]
s_waitcnt lgkmcnt(9)
v_pk_add_f32 v[232:233], v[232:233], v[104:105]
v_pk_add_f32 v[234:235], v[234:235], v[106:107]
s_waitcnt lgkmcnt(8)
v_pk_add_f32 v[236:237], v[236:237], v[108:109]
v_pk_add_f32 v[238:239], v[238:239], v[110:111]
s_waitcnt lgkmcnt(7)
v_pk_add_f32 v[208:209], v[208:209], v[112:113]
v_pk_add_f32 v[210:211], v[210:211], v[114:115]
s_waitcnt lgkmcnt(6)
v_pk_add_f32 v[212:213], v[212:213], v[116:117]
v_pk_add_f32 v[214:215], v[214:215], v[118:119]
s_waitcnt lgkmcnt(5)
v_pk_add_f32 v[216:217], v[216:217], v[120:121]
v_pk_add_f32 v[218:219], v[218:219], v[122:123]
s_waitcnt lgkmcnt(4)
v_pk_add_f32 v[220:221], v[220:221], v[124:125]
v_pk_add_f32 v[222:223], v[222:223], v[126:127]
s_waitcnt lgkmcnt(3)
v_pk_add_f32 v[224:225], v[224:225], v[128:129]
v_pk_add_f32 v[226:227], v[226:227], v[130:131]
s_waitcnt lgkmcnt(2)
v_pk_add_f32 v[228:229], v[228:229], v[132:133]
v_pk_add_f32 v[230:231], v[230:231], v[134:135]
s_waitcnt lgkmcnt(1)
v_pk_add_f32 v[232:233], v[232:233], v[136:137]
v_pk_add_f32 v[234:235], v[234:235], v[138:139]
s_waitcnt lgkmcnt(0)
v_pk_add_f32 v[236:237], v[236:237], v[140:141]
v_pk_add_f32 v[238:239], v[238:239], v[142:143]
s_waitcnt vmcnt(7)
v_lshlrev_b32 v48, 16, v144
v_and_b32 v49, 0xffff0000, v144
v_lshlrev_b32 v50, 16, v145
v_and_b32 v51, 0xffff0000, v145
v_lshlrev_b32 v52, 16, v146
v_and_b32 v53, 0xffff0000, v146
v_lshlrev_b32 v54, 16, v147
v_and_b32 v55, 0xffff0000, v147
s_waitcnt vmcnt(3)
v_fma_f32 v208, v208, v160, v48
v_fma_f32 v209, v209, v161, v49
v_fma_f32 v210, v210, v162, v50
v_fma_f32 v211, v211, v163, v51
s_waitcnt vmcnt(2)
v_fma_f32 v212, v212, v164, v52
v_fma_f32 v213, v213, v165, v53
v_fma_f32 v214, v214, v166, v54
v_fma_f32 v215, v215, v167, v55
CVT v56,v208,v209
CVT v57,v210,v211
CVT v58,v212,v213
CVT v59,v214,v215
buffer_store_dwordx4 v[56:59], v194, s[20:23], s63 offen offset:0 sc1
v_lshlrev_b32 v64, 16, v148
v_and_b32 v65, 0xffff0000, v148
v_lshlrev_b32 v66, 16, v149
v_and_b32 v67, 0xffff0000, v149
v_lshlrev_b32 v68, 16, v150
v_and_b32 v69, 0xffff0000, v150
v_lshlrev_b32 v70, 16, v151
v_and_b32 v71, 0xffff0000, v151
s_waitcnt vmcnt(2)
v_fma_f32 v216, v216, v168, v64
v_fma_f32 v217, v217, v169, v65
v_fma_f32 v218, v218, v170, v66
v_fma_f32 v219, v219, v171, v67
s_waitcnt vmcnt(1)
v_fma_f32 v220, v220, v172, v68
v_fma_f32 v221, v221, v173, v69
v_fma_f32 v222, v222, v174, v70
v_fma_f32 v223, v223, v175, v71
CVT v72,v216,v217
CVT v73,v218,v219
CVT v74,v220,v221
CVT v75,v222,v223
buffer_store_dwordx4 v[72:75], v194, s[20:23], s63 offen offset:64 sc1
v_lshlrev_b32 v80, 16, v152
v_and_b32 v81, 0xffff0000, v152
v_lshlrev_b32 v82, 16, v153
v_and_b32 v83, 0xffff0000, v153
v_lshlrev_b32 v84, 16, v154
v_and_b32 v85, 0xffff0000, v154
v_lshlrev_b32 v86, 16, v155
v_and_b32 v87, 0xffff0000, v155
v_fma_f32 v224, v224, v160, v80
v_fma_f32 v225, v225, v161, v81
v_fma_f32 v226, v226, v162, v82
v_fma_f32 v227, v227, v163, v83
v_fma_f32 v228, v228, v164, v84
v_fma_f32 v229, v229, v165, v85
v_fma_f32 v230, v230, v166, v86
v_fma_f32 v231, v231, v167, v87
CVT v88,v224,v225
CVT v89,v226,v227
CVT v90,v228,v229
CVT v91,v230,v231
buffer_store_dwordx4 v[88:91], v195, s[20:23], s63 offen offset:0 sc1
v_lshlrev_b32 v96, 16, v156
v_and_b32 v97, 0xffff0000, v156
v_lshlrev_b32 v98, 16, v157
v_and_b32 v99, 0xffff0000, v157
v_lshlrev_b32 v100, 16, v158
v_and_b32 v101, 0xffff0000, v158
v_lshlrev_b32 v102, 16, v159
v_and_b32 v103, 0xffff0000, v159
v_fma_f32 v232, v232, v168, v96
v_fma_f32 v233, v233, v169, v97
v_fma_f32 v234, v234, v170, v98
v_fma_f32 v235, v235, v171, v99
v_fma_f32 v236, v236, v172, v100
v_fma_f32 v237, v237, v173, v101
v_fma_f32 v238, v238, v174, v102
v_fma_f32 v239, v239, v175, v103
CVT v104,v232,v233
CVT v105,v234,v235
CVT v106,v236,v237
CVT v107,v238,v239
buffer_store_dwordx4 v[104:107], v195, s[20:23], s63 offen offset:64 sc1
L_ffn2_kernel_end:
s_endpgm
.section .rodata,"a"
.p2align 6
.amdhsa_kernel kvproj_kernel
  .amdhsa_next_free_vgpr 512
  .amdhsa_next_free_sgpr 96
  .amdhsa_accum_offset 256
  .amdhsa_group_segment_fixed_size 0
  .amdhsa_kernarg_size 112
  .amdhsa_user_sgpr_count 2
  .amdhsa_user_sgpr_kernarg_segment_ptr 1
  .amdhsa_system_sgpr_workgroup_id_x 1
.end_amdhsa_kernel
.p2align 6
.amdhsa_kernel attn_kernel
  .amdhsa_next_free_vgpr 512
  .amdhsa_next_free_sgpr 96
  .amdhsa_accum_offset 256
  .amdhsa_group_segment_fixed_size 0
  .amdhsa_kernarg_size 112
  .amdhsa_user_sgpr_count 2
  .amdhsa_user_sgpr_kernarg_segment_ptr 1
  .amdhsa_system_sgpr_workgroup_id_x 1
.end_amdhsa_kernel
.p2align 6
.amdhsa_kernel oproj_kernel
  .amdhsa_next_free_vgpr 512
  .amdhsa_next_free_sgpr 96
  .amdhsa_accum_offset 256
  .amdhsa_group_segment_fixed_size 0
  .amdhsa_kernarg_size 112
  .amdhsa_user_sgpr_count 2
  .amdhsa_user_sgpr_kernarg_segment_ptr 1
  .amdhsa_system_sgpr_workgroup_id_x 1
.end_amdhsa_kernel
.p2align 6
.amdhsa_kernel ffn1_kernel
  .amdhsa_next_free_vgpr 320
  .amdhsa_next_free_sgpr 96
  .amdhsa_accum_offset 256
  .amdhsa_group_segment_fixed_size 0
  .amdhsa_kernarg_size 112
  .amdhsa_user_sgpr_count 2
  .amdhsa_user_sgpr_kernarg_segment_ptr 1
  .amdhsa_system_sgpr_workgroup_id_x 1
.end_amdhsa_kernel
.p2align 6
.amdhsa_kernel ffn2_kernel
  .amdhsa_next_free_vgpr 512
  .amdhsa_next_free_sgpr 96
  .amdhsa_accum_offset 256
  .amdhsa_group_segment_fixed_size 0
  .amdhsa_kernarg_size 112
  .amdhsa_user_sgpr_count 2
  .amdhsa_user_sgpr_kernarg_segment_ptr 1
  .amdhsa_system_sgpr_workgroup_id_x 1
.end_amdhsa_kernel
```
